```python
import torch

def _softmax(x, axis=-1):
    return torch.softmax(x, dim=axis)
def _gelu(x):
    return torch.nn.functional.gelu(x, approximate="tanh")
def _silu(x):
    return torch.nn.functional.silu(x)
def _sigmoid(x):
    return torch.sigmoid(x)
def _layernorm(x, axis=-1, eps=1e-5):
    m = x.mean(dim=axis, keepdim=True)
    v = x.var(dim=axis, keepdim=True, unbiased=False)
    return (x - m) / torch.sqrt(v + eps)
def _scatter_add(tgt, idx, src, axis=0):
    return tgt.clone().index_add_(axis, idx, src)
def _segment_sum(src, seg, n):
    out = torch.zeros((n,) + src.shape[1:], dtype=src.dtype)
    return out.index_add_(0, seg, src)
def _pad(x, pw):
    flat = tuple(v for pair in reversed(pw) for v in pair)
    return torch.nn.functional.pad(x, flat)

kernel_name = 'concat_heads__gqa_block_cached__mha_block_cached__near_ridge'

def setup_inputs():

    _w = (lambda a: (lambda t: t.to(torch.bfloat16) if t.is_floating_point() else t)(torch.as_tensor(a)))
    def _A_setup():
        B, Sq, D = 8, 48, 1024
        Hq, Hkv, Sk, Dh = 32, 4, 2048, 128
        assert Hq % Hkv == 0, (Hq, Hkv)
        return {
            "x": _w((lambda *s: torch.randn(*s, dtype=torch.bfloat16) * 0.8)(B, Sq, D)),
            "k_cache": _w((lambda *s: torch.randn(*s, dtype=torch.bfloat16) * 0.8)(B, Hkv, Sk, Dh)),
            "v_cache": _w((lambda *s: torch.randn(*s, dtype=torch.bfloat16) * 0.05)(B, Hkv, Sk, Dh)),
            "wq": _w((lambda *s: torch.randn(*s, dtype=torch.bfloat16) * 0.8)(D, Hq * Dh) * (D ** -0.5)),
            "wo": _w((lambda *s: torch.randn(*s, dtype=torch.bfloat16) * 0.05)(Hq * Dh, D) * ((Hq * Dh) ** -0.5)),
        }
    _A_in = _A_setup()

    def _B_setup():
        B, Sq, D = 8, 48, 1024
        H, Sk, Dh = 32, 2048, 128
        return {
            "x": _w((lambda *s: torch.randn(*s, dtype=torch.bfloat16) * 0.8)(B, Sq, D)),
            "k_cache": _w((lambda *s: torch.randn(*s, dtype=torch.bfloat16) * 0.8)(B, H, Sk, Dh)),
            "v_cache": _w((lambda *s: torch.randn(*s, dtype=torch.bfloat16) * 0.05)(B, H, Sk, Dh)),
            "wq": _w((lambda *s: torch.randn(*s, dtype=torch.bfloat16) * 0.8)(D, H * Dh) * (D ** -0.5)),
            "wo": _w((lambda *s: torch.randn(*s, dtype=torch.bfloat16) * 0.05)(H * Dh, D) * ((H * Dh) ** -0.5)),
        }
    _B_in = _B_setup()

    return {
        "A_x": _A_in["x"],
        "A_k_cache": _A_in["k_cache"],
        "A_v_cache": _A_in["v_cache"],
        "A_wq": _A_in["wq"],
        "A_wo": _A_in["wo"],
        "B_x": _B_in["x"],
        "B_k_cache": _B_in["k_cache"],
        "B_v_cache": _B_in["v_cache"],
        "B_wq": _B_in["wq"],
        "B_wo": _B_in["wo"],
    }

def reference(A_x, A_k_cache, A_v_cache, A_wq, A_wo, B_x, B_k_cache, B_v_cache, B_wq, B_wo):
    def _A_ref(x, k_cache, v_cache, wq, wo):
        B, Sq, D = x.shape
        Hq, Dh = 32, 128
        Hkv = k_cache.shape[1]
        rep = Hq // Hkv
        q = (lambda x, *d: x.permute(*d))((x @ wq).reshape(B, Sq, Hq, Dh), 0, 2, 1, 3)
        k = (lambda x, n, axis: torch.repeat_interleave(x, n, dim=axis))(k_cache, rep, axis=1)
        v = (lambda x, n, axis: torch.repeat_interleave(x, n, dim=axis))(v_cache, rep, axis=1)
        scores = torch.einsum("bhqd,bhkd->bhqk", q, k) * (Dh ** -0.5)
        p = _softmax(scores, axis=-1)
        o = torch.einsum("bhqk,bhkd->bhqd", p, v)
        return (lambda x, *d: x.permute(*d))(o, 0, 2, 1, 3).reshape(B, Sq, Hq * Dh) @ wo

    def _B_ref(x, k_cache, v_cache, wq, wo):
        B, Sq, D = x.shape
        H, Dh = 32, 128
        q = (lambda x, *d: x.permute(*d))((x @ wq).reshape(B, Sq, H, Dh), 0, 2, 1, 3)
        scores = torch.einsum("bhqd,bhkd->bhqk", q, k_cache) * (Dh ** -0.5)
        p = _softmax(scores, axis=-1)
        o = torch.einsum("bhqk,bhkd->bhqd", p, v_cache)
        return (lambda x, *d: x.permute(*d))(o, 0, 2, 1, 3).reshape(B, Sq, H * Dh) @ wo

    a = _A_ref(A_x, A_k_cache, A_v_cache, A_wq, A_wo)
    b = _B_ref(B_x, B_k_cache, B_v_cache, B_wq, B_wo)
    return torch.concatenate([a, b], axis=-1)
```

```asm
; @launch grid=(256,1,1) block=(256,1,1) lds=163840
.amdgcn_target "amdgcn-amd-amdhsa--gfx950"
.text
.globl concat_heads__gqa_block_cached__mha_block_cached__near_ridge_kernel
.p2align 8
.type concat_heads__gqa_block_cached__mha_block_cached__near_ridge_kernel,@function
concat_heads__gqa_block_cached__mha_block_cached__near_ridge_kernel:
s_cmp_ge_u32 s2, 256
s_cbranch_scc1 L_end
s_load_dwordx16 s[4:19], s[0:1], 0
s_load_dwordx8 s[20:27], s[0:1], 64
s_load_dwordx2 s[28:29], s[0:1], 96
v_lshrrev_b32 v240, 6, v0
v_and_b32 v1, 63, v0
v_readfirstlane_b32 s56, v240
s_mov_b32 s31, 0x200000
s_and_b32 s58, s2, 7
s_lshr_b32 s59, s2, 3
s_mul_i32 s57, s56, 40960
s_lshl2_add_u32 s64, s59, s56
s_sub_u32 s64, s64, 64
s_cmp_ge_u32 s64, 13
s_cbranch_scc1 cp_1
s_getpc_b64 s[66:67]
cppc_2:
s_add_u32 s66, s66, L_code0-cppc_2
s_addc_u32 s67, s67, 0
s_lshl_b32 s64, s64, 13
v_lshl_add_u32 v249, v1, 7, s64
v_min_u32 v249, L_codeend-L_code0-4, v249
global_load_dword v249, v249, s[66:67]
cp_1:
L_code0:
v_lshrrev_b32 v240, 4, v1
v_and_b32 v241, 15, v1
s_mul_i32 s64, s56, 12
v_add3_u32 v243, v240, s64, 0
v_xor_b32 v242, v243, v241
v_and_b32 v242, 15, v242
v_lshlrev_b32 v242, 4, v242
v_lshl_add_u32 v224, v243, 11, v242
v_add3_u32 v243, v240, s64, 4
v_xor_b32 v242, v243, v241
v_and_b32 v242, 15, v242
v_lshlrev_b32 v242, 4, v242
v_lshl_add_u32 v225, v243, 11, v242
v_subrev_u32 v225, 1024, v225
v_add3_u32 v243, v240, s64, 8
v_xor_b32 v242, v243, v241
v_and_b32 v242, 15, v242
v_lshlrev_b32 v242, 4, v242
v_lshl_add_u32 v226, v243, 11, v242
v_subrev_u32 v226, 2048, v226
s_lshl_b32 s64, s56, 18
v_or_b32 v242, 0, v240
v_lshlrev_b32 v242, 1, v242
v_xor_b32 v242, v242, v241
v_lshl_add_u32 v242, v242, 4, s64
v_lshl_add_u32 v242, v240, 13, v242
v_add_u32 v228, 0, v242
v_or_b32 v242, 0, v240
v_lshlrev_b32 v242, 1, v242
v_xor_b32 v242, v242, v241
v_lshl_add_u32 v242, v242, 4, s64
v_lshl_add_u32 v242, v240, 13, v242
v_add_u32 v229, 31744, v242
v_or_b32 v242, 4, v240
v_lshlrev_b32 v242, 1, v242
v_xor_b32 v242, v242, v241
v_lshl_add_u32 v242, v242, 4, s64
v_lshl_add_u32 v242, v240, 13, v242
v_add_u32 v230, 63488, v242
v_or_b32 v242, 4, v240
v_lshlrev_b32 v242, 1, v242
v_xor_b32 v242, v242, v241
v_lshl_add_u32 v242, v242, 4, s64
v_lshl_add_u32 v242, v240, 13, v242
v_add_u32 v231, 95232, v242
s_bfe_u32 s64, s59, 0x10003
s_lshr_b32 s65, s59, 4
s_lshl1_add_u32 s64, s64, s65
s_lshl2_add_u32 s61, s58, s64
s_and_b32 s60, s59, 7
s_mul_i32 s65, s65, 2
s_xor_b32 s60, s60, s65
s_lshl1_add_u32 s62, s64, s60
s_mul_i32 s66, s60, 98304
s_lshl_b32 s67, s61, 8
s_waitcnt lgkmcnt(0)
s_add_u32 s32, s14, s66
s_addc_u32 s33, s15, 0
s_mov_b32 s34, 98304
s_mov_b32 s35, 0x20000
s_add_u32 s36, s20, s67
s_addc_u32 s37, s21, 0
s_sub_u32 s38, 8388608, s67
s_mov_b32 s39, 0x20000
s_add_u32 s98, s28, 12582912
s_addc_u32 s99, s29, 0
s_lshl2_add_u32 s64, s2, s56
s_cmp_lg_u32 s64, 1023
s_cbranch_scc1 noinit_3
v_lshlrev_b32 v240, 7, v1
v_mov_b32 v241, 0
v_mov_b32 v244, 0
v_mov_b32 v245, 0
v_mov_b32 v246, 0
v_mov_b32 v247, 0
global_store_dwordx4 v240, v[244:247], s[98:99] sc1
v_add_u32 v240, 8192, v240
global_store_dwordx4 v240, v[244:247], s[98:99] sc1
v_add_u32 v240, 8192, v240
global_store_dwordx4 v240, v[244:247], s[98:99] sc1
v_add_u32 v240, 8192, v240
global_store_dwordx4 v240, v[244:247], s[98:99] sc1
v_add_u32 v240, 8192, v240
global_store_dwordx4 v240, v[244:247], s[98:99] sc1
v_add_u32 v240, 8192, v240
global_store_dwordx4 v240, v[244:247], s[98:99] sc1
v_add_u32 v240, 8192, v240
global_store_dwordx4 v240, v[244:247], s[98:99] sc1
v_add_u32 v240, 8192, v240
global_store_dwordx4 v240, v[244:247], s[98:99] sc1
v_add_u32 v240, 8192, v240
global_store_dwordx4 v240, v[244:247], s[98:99] sc1
v_add_u32 v240, 8192, v240
global_store_dwordx4 v240, v[244:247], s[98:99] sc1
v_add_u32 v240, 8192, v240
global_store_dwordx4 v240, v[244:247], s[98:99] sc1
v_add_u32 v240, 8192, v240
global_store_dwordx4 v240, v[244:247], s[98:99] sc1
v_add_u32 v240, 8192, v240
s_waitcnt vmcnt(0)
v_mov_b32 v240, 1
s_mov_b64 exec, 1
global_store_dword v241, v240, s[26:27] sc1
s_mov_b64 exec, -1
noinit_3:
s_add_u32 m0, s57, 32768
s_add_u32 s65, s62, 0
s_and_b32 s65, s65, 7
s_lshl_b32 s65, s65, 8
buffer_load_dwordx4 v224, s[32:35], s65 offen offset:0 lds
buffer_load_dwordx4 v225, s[32:35], s65 offen offset:1024 lds
buffer_load_dwordx4 v226, s[32:35], s65 offen offset:2048 lds
s_add_u32 s66, s62, 0
s_and_b32 s66, s66, 7
s_lshl_b32 s66, s66, 20
s_add_u32 m0, s57, 0
s_nop 0
buffer_load_dwordx4 v228, s[36:39], s66 offen offset:0 lds
buffer_load_dwordx4 v229, s[36:39], s66 offen offset:1024 lds
buffer_load_dwordx4 v230, s[36:39], s66 offen offset:2048 lds
buffer_load_dwordx4 v231, s[36:39], s66 offen offset:3072 lds
v_lshrrev_b32 v240, 4, v1
v_bfe_u32 v241, v1, 2, 2
v_and_b32 v242, 1, v240
v_lshl_or_b32 v242, v242, 2, v241
v_lshl_add_u32 v243, v240, 3, v241
v_lshlrev_b32 v243, 8, v243
v_and_b32 v244, 3, v1
v_lshl_add_u32 v243, v244, 3, v243
s_lshl1_add_u32 s65, s56, 0
v_xor_b32 v244, s65, v242
v_lshl_add_u32 v232, v244, 5, v243
s_lshl1_add_u32 s65, s56, 1
v_xor_b32 v244, s65, v242
v_lshl_add_u32 v233, v244, 5, v243
v_add_u32 v234, 40960, v232
v_add_u32 v235, 40960, v233
v_add_u32 v236, 81920, v232
v_add_u32 v237, 81920, v233
v_add_u32 v238, 122880, v232
v_add_u32 v239, 122880, v233
v_and_b32 v241, 15, v1
v_xor_b32 v242, v240, v241
v_lshlrev_b32 v242, 4, v242
v_add_u32 v243, 0, v241
v_mul_u32_u24 v244, 43, v243
v_lshrrev_b32 v244, 9, v244
v_mul_u32_u24 v244, 37888, v244
v_lshl_add_u32 v243, v243, 8, v244
v_add_u32 v168, v243, v242
v_xor_b32 v171, 64, v168
v_xor_b32 v174, 128, v168
v_xor_b32 v177, 192, v168
v_add_u32 v243, 16, v241
v_mul_u32_u24 v244, 43, v243
v_lshrrev_b32 v244, 9, v244
v_mul_u32_u24 v244, 37888, v244
v_lshl_add_u32 v243, v243, 8, v244
v_add_u32 v169, v243, v242
v_xor_b32 v172, 64, v169
v_xor_b32 v175, 128, v169
v_xor_b32 v178, 192, v169
v_add_u32 v243, 32, v241
v_mul_u32_u24 v244, 43, v243
v_lshrrev_b32 v244, 9, v244
v_mul_u32_u24 v244, 37888, v244
v_lshl_add_u32 v243, v243, 8, v244
v_add_u32 v170, v243, v242
v_xor_b32 v173, 64, v170
v_xor_b32 v176, 128, v170
v_xor_b32 v179, 192, v170
v_lshlrev_b32 v213, 4, v1
v_lshlrev_b32 v244, 3, v1
v_add_u32 v200, s57, v213
v_add_u32 v209, s57, v244
s_sub_u32 s64, s56, 1
s_and_b32 s64, s64, 3
s_mul_i32 s64, s64, 40960
v_add_u32 v201, s64, v213
v_add_u32 v210, s64, v244
s_sub_u32 s64, s56, 2
s_and_b32 s64, s64, 3
s_mul_i32 s64, s64, 40960
v_add_u32 v202, s64, v213
v_add_u32 v211, s64, v244
s_sub_u32 s64, s56, 3
s_and_b32 s64, s64, 3
s_mul_i32 s64, s64, 40960
v_add_u32 v203, s64, v213
v_add_u32 v212, s64, v244
v_add_u32 v207, 32768, v213
v_add_u32 v208, 114688, v213
v_lshrrev_b32 v240, 4, v1
v_and_b32 v241, 15, v1
s_mul_i32 s64, s56, 1024
v_lshlrev_b32 v243, 8, v240
v_add_u32 v243, s64, v243
v_add_u32 v242, 0, v240
v_xor_b32 v242, v242, v241
v_lshl_add_u32 v242, v242, 4, v243
v_add_u32 v2, 0, v242
v_add_u32 v242, 0, v240
v_lshlrev_b32 v242, 1, v242
v_xor_b32 v242, v242, v241
v_lshl_add_u32 v242, v242, 4, v243
v_add_u32 v6, 0, v242
v_add_u32 v242, 4, v240
v_xor_b32 v242, v242, v241
v_lshl_add_u32 v242, v242, 4, v243
v_add_u32 v3, 3072, v242
v_add_u32 v242, 4, v240
v_lshlrev_b32 v242, 1, v242
v_xor_b32 v242, v242, v241
v_lshl_add_u32 v242, v242, 4, v243
v_add_u32 v7, 3072, v242
v_add_u32 v242, 8, v240
v_xor_b32 v242, v242, v241
v_lshl_add_u32 v242, v242, 4, v243
v_add_u32 v4, 6144, v242
v_add_u32 v242, 0, v240
v_lshlrev_b32 v242, 1, v242
v_xor_b32 v242, v242, v241
v_lshl_add_u32 v242, v242, 4, v243
v_add_u32 v8, 6144, v242
v_add_u32 v242, 12, v240
v_xor_b32 v242, v242, v241
v_lshl_add_u32 v242, v242, 4, v243
v_add_u32 v5, 9216, v242
v_add_u32 v242, 4, v240
v_lshlrev_b32 v242, 1, v242
v_xor_b32 v242, v242, v241
v_lshl_add_u32 v242, v242, 4, v243
v_add_u32 v9, 9216, v242
v_lshlrev_b32 v242, 8, v241
v_add_u32 v242, s57, v242
v_xor_b32 v244, v240, v241
v_xor_b32 v10, 0, v244
v_lshl_add_u32 v10, v10, 4, v242
v_xor_b32 v11, 4, v244
v_lshl_add_u32 v11, v11, 4, v242
v_xor_b32 v12, 8, v244
v_lshl_add_u32 v12, v12, 4, v242
v_xor_b32 v13, 12, v244
v_lshl_add_u32 v13, v13, 4, v242
v_lshrrev_b32 v241, 2, v1
v_lshlrev_b32 v242, 8, v241
v_and_b32 v244, 3, v1
v_lshl_add_u32 v242, v244, 3, v242
v_add_u32 v242, s57, v242
v_and_b32 v241, 7, v241
s_lshl1_add_u32 s65, s56, 0
s_and_b32 s65, s65, 7
v_xor_b32 v244, s65, v241
v_lshl_add_u32 v14, v244, 5, v242
s_lshl1_add_u32 s65, s56, 1
s_and_b32 s65, s65, 7
v_xor_b32 v244, s65, v241
v_lshl_add_u32 v15, v244, 5, v242
s_lshl1_add_u32 s65, s56, 2
s_and_b32 s65, s65, 7
v_xor_b32 v244, s65, v241
v_lshl_add_u32 v16, v244, 5, v242
s_lshl1_add_u32 s65, s56, 3
s_and_b32 s65, s65, 7
v_xor_b32 v244, s65, v241
v_lshl_add_u32 v17, v244, 5, v242
s_lshl1_add_u32 s65, s56, 4
s_and_b32 s65, s65, 7
v_xor_b32 v244, s65, v241
v_lshl_add_u32 v18, v244, 5, v242
s_lshl1_add_u32 s65, s56, 5
s_and_b32 s65, s65, 7
v_xor_b32 v244, s65, v241
v_lshl_add_u32 v19, v244, 5, v242
s_lshl1_add_u32 s65, s56, 6
s_and_b32 s65, s65, 7
v_xor_b32 v244, s65, v241
v_lshl_add_u32 v20, v244, 5, v242
s_lshl1_add_u32 s65, s56, 7
s_and_b32 s65, s65, 7
v_xor_b32 v244, s65, v241
v_lshl_add_u32 v21, v244, 5, v242
s_add_u32 m0, s57, 4096
s_add_u32 s67, s66, 131072
buffer_load_dwordx4 v228, s[36:39], s67 offen offset:0 lds
buffer_load_dwordx4 v229, s[36:39], s67 offen offset:1024 lds
buffer_load_dwordx4 v230, s[36:39], s67 offen offset:2048 lds
buffer_load_dwordx4 v231, s[36:39], s67 offen offset:3072 lds
s_add_u32 m0, s57, 35840
s_add_u32 s65, s62, 1
s_and_b32 s65, s65, 7
s_lshl_b32 s65, s65, 8
buffer_load_dwordx4 v224, s[32:35], s65 offen offset:0 lds
buffer_load_dwordx4 v225, s[32:35], s65 offen offset:1024 lds
buffer_load_dwordx4 v226, s[32:35], s65 offen offset:2048 lds
s_add_u32 s66, s62, 1
s_and_b32 s66, s66, 7
s_lshl_b32 s66, s66, 20
s_add_u32 m0, s57, 8192
s_nop 0
buffer_load_dwordx4 v228, s[36:39], s66 offen offset:0 lds
buffer_load_dwordx4 v229, s[36:39], s66 offen offset:1024 lds
buffer_load_dwordx4 v230, s[36:39], s66 offen offset:2048 lds
buffer_load_dwordx4 v231, s[36:39], s66 offen offset:3072 lds
s_add_u32 m0, s57, 12288
s_add_u32 s67, s66, 131072
buffer_load_dwordx4 v228, s[36:39], s67 offen offset:0 lds
buffer_load_dwordx4 v229, s[36:39], s67 offen offset:1024 lds
buffer_load_dwordx4 v230, s[36:39], s67 offen offset:2048 lds
buffer_load_dwordx4 v231, s[36:39], s67 offen offset:3072 lds
s_cmp_lt_u32 s59, 16
s_cbranch_scc1 L_nopf
s_lshl_b32 s64, s60, 5
s_add_u32 s64, s64, s61
s_xor_b32 s64, s64, 65
s_lshl_b32 s64, s64, 19
s_lshl_b32 s65, s56, 13
s_add_u32 s64, s64, s65
v_lshl_add_u32 v244, v1, 7, s64
global_load_dword v245, v244, s[16:17]
global_load_dword v245, v244, s[18:19]
L_nopf:
s_add_u32 s66, s62, 2
s_and_b32 s66, s66, 7
s_lshl_b32 s66, s66, 20
s_add_u32 m0, s57, 16384
s_nop 0
buffer_load_dwordx4 v228, s[36:39], s66 offen offset:0 lds
buffer_load_dwordx4 v229, s[36:39], s66 offen offset:1024 lds
buffer_load_dwordx4 v230, s[36:39], s66 offen offset:2048 lds
buffer_load_dwordx4 v231, s[36:39], s66 offen offset:3072 lds
s_add_u32 m0, s57, 20480
s_add_u32 s67, s66, 131072
buffer_load_dwordx4 v228, s[36:39], s67 offen offset:0 lds
buffer_load_dwordx4 v229, s[36:39], s67 offen offset:1024 lds
buffer_load_dwordx4 v230, s[36:39], s67 offen offset:2048 lds
buffer_load_dwordx4 v231, s[36:39], s67 offen offset:3072 lds
s_cmp_ge_u32 s59, 16
s_cbranch_scc1 L_worker
s_mov_b32 s40, s16
s_mov_b32 s41, s17
s_mov_b32 s42, 134217728
s_mov_b32 s43, 0x20000
s_mov_b32 s44, s18
s_mov_b32 s45, s19
s_mov_b32 s46, 134217728
s_mov_b32 s47, 0x20000
s_lshl_b32 s65, s60, 5
s_add_u32 s65, s65, s61
s_lshl_b32 s74, s65, 19
s_xor_b32 s75, s74, 0x2080000
s_mov_b32 s3, 0
s_add_u32 s78, s75, 32768
s_waitcnt vmcnt(19)
s_barrier
ds_read_b64_tr_b16 v[80:81], v232 offset:0
ds_read_b64_tr_b16 v[82:83], v232 offset:1024
ds_read_b64_tr_b16 v[84:85], v233 offset:0
s_add_u32 s66, s62, 3
s_and_b32 s66, s66, 7
s_lshl_b32 s66, s66, 20
s_add_u32 m0, s57, 24576
s_nop 0
buffer_load_dwordx4 v228, s[36:39], s66 offen offset:0 lds
ds_read_b64_tr_b16 v[86:87], v233 offset:1024
ds_read_b128 v[32:35], v168 offset:32768
ds_read_b128 v[36:39], v169 offset:32768
ds_read_b128 v[40:43], v170 offset:32768
ds_read_b64_tr_b16 v[88:89], v234 offset:0
ds_read_b64_tr_b16 v[90:91], v234 offset:1024
ds_read_b64_tr_b16 v[92:93], v235 offset:0
buffer_load_dwordx4 v229, s[36:39], s66 offen offset:1024 lds
ds_read_b64_tr_b16 v[94:95], v235 offset:1024
ds_read_b128 v[44:47], v171 offset:32768
ds_read_b128 v[48:51], v172 offset:32768
ds_read_b128 v[52:55], v173 offset:32768
s_waitcnt lgkmcnt(7)
v_mfma_f32_16x16x32_bf16 v[96:99], v[80:83], v[32:35], 0
ds_read_b64_tr_b16 v[144:145], v236 offset:0
ds_read_b64_tr_b16 v[146:147], v236 offset:1024
buffer_load_dwordx4 v230, s[36:39], s66 offen offset:2048 lds
v_mfma_f32_16x16x32_bf16 v[100:103], v[84:87], v[32:35], 0
ds_read_b64_tr_b16 v[148:149], v237 offset:0
v_mfma_f32_16x16x32_bf16 v[104:107], v[80:83], v[36:39], 0
ds_read_b64_tr_b16 v[150:151], v237 offset:1024
v_mfma_f32_16x16x32_bf16 v[108:111], v[84:87], v[36:39], 0
ds_read_b128 v[56:59], v174 offset:32768
buffer_load_dwordx4 v231, s[36:39], s66 offen offset:3072 lds
v_mfma_f32_16x16x32_bf16 v[112:115], v[80:83], v[40:43], 0
ds_read_b128 v[60:63], v175 offset:32768
v_mfma_f32_16x16x32_bf16 v[116:119], v[84:87], v[40:43], 0
ds_read_b128 v[64:67], v176 offset:32768
s_waitcnt lgkmcnt(7)
v_mfma_f32_16x16x32_bf16 v[96:99], v[88:91], v[44:47], v[96:99]
ds_read_b64_tr_b16 v[152:153], v238 offset:0
ds_read_b64_tr_b16 v[154:155], v238 offset:1024
s_add_u32 m0, s57, 28672
s_add_u32 s67, s66, 131072
buffer_load_dwordx4 v228, s[36:39], s67 offen offset:0 lds
v_mfma_f32_16x16x32_bf16 v[100:103], v[92:95], v[44:47], v[100:103]
ds_read_b64_tr_b16 v[156:157], v239 offset:0
v_mfma_f32_16x16x32_bf16 v[104:107], v[88:91], v[48:51], v[104:107]
ds_read_b64_tr_b16 v[158:159], v239 offset:1024
v_mfma_f32_16x16x32_bf16 v[108:111], v[92:95], v[48:51], v[108:111]
ds_read_b128 v[68:71], v177 offset:32768
buffer_load_dwordx4 v229, s[36:39], s67 offen offset:1024 lds
v_mfma_f32_16x16x32_bf16 v[112:115], v[88:91], v[52:55], v[112:115]
ds_read_b128 v[72:75], v178 offset:32768
v_mfma_f32_16x16x32_bf16 v[116:119], v[92:95], v[52:55], v[116:119]
ds_read_b128 v[76:79], v179 offset:32768
s_waitcnt lgkmcnt(7)
v_mfma_f32_16x16x32_bf16 v[96:99], v[144:147], v[56:59], v[96:99]
buffer_load_dwordx4 v230, s[36:39], s67 offen offset:2048 lds
v_mfma_f32_16x16x32_bf16 v[100:103], v[148:151], v[56:59], v[100:103]
v_mfma_f32_16x16x32_bf16 v[104:107], v[144:147], v[60:63], v[104:107]
v_mfma_f32_16x16x32_bf16 v[108:111], v[148:151], v[60:63], v[108:111]
buffer_load_dwordx4 v231, s[36:39], s67 offen offset:3072 lds
v_mfma_f32_16x16x32_bf16 v[112:115], v[144:147], v[64:67], v[112:115]
v_mfma_f32_16x16x32_bf16 v[116:119], v[148:151], v[64:67], v[116:119]
s_waitcnt vmcnt(16)
s_waitcnt lgkmcnt(0)
s_barrier
v_mfma_f32_16x16x32_bf16 v[96:99], v[152:155], v[68:71], v[96:99]
ds_read_b64_tr_b16 v[80:81], v232 offset:8192
ds_read_b64_tr_b16 v[82:83], v232 offset:9216
ds_read_b64_tr_b16 v[84:85], v233 offset:8192
s_add_u32 m0, s57, 32768
s_add_u32 s65, s62, 2
s_and_b32 s65, s65, 7
s_lshl_b32 s65, s65, 8
buffer_load_dwordx4 v224, s[32:35], s65 offen offset:0 lds
v_mfma_f32_16x16x32_bf16 v[100:103], v[156:159], v[68:71], v[100:103]
ds_read_b64_tr_b16 v[86:87], v233 offset:9216
ds_read_b128 v[32:35], v168 offset:35840
v_mfma_f32_16x16x32_bf16 v[104:107], v[152:155], v[72:75], v[104:107]
ds_read_b128 v[36:39], v169 offset:35840
ds_read_b128 v[40:43], v170 offset:35840
v_mfma_f32_16x16x32_bf16 v[108:111], v[156:159], v[72:75], v[108:111]
ds_read_b64_tr_b16 v[88:89], v234 offset:8192
ds_read_b64_tr_b16 v[90:91], v234 offset:9216
ds_read_b64_tr_b16 v[92:93], v235 offset:8192
buffer_load_dwordx4 v225, s[32:35], s65 offen offset:1024 lds
v_mfma_f32_16x16x32_bf16 v[112:115], v[152:155], v[76:79], v[112:115]
ds_read_b64_tr_b16 v[94:95], v235 offset:9216
ds_read_b128 v[44:47], v171 offset:35840
v_mfma_f32_16x16x32_bf16 v[116:119], v[156:159], v[76:79], v[116:119]
ds_read_b128 v[48:51], v172 offset:35840
ds_read_b128 v[52:55], v173 offset:35840
buffer_load_dwordx4 v226, s[32:35], s65 offen offset:2048 lds
s_waitcnt lgkmcnt(7)
v_mfma_f32_16x16x32_bf16 v[96:99], v[80:83], v[32:35], v[96:99]
ds_read_b64_tr_b16 v[144:145], v236 offset:8192
ds_read_b64_tr_b16 v[146:147], v236 offset:9216
v_mfma_f32_16x16x32_bf16 v[100:103], v[84:87], v[32:35], v[100:103]
ds_read_b64_tr_b16 v[148:149], v237 offset:8192
s_add_u32 s66, s62, 4
s_and_b32 s66, s66, 7
s_lshl_b32 s66, s66, 20
s_add_u32 m0, s57, 0
s_nop 0
buffer_load_dwordx4 v228, s[36:39], s66 offen offset:0 lds
v_mfma_f32_16x16x32_bf16 v[104:107], v[80:83], v[36:39], v[104:107]
ds_read_b64_tr_b16 v[150:151], v237 offset:9216
v_mfma_f32_16x16x32_bf16 v[108:111], v[84:87], v[36:39], v[108:111]
ds_read_b128 v[56:59], v174 offset:35840
buffer_load_dwordx4 v229, s[36:39], s66 offen offset:1024 lds
v_mfma_f32_16x16x32_bf16 v[112:115], v[80:83], v[40:43], v[112:115]
ds_read_b128 v[60:63], v175 offset:35840
v_mfma_f32_16x16x32_bf16 v[116:119], v[84:87], v[40:43], v[116:119]
ds_read_b128 v[64:67], v176 offset:35840
buffer_load_dwordx4 v230, s[36:39], s66 offen offset:2048 lds
s_waitcnt lgkmcnt(7)
v_mfma_f32_16x16x32_bf16 v[96:99], v[88:91], v[44:47], v[96:99]
ds_read_b64_tr_b16 v[152:153], v238 offset:8192
ds_read_b64_tr_b16 v[154:155], v238 offset:9216
v_mfma_f32_16x16x32_bf16 v[100:103], v[92:95], v[44:47], v[100:103]
ds_read_b64_tr_b16 v[156:157], v239 offset:8192
v_mfma_f32_16x16x32_bf16 v[104:107], v[88:91], v[48:51], v[104:107]
ds_read_b64_tr_b16 v[158:159], v239 offset:9216
buffer_load_dwordx4 v231, s[36:39], s66 offen offset:3072 lds
v_mfma_f32_16x16x32_bf16 v[108:111], v[92:95], v[48:51], v[108:111]
ds_read_b128 v[68:71], v177 offset:35840
v_mfma_f32_16x16x32_bf16 v[112:115], v[88:91], v[52:55], v[112:115]
ds_read_b128 v[72:75], v178 offset:35840
s_add_u32 m0, s57, 4096
s_add_u32 s67, s66, 131072
buffer_load_dwordx4 v228, s[36:39], s67 offen offset:0 lds
v_mfma_f32_16x16x32_bf16 v[116:119], v[92:95], v[52:55], v[116:119]
ds_read_b128 v[76:79], v179 offset:35840
s_waitcnt lgkmcnt(7)
v_mfma_f32_16x16x32_bf16 v[96:99], v[144:147], v[56:59], v[96:99]
buffer_load_dwordx4 v229, s[36:39], s67 offen offset:1024 lds
v_mfma_f32_16x16x32_bf16 v[100:103], v[148:151], v[56:59], v[100:103]
v_mfma_f32_16x16x32_bf16 v[104:107], v[144:147], v[60:63], v[104:107]
buffer_load_dwordx4 v230, s[36:39], s67 offen offset:2048 lds
v_mfma_f32_16x16x32_bf16 v[108:111], v[148:151], v[60:63], v[108:111]
v_mfma_f32_16x16x32_bf16 v[112:115], v[144:147], v[64:67], v[112:115]
buffer_load_dwordx4 v231, s[36:39], s67 offen offset:3072 lds
v_mfma_f32_16x16x32_bf16 v[116:119], v[148:151], v[64:67], v[116:119]
s_waitcnt vmcnt(19)
s_waitcnt vmcnt(8)
s_waitcnt lgkmcnt(0)
s_barrier
v_mfma_f32_16x16x32_bf16 v[96:99], v[152:155], v[68:71], v[96:99]
ds_read_b64_tr_b16 v[80:81], v232 offset:16384
ds_read_b64_tr_b16 v[82:83], v232 offset:17408
ds_read_b64_tr_b16 v[84:85], v233 offset:16384
s_add_u32 m0, s57, 35840
s_add_u32 s65, s62, 3
s_and_b32 s65, s65, 7
s_lshl_b32 s65, s65, 8
buffer_load_dwordx4 v224, s[32:35], s65 offen offset:0 lds
v_mfma_f32_16x16x32_bf16 v[100:103], v[156:159], v[68:71], v[100:103]
ds_read_b64_tr_b16 v[86:87], v233 offset:17408
ds_read_b128 v[32:35], v168 offset:32768
v_mfma_f32_16x16x32_bf16 v[104:107], v[152:155], v[72:75], v[104:107]
ds_read_b128 v[36:39], v169 offset:32768
ds_read_b128 v[40:43], v170 offset:32768
v_mfma_f32_16x16x32_bf16 v[108:111], v[156:159], v[72:75], v[108:111]
ds_read_b64_tr_b16 v[88:89], v234 offset:16384
ds_read_b64_tr_b16 v[90:91], v234 offset:17408
ds_read_b64_tr_b16 v[92:93], v235 offset:16384
buffer_load_dwordx4 v225, s[32:35], s65 offen offset:1024 lds
v_mfma_f32_16x16x32_bf16 v[112:115], v[152:155], v[76:79], v[112:115]
ds_read_b64_tr_b16 v[94:95], v235 offset:17408
ds_read_b128 v[44:47], v171 offset:32768
v_mfma_f32_16x16x32_bf16 v[116:119], v[156:159], v[76:79], v[116:119]
ds_read_b128 v[48:51], v172 offset:32768
ds_read_b128 v[52:55], v173 offset:32768
buffer_load_dwordx4 v226, s[32:35], s65 offen offset:2048 lds
s_waitcnt lgkmcnt(7)
v_mfma_f32_16x16x32_bf16 v[96:99], v[80:83], v[32:35], v[96:99]
ds_read_b64_tr_b16 v[144:145], v236 offset:16384
ds_read_b64_tr_b16 v[146:147], v236 offset:17408
v_mfma_f32_16x16x32_bf16 v[100:103], v[84:87], v[32:35], v[100:103]
ds_read_b64_tr_b16 v[148:149], v237 offset:16384
s_add_u32 s66, s62, 5
s_and_b32 s66, s66, 7
s_lshl_b32 s66, s66, 20
s_add_u32 m0, s57, 8192
s_nop 0
buffer_load_dwordx4 v228, s[36:39], s66 offen offset:0 lds
v_mfma_f32_16x16x32_bf16 v[104:107], v[80:83], v[36:39], v[104:107]
ds_read_b64_tr_b16 v[150:151], v237 offset:17408
v_mfma_f32_16x16x32_bf16 v[108:111], v[84:87], v[36:39], v[108:111]
ds_read_b128 v[56:59], v174 offset:32768
buffer_load_dwordx4 v229, s[36:39], s66 offen offset:1024 lds
v_mfma_f32_16x16x32_bf16 v[112:115], v[80:83], v[40:43], v[112:115]
ds_read_b128 v[60:63], v175 offset:32768
v_mfma_f32_16x16x32_bf16 v[116:119], v[84:87], v[40:43], v[116:119]
ds_read_b128 v[64:67], v176 offset:32768
buffer_load_dwordx4 v230, s[36:39], s66 offen offset:2048 lds
s_waitcnt lgkmcnt(7)
v_mfma_f32_16x16x32_bf16 v[96:99], v[88:91], v[44:47], v[96:99]
ds_read_b64_tr_b16 v[152:153], v238 offset:16384
ds_read_b64_tr_b16 v[154:155], v238 offset:17408
v_mfma_f32_16x16x32_bf16 v[100:103], v[92:95], v[44:47], v[100:103]
ds_read_b64_tr_b16 v[156:157], v239 offset:16384
v_mfma_f32_16x16x32_bf16 v[104:107], v[88:91], v[48:51], v[104:107]
ds_read_b64_tr_b16 v[158:159], v239 offset:17408
buffer_load_dwordx4 v231, s[36:39], s66 offen offset:3072 lds
v_mfma_f32_16x16x32_bf16 v[108:111], v[92:95], v[48:51], v[108:111]
ds_read_b128 v[68:71], v177 offset:32768
v_mfma_f32_16x16x32_bf16 v[112:115], v[88:91], v[52:55], v[112:115]
ds_read_b128 v[72:75], v178 offset:32768
s_add_u32 m0, s57, 12288
s_add_u32 s67, s66, 131072
buffer_load_dwordx4 v228, s[36:39], s67 offen offset:0 lds
v_mfma_f32_16x16x32_bf16 v[116:119], v[92:95], v[52:55], v[116:119]
ds_read_b128 v[76:79], v179 offset:32768
s_waitcnt lgkmcnt(7)
v_mfma_f32_16x16x32_bf16 v[96:99], v[144:147], v[56:59], v[96:99]
buffer_load_dwordx4 v229, s[36:39], s67 offen offset:1024 lds
v_mfma_f32_16x16x32_bf16 v[100:103], v[148:151], v[56:59], v[100:103]
v_mfma_f32_16x16x32_bf16 v[104:107], v[144:147], v[60:63], v[104:107]
buffer_load_dwordx4 v230, s[36:39], s67 offen offset:2048 lds
v_mfma_f32_16x16x32_bf16 v[108:111], v[148:151], v[60:63], v[108:111]
v_mfma_f32_16x16x32_bf16 v[112:115], v[144:147], v[64:67], v[112:115]
buffer_load_dwordx4 v231, s[36:39], s67 offen offset:3072 lds
v_mfma_f32_16x16x32_bf16 v[116:119], v[148:151], v[64:67], v[116:119]
s_waitcnt vmcnt(8)
s_waitcnt lgkmcnt(0)
s_barrier
v_mfma_f32_16x16x32_bf16 v[96:99], v[152:155], v[68:71], v[96:99]
ds_read_b64_tr_b16 v[80:81], v232 offset:24576
ds_read_b64_tr_b16 v[82:83], v232 offset:25600
ds_read_b64_tr_b16 v[84:85], v233 offset:24576
s_add_u32 m0, s57, 32768
s_add_u32 s65, s62, 4
s_and_b32 s65, s65, 7
s_lshl_b32 s65, s65, 8
buffer_load_dwordx4 v224, s[32:35], s65 offen offset:0 lds
v_mfma_f32_16x16x32_bf16 v[100:103], v[156:159], v[68:71], v[100:103]
ds_read_b64_tr_b16 v[86:87], v233 offset:25600
ds_read_b128 v[32:35], v168 offset:35840
v_mfma_f32_16x16x32_bf16 v[104:107], v[152:155], v[72:75], v[104:107]
ds_read_b128 v[36:39], v169 offset:35840
ds_read_b128 v[40:43], v170 offset:35840
v_mfma_f32_16x16x32_bf16 v[108:111], v[156:159], v[72:75], v[108:111]
ds_read_b64_tr_b16 v[88:89], v234 offset:24576
ds_read_b64_tr_b16 v[90:91], v234 offset:25600
ds_read_b64_tr_b16 v[92:93], v235 offset:24576
buffer_load_dwordx4 v225, s[32:35], s65 offen offset:1024 lds
v_mfma_f32_16x16x32_bf16 v[112:115], v[152:155], v[76:79], v[112:115]
ds_read_b64_tr_b16 v[94:95], v235 offset:25600
ds_read_b128 v[44:47], v171 offset:35840
v_mfma_f32_16x16x32_bf16 v[116:119], v[156:159], v[76:79], v[116:119]
ds_read_b128 v[48:51], v172 offset:35840
ds_read_b128 v[52:55], v173 offset:35840
buffer_load_dwordx4 v226, s[32:35], s65 offen offset:2048 lds
s_waitcnt lgkmcnt(7)
v_mfma_f32_16x16x32_bf16 v[96:99], v[80:83], v[32:35], v[96:99]
ds_read_b64_tr_b16 v[144:145], v236 offset:24576
ds_read_b64_tr_b16 v[146:147], v236 offset:25600
v_mfma_f32_16x16x32_bf16 v[100:103], v[84:87], v[32:35], v[100:103]
ds_read_b64_tr_b16 v[148:149], v237 offset:24576
s_add_u32 s66, s62, 6
s_and_b32 s66, s66, 7
s_lshl_b32 s66, s66, 20
s_add_u32 m0, s57, 16384
s_nop 0
buffer_load_dwordx4 v228, s[36:39], s66 offen offset:0 lds
v_mfma_f32_16x16x32_bf16 v[104:107], v[80:83], v[36:39], v[104:107]
ds_read_b64_tr_b16 v[150:151], v237 offset:25600
v_mfma_f32_16x16x32_bf16 v[108:111], v[84:87], v[36:39], v[108:111]
ds_read_b128 v[56:59], v174 offset:35840
buffer_load_dwordx4 v229, s[36:39], s66 offen offset:1024 lds
v_mfma_f32_16x16x32_bf16 v[112:115], v[80:83], v[40:43], v[112:115]
ds_read_b128 v[60:63], v175 offset:35840
v_mfma_f32_16x16x32_bf16 v[116:119], v[84:87], v[40:43], v[116:119]
ds_read_b128 v[64:67], v176 offset:35840
buffer_load_dwordx4 v230, s[36:39], s66 offen offset:2048 lds
s_waitcnt lgkmcnt(7)
v_mfma_f32_16x16x32_bf16 v[96:99], v[88:91], v[44:47], v[96:99]
ds_read_b64_tr_b16 v[152:153], v238 offset:24576
ds_read_b64_tr_b16 v[154:155], v238 offset:25600
v_mfma_f32_16x16x32_bf16 v[100:103], v[92:95], v[44:47], v[100:103]
ds_read_b64_tr_b16 v[156:157], v239 offset:24576
v_mfma_f32_16x16x32_bf16 v[104:107], v[88:91], v[48:51], v[104:107]
ds_read_b64_tr_b16 v[158:159], v239 offset:25600
buffer_load_dwordx4 v231, s[36:39], s66 offen offset:3072 lds
v_mfma_f32_16x16x32_bf16 v[108:111], v[92:95], v[48:51], v[108:111]
ds_read_b128 v[68:71], v177 offset:35840
v_mfma_f32_16x16x32_bf16 v[112:115], v[88:91], v[52:55], v[112:115]
ds_read_b128 v[72:75], v178 offset:35840
s_add_u32 m0, s57, 20480
s_add_u32 s67, s66, 131072
buffer_load_dwordx4 v228, s[36:39], s67 offen offset:0 lds
v_mfma_f32_16x16x32_bf16 v[116:119], v[92:95], v[52:55], v[116:119]
ds_read_b128 v[76:79], v179 offset:35840
s_waitcnt lgkmcnt(7)
v_mfma_f32_16x16x32_bf16 v[96:99], v[144:147], v[56:59], v[96:99]
buffer_load_dwordx4 v229, s[36:39], s67 offen offset:1024 lds
v_mfma_f32_16x16x32_bf16 v[100:103], v[148:151], v[56:59], v[100:103]
v_mfma_f32_16x16x32_bf16 v[104:107], v[144:147], v[60:63], v[104:107]
buffer_load_dwordx4 v230, s[36:39], s67 offen offset:2048 lds
v_mfma_f32_16x16x32_bf16 v[108:111], v[148:151], v[60:63], v[108:111]
v_mfma_f32_16x16x32_bf16 v[112:115], v[144:147], v[64:67], v[112:115]
buffer_load_dwordx4 v231, s[36:39], s67 offen offset:3072 lds
v_mfma_f32_16x16x32_bf16 v[116:119], v[148:151], v[64:67], v[116:119]
s_waitcnt vmcnt(8)
s_waitcnt lgkmcnt(0)
s_barrier
v_mfma_f32_16x16x32_bf16 v[96:99], v[152:155], v[68:71], v[96:99]
ds_read_b64_tr_b16 v[80:81], v232 offset:0
ds_read_b64_tr_b16 v[82:83], v232 offset:1024
ds_read_b64_tr_b16 v[84:85], v233 offset:0
s_add_u32 m0, s57, 35840
s_add_u32 s65, s62, 5
s_and_b32 s65, s65, 7
s_lshl_b32 s65, s65, 8
buffer_load_dwordx4 v224, s[32:35], s65 offen offset:0 lds
v_mfma_f32_16x16x32_bf16 v[100:103], v[156:159], v[68:71], v[100:103]
ds_read_b64_tr_b16 v[86:87], v233 offset:1024
ds_read_b128 v[32:35], v168 offset:32768
v_mfma_f32_16x16x32_bf16 v[104:107], v[152:155], v[72:75], v[104:107]
ds_read_b128 v[36:39], v169 offset:32768
ds_read_b128 v[40:43], v170 offset:32768
v_mfma_f32_16x16x32_bf16 v[108:111], v[156:159], v[72:75], v[108:111]
ds_read_b64_tr_b16 v[88:89], v234 offset:0
ds_read_b64_tr_b16 v[90:91], v234 offset:1024
ds_read_b64_tr_b16 v[92:93], v235 offset:0
buffer_load_dwordx4 v225, s[32:35], s65 offen offset:1024 lds
v_mfma_f32_16x16x32_bf16 v[112:115], v[152:155], v[76:79], v[112:115]
ds_read_b64_tr_b16 v[94:95], v235 offset:1024
ds_read_b128 v[44:47], v171 offset:32768
v_mfma_f32_16x16x32_bf16 v[116:119], v[156:159], v[76:79], v[116:119]
ds_read_b128 v[48:51], v172 offset:32768
ds_read_b128 v[52:55], v173 offset:32768
buffer_load_dwordx4 v226, s[32:35], s65 offen offset:2048 lds
s_waitcnt lgkmcnt(7)
v_mfma_f32_16x16x32_bf16 v[96:99], v[80:83], v[32:35], v[96:99]
ds_read_b64_tr_b16 v[144:145], v236 offset:0
ds_read_b64_tr_b16 v[146:147], v236 offset:1024
v_mfma_f32_16x16x32_bf16 v[100:103], v[84:87], v[32:35], v[100:103]
ds_read_b64_tr_b16 v[148:149], v237 offset:0
s_add_u32 s66, s62, 7
s_and_b32 s66, s66, 7
s_lshl_b32 s66, s66, 20
s_add_u32 m0, s57, 24576
s_nop 0
buffer_load_dwordx4 v228, s[36:39], s66 offen offset:0 lds
v_mfma_f32_16x16x32_bf16 v[104:107], v[80:83], v[36:39], v[104:107]
ds_read_b64_tr_b16 v[150:151], v237 offset:1024
v_mfma_f32_16x16x32_bf16 v[108:111], v[84:87], v[36:39], v[108:111]
ds_read_b128 v[56:59], v174 offset:32768
buffer_load_dwordx4 v229, s[36:39], s66 offen offset:1024 lds
v_mfma_f32_16x16x32_bf16 v[112:115], v[80:83], v[40:43], v[112:115]
ds_read_b128 v[60:63], v175 offset:32768
v_mfma_f32_16x16x32_bf16 v[116:119], v[84:87], v[40:43], v[116:119]
ds_read_b128 v[64:67], v176 offset:32768
buffer_load_dwordx4 v230, s[36:39], s66 offen offset:2048 lds
s_waitcnt lgkmcnt(7)
v_mfma_f32_16x16x32_bf16 v[96:99], v[88:91], v[44:47], v[96:99]
ds_read_b64_tr_b16 v[152:153], v238 offset:0
ds_read_b64_tr_b16 v[154:155], v238 offset:1024
v_mfma_f32_16x16x32_bf16 v[100:103], v[92:95], v[44:47], v[100:103]
ds_read_b64_tr_b16 v[156:157], v239 offset:0
v_mfma_f32_16x16x32_bf16 v[104:107], v[88:91], v[48:51], v[104:107]
ds_read_b64_tr_b16 v[158:159], v239 offset:1024
buffer_load_dwordx4 v231, s[36:39], s66 offen offset:3072 lds
v_mfma_f32_16x16x32_bf16 v[108:111], v[92:95], v[48:51], v[108:111]
ds_read_b128 v[68:71], v177 offset:32768
v_mfma_f32_16x16x32_bf16 v[112:115], v[88:91], v[52:55], v[112:115]
ds_read_b128 v[72:75], v178 offset:32768
s_add_u32 m0, s57, 28672
s_add_u32 s67, s66, 131072
buffer_load_dwordx4 v228, s[36:39], s67 offen offset:0 lds
v_mfma_f32_16x16x32_bf16 v[116:119], v[92:95], v[52:55], v[116:119]
ds_read_b128 v[76:79], v179 offset:32768
s_waitcnt lgkmcnt(7)
v_mfma_f32_16x16x32_bf16 v[96:99], v[144:147], v[56:59], v[96:99]
buffer_load_dwordx4 v229, s[36:39], s67 offen offset:1024 lds
v_mfma_f32_16x16x32_bf16 v[100:103], v[148:151], v[56:59], v[100:103]
v_mfma_f32_16x16x32_bf16 v[104:107], v[144:147], v[60:63], v[104:107]
buffer_load_dwordx4 v230, s[36:39], s67 offen offset:2048 lds
v_mfma_f32_16x16x32_bf16 v[108:111], v[148:151], v[60:63], v[108:111]
v_mfma_f32_16x16x32_bf16 v[112:115], v[144:147], v[64:67], v[112:115]
buffer_load_dwordx4 v231, s[36:39], s67 offen offset:3072 lds
v_mfma_f32_16x16x32_bf16 v[116:119], v[148:151], v[64:67], v[116:119]
s_waitcnt vmcnt(8)
s_waitcnt lgkmcnt(0)
s_barrier
v_mfma_f32_16x16x32_bf16 v[96:99], v[152:155], v[68:71], v[96:99]
ds_read_b64_tr_b16 v[80:81], v232 offset:8192
ds_read_b64_tr_b16 v[82:83], v232 offset:9216
ds_read_b64_tr_b16 v[84:85], v233 offset:8192
s_add_u32 m0, s57, 32768
s_add_u32 s65, s62, 6
s_and_b32 s65, s65, 7
s_lshl_b32 s65, s65, 8
buffer_load_dwordx4 v224, s[32:35], s65 offen offset:0 lds
v_mfma_f32_16x16x32_bf16 v[100:103], v[156:159], v[68:71], v[100:103]
ds_read_b64_tr_b16 v[86:87], v233 offset:9216
ds_read_b128 v[32:35], v168 offset:35840
v_mfma_f32_16x16x32_bf16 v[104:107], v[152:155], v[72:75], v[104:107]
ds_read_b128 v[36:39], v169 offset:35840
ds_read_b128 v[40:43], v170 offset:35840
v_mfma_f32_16x16x32_bf16 v[108:111], v[156:159], v[72:75], v[108:111]
ds_read_b64_tr_b16 v[88:89], v234 offset:8192
ds_read_b64_tr_b16 v[90:91], v234 offset:9216
ds_read_b64_tr_b16 v[92:93], v235 offset:8192
buffer_load_dwordx4 v225, s[32:35], s65 offen offset:1024 lds
v_mfma_f32_16x16x32_bf16 v[112:115], v[152:155], v[76:79], v[112:115]
ds_read_b64_tr_b16 v[94:95], v235 offset:9216
ds_read_b128 v[44:47], v171 offset:35840
v_mfma_f32_16x16x32_bf16 v[116:119], v[156:159], v[76:79], v[116:119]
ds_read_b128 v[48:51], v172 offset:35840
ds_read_b128 v[52:55], v173 offset:35840
buffer_load_dwordx4 v226, s[32:35], s65 offen offset:2048 lds
s_waitcnt lgkmcnt(7)
v_mfma_f32_16x16x32_bf16 v[96:99], v[80:83], v[32:35], v[96:99]
ds_read_b64_tr_b16 v[144:145], v236 offset:8192
ds_read_b64_tr_b16 v[146:147], v236 offset:9216
v_mfma_f32_16x16x32_bf16 v[100:103], v[84:87], v[32:35], v[100:103]
ds_read_b64_tr_b16 v[148:149], v237 offset:8192
s_mov_b32 s70, 0
s_lshl_b32 s71, s70, 15
s_add_u32 s71, s71, s74
s_add_u32 s70, s70, 1
s_add_u32 m0, s57, 0
s_nop 0
buffer_load_dwordx4 v2, s[40:43], s71 offen offset:0 nt lds
v_mfma_f32_16x16x32_bf16 v[104:107], v[80:83], v[36:39], v[104:107]
ds_read_b64_tr_b16 v[150:151], v237 offset:9216
v_mfma_f32_16x16x32_bf16 v[108:111], v[84:87], v[36:39], v[108:111]
ds_read_b128 v[56:59], v174 offset:35840
buffer_load_dwordx4 v3, s[40:43], s71 offen offset:1024 nt lds
v_mfma_f32_16x16x32_bf16 v[112:115], v[80:83], v[40:43], v[112:115]
ds_read_b128 v[60:63], v175 offset:35840
v_mfma_f32_16x16x32_bf16 v[116:119], v[84:87], v[40:43], v[116:119]
ds_read_b128 v[64:67], v176 offset:35840
buffer_load_dwordx4 v4, s[40:43], s71 offen offset:2048 nt lds
s_waitcnt lgkmcnt(7)
v_mfma_f32_16x16x32_bf16 v[96:99], v[88:91], v[44:47], v[96:99]
ds_read_b64_tr_b16 v[152:153], v238 offset:8192
ds_read_b64_tr_b16 v[154:155], v238 offset:9216
v_mfma_f32_16x16x32_bf16 v[100:103], v[92:95], v[44:47], v[100:103]
ds_read_b64_tr_b16 v[156:157], v239 offset:8192
v_mfma_f32_16x16x32_bf16 v[104:107], v[88:91], v[48:51], v[104:107]
ds_read_b64_tr_b16 v[158:159], v239 offset:9216
buffer_load_dwordx4 v5, s[40:43], s71 offen offset:3072 nt lds
v_mfma_f32_16x16x32_bf16 v[108:111], v[92:95], v[48:51], v[108:111]
ds_read_b128 v[68:71], v177 offset:35840
v_mfma_f32_16x16x32_bf16 v[112:115], v[88:91], v[52:55], v[112:115]
ds_read_b128 v[72:75], v178 offset:35840
s_add_u32 m0, s57, 4096
s_add_u32 s67, s71, 16384
buffer_load_dwordx4 v2, s[40:43], s67 offen offset:0 nt lds
v_mfma_f32_16x16x32_bf16 v[116:119], v[92:95], v[52:55], v[116:119]
ds_read_b128 v[76:79], v179 offset:35840
s_waitcnt lgkmcnt(7)
v_mfma_f32_16x16x32_bf16 v[96:99], v[144:147], v[56:59], v[96:99]
buffer_load_dwordx4 v3, s[40:43], s67 offen offset:1024 nt lds
v_mfma_f32_16x16x32_bf16 v[100:103], v[148:151], v[56:59], v[100:103]
v_mfma_f32_16x16x32_bf16 v[104:107], v[144:147], v[60:63], v[104:107]
buffer_load_dwordx4 v4, s[40:43], s67 offen offset:2048 nt lds
v_mfma_f32_16x16x32_bf16 v[108:111], v[148:151], v[60:63], v[108:111]
v_mfma_f32_16x16x32_bf16 v[112:115], v[144:147], v[64:67], v[112:115]
buffer_load_dwordx4 v5, s[40:43], s67 offen offset:3072 nt lds
v_mfma_f32_16x16x32_bf16 v[116:119], v[148:151], v[64:67], v[116:119]
s_waitcnt vmcnt(8)
s_waitcnt lgkmcnt(0)
s_barrier
v_mfma_f32_16x16x32_bf16 v[96:99], v[152:155], v[68:71], v[96:99]
ds_read_b64_tr_b16 v[80:81], v232 offset:16384
ds_read_b64_tr_b16 v[82:83], v232 offset:17408
ds_read_b64_tr_b16 v[84:85], v233 offset:16384
s_add_u32 m0, s57, 35840
s_add_u32 s65, s62, 7
s_and_b32 s65, s65, 7
s_lshl_b32 s65, s65, 8
buffer_load_dwordx4 v224, s[32:35], s65 offen offset:0 lds
v_mfma_f32_16x16x32_bf16 v[100:103], v[156:159], v[68:71], v[100:103]
ds_read_b64_tr_b16 v[86:87], v233 offset:17408
ds_read_b128 v[32:35], v168 offset:32768
v_mfma_f32_16x16x32_bf16 v[104:107], v[152:155], v[72:75], v[104:107]
ds_read_b128 v[36:39], v169 offset:32768
ds_read_b128 v[40:43], v170 offset:32768
v_mfma_f32_16x16x32_bf16 v[108:111], v[156:159], v[72:75], v[108:111]
ds_read_b64_tr_b16 v[88:89], v234 offset:16384
ds_read_b64_tr_b16 v[90:91], v234 offset:17408
ds_read_b64_tr_b16 v[92:93], v235 offset:16384
buffer_load_dwordx4 v225, s[32:35], s65 offen offset:1024 lds
v_mfma_f32_16x16x32_bf16 v[112:115], v[152:155], v[76:79], v[112:115]
ds_read_b64_tr_b16 v[94:95], v235 offset:17408
ds_read_b128 v[44:47], v171 offset:32768
v_mfma_f32_16x16x32_bf16 v[116:119], v[156:159], v[76:79], v[116:119]
ds_read_b128 v[48:51], v172 offset:32768
ds_read_b128 v[52:55], v173 offset:32768
buffer_load_dwordx4 v226, s[32:35], s65 offen offset:2048 lds
s_waitcnt lgkmcnt(7)
v_mfma_f32_16x16x32_bf16 v[96:99], v[80:83], v[32:35], v[96:99]
ds_read_b64_tr_b16 v[144:145], v236 offset:16384
ds_read_b64_tr_b16 v[146:147], v236 offset:17408
v_mfma_f32_16x16x32_bf16 v[100:103], v[84:87], v[32:35], v[100:103]
ds_read_b64_tr_b16 v[148:149], v237 offset:16384
s_add_u32 m0, s57, 8192
s_nop 0
buffer_load_dwordx4 v6, s[44:47], s71 offen offset:0 nt lds
v_mfma_f32_16x16x32_bf16 v[104:107], v[80:83], v[36:39], v[104:107]
ds_read_b64_tr_b16 v[150:151], v237 offset:17408
v_mfma_f32_16x16x32_bf16 v[108:111], v[84:87], v[36:39], v[108:111]
ds_read_b128 v[56:59], v174 offset:32768
buffer_load_dwordx4 v7, s[44:47], s71 offen offset:1024 nt lds
v_mfma_f32_16x16x32_bf16 v[112:115], v[80:83], v[40:43], v[112:115]
ds_read_b128 v[60:63], v175 offset:32768
v_mfma_f32_16x16x32_bf16 v[116:119], v[84:87], v[40:43], v[116:119]
ds_read_b128 v[64:67], v176 offset:32768
buffer_load_dwordx4 v8, s[44:47], s71 offen offset:2048 nt lds
s_waitcnt lgkmcnt(7)
v_mfma_f32_16x16x32_bf16 v[96:99], v[88:91], v[44:47], v[96:99]
ds_read_b64_tr_b16 v[152:153], v238 offset:16384
ds_read_b64_tr_b16 v[154:155], v238 offset:17408
v_mfma_f32_16x16x32_bf16 v[100:103], v[92:95], v[44:47], v[100:103]
ds_read_b64_tr_b16 v[156:157], v239 offset:16384
v_mfma_f32_16x16x32_bf16 v[104:107], v[88:91], v[48:51], v[104:107]
ds_read_b64_tr_b16 v[158:159], v239 offset:17408
buffer_load_dwordx4 v9, s[44:47], s71 offen offset:3072 nt lds
v_mfma_f32_16x16x32_bf16 v[108:111], v[92:95], v[48:51], v[108:111]
ds_read_b128 v[68:71], v177 offset:32768
v_mfma_f32_16x16x32_bf16 v[112:115], v[88:91], v[52:55], v[112:115]
ds_read_b128 v[72:75], v178 offset:32768
s_add_u32 m0, s57, 12288
s_add_u32 s67, s71, 16384
buffer_load_dwordx4 v6, s[44:47], s67 offen offset:0 nt lds
v_mfma_f32_16x16x32_bf16 v[116:119], v[92:95], v[52:55], v[116:119]
ds_read_b128 v[76:79], v179 offset:32768
s_waitcnt lgkmcnt(7)
v_mfma_f32_16x16x32_bf16 v[96:99], v[144:147], v[56:59], v[96:99]
buffer_load_dwordx4 v7, s[44:47], s67 offen offset:1024 nt lds
v_mfma_f32_16x16x32_bf16 v[100:103], v[148:151], v[56:59], v[100:103]
v_mfma_f32_16x16x32_bf16 v[104:107], v[144:147], v[60:63], v[104:107]
buffer_load_dwordx4 v8, s[44:47], s67 offen offset:2048 nt lds
v_mfma_f32_16x16x32_bf16 v[108:111], v[148:151], v[60:63], v[108:111]
v_mfma_f32_16x16x32_bf16 v[112:115], v[144:147], v[64:67], v[112:115]
buffer_load_dwordx4 v9, s[44:47], s67 offen offset:3072 nt lds
v_mfma_f32_16x16x32_bf16 v[116:119], v[148:151], v[64:67], v[116:119]
s_waitcnt vmcnt(8)
s_waitcnt lgkmcnt(0)
s_barrier
v_mfma_f32_16x16x32_bf16 v[96:99], v[152:155], v[68:71], v[96:99]
ds_read_b64_tr_b16 v[80:81], v232 offset:24576
ds_read_b64_tr_b16 v[82:83], v232 offset:25600
ds_read_b64_tr_b16 v[84:85], v233 offset:24576
s_lshl_b32 s72, s70, 15
s_add_u32 s72, s72, s74
s_add_u32 s70, s70, 1
s_add_u32 m0, s57, 16384
s_nop 0
buffer_load_dwordx4 v2, s[40:43], s72 offen offset:0 nt lds
v_mfma_f32_16x16x32_bf16 v[100:103], v[156:159], v[68:71], v[100:103]
ds_read_b64_tr_b16 v[86:87], v233 offset:25600
ds_read_b128 v[32:35], v168 offset:35840
v_mfma_f32_16x16x32_bf16 v[104:107], v[152:155], v[72:75], v[104:107]
ds_read_b128 v[36:39], v169 offset:35840
ds_read_b128 v[40:43], v170 offset:35840
v_mfma_f32_16x16x32_bf16 v[108:111], v[156:159], v[72:75], v[108:111]
ds_read_b64_tr_b16 v[88:89], v234 offset:24576
ds_read_b64_tr_b16 v[90:91], v234 offset:25600
ds_read_b64_tr_b16 v[92:93], v235 offset:24576
buffer_load_dwordx4 v3, s[40:43], s72 offen offset:1024 nt lds
v_mfma_f32_16x16x32_bf16 v[112:115], v[152:155], v[76:79], v[112:115]
ds_read_b64_tr_b16 v[94:95], v235 offset:25600
ds_read_b128 v[44:47], v171 offset:35840
v_mfma_f32_16x16x32_bf16 v[116:119], v[156:159], v[76:79], v[116:119]
ds_read_b128 v[48:51], v172 offset:35840
ds_read_b128 v[52:55], v173 offset:35840
s_waitcnt lgkmcnt(7)
v_mfma_f32_16x16x32_bf16 v[96:99], v[80:83], v[32:35], v[96:99]
ds_read_b64_tr_b16 v[144:145], v236 offset:24576
ds_read_b64_tr_b16 v[146:147], v236 offset:25600
buffer_load_dwordx4 v4, s[40:43], s72 offen offset:2048 nt lds
v_mfma_f32_16x16x32_bf16 v[100:103], v[84:87], v[32:35], v[100:103]
ds_read_b64_tr_b16 v[148:149], v237 offset:24576
v_mfma_f32_16x16x32_bf16 v[104:107], v[80:83], v[36:39], v[104:107]
ds_read_b64_tr_b16 v[150:151], v237 offset:25600
v_mfma_f32_16x16x32_bf16 v[108:111], v[84:87], v[36:39], v[108:111]
ds_read_b128 v[56:59], v174 offset:35840
buffer_load_dwordx4 v5, s[40:43], s72 offen offset:3072 nt lds
v_mfma_f32_16x16x32_bf16 v[112:115], v[80:83], v[40:43], v[112:115]
ds_read_b128 v[60:63], v175 offset:35840
v_mfma_f32_16x16x32_bf16 v[116:119], v[84:87], v[40:43], v[116:119]
ds_read_b128 v[64:67], v176 offset:35840
s_waitcnt lgkmcnt(7)
v_mfma_f32_16x16x32_bf16 v[96:99], v[88:91], v[44:47], v[96:99]
ds_read_b64_tr_b16 v[152:153], v238 offset:24576
ds_read_b64_tr_b16 v[154:155], v238 offset:25600
s_add_u32 m0, s57, 20480
s_add_u32 s67, s72, 16384
buffer_load_dwordx4 v2, s[40:43], s67 offen offset:0 nt lds
v_mfma_f32_16x16x32_bf16 v[100:103], v[92:95], v[44:47], v[100:103]
ds_read_b64_tr_b16 v[156:157], v239 offset:24576
v_mfma_f32_16x16x32_bf16 v[104:107], v[88:91], v[48:51], v[104:107]
ds_read_b64_tr_b16 v[158:159], v239 offset:25600
v_mfma_f32_16x16x32_bf16 v[108:111], v[92:95], v[48:51], v[108:111]
ds_read_b128 v[68:71], v177 offset:35840
buffer_load_dwordx4 v3, s[40:43], s67 offen offset:1024 nt lds
v_mfma_f32_16x16x32_bf16 v[112:115], v[88:91], v[52:55], v[112:115]
ds_read_b128 v[72:75], v178 offset:35840
v_mfma_f32_16x16x32_bf16 v[116:119], v[92:95], v[52:55], v[116:119]
ds_read_b128 v[76:79], v179 offset:35840
s_waitcnt lgkmcnt(7)
v_mfma_f32_16x16x32_bf16 v[96:99], v[144:147], v[56:59], v[96:99]
buffer_load_dwordx4 v4, s[40:43], s67 offen offset:2048 nt lds
v_mfma_f32_16x16x32_bf16 v[100:103], v[148:151], v[56:59], v[100:103]
v_mfma_f32_16x16x32_bf16 v[104:107], v[144:147], v[60:63], v[104:107]
v_mfma_f32_16x16x32_bf16 v[108:111], v[148:151], v[60:63], v[108:111]
buffer_load_dwordx4 v5, s[40:43], s67 offen offset:3072 nt lds
v_mfma_f32_16x16x32_bf16 v[112:115], v[144:147], v[64:67], v[112:115]
v_mfma_f32_16x16x32_bf16 v[116:119], v[148:151], v[64:67], v[116:119]
s_waitcnt lgkmcnt(0)
v_mfma_f32_16x16x32_bf16 v[96:99], v[152:155], v[68:71], v[96:99]
v_mfma_f32_16x16x32_bf16 v[100:103], v[156:159], v[68:71], v[100:103]
v_mfma_f32_16x16x32_bf16 v[104:107], v[152:155], v[72:75], v[104:107]
v_mfma_f32_16x16x32_bf16 v[108:111], v[156:159], v[72:75], v[108:111]
v_mfma_f32_16x16x32_bf16 v[112:115], v[152:155], v[76:79], v[112:115]
v_mfma_f32_16x16x32_bf16 v[116:119], v[156:159], v[76:79], v[116:119]
s_mov_b32 s64, 0x3e0293ee
s_mov_b32 s65, 0x3e0293ee
s_nop 0
v_pk_mul_f32 v[96:97], v[96:97], s[64:65]
v_pk_mul_f32 v[98:99], v[98:99], s[64:65]
v_pk_mul_f32 v[100:101], v[100:101], s[64:65]
v_pk_mul_f32 v[102:103], v[102:103], s[64:65]
v_pk_mul_f32 v[104:105], v[104:105], s[64:65]
v_pk_mul_f32 v[106:107], v[106:107], s[64:65]
v_pk_mul_f32 v[108:109], v[108:109], s[64:65]
v_pk_mul_f32 v[110:111], v[110:111], s[64:65]
v_pk_mul_f32 v[112:113], v[112:113], s[64:65]
v_pk_mul_f32 v[114:115], v[114:115], s[64:65]
v_pk_mul_f32 v[116:117], v[116:117], s[64:65]
v_pk_mul_f32 v[118:119], v[118:119], s[64:65]
v_cvt_pk_bf16_f32 v96, v96, v97
v_cvt_pk_bf16_f32 v97, v98, v99
v_cvt_pk_bf16_f32 v98, v100, v101
v_cvt_pk_bf16_f32 v99, v102, v103
v_cvt_pk_bf16_f32 v100, v104, v105
v_cvt_pk_bf16_f32 v101, v106, v107
v_cvt_pk_bf16_f32 v102, v108, v109
v_cvt_pk_bf16_f32 v103, v110, v111
v_cvt_pk_bf16_f32 v104, v112, v113
v_cvt_pk_bf16_f32 v105, v114, v115
v_cvt_pk_bf16_f32 v106, v116, v117
v_cvt_pk_bf16_f32 v107, v118, v119
v_permlane32_swap_b32 v96, v98
v_permlane32_swap_b32 v97, v99
v_permlane32_swap_b32 v100, v102
v_permlane32_swap_b32 v101, v103
v_permlane32_swap_b32 v104, v106
v_permlane32_swap_b32 v105, v107
v_permlane16_swap_b32 v96, v98
v_permlane16_swap_b32 v97, v99
v_permlane16_swap_b32 v100, v102
v_permlane16_swap_b32 v101, v103
v_permlane16_swap_b32 v104, v106
v_permlane16_swap_b32 v105, v107
ds_write_b128 v200, v[96:99] offset:32768
ds_write_b128 v200, v[100:103] offset:33792
ds_write_b128 v200, v[104:107] offset:34816
s_waitcnt lgkmcnt(0)
s_barrier
ds_read_b128 a[192:195], v207 offset:0
ds_read_b128 a[196:199], v207 offset:40960
ds_read_b128 a[200:203], v208 offset:0
ds_read_b128 a[204:207], v208 offset:40960
ds_read_b128 a[208:211], v207 offset:1024
ds_read_b128 a[212:215], v207 offset:41984
ds_read_b128 a[216:219], v208 offset:1024
ds_read_b128 a[220:223], v208 offset:41984
ds_read_b128 a[224:227], v207 offset:2048
ds_read_b128 a[228:231], v207 offset:43008
ds_read_b128 a[232:235], v208 offset:2048
ds_read_b128 a[236:239], v208 offset:43008
s_xor_b32 s61, s61, 1
s_xor_b32 s60, s60, 2
s_lshl_b32 s64, s60, 5
s_add_u32 s64, s64, s61
s_mul_i32 s64, s64, 12288
s_add_u32 s64, s64, 8388608
s_add_u32 s32, s28, s64
s_addc_u32 s33, s29, 0
s_mov_b32 s34, 12288
s_mov_b32 s35, 0x20000
s_lshl_b32 s64, s60, 5
s_add_u32 s64, s64, s61
s_lshl_b32 s64, s64, 7
v_mov_b32 v218, s64
v_mov_b32 v214, s64
s_xor_b32 s61, s61, 1
s_xor_b32 s60, s60, 2
s_mov_b32 s76, 0
s_add_u32 m0, s57, 24576
s_nop 0
buffer_load_dwordx4 v6, s[44:47], s72 offen offset:0 nt lds
buffer_load_dwordx4 v7, s[44:47], s72 offen offset:1024 nt lds
buffer_load_dwordx4 v8, s[44:47], s72 offen offset:2048 nt lds
buffer_load_dwordx4 v9, s[44:47], s72 offen offset:3072 nt lds
s_add_u32 m0, s57, 28672
s_add_u32 s67, s72, 16384
buffer_load_dwordx4 v6, s[44:47], s67 offen offset:0 nt lds
buffer_load_dwordx4 v7, s[44:47], s67 offen offset:1024 nt lds
buffer_load_dwordx4 v8, s[44:47], s67 offen offset:2048 nt lds
buffer_load_dwordx4 v9, s[44:47], s67 offen offset:3072 nt lds
s_mov_b32 s62, 8
s_mov_b32 s79, 0xf8
s_lshl_b32 s64, s60, 5
s_add_u32 s64, s64, s61
s_mul_i32 s64, s64, 12288
s_add_u32 s64, s64, 4194304
s_add_u32 s48, s28, s64
s_addc_u32 s49, s29, 0
s_mov_b32 s50, 12288
s_mov_b32 s51, 0x20000
s_lshl_b32 s64, s60, 5
s_add_u32 s64, s64, s61
s_add_u32 s64, s64, 512
s_lshl_b32 s64, s64, 5
s_add_u32 s64, s64, s56
s_lshl_b32 s64, s64, 2
v_mov_b32 v216, s64
v_mov_b32 v217, 1
S_item:
v_mov_b32 v128, 0
v_mov_b32 v129, 0
v_mov_b32 v130, 0
v_mov_b32 v131, 0
v_mov_b32 v136, 0
v_mov_b32 v137, 0
v_mov_b32 v138, 0
v_mov_b32 v139, 0
v_mfma_f32_32x32x16_bf16 a[0:15], v[128:131], v[128:131], 0
v_mfma_f32_32x32x16_bf16 a[16:31], v[128:131], v[128:131], 0
v_mfma_f32_32x32x16_bf16 a[32:47], v[128:131], v[128:131], 0
v_mfma_f32_32x32x16_bf16 a[48:63], v[128:131], v[128:131], 0
v_mfma_f32_32x32x16_bf16 a[64:79], v[128:131], v[128:131], 0
v_mfma_f32_32x32x16_bf16 a[80:95], v[128:131], v[128:131], 0
v_mov_b32 v144, 0
v_mov_b32 v145, 0
v_mov_b32 v146, 0
v_mov_b32 v147, 0
v_mov_b32 v148, 0
v_mov_b32 v149, 0
v_mov_b32 v150, 0
v_mov_b32 v151, 0
v_mov_b32 v152, 0
v_mov_b32 v153, 0
v_mov_b32 v154, 0
v_mov_b32 v155, 0
v_mov_b32 v22, 0
v_mov_b32 v23, 0
v_mov_b32 v24, 0
v_mov_b32 v25, 0
v_mov_b32 v26, 0
v_mov_b32 v27, 0
v_mov_b32 v28, 0
v_mov_b32 v29, 0
v_mov_b32 v140, 0
v_mov_b32 v141, 0
v_mov_b32 v142, 0
v_mov_b32 v143, 0
v_mov_b32 v252, 0x3f803f80
v_mov_b32 v253, 0x3f803f80
v_mov_b32 v254, 0x3f803f80
v_mov_b32 v255, 0x3f803f80
s_mov_b32 s68, 0xff800000
s_mov_b32 s69, 0xff800000
s_mov_b32 s73, 0
ds_read_b128 v[32:35], v10 offset:0
ds_read_b128 v[36:39], v10 offset:4096
ds_read_b128 v[40:43], v11 offset:0
ds_read_b128 v[44:47], v11 offset:4096
ds_read_b128 v[48:51], v12 offset:0
ds_read_b128 v[52:55], v12 offset:4096
ds_read_b128 v[56:59], v13 offset:0
ds_read_b128 v[60:63], v13 offset:4096
s_waitcnt lgkmcnt(0)
v_mfma_f32_16x16x32_bf16 v[96:99], v[32:35], a[192:195], v[144:147]
v_mfma_f32_16x16x32_bf16 v[100:103], v[36:39], a[192:195], v[144:147]
v_mfma_f32_16x16x32_bf16 v[96:99], v[40:43], a[196:199], v[96:99]
v_mfma_f32_16x16x32_bf16 v[100:103], v[44:47], a[196:199], v[100:103]
v_mfma_f32_16x16x32_bf16 v[96:99], v[48:51], a[200:203], v[96:99]
v_mfma_f32_16x16x32_bf16 v[100:103], v[52:55], a[200:203], v[100:103]
v_mfma_f32_16x16x32_bf16 v[96:99], v[56:59], a[204:207], v[96:99]
v_mfma_f32_16x16x32_bf16 v[100:103], v[60:63], a[204:207], v[100:103]
s_nop 6
v_max3_f32 v30, v96, v97, v98
v_max3_f32 v30, v30, v99, v100
v_max3_f32 v30, v30, v101, v102
v_max_f32 v30, v30, v103
v_cmp_lt_f32 vcc, s68, v30
.p2align 3
B_loop:
s_bitcmp1_b32 s79, s73
s_cbranch_scc1 B_hook
B_hookret:
v_mfma_f32_16x16x32_bf16 v[112:115], v[32:35], a[208:211], v[148:151]
s_cbranch_vccnz B_rare0
B_ret0:
s_lshl_b32 s71, s70, 15
s_add_u32 s71, s71, s74
s_cmp_lt_u32 s70, 16
v_mfma_f32_16x16x32_bf16 v[116:119], v[36:39], a[208:211], v[148:151]
s_cselect_b32 s71, s71, s75
s_add_u32 s70, s70, 1
v_exp_f32 v96, v96
v_mfma_f32_16x16x32_bf16 v[112:115], v[40:43], a[212:215], v[112:115]
s_add_u32 m0, s57, 0
v_exp_f32 v97, v97
v_mfma_f32_16x16x32_bf16 v[116:119], v[44:47], a[212:215], v[116:119]
buffer_load_dwordx4 v2, s[40:43], s71 offen offset:0 nt lds
v_mfma_f32_16x16x32_bf16 v[112:115], v[48:51], a[216:219], v[112:115]
buffer_load_dwordx4 v3, s[40:43], s71 offen offset:1024 nt lds
v_mfma_f32_16x16x32_bf16 v[116:119], v[52:55], a[216:219], v[116:119]
v_exp_f32 v98, v98
v_cvt_pk_bf16_f32 v128, v96, v97
v_mfma_f32_16x16x32_bf16 v[112:115], v[56:59], a[220:223], v[112:115]
buffer_load_dwordx4 v4, s[40:43], s71 offen offset:2048 nt lds
v_mfma_f32_16x16x32_bf16 v[116:119], v[60:63], a[220:223], v[116:119]
buffer_load_dwordx4 v5, s[40:43], s71 offen offset:3072 nt lds
v_mfma_f32_16x16x32_bf16 a[64:67], v[64:67], v[136:139], a[64:67]
s_add_u32 m0, s57, 4096
s_add_u32 s67, s71, 16384
v_exp_f32 v99, v99
v_mfma_f32_16x16x32_bf16 a[68:71], v[68:71], v[136:139], a[68:71]
buffer_load_dwordx4 v2, s[40:43], s67 offen offset:0 nt lds
v_mfma_f32_16x16x32_bf16 a[72:75], v[72:75], v[136:139], a[72:75]
buffer_load_dwordx4 v3, s[40:43], s67 offen offset:1024 nt lds
v_mfma_f32_16x16x32_bf16 a[76:79], v[76:79], v[136:139], a[76:79]
v_exp_f32 v100, v100
v_cvt_pk_bf16_f32 v129, v98, v99
v_mfma_f32_16x16x32_bf16 a[80:83], v[80:83], v[136:139], a[80:83]
buffer_load_dwordx4 v4, s[40:43], s67 offen offset:2048 nt lds
v_max3_f32 v30, v112, v113, v114
v_mfma_f32_16x16x32_bf16 a[84:87], v[84:87], v[136:139], a[84:87]
v_exp_f32 v101, v101
v_max3_f32 v30, v30, v115, v116
v_mfma_f32_16x16x32_bf16 a[88:91], v[88:91], v[136:139], a[88:91]
buffer_load_dwordx4 v5, s[40:43], s67 offen offset:3072 nt lds
v_max3_f32 v30, v30, v117, v118
v_mfma_f32_16x16x32_bf16 a[92:95], v[92:95], v[136:139], a[92:95]
v_exp_f32 v102, v102
v_exp_f32 v103, v103
v_max_f32 v30, v30, v119
v_mfma_f32_16x16x32_bf16 v[140:143], v[252:255], v[136:139], v[140:143]
v_cvt_pk_bf16_f32 v130, v100, v101
v_cvt_pk_bf16_f32 v131, v102, v103
v_cmp_lt_f32 vcc, s68, v30
s_waitcnt vmcnt(24)
v_mfma_f32_16x16x32_bf16 v[96:99], v[32:35], a[224:227], v[152:155]
s_cbranch_vccnz B_rare1
B_ret1:
ds_read_b64_tr_b16 v[64:65], v14 offset:8192
ds_read_b64_tr_b16 v[66:67], v14 offset:12288
v_mfma_f32_16x16x32_bf16 v[100:103], v[36:39], a[224:227], v[152:155]
ds_read_b64_tr_b16 v[68:69], v15 offset:8192
ds_read_b64_tr_b16 v[70:71], v15 offset:12288
v_mfma_f32_16x16x32_bf16 v[96:99], v[40:43], a[228:231], v[96:99]
ds_read_b64_tr_b16 v[72:73], v16 offset:8192
ds_read_b64_tr_b16 v[74:75], v16 offset:12288
v_exp_f32 v112, v112
v_mfma_f32_16x16x32_bf16 v[100:103], v[44:47], a[228:231], v[100:103]
ds_read_b64_tr_b16 v[76:77], v17 offset:8192
ds_read_b64_tr_b16 v[78:79], v17 offset:12288
v_exp_f32 v113, v113
v_mfma_f32_16x16x32_bf16 v[96:99], v[48:51], a[232:235], v[96:99]
ds_read_b64_tr_b16 v[80:81], v18 offset:8192
ds_read_b64_tr_b16 v[82:83], v18 offset:12288
v_exp_f32 v114, v114
v_mfma_f32_16x16x32_bf16 v[100:103], v[52:55], a[232:235], v[100:103]
ds_read_b64_tr_b16 v[84:85], v19 offset:8192
ds_read_b64_tr_b16 v[86:87], v19 offset:12288
v_cvt_pk_bf16_f32 v136, v112, v113
v_mfma_f32_16x16x32_bf16 v[96:99], v[56:59], a[236:239], v[96:99]
ds_read_b64_tr_b16 v[88:89], v20 offset:8192
ds_read_b64_tr_b16 v[90:91], v20 offset:12288
v_exp_f32 v115, v115
v_mfma_f32_16x16x32_bf16 v[100:103], v[60:63], a[236:239], v[100:103]
ds_read_b64_tr_b16 v[92:93], v21 offset:8192
ds_read_b64_tr_b16 v[94:95], v21 offset:12288
s_waitcnt vmcnt(16)
s_waitcnt lgkmcnt(12)
v_mfma_f32_16x16x32_bf16 a[0:3], v[64:67], v[128:131], a[0:3]
ds_read_b128 v[32:35], v10 offset:16384
v_exp_f32 v116, v116
v_mfma_f32_16x16x32_bf16 a[4:7], v[68:71], v[128:131], a[4:7]
ds_read_b128 v[36:39], v10 offset:20480
v_cvt_pk_bf16_f32 v137, v114, v115
s_waitcnt lgkmcnt(10)
v_mfma_f32_16x16x32_bf16 a[8:11], v[72:75], v[128:131], a[8:11]
ds_read_b128 v[40:43], v11 offset:16384
v_exp_f32 v117, v117
v_mfma_f32_16x16x32_bf16 a[12:15], v[76:79], v[128:131], a[12:15]
ds_read_b128 v[44:47], v11 offset:20480
v_exp_f32 v118, v118
s_waitcnt lgkmcnt(8)
v_mfma_f32_16x16x32_bf16 a[16:19], v[80:83], v[128:131], a[16:19]
ds_read_b128 v[48:51], v12 offset:16384
v_max3_f32 v30, v96, v97, v98
v_mfma_f32_16x16x32_bf16 a[20:23], v[84:87], v[128:131], a[20:23]
ds_read_b128 v[52:55], v12 offset:20480
v_max3_f32 v30, v30, v99, v100
s_waitcnt lgkmcnt(6)
v_mfma_f32_16x16x32_bf16 a[24:27], v[88:91], v[128:131], a[24:27]
ds_read_b128 v[56:59], v13 offset:16384
v_max3_f32 v30, v30, v101, v102
v_mfma_f32_16x16x32_bf16 a[28:31], v[92:95], v[128:131], a[28:31]
ds_read_b128 v[60:63], v13 offset:20480
v_exp_f32 v119, v119
v_max_f32 v30, v30, v103
v_mfma_f32_16x16x32_bf16 v[22:25], v[252:255], v[128:131], v[22:25]
v_cvt_pk_bf16_f32 v138, v116, v117
v_cvt_pk_bf16_f32 v139, v118, v119
v_cmp_lt_f32 vcc, s68, v30
s_barrier
s_waitcnt lgkmcnt(6)
v_mfma_f32_16x16x32_bf16 v[112:115], v[32:35], a[192:195], v[144:147]
s_cbranch_vccnz B_rare2
B_ret2:
s_add_u32 m0, s57, 8192
v_exp_f32 v96, v96
v_mfma_f32_16x16x32_bf16 v[116:119], v[36:39], a[192:195], v[144:147]
buffer_load_dwordx4 v6, s[44:47], s71 offen offset:0 nt lds
s_waitcnt lgkmcnt(4)
v_mfma_f32_16x16x32_bf16 v[112:115], v[40:43], a[196:199], v[112:115]
buffer_load_dwordx4 v7, s[44:47], s71 offen offset:1024 nt lds
v_mfma_f32_16x16x32_bf16 v[116:119], v[44:47], a[196:199], v[116:119]
v_exp_f32 v97, v97
s_waitcnt lgkmcnt(2)
v_mfma_f32_16x16x32_bf16 v[112:115], v[48:51], a[200:203], v[112:115]
buffer_load_dwordx4 v8, s[44:47], s71 offen offset:2048 nt lds
v_mfma_f32_16x16x32_bf16 v[116:119], v[52:55], a[200:203], v[116:119]
s_mov_b32 s68, 0x41000000
s_mov_b32 s69, 0
s_waitcnt lgkmcnt(0)
v_mfma_f32_16x16x32_bf16 v[112:115], v[56:59], a[204:207], v[112:115]
buffer_load_dwordx4 v9, s[44:47], s71 offen offset:3072 nt lds
v_mfma_f32_16x16x32_bf16 v[116:119], v[60:63], a[204:207], v[116:119]
s_add_u32 m0, s57, 12288
s_add_u32 s67, s71, 16384
v_exp_f32 v98, v98
v_mfma_f32_16x16x32_bf16 a[32:35], v[64:67], v[136:139], a[32:35]
buffer_load_dwordx4 v6, s[44:47], s67 offen offset:0 nt lds
v_cvt_pk_bf16_f32 v128, v96, v97
v_mfma_f32_16x16x32_bf16 a[36:39], v[68:71], v[136:139], a[36:39]
v_exp_f32 v99, v99
v_exp_f32 v100, v100
v_mfma_f32_16x16x32_bf16 a[40:43], v[72:75], v[136:139], a[40:43]
buffer_load_dwordx4 v7, s[44:47], s67 offen offset:1024 nt lds
v_mfma_f32_16x16x32_bf16 a[44:47], v[76:79], v[136:139], a[44:47]
v_cvt_pk_bf16_f32 v129, v98, v99
v_exp_f32 v101, v101
v_mfma_f32_16x16x32_bf16 a[48:51], v[80:83], v[136:139], a[48:51]
buffer_load_dwordx4 v8, s[44:47], s67 offen offset:2048 nt lds
v_max3_f32 v30, v112, v113, v114
v_mfma_f32_16x16x32_bf16 a[52:55], v[84:87], v[136:139], a[52:55]
v_exp_f32 v102, v102
v_max3_f32 v30, v30, v115, v116
v_mfma_f32_16x16x32_bf16 a[56:59], v[88:91], v[136:139], a[56:59]
buffer_load_dwordx4 v9, s[44:47], s67 offen offset:3072 nt lds
v_max3_f32 v30, v30, v117, v118
v_mfma_f32_16x16x32_bf16 a[60:63], v[92:95], v[136:139], a[60:63]
v_exp_f32 v103, v103
v_max_f32 v30, v30, v119
v_mfma_f32_16x16x32_bf16 v[26:29], v[252:255], v[136:139], v[26:29]
v_cvt_pk_bf16_f32 v130, v100, v101
v_cvt_pk_bf16_f32 v131, v102, v103
v_cmp_lt_f32 vcc, s68, v30
s_bitcmp1_b32 s3, s73
s_cbranch_scc1 B_hookm
B_hookret1:
v_mfma_f32_16x16x32_bf16 v[96:99], v[32:35], a[208:211], v[148:151]
s_cbranch_vccnz B_rare3
B_ret3:
s_lshl_b32 s72, s70, 15
s_add_u32 s72, s72, s74
s_cmp_lt_u32 s70, 16
v_mfma_f32_16x16x32_bf16 v[100:103], v[36:39], a[208:211], v[148:151]
s_cselect_b32 s72, s72, s78
s_add_u32 s70, s70, 1
v_exp_f32 v112, v112
v_mfma_f32_16x16x32_bf16 v[96:99], v[40:43], a[212:215], v[96:99]
s_add_u32 m0, s57, 16384
v_exp_f32 v113, v113
v_mfma_f32_16x16x32_bf16 v[100:103], v[44:47], a[212:215], v[100:103]
buffer_load_dwordx4 v2, s[40:43], s72 offen offset:0 nt lds
v_mfma_f32_16x16x32_bf16 v[96:99], v[48:51], a[216:219], v[96:99]
buffer_load_dwordx4 v3, s[40:43], s72 offen offset:1024 nt lds
v_mfma_f32_16x16x32_bf16 v[100:103], v[52:55], a[216:219], v[100:103]
v_exp_f32 v114, v114
v_cvt_pk_bf16_f32 v136, v112, v113
v_mfma_f32_16x16x32_bf16 v[96:99], v[56:59], a[220:223], v[96:99]
buffer_load_dwordx4 v4, s[40:43], s72 offen offset:2048 nt lds
v_mfma_f32_16x16x32_bf16 v[100:103], v[60:63], a[220:223], v[100:103]
buffer_load_dwordx4 v5, s[40:43], s72 offen offset:3072 nt lds
v_mfma_f32_16x16x32_bf16 a[64:67], v[64:67], v[128:131], a[64:67]
s_add_u32 m0, s57, 20480
s_add_u32 s67, s72, 16384
v_exp_f32 v115, v115
v_mfma_f32_16x16x32_bf16 a[68:71], v[68:71], v[128:131], a[68:71]
buffer_load_dwordx4 v2, s[40:43], s67 offen offset:0 nt lds
v_mfma_f32_16x16x32_bf16 a[72:75], v[72:75], v[128:131], a[72:75]
buffer_load_dwordx4 v3, s[40:43], s67 offen offset:1024 nt lds
v_mfma_f32_16x16x32_bf16 a[76:79], v[76:79], v[128:131], a[76:79]
v_exp_f32 v116, v116
v_cvt_pk_bf16_f32 v137, v114, v115
v_mfma_f32_16x16x32_bf16 a[80:83], v[80:83], v[128:131], a[80:83]
buffer_load_dwordx4 v4, s[40:43], s67 offen offset:2048 nt lds
v_max3_f32 v30, v96, v97, v98
v_mfma_f32_16x16x32_bf16 a[84:87], v[84:87], v[128:131], a[84:87]
v_exp_f32 v117, v117
v_max3_f32 v30, v30, v99, v100
v_mfma_f32_16x16x32_bf16 a[88:91], v[88:91], v[128:131], a[88:91]
buffer_load_dwordx4 v5, s[40:43], s67 offen offset:3072 nt lds
v_max3_f32 v30, v30, v101, v102
v_mfma_f32_16x16x32_bf16 a[92:95], v[92:95], v[128:131], a[92:95]
v_exp_f32 v118, v118
v_exp_f32 v119, v119
v_max_f32 v30, v30, v103
v_mfma_f32_16x16x32_bf16 v[140:143], v[252:255], v[128:131], v[140:143]
v_cvt_pk_bf16_f32 v138, v116, v117
v_cvt_pk_bf16_f32 v139, v118, v119
v_cmp_lt_f32 vcc, s68, v30
s_waitcnt vmcnt(24)
v_mfma_f32_16x16x32_bf16 v[112:115], v[32:35], a[224:227], v[152:155]
s_cbranch_vccnz B_rare4
B_ret4:
ds_read_b64_tr_b16 v[64:65], v14 offset:24576
ds_read_b64_tr_b16 v[66:67], v14 offset:28672
v_mfma_f32_16x16x32_bf16 v[116:119], v[36:39], a[224:227], v[152:155]
ds_read_b64_tr_b16 v[68:69], v15 offset:24576
ds_read_b64_tr_b16 v[70:71], v15 offset:28672
v_mfma_f32_16x16x32_bf16 v[112:115], v[40:43], a[228:231], v[112:115]
ds_read_b64_tr_b16 v[72:73], v16 offset:24576
ds_read_b64_tr_b16 v[74:75], v16 offset:28672
v_exp_f32 v96, v96
v_mfma_f32_16x16x32_bf16 v[116:119], v[44:47], a[228:231], v[116:119]
ds_read_b64_tr_b16 v[76:77], v17 offset:24576
ds_read_b64_tr_b16 v[78:79], v17 offset:28672
v_exp_f32 v97, v97
v_mfma_f32_16x16x32_bf16 v[112:115], v[48:51], a[232:235], v[112:115]
ds_read_b64_tr_b16 v[80:81], v18 offset:24576
ds_read_b64_tr_b16 v[82:83], v18 offset:28672
v_exp_f32 v98, v98
v_mfma_f32_16x16x32_bf16 v[116:119], v[52:55], a[232:235], v[116:119]
ds_read_b64_tr_b16 v[84:85], v19 offset:24576
ds_read_b64_tr_b16 v[86:87], v19 offset:28672
v_cvt_pk_bf16_f32 v128, v96, v97
v_mfma_f32_16x16x32_bf16 v[112:115], v[56:59], a[236:239], v[112:115]
ds_read_b64_tr_b16 v[88:89], v20 offset:24576
ds_read_b64_tr_b16 v[90:91], v20 offset:28672
v_exp_f32 v99, v99
v_mfma_f32_16x16x32_bf16 v[116:119], v[60:63], a[236:239], v[116:119]
ds_read_b64_tr_b16 v[92:93], v21 offset:24576
ds_read_b64_tr_b16 v[94:95], v21 offset:28672
s_waitcnt vmcnt(16)
s_waitcnt lgkmcnt(12)
v_mfma_f32_16x16x32_bf16 a[0:3], v[64:67], v[136:139], a[0:3]
ds_read_b128 v[32:35], v10 offset:0
v_exp_f32 v100, v100
v_mfma_f32_16x16x32_bf16 a[4:7], v[68:71], v[136:139], a[4:7]
ds_read_b128 v[36:39], v10 offset:4096
v_cvt_pk_bf16_f32 v129, v98, v99
s_waitcnt lgkmcnt(10)
v_mfma_f32_16x16x32_bf16 a[8:11], v[72:75], v[136:139], a[8:11]
ds_read_b128 v[40:43], v11 offset:0
v_exp_f32 v101, v101
v_mfma_f32_16x16x32_bf16 a[12:15], v[76:79], v[136:139], a[12:15]
ds_read_b128 v[44:47], v11 offset:4096
v_exp_f32 v102, v102
s_waitcnt lgkmcnt(8)
v_mfma_f32_16x16x32_bf16 a[16:19], v[80:83], v[136:139], a[16:19]
ds_read_b128 v[48:51], v12 offset:0
v_max3_f32 v30, v112, v113, v114
v_mfma_f32_16x16x32_bf16 a[20:23], v[84:87], v[136:139], a[20:23]
ds_read_b128 v[52:55], v12 offset:4096
v_max3_f32 v30, v30, v115, v116
s_waitcnt lgkmcnt(6)
v_mfma_f32_16x16x32_bf16 a[24:27], v[88:91], v[136:139], a[24:27]
ds_read_b128 v[56:59], v13 offset:0
v_max3_f32 v30, v30, v117, v118
v_mfma_f32_16x16x32_bf16 a[28:31], v[92:95], v[136:139], a[28:31]
ds_read_b128 v[60:63], v13 offset:4096
v_exp_f32 v103, v103
v_max_f32 v30, v30, v119
v_mfma_f32_16x16x32_bf16 v[22:25], v[252:255], v[136:139], v[22:25]
v_cvt_pk_bf16_f32 v130, v100, v101
v_cvt_pk_bf16_f32 v131, v102, v103
v_cmp_lt_f32 vcc, s68, v30
s_barrier
s_waitcnt lgkmcnt(6)
v_mfma_f32_16x16x32_bf16 v[96:99], v[32:35], a[192:195], v[144:147]
s_cbranch_vccnz B_rare5
B_ret5:
s_add_u32 m0, s57, 24576
v_exp_f32 v112, v112
v_mfma_f32_16x16x32_bf16 v[100:103], v[36:39], a[192:195], v[144:147]
buffer_load_dwordx4 v6, s[44:47], s72 offen offset:0 nt lds
s_waitcnt lgkmcnt(4)
v_mfma_f32_16x16x32_bf16 v[96:99], v[40:43], a[196:199], v[96:99]
buffer_load_dwordx4 v7, s[44:47], s72 offen offset:1024 nt lds
v_mfma_f32_16x16x32_bf16 v[100:103], v[44:47], a[196:199], v[100:103]
v_exp_f32 v113, v113
s_waitcnt lgkmcnt(2)
v_mfma_f32_16x16x32_bf16 v[96:99], v[48:51], a[200:203], v[96:99]
buffer_load_dwordx4 v8, s[44:47], s72 offen offset:2048 nt lds
v_mfma_f32_16x16x32_bf16 v[100:103], v[52:55], a[200:203], v[100:103]
v_exp_f32 v114, v114
s_waitcnt lgkmcnt(0)
v_mfma_f32_16x16x32_bf16 v[96:99], v[56:59], a[204:207], v[96:99]
buffer_load_dwordx4 v9, s[44:47], s72 offen offset:3072 nt lds
v_mfma_f32_16x16x32_bf16 v[100:103], v[60:63], a[204:207], v[100:103]
s_add_u32 m0, s57, 28672
s_add_u32 s67, s72, 16384
v_cvt_pk_bf16_f32 v136, v112, v113
v_mfma_f32_16x16x32_bf16 a[32:35], v[64:67], v[128:131], a[32:35]
buffer_load_dwordx4 v6, s[44:47], s67 offen offset:0 nt lds
v_mfma_f32_16x16x32_bf16 a[36:39], v[68:71], v[128:131], a[36:39]
v_exp_f32 v115, v115
v_exp_f32 v116, v116
v_mfma_f32_16x16x32_bf16 a[40:43], v[72:75], v[128:131], a[40:43]
buffer_load_dwordx4 v7, s[44:47], s67 offen offset:1024 nt lds
v_cvt_pk_bf16_f32 v137, v114, v115
v_mfma_f32_16x16x32_bf16 a[44:47], v[76:79], v[128:131], a[44:47]
v_exp_f32 v117, v117
v_exp_f32 v118, v118
v_mfma_f32_16x16x32_bf16 a[48:51], v[80:83], v[128:131], a[48:51]
buffer_load_dwordx4 v8, s[44:47], s67 offen offset:2048 nt lds
v_max3_f32 v30, v96, v97, v98
v_mfma_f32_16x16x32_bf16 a[52:55], v[84:87], v[128:131], a[52:55]
v_exp_f32 v119, v119
v_max3_f32 v30, v30, v99, v100
v_mfma_f32_16x16x32_bf16 a[56:59], v[88:91], v[128:131], a[56:59]
buffer_load_dwordx4 v9, s[44:47], s67 offen offset:3072 nt lds
v_max3_f32 v30, v30, v101, v102
v_mfma_f32_16x16x32_bf16 a[60:63], v[92:95], v[128:131], a[60:63]
s_add_u32 s73, s73, 1
s_cmp_lt_u32 s73, s62
v_max_f32 v30, v30, v103
v_mfma_f32_16x16x32_bf16 v[26:29], v[252:255], v[128:131], v[26:29]
v_cvt_pk_bf16_f32 v138, v116, v117
v_cvt_pk_bf16_f32 v139, v118, v119
v_cmp_lt_f32 vcc, s68, v30
s_cbranch_scc1 B_loop
s_cmp_lg_u32 s76, 0
s_cbranch_scc1 S_last
v_mfma_f32_16x16x32_bf16 v[140:143], v[252:255], v[136:139], v[140:143]
v_mfma_f32_16x16x32_bf16 a[64:67], v[64:67], v[136:139], a[64:67]
v_mfma_f32_16x16x32_bf16 a[68:71], v[68:71], v[136:139], a[68:71]
v_mfma_f32_16x16x32_bf16 a[72:75], v[72:75], v[136:139], a[72:75]
v_mfma_f32_16x16x32_bf16 a[76:79], v[76:79], v[136:139], a[76:79]
v_mfma_f32_16x16x32_bf16 a[80:83], v[80:83], v[136:139], a[80:83]
v_mfma_f32_16x16x32_bf16 a[84:87], v[84:87], v[136:139], a[84:87]
v_mfma_f32_16x16x32_bf16 a[88:91], v[88:91], v[136:139], a[88:91]
v_mfma_f32_16x16x32_bf16 a[92:95], v[92:95], v[136:139], a[92:95]
ds_read_b128 a[192:195], v207 offset:3072
ds_read_b128 a[196:199], v207 offset:44032
ds_read_b128 a[200:203], v208 offset:3072
ds_read_b128 a[204:207], v208 offset:44032
ds_read_b128 a[208:211], v207 offset:4096
ds_read_b128 a[212:215], v207 offset:45056
ds_read_b128 a[216:219], v208 offset:4096
ds_read_b128 a[220:223], v208 offset:45056
ds_read_b128 a[224:227], v207 offset:5120
ds_read_b128 a[228:231], v207 offset:46080
ds_read_b128 a[232:235], v208 offset:5120
ds_read_b128 a[236:239], v208 offset:46080
v_mov_b32 v156, v144
v_mov_b32 v157, v22
v_mov_b32 v160, v148
v_mov_b32 v161, v26
v_mov_b32 v164, v152
v_mov_b32 v165, v140
v_accvgpr_read_b32 v180, a0
v_accvgpr_read_b32 v181, a1
v_accvgpr_read_b32 v182, a2
v_accvgpr_read_b32 v183, a3
v_accvgpr_read_b32 v184, a4
v_accvgpr_read_b32 v185, a5
v_accvgpr_read_b32 v186, a6
v_accvgpr_read_b32 v187, a7
v_accvgpr_mov_b32 a104, a8
v_accvgpr_mov_b32 a105, a9
v_accvgpr_mov_b32 a106, a10
v_accvgpr_mov_b32 a107, a11
v_accvgpr_mov_b32 a108, a12
v_accvgpr_mov_b32 a109, a13
v_accvgpr_mov_b32 a110, a14
v_accvgpr_mov_b32 a111, a15
v_accvgpr_mov_b32 a112, a16
v_accvgpr_mov_b32 a113, a17
v_accvgpr_mov_b32 a114, a18
v_accvgpr_mov_b32 a115, a19
v_accvgpr_mov_b32 a116, a20
v_accvgpr_mov_b32 a117, a21
v_accvgpr_mov_b32 a118, a22
v_accvgpr_mov_b32 a119, a23
v_accvgpr_mov_b32 a120, a24
v_accvgpr_mov_b32 a121, a25
v_accvgpr_mov_b32 a122, a26
v_accvgpr_mov_b32 a123, a27
v_accvgpr_mov_b32 a124, a28
v_accvgpr_mov_b32 a125, a29
v_accvgpr_mov_b32 a126, a30
v_accvgpr_mov_b32 a127, a31
v_accvgpr_read_b32 v188, a32
v_accvgpr_read_b32 v189, a33
v_accvgpr_read_b32 v190, a34
v_accvgpr_read_b32 v191, a35
v_accvgpr_read_b32 v192, a36
v_accvgpr_read_b32 v193, a37
v_accvgpr_read_b32 v194, a38
v_accvgpr_read_b32 v195, a39
v_accvgpr_mov_b32 a136, a40
v_accvgpr_mov_b32 a137, a41
v_accvgpr_mov_b32 a138, a42
v_accvgpr_mov_b32 a139, a43
v_accvgpr_mov_b32 a140, a44
v_accvgpr_mov_b32 a141, a45
v_accvgpr_mov_b32 a142, a46
v_accvgpr_mov_b32 a143, a47
v_accvgpr_mov_b32 a144, a48
v_accvgpr_mov_b32 a145, a49
v_accvgpr_mov_b32 a146, a50
v_accvgpr_mov_b32 a147, a51
v_accvgpr_mov_b32 a148, a52
v_accvgpr_mov_b32 a149, a53
v_accvgpr_mov_b32 a150, a54
v_accvgpr_mov_b32 a151, a55
v_accvgpr_mov_b32 a152, a56
v_accvgpr_mov_b32 a153, a57
v_accvgpr_mov_b32 a154, a58
v_accvgpr_mov_b32 a155, a59
v_accvgpr_mov_b32 a156, a60
v_accvgpr_mov_b32 a157, a61
v_accvgpr_mov_b32 a158, a62
v_accvgpr_mov_b32 a159, a63
v_accvgpr_read_b32 v104, a64
v_accvgpr_read_b32 v105, a65
v_accvgpr_read_b32 v106, a66
v_accvgpr_read_b32 v107, a67
v_accvgpr_read_b32 v108, a68
v_accvgpr_read_b32 v109, a69
v_accvgpr_read_b32 v110, a70
v_accvgpr_read_b32 v111, a71
v_accvgpr_mov_b32 a168, a72
v_accvgpr_mov_b32 a169, a73
v_accvgpr_mov_b32 a170, a74
v_accvgpr_mov_b32 a171, a75
v_accvgpr_mov_b32 a172, a76
v_accvgpr_mov_b32 a173, a77
v_accvgpr_mov_b32 a174, a78
v_accvgpr_mov_b32 a175, a79
v_accvgpr_mov_b32 a176, a80
v_accvgpr_mov_b32 a177, a81
v_accvgpr_mov_b32 a178, a82
v_accvgpr_mov_b32 a179, a83
v_accvgpr_mov_b32 a180, a84
v_accvgpr_mov_b32 a181, a85
v_accvgpr_mov_b32 a182, a86
v_accvgpr_mov_b32 a183, a87
v_accvgpr_mov_b32 a184, a88
v_accvgpr_mov_b32 a185, a89
v_accvgpr_mov_b32 a186, a90
v_accvgpr_mov_b32 a187, a91
v_accvgpr_mov_b32 a188, a92
v_accvgpr_mov_b32 a189, a93
v_accvgpr_mov_b32 a190, a94
v_accvgpr_mov_b32 a191, a95
s_xor_b32 s61, s61, 1
s_xor_b32 s60, s60, 2
s_and_b32 s74, s75, 0xfff80000
s_mov_b32 s75, 0x20000000
s_mov_b32 s78, 0x20000000
s_mov_b32 s62, 7
s_mov_b32 s70, 2
s_mov_b32 s76, 1
s_mov_b32 s79, 0x2
s_mov_b32 s3, 0x23
s_branch S_item
S_last:
v_mfma_f32_16x16x32_bf16 v[112:115], v[32:35], a[208:211], v[148:151]
s_cbranch_vccnz B_rare0z
B_ret0z:
v_mfma_f32_16x16x32_bf16 v[116:119], v[36:39], a[208:211], v[148:151]
v_exp_f32 v96, v96
v_mfma_f32_16x16x32_bf16 v[112:115], v[40:43], a[212:215], v[112:115]
v_exp_f32 v97, v97
v_mfma_f32_16x16x32_bf16 v[116:119], v[44:47], a[212:215], v[116:119]
v_exp_f32 v98, v98
v_mfma_f32_16x16x32_bf16 v[112:115], v[48:51], a[216:219], v[112:115]
v_cvt_pk_bf16_f32 v128, v96, v97
v_mfma_f32_16x16x32_bf16 v[116:119], v[52:55], a[216:219], v[116:119]
v_exp_f32 v99, v99
v_mfma_f32_16x16x32_bf16 v[112:115], v[56:59], a[220:223], v[112:115]
v_exp_f32 v100, v100
v_mfma_f32_16x16x32_bf16 v[116:119], v[60:63], a[220:223], v[116:119]
v_cvt_pk_bf16_f32 v129, v98, v99
v_mfma_f32_16x16x32_bf16 a[64:67], v[64:67], v[136:139], a[64:67]
v_exp_f32 v101, v101
v_mfma_f32_16x16x32_bf16 a[68:71], v[68:71], v[136:139], a[68:71]
v_exp_f32 v102, v102
v_mfma_f32_16x16x32_bf16 a[72:75], v[72:75], v[136:139], a[72:75]
v_exp_f32 v103, v103
v_mfma_f32_16x16x32_bf16 a[76:79], v[76:79], v[136:139], a[76:79]
v_cvt_pk_bf16_f32 v130, v100, v101
v_mfma_f32_16x16x32_bf16 a[80:83], v[80:83], v[136:139], a[80:83]
v_max3_f32 v30, v112, v113, v114
v_mfma_f32_16x16x32_bf16 a[84:87], v[84:87], v[136:139], a[84:87]
v_max3_f32 v30, v30, v115, v116
v_mfma_f32_16x16x32_bf16 a[88:91], v[88:91], v[136:139], a[88:91]
v_max3_f32 v30, v30, v117, v118
v_mfma_f32_16x16x32_bf16 a[92:95], v[92:95], v[136:139], a[92:95]
v_max_f32 v30, v30, v119
v_cmp_lt_f32 vcc, s68, v30
v_mfma_f32_16x16x32_bf16 v[140:143], v[252:255], v[136:139], v[140:143]
v_cvt_pk_bf16_f32 v131, v102, v103
s_waitcnt vmcnt(16)
v_mfma_f32_16x16x32_bf16 v[96:99], v[32:35], a[224:227], v[152:155]
s_cbranch_vccnz B_rare1z
B_ret1z:
ds_read_b64_tr_b16 v[64:65], v14 offset:8192
ds_read_b64_tr_b16 v[66:67], v14 offset:12288
v_mfma_f32_16x16x32_bf16 v[100:103], v[36:39], a[224:227], v[152:155]
ds_read_b64_tr_b16 v[68:69], v15 offset:8192
ds_read_b64_tr_b16 v[70:71], v15 offset:12288
v_mfma_f32_16x16x32_bf16 v[96:99], v[40:43], a[228:231], v[96:99]
ds_read_b64_tr_b16 v[72:73], v16 offset:8192
ds_read_b64_tr_b16 v[74:75], v16 offset:12288
v_exp_f32 v112, v112
v_mfma_f32_16x16x32_bf16 v[100:103], v[44:47], a[228:231], v[100:103]
ds_read_b64_tr_b16 v[76:77], v17 offset:8192
ds_read_b64_tr_b16 v[78:79], v17 offset:12288
v_exp_f32 v113, v113
v_mfma_f32_16x16x32_bf16 v[96:99], v[48:51], a[232:235], v[96:99]
ds_read_b64_tr_b16 v[80:81], v18 offset:8192
ds_read_b64_tr_b16 v[82:83], v18 offset:12288
v_exp_f32 v114, v114
v_mfma_f32_16x16x32_bf16 v[100:103], v[52:55], a[232:235], v[100:103]
ds_read_b64_tr_b16 v[84:85], v19 offset:8192
ds_read_b64_tr_b16 v[86:87], v19 offset:12288
v_cvt_pk_bf16_f32 v136, v112, v113
v_mfma_f32_16x16x32_bf16 v[96:99], v[56:59], a[236:239], v[96:99]
ds_read_b64_tr_b16 v[88:89], v20 offset:8192
ds_read_b64_tr_b16 v[90:91], v20 offset:12288
v_exp_f32 v115, v115
v_mfma_f32_16x16x32_bf16 v[100:103], v[60:63], a[236:239], v[100:103]
ds_read_b64_tr_b16 v[92:93], v21 offset:8192
ds_read_b64_tr_b16 v[94:95], v21 offset:12288
s_waitcnt vmcnt(8)
s_waitcnt lgkmcnt(12)
v_mfma_f32_16x16x32_bf16 a[0:3], v[64:67], v[128:131], a[0:3]
ds_read_b128 v[32:35], v10 offset:16384
v_exp_f32 v116, v116
v_mfma_f32_16x16x32_bf16 a[4:7], v[68:71], v[128:131], a[4:7]
ds_read_b128 v[36:39], v10 offset:20480
v_cvt_pk_bf16_f32 v137, v114, v115
s_waitcnt lgkmcnt(10)
v_mfma_f32_16x16x32_bf16 a[8:11], v[72:75], v[128:131], a[8:11]
ds_read_b128 v[40:43], v11 offset:16384
v_exp_f32 v117, v117
v_mfma_f32_16x16x32_bf16 a[12:15], v[76:79], v[128:131], a[12:15]
ds_read_b128 v[44:47], v11 offset:20480
v_exp_f32 v118, v118
s_waitcnt lgkmcnt(8)
v_mfma_f32_16x16x32_bf16 a[16:19], v[80:83], v[128:131], a[16:19]
ds_read_b128 v[48:51], v12 offset:16384
v_max3_f32 v30, v96, v97, v98
v_mfma_f32_16x16x32_bf16 a[20:23], v[84:87], v[128:131], a[20:23]
ds_read_b128 v[52:55], v12 offset:20480
v_max3_f32 v30, v30, v99, v100
s_waitcnt lgkmcnt(6)
v_mfma_f32_16x16x32_bf16 a[24:27], v[88:91], v[128:131], a[24:27]
ds_read_b128 v[56:59], v13 offset:16384
v_max3_f32 v30, v30, v101, v102
v_mfma_f32_16x16x32_bf16 a[28:31], v[92:95], v[128:131], a[28:31]
ds_read_b128 v[60:63], v13 offset:20480
v_exp_f32 v119, v119
v_max_f32 v30, v30, v103
v_mfma_f32_16x16x32_bf16 v[22:25], v[252:255], v[128:131], v[22:25]
v_cvt_pk_bf16_f32 v138, v116, v117
v_cvt_pk_bf16_f32 v139, v118, v119
v_cmp_lt_f32 vcc, s68, v30
s_waitcnt lgkmcnt(6)
v_mfma_f32_16x16x32_bf16 v[112:115], v[32:35], a[192:195], v[144:147]
s_cbranch_vccnz B_rare2z
B_ret2z:
v_mfma_f32_16x16x32_bf16 v[116:119], v[36:39], a[192:195], v[144:147]
s_waitcnt lgkmcnt(4)
v_mfma_f32_16x16x32_bf16 v[112:115], v[40:43], a[196:199], v[112:115]
v_exp_f32 v96, v96
v_mfma_f32_16x16x32_bf16 v[116:119], v[44:47], a[196:199], v[116:119]
v_exp_f32 v97, v97
s_waitcnt lgkmcnt(2)
v_mfma_f32_16x16x32_bf16 v[112:115], v[48:51], a[200:203], v[112:115]
v_exp_f32 v98, v98
v_mfma_f32_16x16x32_bf16 v[116:119], v[52:55], a[200:203], v[116:119]
v_cvt_pk_bf16_f32 v128, v96, v97
s_waitcnt lgkmcnt(0)
v_mfma_f32_16x16x32_bf16 v[112:115], v[56:59], a[204:207], v[112:115]
v_exp_f32 v99, v99
v_mfma_f32_16x16x32_bf16 v[116:119], v[60:63], a[204:207], v[116:119]
v_exp_f32 v100, v100
v_mfma_f32_16x16x32_bf16 a[32:35], v[64:67], v[136:139], a[32:35]
v_cvt_pk_bf16_f32 v129, v98, v99
v_mfma_f32_16x16x32_bf16 a[36:39], v[68:71], v[136:139], a[36:39]
v_exp_f32 v101, v101
v_mfma_f32_16x16x32_bf16 a[40:43], v[72:75], v[136:139], a[40:43]
v_exp_f32 v102, v102
v_mfma_f32_16x16x32_bf16 a[44:47], v[76:79], v[136:139], a[44:47]
v_exp_f32 v103, v103
v_mfma_f32_16x16x32_bf16 a[48:51], v[80:83], v[136:139], a[48:51]
v_max3_f32 v30, v112, v113, v114
v_mfma_f32_16x16x32_bf16 a[52:55], v[84:87], v[136:139], a[52:55]
v_max3_f32 v30, v30, v115, v116
v_mfma_f32_16x16x32_bf16 a[56:59], v[88:91], v[136:139], a[56:59]
v_max3_f32 v30, v30, v117, v118
v_mfma_f32_16x16x32_bf16 a[60:63], v[92:95], v[136:139], a[60:63]
v_cvt_pk_bf16_f32 v130, v100, v101
v_max_f32 v30, v30, v119
v_mfma_f32_16x16x32_bf16 v[26:29], v[252:255], v[136:139], v[26:29]
v_cvt_pk_bf16_f32 v131, v102, v103
v_cmp_lt_f32 vcc, s68, v30
v_mfma_f32_16x16x32_bf16 v[96:99], v[32:35], a[208:211], v[148:151]
s_cbranch_vccnz B_rare3z
B_ret3z:
v_mfma_f32_16x16x32_bf16 v[100:103], v[36:39], a[208:211], v[148:151]
v_exp_f32 v112, v112
v_mfma_f32_16x16x32_bf16 v[96:99], v[40:43], a[212:215], v[96:99]
v_exp_f32 v113, v113
v_mfma_f32_16x16x32_bf16 v[100:103], v[44:47], a[212:215], v[100:103]
v_exp_f32 v114, v114
v_mfma_f32_16x16x32_bf16 v[96:99], v[48:51], a[216:219], v[96:99]
v_cvt_pk_bf16_f32 v136, v112, v113
v_mfma_f32_16x16x32_bf16 v[100:103], v[52:55], a[216:219], v[100:103]
v_exp_f32 v115, v115
v_mfma_f32_16x16x32_bf16 v[96:99], v[56:59], a[220:223], v[96:99]
v_exp_f32 v116, v116
v_mfma_f32_16x16x32_bf16 v[100:103], v[60:63], a[220:223], v[100:103]
v_cvt_pk_bf16_f32 v137, v114, v115
v_mfma_f32_16x16x32_bf16 a[64:67], v[64:67], v[128:131], a[64:67]
v_exp_f32 v117, v117
v_mfma_f32_16x16x32_bf16 a[68:71], v[68:71], v[128:131], a[68:71]
v_exp_f32 v118, v118
v_mfma_f32_16x16x32_bf16 a[72:75], v[72:75], v[128:131], a[72:75]
v_exp_f32 v119, v119
v_mfma_f32_16x16x32_bf16 a[76:79], v[76:79], v[128:131], a[76:79]
v_cvt_pk_bf16_f32 v138, v116, v117
v_mfma_f32_16x16x32_bf16 a[80:83], v[80:83], v[128:131], a[80:83]
v_max3_f32 v30, v96, v97, v98
v_mfma_f32_16x16x32_bf16 a[84:87], v[84:87], v[128:131], a[84:87]
v_max3_f32 v30, v30, v99, v100
v_mfma_f32_16x16x32_bf16 a[88:91], v[88:91], v[128:131], a[88:91]
v_max3_f32 v30, v30, v101, v102
v_mfma_f32_16x16x32_bf16 a[92:95], v[92:95], v[128:131], a[92:95]
v_max_f32 v30, v30, v103
v_cmp_lt_f32 vcc, s68, v30
v_mfma_f32_16x16x32_bf16 v[140:143], v[252:255], v[128:131], v[140:143]
v_cvt_pk_bf16_f32 v139, v118, v119
s_waitcnt vmcnt(0)
v_mfma_f32_16x16x32_bf16 v[112:115], v[32:35], a[224:227], v[152:155]
s_cbranch_vccnz B_rare4z
B_ret4z:
ds_read_b64_tr_b16 v[64:65], v14 offset:24576
ds_read_b64_tr_b16 v[66:67], v14 offset:28672
v_mfma_f32_16x16x32_bf16 v[116:119], v[36:39], a[224:227], v[152:155]
ds_read_b64_tr_b16 v[68:69], v15 offset:24576
ds_read_b64_tr_b16 v[70:71], v15 offset:28672
v_mfma_f32_16x16x32_bf16 v[112:115], v[40:43], a[228:231], v[112:115]
ds_read_b64_tr_b16 v[72:73], v16 offset:24576
ds_read_b64_tr_b16 v[74:75], v16 offset:28672
v_mfma_f32_16x16x32_bf16 v[116:119], v[44:47], a[228:231], v[116:119]
ds_read_b64_tr_b16 v[76:77], v17 offset:24576
ds_read_b64_tr_b16 v[78:79], v17 offset:28672
v_mfma_f32_16x16x32_bf16 v[112:115], v[48:51], a[232:235], v[112:115]
ds_read_b64_tr_b16 v[80:81], v18 offset:24576
ds_read_b64_tr_b16 v[82:83], v18 offset:28672
v_mfma_f32_16x16x32_bf16 v[116:119], v[52:55], a[232:235], v[116:119]
ds_read_b64_tr_b16 v[84:85], v19 offset:24576
ds_read_b64_tr_b16 v[86:87], v19 offset:28672
v_mfma_f32_16x16x32_bf16 v[112:115], v[56:59], a[236:239], v[112:115]
ds_read_b64_tr_b16 v[88:89], v20 offset:24576
ds_read_b64_tr_b16 v[90:91], v20 offset:28672
v_mfma_f32_16x16x32_bf16 v[116:119], v[60:63], a[236:239], v[116:119]
ds_read_b64_tr_b16 v[92:93], v21 offset:24576
ds_read_b64_tr_b16 v[94:95], v21 offset:28672
s_waitcnt lgkmcnt(12)
v_mfma_f32_16x16x32_bf16 a[0:3], v[64:67], v[136:139], a[0:3]
v_exp_f32 v96, v96
v_exp_f32 v97, v97
v_mfma_f32_16x16x32_bf16 a[4:7], v[68:71], v[136:139], a[4:7]
v_exp_f32 v98, v98
s_waitcnt lgkmcnt(8)
v_mfma_f32_16x16x32_bf16 a[8:11], v[72:75], v[136:139], a[8:11]
v_cvt_pk_bf16_f32 v128, v96, v97
v_exp_f32 v99, v99
v_mfma_f32_16x16x32_bf16 a[12:15], v[76:79], v[136:139], a[12:15]
v_exp_f32 v100, v100
s_waitcnt lgkmcnt(4)
v_mfma_f32_16x16x32_bf16 a[16:19], v[80:83], v[136:139], a[16:19]
v_cvt_pk_bf16_f32 v129, v98, v99
v_max3_f32 v30, v112, v113, v114
v_mfma_f32_16x16x32_bf16 a[20:23], v[84:87], v[136:139], a[20:23]
v_exp_f32 v101, v101
v_max3_f32 v30, v30, v115, v116
s_waitcnt lgkmcnt(0)
v_mfma_f32_16x16x32_bf16 a[24:27], v[88:91], v[136:139], a[24:27]
v_exp_f32 v102, v102
v_max3_f32 v30, v30, v117, v118
v_mfma_f32_16x16x32_bf16 a[28:31], v[92:95], v[136:139], a[28:31]
v_exp_f32 v103, v103
v_max_f32 v30, v30, v119
v_mfma_f32_16x16x32_bf16 v[22:25], v[252:255], v[136:139], v[22:25]
v_cvt_pk_bf16_f32 v130, v100, v101
v_cvt_pk_bf16_f32 v131, v102, v103
v_cmp_lt_f32 vcc, s68, v30
s_nop 0
v_mfma_f32_16x16x32_bf16 a[32:35], v[64:67], v[128:131], a[32:35]
s_cbranch_vccnz B_rare5z
B_ret5z:
v_exp_f32 v112, v112
v_mfma_f32_16x16x32_bf16 a[36:39], v[68:71], v[128:131], a[36:39]
v_exp_f32 v113, v113
v_exp_f32 v114, v114
v_mfma_f32_16x16x32_bf16 a[40:43], v[72:75], v[128:131], a[40:43]
ds_write_b128 v200, a[8:11] offset:0
v_cvt_pk_bf16_f32 v136, v112, v113
v_mfma_f32_16x16x32_bf16 a[44:47], v[76:79], v[128:131], a[44:47]
ds_write_b128 v200, a[12:15] offset:1024
v_exp_f32 v115, v115
v_mfma_f32_16x16x32_bf16 a[48:51], v[80:83], v[128:131], a[48:51]
ds_write_b128 v200, a[16:19] offset:2048
v_exp_f32 v116, v116
v_mfma_f32_16x16x32_bf16 a[52:55], v[84:87], v[128:131], a[52:55]
ds_write_b128 v200, a[20:23] offset:3072
v_cvt_pk_bf16_f32 v137, v114, v115
v_mfma_f32_16x16x32_bf16 a[56:59], v[88:91], v[128:131], a[56:59]
ds_write_b128 v200, a[24:27] offset:4096
v_exp_f32 v117, v117
v_mfma_f32_16x16x32_bf16 a[60:63], v[92:95], v[128:131], a[60:63]
ds_write_b128 v200, a[28:31] offset:5120
v_exp_f32 v118, v118
v_mfma_f32_16x16x32_bf16 v[26:29], v[252:255], v[128:131], v[26:29]
v_exp_f32 v119, v119
v_cvt_pk_bf16_f32 v138, v116, v117
v_cvt_pk_bf16_f32 v139, v118, v119
s_nop 1
v_mfma_f32_16x16x32_bf16 v[140:143], v[252:255], v[136:139], v[140:143]
v_mfma_f32_16x16x32_bf16 a[64:67], v[64:67], v[136:139], a[64:67]
v_mfma_f32_16x16x32_bf16 a[68:71], v[68:71], v[136:139], a[68:71]
ds_write_b128 v200, a[40:43] offset:6144
v_mfma_f32_16x16x32_bf16 a[72:75], v[72:75], v[136:139], a[72:75]
ds_write_b128 v200, a[44:47] offset:7168
v_mfma_f32_16x16x32_bf16 a[76:79], v[76:79], v[136:139], a[76:79]
ds_write_b128 v200, a[48:51] offset:8192
v_mfma_f32_16x16x32_bf16 a[80:83], v[80:83], v[136:139], a[80:83]
ds_write_b128 v200, a[52:55] offset:9216
v_mfma_f32_16x16x32_bf16 a[84:87], v[84:87], v[136:139], a[84:87]
ds_write_b128 v200, a[56:59] offset:10240
v_mfma_f32_16x16x32_bf16 a[88:91], v[88:91], v[136:139], a[88:91]
ds_write_b128 v200, a[60:63] offset:11264
v_mfma_f32_16x16x32_bf16 a[92:95], v[92:95], v[136:139], a[92:95]
v_mov_b32 v145, v22
v_mov_b32 v149, v26
v_mov_b32 v153, v140
ds_write_b64 v209, v[144:145] offset:18432
ds_write_b64 v209, v[148:149] offset:18944
ds_write_b64 v209, v[152:153] offset:19456
ds_write_b128 v200, a[72:75] offset:12288
ds_write_b128 v200, a[76:79] offset:13312
ds_write_b128 v200, a[80:83] offset:14336
ds_write_b128 v200, a[84:87] offset:15360
ds_write_b128 v200, a[88:91] offset:16384
ds_write_b128 v200, a[92:95] offset:17408
v_accvgpr_read_b32 v112, a64
v_accvgpr_read_b32 v113, a65
v_accvgpr_read_b32 v114, a66
v_accvgpr_read_b32 v115, a67
v_accvgpr_read_b32 v116, a68
v_accvgpr_read_b32 v117, a69
v_accvgpr_read_b32 v118, a70
v_accvgpr_read_b32 v119, a71
v_accvgpr_read_b32 v104, a32
v_accvgpr_read_b32 v105, a33
v_accvgpr_read_b32 v106, a34
v_accvgpr_read_b32 v107, a35
v_accvgpr_read_b32 v108, a36
v_accvgpr_read_b32 v109, a37
v_accvgpr_read_b32 v110, a38
v_accvgpr_read_b32 v111, a39
v_accvgpr_read_b32 v96, a0
v_accvgpr_read_b32 v97, a1
v_accvgpr_read_b32 v98, a2
v_accvgpr_read_b32 v99, a3
v_accvgpr_read_b32 v100, a4
v_accvgpr_read_b32 v101, a5
v_accvgpr_read_b32 v102, a6
v_accvgpr_read_b32 v103, a7
s_lshl_b32 s65, s56, 10
s_waitcnt lgkmcnt(0)
s_barrier
ds_read_b64 v[146:147], v210 offset:18432
ds_read_b64 v[168:169], v211 offset:18432
ds_read_b64 v[170:171], v212 offset:18432
ds_read_b64 v[150:151], v210 offset:18944
ds_read_b64 v[172:173], v211 offset:18944
ds_read_b64 v[174:175], v212 offset:18944
ds_read_b64 v[154:155], v210 offset:19456
ds_read_b64 v[176:177], v211 offset:19456
ds_read_b64 v[178:179], v212 offset:19456
ds_read_b128 v[32:35], v201 offset:0
ds_read_b128 v[36:39], v201 offset:1024
ds_read_b128 v[40:43], v202 offset:2048
ds_read_b128 v[44:47], v202 offset:3072
ds_read_b128 v[48:51], v203 offset:4096
ds_read_b128 v[52:55], v203 offset:5120
ds_read_b128 v[120:123], v201 offset:6144
ds_read_b128 v[124:127], v201 offset:7168
ds_read_b128 v[128:131], v202 offset:8192
ds_read_b128 v[132:135], v202 offset:9216
ds_read_b128 v[136:139], v203 offset:10240
ds_read_b128 v[140:143], v203 offset:11264
ds_read_b128 v[56:59], v201 offset:12288
ds_read_b128 v[60:63], v201 offset:13312
ds_read_b128 v[180:183], v202 offset:14336
ds_read_b128 v[184:187], v202 offset:15360
ds_read_b128 v[188:191], v203 offset:16384
ds_read_b128 v[192:195], v203 offset:17408
s_waitcnt lgkmcnt(15)
v_min3_f32 v240, v144, v146, v168
v_min3_f32 v241, v148, v150, v172
v_min3_f32 v242, v152, v154, v176
v_min_f32 v240, v240, v170
v_min_f32 v241, v241, v174
v_min_f32 v242, v242, v178
v_sub_f32 v144, v240, v144
v_sub_f32 v146, v240, v146
v_sub_f32 v168, v240, v168
v_sub_f32 v170, v240, v170
v_sub_f32 v148, v241, v148
v_sub_f32 v150, v241, v150
v_sub_f32 v172, v241, v172
v_sub_f32 v174, v241, v174
v_sub_f32 v152, v242, v152
v_sub_f32 v154, v242, v154
v_sub_f32 v176, v242, v176
v_sub_f32 v178, v242, v178
v_exp_f32 v144, v144
v_exp_f32 v146, v146
v_exp_f32 v168, v168
v_exp_f32 v170, v170
v_exp_f32 v148, v148
v_exp_f32 v150, v150
v_exp_f32 v172, v172
v_exp_f32 v174, v174
v_exp_f32 v152, v152
v_exp_f32 v154, v154
v_exp_f32 v176, v176
v_exp_f32 v178, v178
v_mul_f32 v240, v144, v145
v_fmac_f32 v240, v146, v147
v_fmac_f32 v240, v168, v169
v_fmac_f32 v240, v170, v171
v_mul_f32 v241, v148, v149
v_fmac_f32 v241, v150, v151
v_fmac_f32 v241, v172, v173
v_fmac_f32 v241, v174, v175
v_mul_f32 v242, v152, v153
v_fmac_f32 v242, v154, v155
v_fmac_f32 v242, v176, v177
v_fmac_f32 v242, v178, v179
v_rcp_f32 v240, v240
v_rcp_f32 v241, v241
v_rcp_f32 v242, v242
v_mul_f32 v144, v144, v240
v_mul_f32 v146, v146, v240
v_mul_f32 v168, v168, v240
v_mul_f32 v170, v170, v240
v_pk_mul_f32 v[96:97], v[96:97], v[144:145] op_sel_hi:[1,0]
v_pk_mul_f32 v[98:99], v[98:99], v[144:145] op_sel_hi:[1,0]
v_pk_mul_f32 v[100:101], v[100:101], v[144:145] op_sel_hi:[1,0]
v_pk_mul_f32 v[102:103], v[102:103], v[144:145] op_sel_hi:[1,0]
s_waitcnt lgkmcnt(12)
v_pk_fma_f32 v[96:97], v[32:33], v[146:147], v[96:97] op_sel_hi:[1,0,1]
v_pk_fma_f32 v[98:99], v[34:35], v[146:147], v[98:99] op_sel_hi:[1,0,1]
v_pk_fma_f32 v[100:101], v[36:37], v[146:147], v[100:101] op_sel_hi:[1,0,1]
v_pk_fma_f32 v[102:103], v[38:39], v[146:147], v[102:103] op_sel_hi:[1,0,1]
v_pk_fma_f32 v[96:97], v[40:41], v[168:169], v[96:97] op_sel_hi:[1,0,1]
v_pk_fma_f32 v[98:99], v[42:43], v[168:169], v[98:99] op_sel_hi:[1,0,1]
v_pk_fma_f32 v[100:101], v[44:45], v[168:169], v[100:101] op_sel_hi:[1,0,1]
v_pk_fma_f32 v[102:103], v[46:47], v[168:169], v[102:103] op_sel_hi:[1,0,1]
v_pk_fma_f32 v[96:97], v[48:49], v[170:171], v[96:97] op_sel_hi:[1,0,1]
v_pk_fma_f32 v[98:99], v[50:51], v[170:171], v[98:99] op_sel_hi:[1,0,1]
v_pk_fma_f32 v[100:101], v[52:53], v[170:171], v[100:101] op_sel_hi:[1,0,1]
v_pk_fma_f32 v[102:103], v[54:55], v[170:171], v[102:103] op_sel_hi:[1,0,1]
v_cvt_pk_bf16_f32 v96, v96, v97
v_cvt_pk_bf16_f32 v97, v98, v99
v_cvt_pk_bf16_f32 v98, v100, v101
v_cvt_pk_bf16_f32 v99, v102, v103
buffer_store_dwordx4 v[96:99], v213, s[48:51], s65 offen sc1
s_add_u32 s65, s65, 4096
v_mul_f32 v148, v148, v241
v_mul_f32 v150, v150, v241
v_mul_f32 v172, v172, v241
v_mul_f32 v174, v174, v241
v_pk_mul_f32 v[104:105], v[104:105], v[148:149] op_sel_hi:[1,0]
v_pk_mul_f32 v[106:107], v[106:107], v[148:149] op_sel_hi:[1,0]
v_pk_mul_f32 v[108:109], v[108:109], v[148:149] op_sel_hi:[1,0]
v_pk_mul_f32 v[110:111], v[110:111], v[148:149] op_sel_hi:[1,0]
s_waitcnt lgkmcnt(6)
v_pk_fma_f32 v[104:105], v[120:121], v[150:151], v[104:105] op_sel_hi:[1,0,1]
v_pk_fma_f32 v[106:107], v[122:123], v[150:151], v[106:107] op_sel_hi:[1,0,1]
v_pk_fma_f32 v[108:109], v[124:125], v[150:151], v[108:109] op_sel_hi:[1,0,1]
v_pk_fma_f32 v[110:111], v[126:127], v[150:151], v[110:111] op_sel_hi:[1,0,1]
v_pk_fma_f32 v[104:105], v[128:129], v[172:173], v[104:105] op_sel_hi:[1,0,1]
v_pk_fma_f32 v[106:107], v[130:131], v[172:173], v[106:107] op_sel_hi:[1,0,1]
v_pk_fma_f32 v[108:109], v[132:133], v[172:173], v[108:109] op_sel_hi:[1,0,1]
v_pk_fma_f32 v[110:111], v[134:135], v[172:173], v[110:111] op_sel_hi:[1,0,1]
v_pk_fma_f32 v[104:105], v[136:137], v[174:175], v[104:105] op_sel_hi:[1,0,1]
v_pk_fma_f32 v[106:107], v[138:139], v[174:175], v[106:107] op_sel_hi:[1,0,1]
v_pk_fma_f32 v[108:109], v[140:141], v[174:175], v[108:109] op_sel_hi:[1,0,1]
v_pk_fma_f32 v[110:111], v[142:143], v[174:175], v[110:111] op_sel_hi:[1,0,1]
v_cvt_pk_bf16_f32 v104, v104, v105
v_cvt_pk_bf16_f32 v105, v106, v107
v_cvt_pk_bf16_f32 v106, v108, v109
v_cvt_pk_bf16_f32 v107, v110, v111
buffer_store_dwordx4 v[104:107], v213, s[48:51], s65 offen sc1
s_add_u32 s65, s65, 4096
v_mul_f32 v152, v152, v242
v_mul_f32 v154, v154, v242
v_mul_f32 v176, v176, v242
v_mul_f32 v178, v178, v242
v_pk_mul_f32 v[112:113], v[112:113], v[152:153] op_sel_hi:[1,0]
v_pk_mul_f32 v[114:115], v[114:115], v[152:153] op_sel_hi:[1,0]
v_pk_mul_f32 v[116:117], v[116:117], v[152:153] op_sel_hi:[1,0]
v_pk_mul_f32 v[118:119], v[118:119], v[152:153] op_sel_hi:[1,0]
s_waitcnt lgkmcnt(0)
v_pk_fma_f32 v[112:113], v[56:57], v[154:155], v[112:113] op_sel_hi:[1,0,1]
v_pk_fma_f32 v[114:115], v[58:59], v[154:155], v[114:115] op_sel_hi:[1,0,1]
v_pk_fma_f32 v[116:117], v[60:61], v[154:155], v[116:117] op_sel_hi:[1,0,1]
v_pk_fma_f32 v[118:119], v[62:63], v[154:155], v[118:119] op_sel_hi:[1,0,1]
v_pk_fma_f32 v[112:113], v[180:181], v[176:177], v[112:113] op_sel_hi:[1,0,1]
v_pk_fma_f32 v[114:115], v[182:183], v[176:177], v[114:115] op_sel_hi:[1,0,1]
v_pk_fma_f32 v[116:117], v[184:185], v[176:177], v[116:117] op_sel_hi:[1,0,1]
v_pk_fma_f32 v[118:119], v[186:187], v[176:177], v[118:119] op_sel_hi:[1,0,1]
v_pk_fma_f32 v[112:113], v[188:189], v[178:179], v[112:113] op_sel_hi:[1,0,1]
v_pk_fma_f32 v[114:115], v[190:191], v[178:179], v[114:115] op_sel_hi:[1,0,1]
v_pk_fma_f32 v[116:117], v[192:193], v[178:179], v[116:117] op_sel_hi:[1,0,1]
v_pk_fma_f32 v[118:119], v[194:195], v[178:179], v[118:119] op_sel_hi:[1,0,1]
v_cvt_pk_bf16_f32 v112, v112, v113
v_cvt_pk_bf16_f32 v113, v114, v115
v_cvt_pk_bf16_f32 v114, v116, v117
v_cvt_pk_bf16_f32 v115, v118, v119
buffer_store_dwordx4 v[112:115], v213, s[48:51], s65 offen sc1
v_mov_b32 v248, 1
v_mov_b32 v249, 1
v_mov_b32 v250, 1
v_mov_b32 v251, 1
s_waitcnt vmcnt(0)
s_barrier
s_cmp_lg_u32 s56, 0
s_cbranch_scc1 S_nosig
s_mov_b64 exec, 1
global_store_dwordx4 v216, v[248:251], s[98:99] sc1
s_mov_b64 exec, -1
S_nosig:
s_branch L_fin
B_hookm:
s_cmp_eq_u32 s73, 0
s_cbranch_scc1 B_ev1
s_cmp_eq_u32 s73, 1
s_cbranch_scc1 B_ev3
s_cmp_eq_u32 s73, 5
s_cbranch_scc1 B_ev11
s_branch B_hookret1
B_hook:
s_mov_b32 s64, s73
s_cmp_eq_u32 s64, 1
s_cbranch_scc1 B_ev2
s_cmp_eq_u32 s64, 4
s_cbranch_scc1 B_hook4
s_cmp_eq_u32 s64, 5
s_cbranch_scc1 B_hook5
s_cmp_eq_u32 s64, 6
s_cbranch_scc1 B_hook6
s_cmp_eq_u32 s64, 7
s_cbranch_scc1 B_hook7
v_mov_b32 v31, 0
global_load_dword v31, v31, s[26:27] sc1
s_branch B_hookret
B_hook4:
s_mov_b32 s31, 0x200000
ic_4:
v_readfirstlane_b32 s64, v31
s_nop 0
s_cmp_lg_u32 s64, 0
s_cbranch_scc1 icok_5
s_sleep 8
v_mov_b32 v31, 0
global_load_dword v31, v31, s[26:27] sc1
s_waitcnt vmcnt(0)
s_sub_u32 s31, s31, 1
s_cbranch_scc0 ic_4
icok_5:
s_mov_b64 exec, 0xff
global_load_dwordx4 v[248:251], v218, s[98:99] sc1
s_mov_b64 exec, -1
s_branch B_hookret
B_hook5:
s_mov_b64 s[96:97], vcc
v_min3_u32 v248, v248, v249, v250
v_min_u32 v248, v248, v251
v_cmp_ne_u32 vcc, 0, v248
s_nop 0
s_andn2_b32 s64, 0xff, vcc_lo
s_cbranch_scc0 B_hook5b
s_mov_b32 s31, 0x200000
poll_6:
s_mov_b64 exec, 0xff
global_load_dwordx4 v[248:251], v218, s[98:99] sc1
s_mov_b64 exec, -1
pollw_8:
s_waitcnt vmcnt(0)
v_min3_u32 v248, v248, v249, v250
v_min_u32 v248, v248, v251
v_cmp_ne_u32 vcc, 0, v248
s_nop 0
s_andn2_b32 s64, 0xff, vcc_lo
s_cbranch_scc0 polled_7
s_sleep 4
s_sub_u32 s31, s31, 1
s_cbranch_scc0 poll_6
polled_7:
B_hook5b:
s_lshl_b32 s64, s56, 10
buffer_load_dwordx4 a[240:243], v213, s[32:35], s64 offen sc1
s_add_u32 s64, s64, 4096
buffer_load_dwordx4 a[244:247], v213, s[32:35], s64 offen sc1
s_add_u32 s64, s64, 4096
buffer_load_dwordx4 a[248:251], v213, s[32:35], s64 offen sc1
s_mov_b64 vcc, s[96:97]
s_branch B_hookret
B_hook6:
ds_write_b128 v200, a[240:243] offset:35840
ds_write_b128 v200, a[244:247] offset:36864
ds_write_b128 v200, a[248:251] offset:37888
s_waitcnt lgkmcnt(0)
s_branch B_hookret
B_hook7:
s_barrier
s_branch B_hookret
B_ev1:
s_barrier
ds_write_b128 v200, a[104:107] offset:32768
ds_write_b128 v200, a[108:111] offset:33792
ds_write_b128 v200, a[112:115] offset:34816
ds_write_b128 v200, a[116:119] offset:35840
ds_write_b128 v200, a[120:123] offset:36864
ds_write_b128 v200, a[124:127] offset:37888
ds_write_b64 v209, v[156:157] offset:38912
ds_write_b64 v209, v[160:161] offset:39424
ds_write_b64 v209, v[164:165] offset:39936
s_lshl_b32 s77, s56, 10
s_waitcnt lgkmcnt(0)
s_barrier
ds_read_b64 v[158:159], v210 offset:38912
ds_read_b64 v[168:169], v211 offset:38912
ds_read_b64 v[170:171], v212 offset:38912
ds_read_b64 v[162:163], v210 offset:39424
ds_read_b64 v[172:173], v211 offset:39424
ds_read_b64 v[174:175], v212 offset:39424
ds_read_b64 v[166:167], v210 offset:39936
ds_read_b64 v[176:177], v211 offset:39936
ds_read_b64 v[178:179], v212 offset:39936
ds_read_b128 v[224:227], v201 offset:32768
ds_read_b128 v[228:231], v201 offset:33792
ds_read_b128 v[232:235], v202 offset:34816
ds_read_b128 v[236:239], v202 offset:35840
ds_read_b128 v[120:123], v203 offset:36864
ds_read_b128 v[124:127], v203 offset:37888
s_waitcnt lgkmcnt(6)
v_min3_f32 v196, v156, v158, v168
v_min3_f32 v197, v160, v162, v172
v_min3_f32 v198, v164, v166, v176
v_min_f32 v196, v196, v170
v_min_f32 v197, v197, v174
v_min_f32 v198, v198, v178
v_sub_f32 v156, v196, v156
v_sub_f32 v158, v196, v158
v_sub_f32 v168, v196, v168
v_sub_f32 v170, v196, v170
v_sub_f32 v160, v197, v160
v_sub_f32 v162, v197, v162
v_sub_f32 v172, v197, v172
v_sub_f32 v174, v197, v174
v_sub_f32 v164, v198, v164
v_sub_f32 v166, v198, v166
v_sub_f32 v176, v198, v176
v_sub_f32 v178, v198, v178
v_exp_f32 v156, v156
v_exp_f32 v158, v158
v_exp_f32 v168, v168
v_exp_f32 v170, v170
v_exp_f32 v160, v160
v_exp_f32 v162, v162
v_exp_f32 v172, v172
v_exp_f32 v174, v174
v_exp_f32 v164, v164
v_exp_f32 v166, v166
v_exp_f32 v176, v176
v_exp_f32 v178, v178
v_mul_f32 v196, v156, v157
v_fmac_f32 v196, v158, v159
v_fmac_f32 v196, v168, v169
v_fmac_f32 v196, v170, v171
v_mul_f32 v197, v160, v161
v_fmac_f32 v197, v162, v163
v_fmac_f32 v197, v172, v173
v_fmac_f32 v197, v174, v175
v_mul_f32 v198, v164, v165
v_fmac_f32 v198, v166, v167
v_fmac_f32 v198, v176, v177
v_fmac_f32 v198, v178, v179
v_rcp_f32 v196, v196
v_rcp_f32 v197, v197
v_rcp_f32 v198, v198
v_mul_f32 v156, v156, v196
v_mul_f32 v158, v158, v196
v_mul_f32 v168, v168, v196
v_mul_f32 v170, v170, v196
v_pk_mul_f32 v[180:181], v[180:181], v[156:157] op_sel_hi:[1,0]
v_pk_mul_f32 v[182:183], v[182:183], v[156:157] op_sel_hi:[1,0]
v_pk_mul_f32 v[184:185], v[184:185], v[156:157] op_sel_hi:[1,0]
v_pk_mul_f32 v[186:187], v[186:187], v[156:157] op_sel_hi:[1,0]
s_waitcnt lgkmcnt(0)
s_barrier
ds_write_b128 v200, a[136:139] offset:32768
ds_write_b128 v200, a[140:143] offset:33792
ds_write_b128 v200, a[144:147] offset:34816
ds_write_b128 v200, a[148:151] offset:35840
ds_write_b128 v200, a[152:155] offset:36864
ds_write_b128 v200, a[156:159] offset:37888
v_pk_fma_f32 v[180:181], v[224:225], v[158:159], v[180:181] op_sel_hi:[1,0,1]
v_pk_fma_f32 v[182:183], v[226:227], v[158:159], v[182:183] op_sel_hi:[1,0,1]
v_pk_fma_f32 v[184:185], v[228:229], v[158:159], v[184:185] op_sel_hi:[1,0,1]
v_pk_fma_f32 v[186:187], v[230:231], v[158:159], v[186:187] op_sel_hi:[1,0,1]
v_pk_fma_f32 v[180:181], v[232:233], v[168:169], v[180:181] op_sel_hi:[1,0,1]
v_pk_fma_f32 v[182:183], v[234:235], v[168:169], v[182:183] op_sel_hi:[1,0,1]
v_pk_fma_f32 v[184:185], v[236:237], v[168:169], v[184:185] op_sel_hi:[1,0,1]
v_pk_fma_f32 v[186:187], v[238:239], v[168:169], v[186:187] op_sel_hi:[1,0,1]
v_pk_fma_f32 v[180:181], v[120:121], v[170:171], v[180:181] op_sel_hi:[1,0,1]
v_pk_fma_f32 v[182:183], v[122:123], v[170:171], v[182:183] op_sel_hi:[1,0,1]
v_pk_fma_f32 v[184:185], v[124:125], v[170:171], v[184:185] op_sel_hi:[1,0,1]
v_pk_fma_f32 v[186:187], v[126:127], v[170:171], v[186:187] op_sel_hi:[1,0,1]
s_waitcnt lgkmcnt(0)
s_branch B_hookret1
B_ev2:
s_barrier
ds_read_b128 v[224:227], v201 offset:32768
ds_read_b128 v[228:231], v201 offset:33792
ds_read_b128 v[232:235], v202 offset:34816
ds_read_b128 v[236:239], v202 offset:35840
ds_read_b128 v[120:123], v203 offset:36864
ds_read_b128 v[124:127], v203 offset:37888
v_cvt_pk_bf16_f32 v180, v180, v181
v_cvt_pk_bf16_f32 v181, v182, v183
v_cvt_pk_bf16_f32 v182, v184, v185
v_cvt_pk_bf16_f32 v183, v186, v187
buffer_store_dwordx4 v[180:183], v213, s[48:51], s77 offen sc1 nt
s_add_u32 s77, s77, 4096
v_mul_f32 v160, v160, v197
v_mul_f32 v162, v162, v197
v_mul_f32 v172, v172, v197
v_mul_f32 v174, v174, v197
v_pk_mul_f32 v[188:189], v[188:189], v[160:161] op_sel_hi:[1,0]
v_pk_mul_f32 v[190:191], v[190:191], v[160:161] op_sel_hi:[1,0]
v_pk_mul_f32 v[192:193], v[192:193], v[160:161] op_sel_hi:[1,0]
v_pk_mul_f32 v[194:195], v[194:195], v[160:161] op_sel_hi:[1,0]
s_waitcnt lgkmcnt(0)
s_barrier
ds_write_b128 v200, a[168:171] offset:32768
ds_write_b128 v200, a[172:175] offset:33792
ds_write_b128 v200, a[176:179] offset:34816
ds_write_b128 v200, a[180:183] offset:35840
ds_write_b128 v200, a[184:187] offset:36864
ds_write_b128 v200, a[188:191] offset:37888
v_pk_fma_f32 v[188:189], v[224:225], v[162:163], v[188:189] op_sel_hi:[1,0,1]
v_pk_fma_f32 v[190:191], v[226:227], v[162:163], v[190:191] op_sel_hi:[1,0,1]
v_pk_fma_f32 v[192:193], v[228:229], v[162:163], v[192:193] op_sel_hi:[1,0,1]
v_pk_fma_f32 v[194:195], v[230:231], v[162:163], v[194:195] op_sel_hi:[1,0,1]
v_pk_fma_f32 v[188:189], v[232:233], v[172:173], v[188:189] op_sel_hi:[1,0,1]
v_pk_fma_f32 v[190:191], v[234:235], v[172:173], v[190:191] op_sel_hi:[1,0,1]
v_pk_fma_f32 v[192:193], v[236:237], v[172:173], v[192:193] op_sel_hi:[1,0,1]
v_pk_fma_f32 v[194:195], v[238:239], v[172:173], v[194:195] op_sel_hi:[1,0,1]
v_pk_fma_f32 v[188:189], v[120:121], v[174:175], v[188:189] op_sel_hi:[1,0,1]
v_pk_fma_f32 v[190:191], v[122:123], v[174:175], v[190:191] op_sel_hi:[1,0,1]
v_pk_fma_f32 v[192:193], v[124:125], v[174:175], v[192:193] op_sel_hi:[1,0,1]
v_pk_fma_f32 v[194:195], v[126:127], v[174:175], v[194:195] op_sel_hi:[1,0,1]
s_waitcnt lgkmcnt(0)
s_barrier
ds_read_b128 v[224:227], v201 offset:32768
ds_read_b128 v[228:231], v201 offset:33792
ds_read_b128 v[232:235], v202 offset:34816
ds_read_b128 v[236:239], v202 offset:35840
ds_read_b128 v[120:123], v203 offset:36864
ds_read_b128 v[124:127], v203 offset:37888
v_cvt_pk_bf16_f32 v188, v188, v189
v_cvt_pk_bf16_f32 v189, v190, v191
v_cvt_pk_bf16_f32 v190, v192, v193
v_cvt_pk_bf16_f32 v191, v194, v195
buffer_store_dwordx4 v[188:191], v213, s[48:51], s77 offen sc1 nt
s_add_u32 s77, s77, 4096
v_mul_f32 v164, v164, v198
v_mul_f32 v166, v166, v198
v_mul_f32 v176, v176, v198
v_mul_f32 v178, v178, v198
v_pk_mul_f32 v[104:105], v[104:105], v[164:165] op_sel_hi:[1,0]
v_pk_mul_f32 v[106:107], v[106:107], v[164:165] op_sel_hi:[1,0]
v_pk_mul_f32 v[108:109], v[108:109], v[164:165] op_sel_hi:[1,0]
v_pk_mul_f32 v[110:111], v[110:111], v[164:165] op_sel_hi:[1,0]
s_waitcnt lgkmcnt(0)
v_pk_fma_f32 v[104:105], v[224:225], v[166:167], v[104:105] op_sel_hi:[1,0,1]
v_pk_fma_f32 v[106:107], v[226:227], v[166:167], v[106:107] op_sel_hi:[1,0,1]
v_pk_fma_f32 v[108:109], v[228:229], v[166:167], v[108:109] op_sel_hi:[1,0,1]
v_pk_fma_f32 v[110:111], v[230:231], v[166:167], v[110:111] op_sel_hi:[1,0,1]
v_pk_fma_f32 v[104:105], v[232:233], v[176:177], v[104:105] op_sel_hi:[1,0,1]
v_pk_fma_f32 v[106:107], v[234:235], v[176:177], v[106:107] op_sel_hi:[1,0,1]
v_pk_fma_f32 v[108:109], v[236:237], v[176:177], v[108:109] op_sel_hi:[1,0,1]
v_pk_fma_f32 v[110:111], v[238:239], v[176:177], v[110:111] op_sel_hi:[1,0,1]
v_pk_fma_f32 v[104:105], v[120:121], v[178:179], v[104:105] op_sel_hi:[1,0,1]
v_pk_fma_f32 v[106:107], v[122:123], v[178:179], v[106:107] op_sel_hi:[1,0,1]
v_pk_fma_f32 v[108:109], v[124:125], v[178:179], v[108:109] op_sel_hi:[1,0,1]
v_pk_fma_f32 v[110:111], v[126:127], v[178:179], v[110:111] op_sel_hi:[1,0,1]
v_cvt_pk_bf16_f32 v104, v104, v105
v_cvt_pk_bf16_f32 v105, v106, v107
v_cvt_pk_bf16_f32 v106, v108, v109
v_cvt_pk_bf16_f32 v107, v110, v111
buffer_store_dwordx4 v[104:107], v213, s[48:51], s77 offen sc1 nt
s_branch B_hookret
B_ev3:
s_waitcnt vmcnt(16)
s_mov_b64 exec, 1
global_store_dword v216, v217, s[98:99] sc1
s_mov_b64 exec, -1
s_lshl_b32 s64, s60, 5
s_add_u32 s64, s64, s61
s_mul_i32 s64, s64, 12288
s_add_u32 s64, s64, 4194304
s_add_u32 s48, s28, s64
s_addc_u32 s49, s29, 0
s_mov_b32 s50, 12288
s_mov_b32 s51, 0x20000
s_lshl_b32 s64, s60, 5
s_add_u32 s64, s64, s61
s_add_u32 s64, s64, 512
s_lshl_b32 s64, s64, 5
s_add_u32 s64, s64, s56
s_lshl_b32 s64, s64, 2
v_mov_b32 v216, s64
v_mov_b32 v217, 1
s_branch B_hookret1
B_ev11:
s_lshl2_add_u32 s64, s59, s56
s_sub_u32 s64, s64, 0
s_cmp_ge_u32 s64, 1
s_cbranch_scc1 cp_9
s_getpc_b64 s[66:67]
cppc_10:
s_sub_u32 s66, s66, cppc_10-S_last
s_subb_u32 s67, s67, 0
s_lshl_b32 s64, s64, 13
v_lshl_add_u32 v222, v1, 7, s64
v_min_u32 v222, L_codeend-S_last-4, v222
global_load_dword v222, v222, s[66:67]
cp_9:
s_branch B_hookret1
B_rare0:
v_max3_f32 v240, v96, v97, v98
v_max3_f32 v240, v240, v99, v100
v_max3_f32 v240, v240, v101, v102
v_max_f32 v240, v240, v103
v_mov_b32 v242, v240
s_nop 1
v_permlane32_swap_b32 v242, v240
v_max_f32 v240, v242, v240
v_mov_b32 v242, v240
s_nop 1
v_permlane16_swap_b32 v242, v240
v_max_f32 v240, v242, v240
v_max_f32 v240, s69, v240
v_sub_f32 v96, v96, v240
v_sub_f32 v97, v97, v240
v_sub_f32 v98, v98, v240
v_sub_f32 v99, v99, v240
v_sub_f32 v100, v100, v240
v_sub_f32 v101, v101, v240
v_sub_f32 v102, v102, v240
v_sub_f32 v103, v103, v240
v_sub_f32 v144, v144, v240
v_sub_f32 v145, v145, v240
v_sub_f32 v146, v146, v240
v_sub_f32 v147, v147, v240
s_cmp_lg_u32 s69, 0
s_cbranch_scc1 B_ret0
s_branch B_rare0_b
B_rare1:
v_max3_f32 v240, v112, v113, v114
v_max3_f32 v240, v240, v115, v116
v_max3_f32 v240, v240, v117, v118
v_max_f32 v240, v240, v119
v_mov_b32 v242, v240
s_nop 1
v_permlane32_swap_b32 v242, v240
v_max_f32 v240, v242, v240
v_mov_b32 v242, v240
s_nop 1
v_permlane16_swap_b32 v242, v240
v_max_f32 v240, v242, v240
v_max_f32 v240, s69, v240
v_sub_f32 v112, v112, v240
v_sub_f32 v113, v113, v240
v_sub_f32 v114, v114, v240
v_sub_f32 v115, v115, v240
v_sub_f32 v116, v116, v240
v_sub_f32 v117, v117, v240
v_sub_f32 v118, v118, v240
v_sub_f32 v119, v119, v240
v_sub_f32 v148, v148, v240
v_sub_f32 v149, v149, v240
v_sub_f32 v150, v150, v240
v_sub_f32 v151, v151, v240
s_cmp_lg_u32 s69, 0
s_cbranch_scc1 B_ret1
s_branch B_rare1_b
B_rare2:
v_max3_f32 v240, v96, v97, v98
v_max3_f32 v240, v240, v99, v100
v_max3_f32 v240, v240, v101, v102
v_max_f32 v240, v240, v103
v_mov_b32 v242, v240
s_nop 1
v_permlane32_swap_b32 v242, v240
v_max_f32 v240, v242, v240
v_mov_b32 v242, v240
s_nop 1
v_permlane16_swap_b32 v242, v240
v_max_f32 v240, v242, v240
v_max_f32 v240, s69, v240
v_sub_f32 v96, v96, v240
v_sub_f32 v97, v97, v240
v_sub_f32 v98, v98, v240
v_sub_f32 v99, v99, v240
v_sub_f32 v100, v100, v240
v_sub_f32 v101, v101, v240
v_sub_f32 v102, v102, v240
v_sub_f32 v103, v103, v240
v_sub_f32 v152, v152, v240
v_sub_f32 v153, v153, v240
v_sub_f32 v154, v154, v240
v_sub_f32 v155, v155, v240
s_cmp_lg_u32 s69, 0
s_cbranch_scc1 B_ret2
s_branch B_rare2_b
B_rare3:
v_max3_f32 v240, v112, v113, v114
v_max3_f32 v240, v240, v115, v116
v_max3_f32 v240, v240, v117, v118
v_max_f32 v240, v240, v119
v_mov_b32 v242, v240
s_nop 1
v_permlane32_swap_b32 v242, v240
v_max_f32 v240, v242, v240
v_mov_b32 v242, v240
s_nop 1
v_permlane16_swap_b32 v242, v240
v_max_f32 v240, v242, v240
v_max_f32 v240, s69, v240
v_sub_f32 v112, v112, v240
v_sub_f32 v113, v113, v240
v_sub_f32 v114, v114, v240
v_sub_f32 v115, v115, v240
v_sub_f32 v116, v116, v240
v_sub_f32 v117, v117, v240
v_sub_f32 v118, v118, v240
v_sub_f32 v119, v119, v240
v_sub_f32 v144, v144, v240
v_sub_f32 v145, v145, v240
v_sub_f32 v146, v146, v240
v_sub_f32 v147, v147, v240
s_cmp_lg_u32 s69, 0
s_cbranch_scc1 B_ret3
s_branch B_rare3_b
B_rare4:
v_max3_f32 v240, v96, v97, v98
v_max3_f32 v240, v240, v99, v100
v_max3_f32 v240, v240, v101, v102
v_max_f32 v240, v240, v103
v_mov_b32 v242, v240
s_nop 1
v_permlane32_swap_b32 v242, v240
v_max_f32 v240, v242, v240
v_mov_b32 v242, v240
s_nop 1
v_permlane16_swap_b32 v242, v240
v_max_f32 v240, v242, v240
v_max_f32 v240, s69, v240
v_sub_f32 v96, v96, v240
v_sub_f32 v97, v97, v240
v_sub_f32 v98, v98, v240
v_sub_f32 v99, v99, v240
v_sub_f32 v100, v100, v240
v_sub_f32 v101, v101, v240
v_sub_f32 v102, v102, v240
v_sub_f32 v103, v103, v240
v_sub_f32 v148, v148, v240
v_sub_f32 v149, v149, v240
v_sub_f32 v150, v150, v240
v_sub_f32 v151, v151, v240
s_cmp_lg_u32 s69, 0
s_cbranch_scc1 B_ret4
s_branch B_rare4_b
B_rare5:
v_max3_f32 v240, v112, v113, v114
v_max3_f32 v240, v240, v115, v116
v_max3_f32 v240, v240, v117, v118
v_max_f32 v240, v240, v119
v_mov_b32 v242, v240
s_nop 1
v_permlane32_swap_b32 v242, v240
v_max_f32 v240, v242, v240
v_mov_b32 v242, v240
s_nop 1
v_permlane16_swap_b32 v242, v240
v_max_f32 v240, v242, v240
v_max_f32 v240, s69, v240
v_sub_f32 v112, v112, v240
v_sub_f32 v113, v113, v240
v_sub_f32 v114, v114, v240
v_sub_f32 v115, v115, v240
v_sub_f32 v116, v116, v240
v_sub_f32 v117, v117, v240
v_sub_f32 v118, v118, v240
v_sub_f32 v119, v119, v240
v_sub_f32 v152, v152, v240
v_sub_f32 v153, v153, v240
v_sub_f32 v154, v154, v240
v_sub_f32 v155, v155, v240
s_cmp_lg_u32 s69, 0
s_cbranch_scc1 B_ret5
s_branch B_rare5_b
B_rare0z:
v_max3_f32 v240, v96, v97, v98
v_max3_f32 v240, v240, v99, v100
v_max3_f32 v240, v240, v101, v102
v_max_f32 v240, v240, v103
v_mov_b32 v242, v240
s_nop 1
v_permlane32_swap_b32 v242, v240
v_max_f32 v240, v242, v240
v_mov_b32 v242, v240
s_nop 1
v_permlane16_swap_b32 v242, v240
v_max_f32 v240, v242, v240
v_max_f32 v240, s69, v240
v_sub_f32 v96, v96, v240
v_sub_f32 v97, v97, v240
v_sub_f32 v98, v98, v240
v_sub_f32 v99, v99, v240
v_sub_f32 v100, v100, v240
v_sub_f32 v101, v101, v240
v_sub_f32 v102, v102, v240
v_sub_f32 v103, v103, v240
v_sub_f32 v144, v144, v240
v_sub_f32 v145, v145, v240
v_sub_f32 v146, v146, v240
v_sub_f32 v147, v147, v240
s_cmp_lg_u32 s69, 0
s_cbranch_scc1 B_ret0z
s_branch B_rare0z_b
B_rare1z:
v_max3_f32 v240, v112, v113, v114
v_max3_f32 v240, v240, v115, v116
v_max3_f32 v240, v240, v117, v118
v_max_f32 v240, v240, v119
v_mov_b32 v242, v240
s_nop 1
v_permlane32_swap_b32 v242, v240
v_max_f32 v240, v242, v240
v_mov_b32 v242, v240
s_nop 1
v_permlane16_swap_b32 v242, v240
v_max_f32 v240, v242, v240
v_max_f32 v240, s69, v240
v_sub_f32 v112, v112, v240
v_sub_f32 v113, v113, v240
v_sub_f32 v114, v114, v240
v_sub_f32 v115, v115, v240
v_sub_f32 v116, v116, v240
v_sub_f32 v117, v117, v240
v_sub_f32 v118, v118, v240
v_sub_f32 v119, v119, v240
v_sub_f32 v148, v148, v240
v_sub_f32 v149, v149, v240
v_sub_f32 v150, v150, v240
v_sub_f32 v151, v151, v240
s_cmp_lg_u32 s69, 0
s_cbranch_scc1 B_ret1z
s_branch B_rare1z_b
B_rare2z:
v_max3_f32 v240, v96, v97, v98
v_max3_f32 v240, v240, v99, v100
v_max3_f32 v240, v240, v101, v102
v_max_f32 v240, v240, v103
v_mov_b32 v242, v240
s_nop 1
v_permlane32_swap_b32 v242, v240
v_max_f32 v240, v242, v240
v_mov_b32 v242, v240
s_nop 1
v_permlane16_swap_b32 v242, v240
v_max_f32 v240, v242, v240
v_max_f32 v240, s69, v240
v_sub_f32 v96, v96, v240
v_sub_f32 v97, v97, v240
v_sub_f32 v98, v98, v240
v_sub_f32 v99, v99, v240
v_sub_f32 v100, v100, v240
v_sub_f32 v101, v101, v240
v_sub_f32 v102, v102, v240
v_sub_f32 v103, v103, v240
v_sub_f32 v152, v152, v240
v_sub_f32 v153, v153, v240
v_sub_f32 v154, v154, v240
v_sub_f32 v155, v155, v240
s_cmp_lg_u32 s69, 0
s_cbranch_scc1 B_ret2z
s_branch B_rare2z_b
B_rare3z:
v_max3_f32 v240, v112, v113, v114
v_max3_f32 v240, v240, v115, v116
v_max3_f32 v240, v240, v117, v118
v_max_f32 v240, v240, v119
v_mov_b32 v242, v240
s_nop 1
v_permlane32_swap_b32 v242, v240
v_max_f32 v240, v242, v240
v_mov_b32 v242, v240
s_nop 1
v_permlane16_swap_b32 v242, v240
v_max_f32 v240, v242, v240
v_max_f32 v240, s69, v240
v_sub_f32 v112, v112, v240
v_sub_f32 v113, v113, v240
v_sub_f32 v114, v114, v240
v_sub_f32 v115, v115, v240
v_sub_f32 v116, v116, v240
v_sub_f32 v117, v117, v240
v_sub_f32 v118, v118, v240
v_sub_f32 v119, v119, v240
v_sub_f32 v144, v144, v240
v_sub_f32 v145, v145, v240
v_sub_f32 v146, v146, v240
v_sub_f32 v147, v147, v240
s_cmp_lg_u32 s69, 0
s_cbranch_scc1 B_ret3z
s_branch B_rare3z_b
B_rare4z:
v_max3_f32 v240, v96, v97, v98
v_max3_f32 v240, v240, v99, v100
v_max3_f32 v240, v240, v101, v102
v_max_f32 v240, v240, v103
v_mov_b32 v242, v240
s_nop 1
v_permlane32_swap_b32 v242, v240
v_max_f32 v240, v242, v240
v_mov_b32 v242, v240
s_nop 1
v_permlane16_swap_b32 v242, v240
v_max_f32 v240, v242, v240
v_max_f32 v240, s69, v240
v_sub_f32 v96, v96, v240
v_sub_f32 v97, v97, v240
v_sub_f32 v98, v98, v240
v_sub_f32 v99, v99, v240
v_sub_f32 v100, v100, v240
v_sub_f32 v101, v101, v240
v_sub_f32 v102, v102, v240
v_sub_f32 v103, v103, v240
v_sub_f32 v148, v148, v240
v_sub_f32 v149, v149, v240
v_sub_f32 v150, v150, v240
v_sub_f32 v151, v151, v240
s_cmp_lg_u32 s69, 0
s_cbranch_scc1 B_ret4z
s_branch B_rare4z_b
B_rare5z:
v_max3_f32 v240, v112, v113, v114
v_max3_f32 v240, v240, v115, v116
v_max3_f32 v240, v240, v117, v118
v_max_f32 v240, v240, v119
v_mov_b32 v242, v240
s_nop 1
v_permlane32_swap_b32 v242, v240
v_max_f32 v240, v242, v240
v_mov_b32 v242, v240
s_nop 1
v_permlane16_swap_b32 v242, v240
v_max_f32 v240, v242, v240
v_max_f32 v240, s69, v240
v_sub_f32 v112, v112, v240
v_sub_f32 v113, v113, v240
v_sub_f32 v114, v114, v240
v_sub_f32 v115, v115, v240
v_sub_f32 v116, v116, v240
v_sub_f32 v117, v117, v240
v_sub_f32 v118, v118, v240
v_sub_f32 v119, v119, v240
v_sub_f32 v152, v152, v240
v_sub_f32 v153, v153, v240
v_sub_f32 v154, v154, v240
v_sub_f32 v155, v155, v240
s_cmp_lg_u32 s69, 0
s_cbranch_scc1 B_ret5z
s_branch B_rare5z_b
B_rare0_b:
s_nop 15
v_sub_f32 v240, 0, v240
v_exp_f32 v240, v240
s_nop 0
v_mul_f32 v22, v22, v240
v_accvgpr_read_b32 v242, a0
v_mul_f32 v242, v242, v240
v_accvgpr_write_b32 a0, v242
v_accvgpr_read_b32 v243, a1
v_mul_f32 v243, v243, v240
v_accvgpr_write_b32 a1, v243
v_accvgpr_read_b32 v244, a2
v_mul_f32 v244, v244, v240
v_accvgpr_write_b32 a2, v244
v_accvgpr_read_b32 v245, a3
v_mul_f32 v245, v245, v240
v_accvgpr_write_b32 a3, v245
v_accvgpr_read_b32 v242, a4
v_mul_f32 v242, v242, v240
v_accvgpr_write_b32 a4, v242
v_accvgpr_read_b32 v243, a5
v_mul_f32 v243, v243, v240
v_accvgpr_write_b32 a5, v243
v_accvgpr_read_b32 v244, a6
v_mul_f32 v244, v244, v240
v_accvgpr_write_b32 a6, v244
v_accvgpr_read_b32 v245, a7
v_mul_f32 v245, v245, v240
v_accvgpr_write_b32 a7, v245
v_accvgpr_read_b32 v242, a8
v_mul_f32 v242, v242, v240
v_accvgpr_write_b32 a8, v242
v_accvgpr_read_b32 v243, a9
v_mul_f32 v243, v243, v240
v_accvgpr_write_b32 a9, v243
v_accvgpr_read_b32 v244, a10
v_mul_f32 v244, v244, v240
v_accvgpr_write_b32 a10, v244
v_accvgpr_read_b32 v245, a11
v_mul_f32 v245, v245, v240
v_accvgpr_write_b32 a11, v245
v_accvgpr_read_b32 v242, a12
v_mul_f32 v242, v242, v240
v_accvgpr_write_b32 a12, v242
v_accvgpr_read_b32 v243, a13
v_mul_f32 v243, v243, v240
v_accvgpr_write_b32 a13, v243
v_accvgpr_read_b32 v244, a14
v_mul_f32 v244, v244, v240
v_accvgpr_write_b32 a14, v244
v_accvgpr_read_b32 v245, a15
v_mul_f32 v245, v245, v240
v_accvgpr_write_b32 a15, v245
v_accvgpr_read_b32 v242, a16
v_mul_f32 v242, v242, v240
v_accvgpr_write_b32 a16, v242
v_accvgpr_read_b32 v243, a17
v_mul_f32 v243, v243, v240
v_accvgpr_write_b32 a17, v243
v_accvgpr_read_b32 v244, a18
v_mul_f32 v244, v244, v240
v_accvgpr_write_b32 a18, v244
v_accvgpr_read_b32 v245, a19
v_mul_f32 v245, v245, v240
v_accvgpr_write_b32 a19, v245
v_accvgpr_read_b32 v242, a20
v_mul_f32 v242, v242, v240
v_accvgpr_write_b32 a20, v242
v_accvgpr_read_b32 v243, a21
v_mul_f32 v243, v243, v240
v_accvgpr_write_b32 a21, v243
v_accvgpr_read_b32 v244, a22
v_mul_f32 v244, v244, v240
v_accvgpr_write_b32 a22, v244
v_accvgpr_read_b32 v245, a23
v_mul_f32 v245, v245, v240
v_accvgpr_write_b32 a23, v245
v_accvgpr_read_b32 v242, a24
v_mul_f32 v242, v242, v240
v_accvgpr_write_b32 a24, v242
v_accvgpr_read_b32 v243, a25
v_mul_f32 v243, v243, v240
v_accvgpr_write_b32 a25, v243
v_accvgpr_read_b32 v244, a26
v_mul_f32 v244, v244, v240
v_accvgpr_write_b32 a26, v244
v_accvgpr_read_b32 v245, a27
v_mul_f32 v245, v245, v240
v_accvgpr_write_b32 a27, v245
v_accvgpr_read_b32 v242, a28
v_mul_f32 v242, v242, v240
v_accvgpr_write_b32 a28, v242
v_accvgpr_read_b32 v243, a29
v_mul_f32 v243, v243, v240
v_accvgpr_write_b32 a29, v243
v_accvgpr_read_b32 v244, a30
v_mul_f32 v244, v244, v240
v_accvgpr_write_b32 a30, v244
v_accvgpr_read_b32 v245, a31
v_mul_f32 v245, v245, v240
v_accvgpr_write_b32 a31, v245
s_branch B_ret0
B_rare1_b:
s_nop 15
v_sub_f32 v240, 0, v240
v_exp_f32 v240, v240
s_nop 0
v_mul_f32 v26, v26, v240
v_accvgpr_read_b32 v242, a32
v_mul_f32 v242, v242, v240
v_accvgpr_write_b32 a32, v242
v_accvgpr_read_b32 v243, a33
v_mul_f32 v243, v243, v240
v_accvgpr_write_b32 a33, v243
v_accvgpr_read_b32 v244, a34
v_mul_f32 v244, v244, v240
v_accvgpr_write_b32 a34, v244
v_accvgpr_read_b32 v245, a35
v_mul_f32 v245, v245, v240
v_accvgpr_write_b32 a35, v245
v_accvgpr_read_b32 v242, a36
v_mul_f32 v242, v242, v240
v_accvgpr_write_b32 a36, v242
v_accvgpr_read_b32 v243, a37
v_mul_f32 v243, v243, v240
v_accvgpr_write_b32 a37, v243
v_accvgpr_read_b32 v244, a38
v_mul_f32 v244, v244, v240
v_accvgpr_write_b32 a38, v244
v_accvgpr_read_b32 v245, a39
v_mul_f32 v245, v245, v240
v_accvgpr_write_b32 a39, v245
v_accvgpr_read_b32 v242, a40
v_mul_f32 v242, v242, v240
v_accvgpr_write_b32 a40, v242
v_accvgpr_read_b32 v243, a41
v_mul_f32 v243, v243, v240
v_accvgpr_write_b32 a41, v243
v_accvgpr_read_b32 v244, a42
v_mul_f32 v244, v244, v240
v_accvgpr_write_b32 a42, v244
v_accvgpr_read_b32 v245, a43
v_mul_f32 v245, v245, v240
v_accvgpr_write_b32 a43, v245
v_accvgpr_read_b32 v242, a44
v_mul_f32 v242, v242, v240
v_accvgpr_write_b32 a44, v242
v_accvgpr_read_b32 v243, a45
v_mul_f32 v243, v243, v240
v_accvgpr_write_b32 a45, v243
v_accvgpr_read_b32 v244, a46
v_mul_f32 v244, v244, v240
v_accvgpr_write_b32 a46, v244
v_accvgpr_read_b32 v245, a47
v_mul_f32 v245, v245, v240
v_accvgpr_write_b32 a47, v245
v_accvgpr_read_b32 v242, a48
v_mul_f32 v242, v242, v240
v_accvgpr_write_b32 a48, v242
v_accvgpr_read_b32 v243, a49
v_mul_f32 v243, v243, v240
v_accvgpr_write_b32 a49, v243
v_accvgpr_read_b32 v244, a50
v_mul_f32 v244, v244, v240
v_accvgpr_write_b32 a50, v244
v_accvgpr_read_b32 v245, a51
v_mul_f32 v245, v245, v240
v_accvgpr_write_b32 a51, v245
v_accvgpr_read_b32 v242, a52
v_mul_f32 v242, v242, v240
v_accvgpr_write_b32 a52, v242
v_accvgpr_read_b32 v243, a53
v_mul_f32 v243, v243, v240
v_accvgpr_write_b32 a53, v243
v_accvgpr_read_b32 v244, a54
v_mul_f32 v244, v244, v240
v_accvgpr_write_b32 a54, v244
v_accvgpr_read_b32 v245, a55
v_mul_f32 v245, v245, v240
v_accvgpr_write_b32 a55, v245
v_accvgpr_read_b32 v242, a56
v_mul_f32 v242, v242, v240
v_accvgpr_write_b32 a56, v242
v_accvgpr_read_b32 v243, a57
v_mul_f32 v243, v243, v240
v_accvgpr_write_b32 a57, v243
v_accvgpr_read_b32 v244, a58
v_mul_f32 v244, v244, v240
v_accvgpr_write_b32 a58, v244
v_accvgpr_read_b32 v245, a59
v_mul_f32 v245, v245, v240
v_accvgpr_write_b32 a59, v245
v_accvgpr_read_b32 v242, a60
v_mul_f32 v242, v242, v240
v_accvgpr_write_b32 a60, v242
v_accvgpr_read_b32 v243, a61
v_mul_f32 v243, v243, v240
v_accvgpr_write_b32 a61, v243
v_accvgpr_read_b32 v244, a62
v_mul_f32 v244, v244, v240
v_accvgpr_write_b32 a62, v244
v_accvgpr_read_b32 v245, a63
v_mul_f32 v245, v245, v240
v_accvgpr_write_b32 a63, v245
s_branch B_ret1
B_rare2_b:
s_nop 15
v_sub_f32 v240, 0, v240
v_exp_f32 v240, v240
s_nop 0
v_mul_f32 v140, v140, v240
v_accvgpr_read_b32 v242, a64
v_mul_f32 v242, v242, v240
v_accvgpr_write_b32 a64, v242
v_accvgpr_read_b32 v243, a65
v_mul_f32 v243, v243, v240
v_accvgpr_write_b32 a65, v243
v_accvgpr_read_b32 v244, a66
v_mul_f32 v244, v244, v240
v_accvgpr_write_b32 a66, v244
v_accvgpr_read_b32 v245, a67
v_mul_f32 v245, v245, v240
v_accvgpr_write_b32 a67, v245
v_accvgpr_read_b32 v242, a68
v_mul_f32 v242, v242, v240
v_accvgpr_write_b32 a68, v242
v_accvgpr_read_b32 v243, a69
v_mul_f32 v243, v243, v240
v_accvgpr_write_b32 a69, v243
v_accvgpr_read_b32 v244, a70
v_mul_f32 v244, v244, v240
v_accvgpr_write_b32 a70, v244
v_accvgpr_read_b32 v245, a71
v_mul_f32 v245, v245, v240
v_accvgpr_write_b32 a71, v245
v_accvgpr_read_b32 v242, a72
v_mul_f32 v242, v242, v240
v_accvgpr_write_b32 a72, v242
v_accvgpr_read_b32 v243, a73
v_mul_f32 v243, v243, v240
v_accvgpr_write_b32 a73, v243
v_accvgpr_read_b32 v244, a74
v_mul_f32 v244, v244, v240
v_accvgpr_write_b32 a74, v244
v_accvgpr_read_b32 v245, a75
v_mul_f32 v245, v245, v240
v_accvgpr_write_b32 a75, v245
v_accvgpr_read_b32 v242, a76
v_mul_f32 v242, v242, v240
v_accvgpr_write_b32 a76, v242
v_accvgpr_read_b32 v243, a77
v_mul_f32 v243, v243, v240
v_accvgpr_write_b32 a77, v243
v_accvgpr_read_b32 v244, a78
v_mul_f32 v244, v244, v240
v_accvgpr_write_b32 a78, v244
v_accvgpr_read_b32 v245, a79
v_mul_f32 v245, v245, v240
v_accvgpr_write_b32 a79, v245
v_accvgpr_read_b32 v242, a80
v_mul_f32 v242, v242, v240
v_accvgpr_write_b32 a80, v242
v_accvgpr_read_b32 v243, a81
v_mul_f32 v243, v243, v240
v_accvgpr_write_b32 a81, v243
v_accvgpr_read_b32 v244, a82
v_mul_f32 v244, v244, v240
v_accvgpr_write_b32 a82, v244
v_accvgpr_read_b32 v245, a83
v_mul_f32 v245, v245, v240
v_accvgpr_write_b32 a83, v245
v_accvgpr_read_b32 v242, a84
v_mul_f32 v242, v242, v240
v_accvgpr_write_b32 a84, v242
v_accvgpr_read_b32 v243, a85
v_mul_f32 v243, v243, v240
v_accvgpr_write_b32 a85, v243
v_accvgpr_read_b32 v244, a86
v_mul_f32 v244, v244, v240
v_accvgpr_write_b32 a86, v244
v_accvgpr_read_b32 v245, a87
v_mul_f32 v245, v245, v240
v_accvgpr_write_b32 a87, v245
v_accvgpr_read_b32 v242, a88
v_mul_f32 v242, v242, v240
v_accvgpr_write_b32 a88, v242
v_accvgpr_read_b32 v243, a89
v_mul_f32 v243, v243, v240
v_accvgpr_write_b32 a89, v243
v_accvgpr_read_b32 v244, a90
v_mul_f32 v244, v244, v240
v_accvgpr_write_b32 a90, v244
v_accvgpr_read_b32 v245, a91
v_mul_f32 v245, v245, v240
v_accvgpr_write_b32 a91, v245
v_accvgpr_read_b32 v242, a92
v_mul_f32 v242, v242, v240
v_accvgpr_write_b32 a92, v242
v_accvgpr_read_b32 v243, a93
v_mul_f32 v243, v243, v240
v_accvgpr_write_b32 a93, v243
v_accvgpr_read_b32 v244, a94
v_mul_f32 v244, v244, v240
v_accvgpr_write_b32 a94, v244
v_accvgpr_read_b32 v245, a95
v_mul_f32 v245, v245, v240
v_accvgpr_write_b32 a95, v245
s_branch B_ret2
B_rare3_b:
s_nop 15
v_sub_f32 v240, 0, v240
v_exp_f32 v240, v240
s_nop 0
v_mul_f32 v22, v22, v240
v_accvgpr_read_b32 v242, a0
v_mul_f32 v242, v242, v240
v_accvgpr_write_b32 a0, v242
v_accvgpr_read_b32 v243, a1
v_mul_f32 v243, v243, v240
v_accvgpr_write_b32 a1, v243
v_accvgpr_read_b32 v244, a2
v_mul_f32 v244, v244, v240
v_accvgpr_write_b32 a2, v244
v_accvgpr_read_b32 v245, a3
v_mul_f32 v245, v245, v240
v_accvgpr_write_b32 a3, v245
v_accvgpr_read_b32 v242, a4
v_mul_f32 v242, v242, v240
v_accvgpr_write_b32 a4, v242
v_accvgpr_read_b32 v243, a5
v_mul_f32 v243, v243, v240
v_accvgpr_write_b32 a5, v243
v_accvgpr_read_b32 v244, a6
v_mul_f32 v244, v244, v240
v_accvgpr_write_b32 a6, v244
v_accvgpr_read_b32 v245, a7
v_mul_f32 v245, v245, v240
v_accvgpr_write_b32 a7, v245
v_accvgpr_read_b32 v242, a8
v_mul_f32 v242, v242, v240
v_accvgpr_write_b32 a8, v242
v_accvgpr_read_b32 v243, a9
v_mul_f32 v243, v243, v240
v_accvgpr_write_b32 a9, v243
v_accvgpr_read_b32 v244, a10
v_mul_f32 v244, v244, v240
v_accvgpr_write_b32 a10, v244
v_accvgpr_read_b32 v245, a11
v_mul_f32 v245, v245, v240
v_accvgpr_write_b32 a11, v245
v_accvgpr_read_b32 v242, a12
v_mul_f32 v242, v242, v240
v_accvgpr_write_b32 a12, v242
v_accvgpr_read_b32 v243, a13
v_mul_f32 v243, v243, v240
v_accvgpr_write_b32 a13, v243
v_accvgpr_read_b32 v244, a14
v_mul_f32 v244, v244, v240
v_accvgpr_write_b32 a14, v244
v_accvgpr_read_b32 v245, a15
v_mul_f32 v245, v245, v240
v_accvgpr_write_b32 a15, v245
v_accvgpr_read_b32 v242, a16
v_mul_f32 v242, v242, v240
v_accvgpr_write_b32 a16, v242
v_accvgpr_read_b32 v243, a17
v_mul_f32 v243, v243, v240
v_accvgpr_write_b32 a17, v243
v_accvgpr_read_b32 v244, a18
v_mul_f32 v244, v244, v240
v_accvgpr_write_b32 a18, v244
v_accvgpr_read_b32 v245, a19
v_mul_f32 v245, v245, v240
v_accvgpr_write_b32 a19, v245
v_accvgpr_read_b32 v242, a20
v_mul_f32 v242, v242, v240
v_accvgpr_write_b32 a20, v242
v_accvgpr_read_b32 v243, a21
v_mul_f32 v243, v243, v240
v_accvgpr_write_b32 a21, v243
v_accvgpr_read_b32 v244, a22
v_mul_f32 v244, v244, v240
v_accvgpr_write_b32 a22, v244
v_accvgpr_read_b32 v245, a23
v_mul_f32 v245, v245, v240
v_accvgpr_write_b32 a23, v245
v_accvgpr_read_b32 v242, a24
v_mul_f32 v242, v242, v240
v_accvgpr_write_b32 a24, v242
v_accvgpr_read_b32 v243, a25
v_mul_f32 v243, v243, v240
v_accvgpr_write_b32 a25, v243
v_accvgpr_read_b32 v244, a26
v_mul_f32 v244, v244, v240
v_accvgpr_write_b32 a26, v244
v_accvgpr_read_b32 v245, a27
v_mul_f32 v245, v245, v240
v_accvgpr_write_b32 a27, v245
v_accvgpr_read_b32 v242, a28
v_mul_f32 v242, v242, v240
v_accvgpr_write_b32 a28, v242
v_accvgpr_read_b32 v243, a29
v_mul_f32 v243, v243, v240
v_accvgpr_write_b32 a29, v243
v_accvgpr_read_b32 v244, a30
v_mul_f32 v244, v244, v240
v_accvgpr_write_b32 a30, v244
v_accvgpr_read_b32 v245, a31
v_mul_f32 v245, v245, v240
v_accvgpr_write_b32 a31, v245
s_branch B_ret3
B_rare4_b:
s_nop 15
v_sub_f32 v240, 0, v240
v_exp_f32 v240, v240
s_nop 0
v_mul_f32 v26, v26, v240
v_accvgpr_read_b32 v242, a32
v_mul_f32 v242, v242, v240
v_accvgpr_write_b32 a32, v242
v_accvgpr_read_b32 v243, a33
v_mul_f32 v243, v243, v240
v_accvgpr_write_b32 a33, v243
v_accvgpr_read_b32 v244, a34
v_mul_f32 v244, v244, v240
v_accvgpr_write_b32 a34, v244
v_accvgpr_read_b32 v245, a35
v_mul_f32 v245, v245, v240
v_accvgpr_write_b32 a35, v245
v_accvgpr_read_b32 v242, a36
v_mul_f32 v242, v242, v240
v_accvgpr_write_b32 a36, v242
v_accvgpr_read_b32 v243, a37
v_mul_f32 v243, v243, v240
v_accvgpr_write_b32 a37, v243
v_accvgpr_read_b32 v244, a38
v_mul_f32 v244, v244, v240
v_accvgpr_write_b32 a38, v244
v_accvgpr_read_b32 v245, a39
v_mul_f32 v245, v245, v240
v_accvgpr_write_b32 a39, v245
v_accvgpr_read_b32 v242, a40
v_mul_f32 v242, v242, v240
v_accvgpr_write_b32 a40, v242
v_accvgpr_read_b32 v243, a41
v_mul_f32 v243, v243, v240
v_accvgpr_write_b32 a41, v243
v_accvgpr_read_b32 v244, a42
v_mul_f32 v244, v244, v240
v_accvgpr_write_b32 a42, v244
v_accvgpr_read_b32 v245, a43
v_mul_f32 v245, v245, v240
v_accvgpr_write_b32 a43, v245
v_accvgpr_read_b32 v242, a44
v_mul_f32 v242, v242, v240
v_accvgpr_write_b32 a44, v242
v_accvgpr_read_b32 v243, a45
v_mul_f32 v243, v243, v240
v_accvgpr_write_b32 a45, v243
v_accvgpr_read_b32 v244, a46
v_mul_f32 v244, v244, v240
v_accvgpr_write_b32 a46, v244
v_accvgpr_read_b32 v245, a47
v_mul_f32 v245, v245, v240
v_accvgpr_write_b32 a47, v245
v_accvgpr_read_b32 v242, a48
v_mul_f32 v242, v242, v240
v_accvgpr_write_b32 a48, v242
v_accvgpr_read_b32 v243, a49
v_mul_f32 v243, v243, v240
v_accvgpr_write_b32 a49, v243
v_accvgpr_read_b32 v244, a50
v_mul_f32 v244, v244, v240
v_accvgpr_write_b32 a50, v244
v_accvgpr_read_b32 v245, a51
v_mul_f32 v245, v245, v240
v_accvgpr_write_b32 a51, v245
v_accvgpr_read_b32 v242, a52
v_mul_f32 v242, v242, v240
v_accvgpr_write_b32 a52, v242
v_accvgpr_read_b32 v243, a53
v_mul_f32 v243, v243, v240
v_accvgpr_write_b32 a53, v243
v_accvgpr_read_b32 v244, a54
v_mul_f32 v244, v244, v240
v_accvgpr_write_b32 a54, v244
v_accvgpr_read_b32 v245, a55
v_mul_f32 v245, v245, v240
v_accvgpr_write_b32 a55, v245
v_accvgpr_read_b32 v242, a56
v_mul_f32 v242, v242, v240
v_accvgpr_write_b32 a56, v242
v_accvgpr_read_b32 v243, a57
v_mul_f32 v243, v243, v240
v_accvgpr_write_b32 a57, v243
v_accvgpr_read_b32 v244, a58
v_mul_f32 v244, v244, v240
v_accvgpr_write_b32 a58, v244
v_accvgpr_read_b32 v245, a59
v_mul_f32 v245, v245, v240
v_accvgpr_write_b32 a59, v245
v_accvgpr_read_b32 v242, a60
v_mul_f32 v242, v242, v240
v_accvgpr_write_b32 a60, v242
v_accvgpr_read_b32 v243, a61
v_mul_f32 v243, v243, v240
v_accvgpr_write_b32 a61, v243
v_accvgpr_read_b32 v244, a62
v_mul_f32 v244, v244, v240
v_accvgpr_write_b32 a62, v244
v_accvgpr_read_b32 v245, a63
v_mul_f32 v245, v245, v240
v_accvgpr_write_b32 a63, v245
s_branch B_ret4
B_rare5_b:
s_nop 15
v_sub_f32 v240, 0, v240
v_exp_f32 v240, v240
s_nop 0
v_mul_f32 v140, v140, v240
v_accvgpr_read_b32 v242, a64
v_mul_f32 v242, v242, v240
v_accvgpr_write_b32 a64, v242
v_accvgpr_read_b32 v243, a65
v_mul_f32 v243, v243, v240
v_accvgpr_write_b32 a65, v243
v_accvgpr_read_b32 v244, a66
v_mul_f32 v244, v244, v240
v_accvgpr_write_b32 a66, v244
v_accvgpr_read_b32 v245, a67
v_mul_f32 v245, v245, v240
v_accvgpr_write_b32 a67, v245
v_accvgpr_read_b32 v242, a68
v_mul_f32 v242, v242, v240
v_accvgpr_write_b32 a68, v242
v_accvgpr_read_b32 v243, a69
v_mul_f32 v243, v243, v240
v_accvgpr_write_b32 a69, v243
v_accvgpr_read_b32 v244, a70
v_mul_f32 v244, v244, v240
v_accvgpr_write_b32 a70, v244
v_accvgpr_read_b32 v245, a71
v_mul_f32 v245, v245, v240
v_accvgpr_write_b32 a71, v245
v_accvgpr_read_b32 v242, a72
v_mul_f32 v242, v242, v240
v_accvgpr_write_b32 a72, v242
v_accvgpr_read_b32 v243, a73
v_mul_f32 v243, v243, v240
v_accvgpr_write_b32 a73, v243
v_accvgpr_read_b32 v244, a74
v_mul_f32 v244, v244, v240
v_accvgpr_write_b32 a74, v244
v_accvgpr_read_b32 v245, a75
v_mul_f32 v245, v245, v240
v_accvgpr_write_b32 a75, v245
v_accvgpr_read_b32 v242, a76
v_mul_f32 v242, v242, v240
v_accvgpr_write_b32 a76, v242
v_accvgpr_read_b32 v243, a77
v_mul_f32 v243, v243, v240
v_accvgpr_write_b32 a77, v243
v_accvgpr_read_b32 v244, a78
v_mul_f32 v244, v244, v240
v_accvgpr_write_b32 a78, v244
v_accvgpr_read_b32 v245, a79
v_mul_f32 v245, v245, v240
v_accvgpr_write_b32 a79, v245
v_accvgpr_read_b32 v242, a80
v_mul_f32 v242, v242, v240
v_accvgpr_write_b32 a80, v242
v_accvgpr_read_b32 v243, a81
v_mul_f32 v243, v243, v240
v_accvgpr_write_b32 a81, v243
v_accvgpr_read_b32 v244, a82
v_mul_f32 v244, v244, v240
v_accvgpr_write_b32 a82, v244
v_accvgpr_read_b32 v245, a83
v_mul_f32 v245, v245, v240
v_accvgpr_write_b32 a83, v245
v_accvgpr_read_b32 v242, a84
v_mul_f32 v242, v242, v240
v_accvgpr_write_b32 a84, v242
v_accvgpr_read_b32 v243, a85
v_mul_f32 v243, v243, v240
v_accvgpr_write_b32 a85, v243
v_accvgpr_read_b32 v244, a86
v_mul_f32 v244, v244, v240
v_accvgpr_write_b32 a86, v244
v_accvgpr_read_b32 v245, a87
v_mul_f32 v245, v245, v240
v_accvgpr_write_b32 a87, v245
v_accvgpr_read_b32 v242, a88
v_mul_f32 v242, v242, v240
v_accvgpr_write_b32 a88, v242
v_accvgpr_read_b32 v243, a89
v_mul_f32 v243, v243, v240
v_accvgpr_write_b32 a89, v243
v_accvgpr_read_b32 v244, a90
v_mul_f32 v244, v244, v240
v_accvgpr_write_b32 a90, v244
v_accvgpr_read_b32 v245, a91
v_mul_f32 v245, v245, v240
v_accvgpr_write_b32 a91, v245
v_accvgpr_read_b32 v242, a92
v_mul_f32 v242, v242, v240
v_accvgpr_write_b32 a92, v242
v_accvgpr_read_b32 v243, a93
v_mul_f32 v243, v243, v240
v_accvgpr_write_b32 a93, v243
v_accvgpr_read_b32 v244, a94
v_mul_f32 v244, v244, v240
v_accvgpr_write_b32 a94, v244
v_accvgpr_read_b32 v245, a95
v_mul_f32 v245, v245, v240
v_accvgpr_write_b32 a95, v245
s_branch B_ret5
B_rare0z_b:
s_nop 15
v_sub_f32 v240, 0, v240
v_exp_f32 v240, v240
s_nop 0
v_mul_f32 v22, v22, v240
v_accvgpr_read_b32 v242, a0
v_mul_f32 v242, v242, v240
v_accvgpr_write_b32 a0, v242
v_accvgpr_read_b32 v243, a1
v_mul_f32 v243, v243, v240
v_accvgpr_write_b32 a1, v243
v_accvgpr_read_b32 v244, a2
v_mul_f32 v244, v244, v240
v_accvgpr_write_b32 a2, v244
v_accvgpr_read_b32 v245, a3
v_mul_f32 v245, v245, v240
v_accvgpr_write_b32 a3, v245
v_accvgpr_read_b32 v242, a4
v_mul_f32 v242, v242, v240
v_accvgpr_write_b32 a4, v242
v_accvgpr_read_b32 v243, a5
v_mul_f32 v243, v243, v240
v_accvgpr_write_b32 a5, v243
v_accvgpr_read_b32 v244, a6
v_mul_f32 v244, v244, v240
v_accvgpr_write_b32 a6, v244
v_accvgpr_read_b32 v245, a7
v_mul_f32 v245, v245, v240
v_accvgpr_write_b32 a7, v245
v_accvgpr_read_b32 v242, a8
v_mul_f32 v242, v242, v240
v_accvgpr_write_b32 a8, v242
v_accvgpr_read_b32 v243, a9
v_mul_f32 v243, v243, v240
v_accvgpr_write_b32 a9, v243
v_accvgpr_read_b32 v244, a10
v_mul_f32 v244, v244, v240
v_accvgpr_write_b32 a10, v244
v_accvgpr_read_b32 v245, a11
v_mul_f32 v245, v245, v240
v_accvgpr_write_b32 a11, v245
v_accvgpr_read_b32 v242, a12
v_mul_f32 v242, v242, v240
v_accvgpr_write_b32 a12, v242
v_accvgpr_read_b32 v243, a13
v_mul_f32 v243, v243, v240
v_accvgpr_write_b32 a13, v243
v_accvgpr_read_b32 v244, a14
v_mul_f32 v244, v244, v240
v_accvgpr_write_b32 a14, v244
v_accvgpr_read_b32 v245, a15
v_mul_f32 v245, v245, v240
v_accvgpr_write_b32 a15, v245
v_accvgpr_read_b32 v242, a16
v_mul_f32 v242, v242, v240
v_accvgpr_write_b32 a16, v242
v_accvgpr_read_b32 v243, a17
v_mul_f32 v243, v243, v240
v_accvgpr_write_b32 a17, v243
v_accvgpr_read_b32 v244, a18
v_mul_f32 v244, v244, v240
v_accvgpr_write_b32 a18, v244
v_accvgpr_read_b32 v245, a19
v_mul_f32 v245, v245, v240
v_accvgpr_write_b32 a19, v245
v_accvgpr_read_b32 v242, a20
v_mul_f32 v242, v242, v240
v_accvgpr_write_b32 a20, v242
v_accvgpr_read_b32 v243, a21
v_mul_f32 v243, v243, v240
v_accvgpr_write_b32 a21, v243
v_accvgpr_read_b32 v244, a22
v_mul_f32 v244, v244, v240
v_accvgpr_write_b32 a22, v244
v_accvgpr_read_b32 v245, a23
v_mul_f32 v245, v245, v240
v_accvgpr_write_b32 a23, v245
v_accvgpr_read_b32 v242, a24
v_mul_f32 v242, v242, v240
v_accvgpr_write_b32 a24, v242
v_accvgpr_read_b32 v243, a25
v_mul_f32 v243, v243, v240
v_accvgpr_write_b32 a25, v243
v_accvgpr_read_b32 v244, a26
v_mul_f32 v244, v244, v240
v_accvgpr_write_b32 a26, v244
v_accvgpr_read_b32 v245, a27
v_mul_f32 v245, v245, v240
v_accvgpr_write_b32 a27, v245
v_accvgpr_read_b32 v242, a28
v_mul_f32 v242, v242, v240
v_accvgpr_write_b32 a28, v242
v_accvgpr_read_b32 v243, a29
v_mul_f32 v243, v243, v240
v_accvgpr_write_b32 a29, v243
v_accvgpr_read_b32 v244, a30
v_mul_f32 v244, v244, v240
v_accvgpr_write_b32 a30, v244
v_accvgpr_read_b32 v245, a31
v_mul_f32 v245, v245, v240
v_accvgpr_write_b32 a31, v245
s_branch B_ret0z
B_rare1z_b:
s_nop 15
v_sub_f32 v240, 0, v240
v_exp_f32 v240, v240
s_nop 0
v_mul_f32 v26, v26, v240
v_accvgpr_read_b32 v242, a32
v_mul_f32 v242, v242, v240
v_accvgpr_write_b32 a32, v242
v_accvgpr_read_b32 v243, a33
v_mul_f32 v243, v243, v240
v_accvgpr_write_b32 a33, v243
v_accvgpr_read_b32 v244, a34
v_mul_f32 v244, v244, v240
v_accvgpr_write_b32 a34, v244
v_accvgpr_read_b32 v245, a35
v_mul_f32 v245, v245, v240
v_accvgpr_write_b32 a35, v245
v_accvgpr_read_b32 v242, a36
v_mul_f32 v242, v242, v240
v_accvgpr_write_b32 a36, v242
v_accvgpr_read_b32 v243, a37
v_mul_f32 v243, v243, v240
v_accvgpr_write_b32 a37, v243
v_accvgpr_read_b32 v244, a38
v_mul_f32 v244, v244, v240
v_accvgpr_write_b32 a38, v244
v_accvgpr_read_b32 v245, a39
v_mul_f32 v245, v245, v240
v_accvgpr_write_b32 a39, v245
v_accvgpr_read_b32 v242, a40
v_mul_f32 v242, v242, v240
v_accvgpr_write_b32 a40, v242
v_accvgpr_read_b32 v243, a41
v_mul_f32 v243, v243, v240
v_accvgpr_write_b32 a41, v243
v_accvgpr_read_b32 v244, a42
v_mul_f32 v244, v244, v240
v_accvgpr_write_b32 a42, v244
v_accvgpr_read_b32 v245, a43
v_mul_f32 v245, v245, v240
v_accvgpr_write_b32 a43, v245
v_accvgpr_read_b32 v242, a44
v_mul_f32 v242, v242, v240
v_accvgpr_write_b32 a44, v242
v_accvgpr_read_b32 v243, a45
v_mul_f32 v243, v243, v240
v_accvgpr_write_b32 a45, v243
v_accvgpr_read_b32 v244, a46
v_mul_f32 v244, v244, v240
v_accvgpr_write_b32 a46, v244
v_accvgpr_read_b32 v245, a47
v_mul_f32 v245, v245, v240
v_accvgpr_write_b32 a47, v245
v_accvgpr_read_b32 v242, a48
v_mul_f32 v242, v242, v240
v_accvgpr_write_b32 a48, v242
v_accvgpr_read_b32 v243, a49
v_mul_f32 v243, v243, v240
v_accvgpr_write_b32 a49, v243
v_accvgpr_read_b32 v244, a50
v_mul_f32 v244, v244, v240
v_accvgpr_write_b32 a50, v244
v_accvgpr_read_b32 v245, a51
v_mul_f32 v245, v245, v240
v_accvgpr_write_b32 a51, v245
v_accvgpr_read_b32 v242, a52
v_mul_f32 v242, v242, v240
v_accvgpr_write_b32 a52, v242
v_accvgpr_read_b32 v243, a53
v_mul_f32 v243, v243, v240
v_accvgpr_write_b32 a53, v243
v_accvgpr_read_b32 v244, a54
v_mul_f32 v244, v244, v240
v_accvgpr_write_b32 a54, v244
v_accvgpr_read_b32 v245, a55
v_mul_f32 v245, v245, v240
v_accvgpr_write_b32 a55, v245
v_accvgpr_read_b32 v242, a56
v_mul_f32 v242, v242, v240
v_accvgpr_write_b32 a56, v242
v_accvgpr_read_b32 v243, a57
v_mul_f32 v243, v243, v240
v_accvgpr_write_b32 a57, v243
v_accvgpr_read_b32 v244, a58
v_mul_f32 v244, v244, v240
v_accvgpr_write_b32 a58, v244
v_accvgpr_read_b32 v245, a59
v_mul_f32 v245, v245, v240
v_accvgpr_write_b32 a59, v245
v_accvgpr_read_b32 v242, a60
v_mul_f32 v242, v242, v240
v_accvgpr_write_b32 a60, v242
v_accvgpr_read_b32 v243, a61
v_mul_f32 v243, v243, v240
v_accvgpr_write_b32 a61, v243
v_accvgpr_read_b32 v244, a62
v_mul_f32 v244, v244, v240
v_accvgpr_write_b32 a62, v244
v_accvgpr_read_b32 v245, a63
v_mul_f32 v245, v245, v240
v_accvgpr_write_b32 a63, v245
s_branch B_ret1z
B_rare2z_b:
s_nop 15
v_sub_f32 v240, 0, v240
v_exp_f32 v240, v240
s_nop 0
v_mul_f32 v140, v140, v240
v_accvgpr_read_b32 v242, a64
v_mul_f32 v242, v242, v240
v_accvgpr_write_b32 a64, v242
v_accvgpr_read_b32 v243, a65
v_mul_f32 v243, v243, v240
v_accvgpr_write_b32 a65, v243
v_accvgpr_read_b32 v244, a66
v_mul_f32 v244, v244, v240
v_accvgpr_write_b32 a66, v244
v_accvgpr_read_b32 v245, a67
v_mul_f32 v245, v245, v240
v_accvgpr_write_b32 a67, v245
v_accvgpr_read_b32 v242, a68
v_mul_f32 v242, v242, v240
v_accvgpr_write_b32 a68, v242
v_accvgpr_read_b32 v243, a69
v_mul_f32 v243, v243, v240
v_accvgpr_write_b32 a69, v243
v_accvgpr_read_b32 v244, a70
v_mul_f32 v244, v244, v240
v_accvgpr_write_b32 a70, v244
v_accvgpr_read_b32 v245, a71
v_mul_f32 v245, v245, v240
v_accvgpr_write_b32 a71, v245
v_accvgpr_read_b32 v242, a72
v_mul_f32 v242, v242, v240
v_accvgpr_write_b32 a72, v242
v_accvgpr_read_b32 v243, a73
v_mul_f32 v243, v243, v240
v_accvgpr_write_b32 a73, v243
v_accvgpr_read_b32 v244, a74
v_mul_f32 v244, v244, v240
v_accvgpr_write_b32 a74, v244
v_accvgpr_read_b32 v245, a75
v_mul_f32 v245, v245, v240
v_accvgpr_write_b32 a75, v245
v_accvgpr_read_b32 v242, a76
v_mul_f32 v242, v242, v240
v_accvgpr_write_b32 a76, v242
v_accvgpr_read_b32 v243, a77
v_mul_f32 v243, v243, v240
v_accvgpr_write_b32 a77, v243
v_accvgpr_read_b32 v244, a78
v_mul_f32 v244, v244, v240
v_accvgpr_write_b32 a78, v244
v_accvgpr_read_b32 v245, a79
v_mul_f32 v245, v245, v240
v_accvgpr_write_b32 a79, v245
v_accvgpr_read_b32 v242, a80
v_mul_f32 v242, v242, v240
v_accvgpr_write_b32 a80, v242
v_accvgpr_read_b32 v243, a81
v_mul_f32 v243, v243, v240
v_accvgpr_write_b32 a81, v243
v_accvgpr_read_b32 v244, a82
v_mul_f32 v244, v244, v240
v_accvgpr_write_b32 a82, v244
v_accvgpr_read_b32 v245, a83
v_mul_f32 v245, v245, v240
v_accvgpr_write_b32 a83, v245
v_accvgpr_read_b32 v242, a84
v_mul_f32 v242, v242, v240
v_accvgpr_write_b32 a84, v242
v_accvgpr_read_b32 v243, a85
v_mul_f32 v243, v243, v240
v_accvgpr_write_b32 a85, v243
v_accvgpr_read_b32 v244, a86
v_mul_f32 v244, v244, v240
v_accvgpr_write_b32 a86, v244
v_accvgpr_read_b32 v245, a87
v_mul_f32 v245, v245, v240
v_accvgpr_write_b32 a87, v245
v_accvgpr_read_b32 v242, a88
v_mul_f32 v242, v242, v240
v_accvgpr_write_b32 a88, v242
v_accvgpr_read_b32 v243, a89
v_mul_f32 v243, v243, v240
v_accvgpr_write_b32 a89, v243
v_accvgpr_read_b32 v244, a90
v_mul_f32 v244, v244, v240
v_accvgpr_write_b32 a90, v244
v_accvgpr_read_b32 v245, a91
v_mul_f32 v245, v245, v240
v_accvgpr_write_b32 a91, v245
v_accvgpr_read_b32 v242, a92
v_mul_f32 v242, v242, v240
v_accvgpr_write_b32 a92, v242
v_accvgpr_read_b32 v243, a93
v_mul_f32 v243, v243, v240
v_accvgpr_write_b32 a93, v243
v_accvgpr_read_b32 v244, a94
v_mul_f32 v244, v244, v240
v_accvgpr_write_b32 a94, v244
v_accvgpr_read_b32 v245, a95
v_mul_f32 v245, v245, v240
v_accvgpr_write_b32 a95, v245
s_branch B_ret2z
B_rare3z_b:
s_nop 15
v_sub_f32 v240, 0, v240
v_exp_f32 v240, v240
s_nop 0
v_mul_f32 v22, v22, v240
v_accvgpr_read_b32 v242, a0
v_mul_f32 v242, v242, v240
v_accvgpr_write_b32 a0, v242
v_accvgpr_read_b32 v243, a1
v_mul_f32 v243, v243, v240
v_accvgpr_write_b32 a1, v243
v_accvgpr_read_b32 v244, a2
v_mul_f32 v244, v244, v240
v_accvgpr_write_b32 a2, v244
v_accvgpr_read_b32 v245, a3
v_mul_f32 v245, v245, v240
v_accvgpr_write_b32 a3, v245
v_accvgpr_read_b32 v242, a4
v_mul_f32 v242, v242, v240
v_accvgpr_write_b32 a4, v242
v_accvgpr_read_b32 v243, a5
v_mul_f32 v243, v243, v240
v_accvgpr_write_b32 a5, v243
v_accvgpr_read_b32 v244, a6
v_mul_f32 v244, v244, v240
v_accvgpr_write_b32 a6, v244
v_accvgpr_read_b32 v245, a7
v_mul_f32 v245, v245, v240
v_accvgpr_write_b32 a7, v245
v_accvgpr_read_b32 v242, a8
v_mul_f32 v242, v242, v240
v_accvgpr_write_b32 a8, v242
v_accvgpr_read_b32 v243, a9
v_mul_f32 v243, v243, v240
v_accvgpr_write_b32 a9, v243
v_accvgpr_read_b32 v244, a10
v_mul_f32 v244, v244, v240
v_accvgpr_write_b32 a10, v244
v_accvgpr_read_b32 v245, a11
v_mul_f32 v245, v245, v240
v_accvgpr_write_b32 a11, v245
v_accvgpr_read_b32 v242, a12
v_mul_f32 v242, v242, v240
v_accvgpr_write_b32 a12, v242
v_accvgpr_read_b32 v243, a13
v_mul_f32 v243, v243, v240
v_accvgpr_write_b32 a13, v243
v_accvgpr_read_b32 v244, a14
v_mul_f32 v244, v244, v240
v_accvgpr_write_b32 a14, v244
v_accvgpr_read_b32 v245, a15
v_mul_f32 v245, v245, v240
v_accvgpr_write_b32 a15, v245
v_accvgpr_read_b32 v242, a16
v_mul_f32 v242, v242, v240
v_accvgpr_write_b32 a16, v242
v_accvgpr_read_b32 v243, a17
v_mul_f32 v243, v243, v240
v_accvgpr_write_b32 a17, v243
v_accvgpr_read_b32 v244, a18
v_mul_f32 v244, v244, v240
v_accvgpr_write_b32 a18, v244
v_accvgpr_read_b32 v245, a19
v_mul_f32 v245, v245, v240
v_accvgpr_write_b32 a19, v245
v_accvgpr_read_b32 v242, a20
v_mul_f32 v242, v242, v240
v_accvgpr_write_b32 a20, v242
v_accvgpr_read_b32 v243, a21
v_mul_f32 v243, v243, v240
v_accvgpr_write_b32 a21, v243
v_accvgpr_read_b32 v244, a22
v_mul_f32 v244, v244, v240
v_accvgpr_write_b32 a22, v244
v_accvgpr_read_b32 v245, a23
v_mul_f32 v245, v245, v240
v_accvgpr_write_b32 a23, v245
v_accvgpr_read_b32 v242, a24
v_mul_f32 v242, v242, v240
v_accvgpr_write_b32 a24, v242
v_accvgpr_read_b32 v243, a25
v_mul_f32 v243, v243, v240
v_accvgpr_write_b32 a25, v243
v_accvgpr_read_b32 v244, a26
v_mul_f32 v244, v244, v240
v_accvgpr_write_b32 a26, v244
v_accvgpr_read_b32 v245, a27
v_mul_f32 v245, v245, v240
v_accvgpr_write_b32 a27, v245
v_accvgpr_read_b32 v242, a28
v_mul_f32 v242, v242, v240
v_accvgpr_write_b32 a28, v242
v_accvgpr_read_b32 v243, a29
v_mul_f32 v243, v243, v240
v_accvgpr_write_b32 a29, v243
v_accvgpr_read_b32 v244, a30
v_mul_f32 v244, v244, v240
v_accvgpr_write_b32 a30, v244
v_accvgpr_read_b32 v245, a31
v_mul_f32 v245, v245, v240
v_accvgpr_write_b32 a31, v245
s_branch B_ret3z
B_rare4z_b:
s_nop 15
v_sub_f32 v240, 0, v240
v_exp_f32 v240, v240
s_nop 0
v_mul_f32 v26, v26, v240
v_accvgpr_read_b32 v242, a32
v_mul_f32 v242, v242, v240
v_accvgpr_write_b32 a32, v242
v_accvgpr_read_b32 v243, a33
v_mul_f32 v243, v243, v240
v_accvgpr_write_b32 a33, v243
v_accvgpr_read_b32 v244, a34
v_mul_f32 v244, v244, v240
v_accvgpr_write_b32 a34, v244
v_accvgpr_read_b32 v245, a35
v_mul_f32 v245, v245, v240
v_accvgpr_write_b32 a35, v245
v_accvgpr_read_b32 v242, a36
v_mul_f32 v242, v242, v240
v_accvgpr_write_b32 a36, v242
v_accvgpr_read_b32 v243, a37
v_mul_f32 v243, v243, v240
v_accvgpr_write_b32 a37, v243
v_accvgpr_read_b32 v244, a38
v_mul_f32 v244, v244, v240
v_accvgpr_write_b32 a38, v244
v_accvgpr_read_b32 v245, a39
v_mul_f32 v245, v245, v240
v_accvgpr_write_b32 a39, v245
v_accvgpr_read_b32 v242, a40
v_mul_f32 v242, v242, v240
v_accvgpr_write_b32 a40, v242
v_accvgpr_read_b32 v243, a41
v_mul_f32 v243, v243, v240
v_accvgpr_write_b32 a41, v243
v_accvgpr_read_b32 v244, a42
v_mul_f32 v244, v244, v240
v_accvgpr_write_b32 a42, v244
v_accvgpr_read_b32 v245, a43
v_mul_f32 v245, v245, v240
v_accvgpr_write_b32 a43, v245
v_accvgpr_read_b32 v242, a44
v_mul_f32 v242, v242, v240
v_accvgpr_write_b32 a44, v242
v_accvgpr_read_b32 v243, a45
v_mul_f32 v243, v243, v240
v_accvgpr_write_b32 a45, v243
v_accvgpr_read_b32 v244, a46
v_mul_f32 v244, v244, v240
v_accvgpr_write_b32 a46, v244
v_accvgpr_read_b32 v245, a47
v_mul_f32 v245, v245, v240
v_accvgpr_write_b32 a47, v245
v_accvgpr_read_b32 v242, a48
v_mul_f32 v242, v242, v240
v_accvgpr_write_b32 a48, v242
v_accvgpr_read_b32 v243, a49
v_mul_f32 v243, v243, v240
v_accvgpr_write_b32 a49, v243
v_accvgpr_read_b32 v244, a50
v_mul_f32 v244, v244, v240
v_accvgpr_write_b32 a50, v244
v_accvgpr_read_b32 v245, a51
v_mul_f32 v245, v245, v240
v_accvgpr_write_b32 a51, v245
v_accvgpr_read_b32 v242, a52
v_mul_f32 v242, v242, v240
v_accvgpr_write_b32 a52, v242
v_accvgpr_read_b32 v243, a53
v_mul_f32 v243, v243, v240
v_accvgpr_write_b32 a53, v243
v_accvgpr_read_b32 v244, a54
v_mul_f32 v244, v244, v240
v_accvgpr_write_b32 a54, v244
v_accvgpr_read_b32 v245, a55
v_mul_f32 v245, v245, v240
v_accvgpr_write_b32 a55, v245
v_accvgpr_read_b32 v242, a56
v_mul_f32 v242, v242, v240
v_accvgpr_write_b32 a56, v242
v_accvgpr_read_b32 v243, a57
v_mul_f32 v243, v243, v240
v_accvgpr_write_b32 a57, v243
v_accvgpr_read_b32 v244, a58
v_mul_f32 v244, v244, v240
v_accvgpr_write_b32 a58, v244
v_accvgpr_read_b32 v245, a59
v_mul_f32 v245, v245, v240
v_accvgpr_write_b32 a59, v245
v_accvgpr_read_b32 v242, a60
v_mul_f32 v242, v242, v240
v_accvgpr_write_b32 a60, v242
v_accvgpr_read_b32 v243, a61
v_mul_f32 v243, v243, v240
v_accvgpr_write_b32 a61, v243
v_accvgpr_read_b32 v244, a62
v_mul_f32 v244, v244, v240
v_accvgpr_write_b32 a62, v244
v_accvgpr_read_b32 v245, a63
v_mul_f32 v245, v245, v240
v_accvgpr_write_b32 a63, v245
s_branch B_ret4z
B_rare5z_b:
s_nop 15
v_sub_f32 v240, 0, v240
v_exp_f32 v240, v240
s_nop 0
v_mul_f32 v140, v140, v240
v_accvgpr_read_b32 v242, a64
v_mul_f32 v242, v242, v240
v_accvgpr_write_b32 a64, v242
v_accvgpr_read_b32 v243, a65
v_mul_f32 v243, v243, v240
v_accvgpr_write_b32 a65, v243
v_accvgpr_read_b32 v244, a66
v_mul_f32 v244, v244, v240
v_accvgpr_write_b32 a66, v244
v_accvgpr_read_b32 v245, a67
v_mul_f32 v245, v245, v240
v_accvgpr_write_b32 a67, v245
v_accvgpr_read_b32 v242, a68
v_mul_f32 v242, v242, v240
v_accvgpr_write_b32 a68, v242
v_accvgpr_read_b32 v243, a69
v_mul_f32 v243, v243, v240
v_accvgpr_write_b32 a69, v243
v_accvgpr_read_b32 v244, a70
v_mul_f32 v244, v244, v240
v_accvgpr_write_b32 a70, v244
v_accvgpr_read_b32 v245, a71
v_mul_f32 v245, v245, v240
v_accvgpr_write_b32 a71, v245
v_accvgpr_read_b32 v242, a72
v_mul_f32 v242, v242, v240
v_accvgpr_write_b32 a72, v242
v_accvgpr_read_b32 v243, a73
v_mul_f32 v243, v243, v240
v_accvgpr_write_b32 a73, v243
v_accvgpr_read_b32 v244, a74
v_mul_f32 v244, v244, v240
v_accvgpr_write_b32 a74, v244
v_accvgpr_read_b32 v245, a75
v_mul_f32 v245, v245, v240
v_accvgpr_write_b32 a75, v245
v_accvgpr_read_b32 v242, a76
v_mul_f32 v242, v242, v240
v_accvgpr_write_b32 a76, v242
v_accvgpr_read_b32 v243, a77
v_mul_f32 v243, v243, v240
v_accvgpr_write_b32 a77, v243
v_accvgpr_read_b32 v244, a78
v_mul_f32 v244, v244, v240
v_accvgpr_write_b32 a78, v244
v_accvgpr_read_b32 v245, a79
v_mul_f32 v245, v245, v240
v_accvgpr_write_b32 a79, v245
v_accvgpr_read_b32 v242, a80
v_mul_f32 v242, v242, v240
v_accvgpr_write_b32 a80, v242
v_accvgpr_read_b32 v243, a81
v_mul_f32 v243, v243, v240
v_accvgpr_write_b32 a81, v243
v_accvgpr_read_b32 v244, a82
v_mul_f32 v244, v244, v240
v_accvgpr_write_b32 a82, v244
v_accvgpr_read_b32 v245, a83
v_mul_f32 v245, v245, v240
v_accvgpr_write_b32 a83, v245
v_accvgpr_read_b32 v242, a84
v_mul_f32 v242, v242, v240
v_accvgpr_write_b32 a84, v242
v_accvgpr_read_b32 v243, a85
v_mul_f32 v243, v243, v240
v_accvgpr_write_b32 a85, v243
v_accvgpr_read_b32 v244, a86
v_mul_f32 v244, v244, v240
v_accvgpr_write_b32 a86, v244
v_accvgpr_read_b32 v245, a87
v_mul_f32 v245, v245, v240
v_accvgpr_write_b32 a87, v245
v_accvgpr_read_b32 v242, a88
v_mul_f32 v242, v242, v240
v_accvgpr_write_b32 a88, v242
v_accvgpr_read_b32 v243, a89
v_mul_f32 v243, v243, v240
v_accvgpr_write_b32 a89, v243
v_accvgpr_read_b32 v244, a90
v_mul_f32 v244, v244, v240
v_accvgpr_write_b32 a90, v244
v_accvgpr_read_b32 v245, a91
v_mul_f32 v245, v245, v240
v_accvgpr_write_b32 a91, v245
v_accvgpr_read_b32 v242, a92
v_mul_f32 v242, v242, v240
v_accvgpr_write_b32 a92, v242
v_accvgpr_read_b32 v243, a93
v_mul_f32 v243, v243, v240
v_accvgpr_write_b32 a93, v243
v_accvgpr_read_b32 v244, a94
v_mul_f32 v244, v244, v240
v_accvgpr_write_b32 a94, v244
v_accvgpr_read_b32 v245, a95
v_mul_f32 v245, v245, v240
v_accvgpr_write_b32 a95, v245
s_branch B_ret5z
L_worker:
s_and_b32 s64, s59, 3
s_bfe_u32 s63, s59, 0x20002
s_add_u32 s77, s64, s63
s_lshl_b32 s77, s77, 1
s_and_b32 s30, s58, 4
s_add_u32 s30, s30, s64
s_and_b32 s65, s58, 3
s_lshl_b32 s78, s65, 3
s_lshl1_add_u32 s78, s63, s78
s_mul_i32 s64, s30, 98304
s_add_u32 s52, s4, s64
s_addc_u32 s53, s5, 0
s_mov_b32 s54, 98304
s_mov_b32 s55, 0x20000
s_lshl_b32 s64, s78, 8
s_add_u32 s16, s10, s64
s_addc_u32 s17, s11, 0
s_sub_u32 s18, 8388608, s64
s_mov_b32 s19, 0x20000
s_lshl2_add_u32 s64, s30, s65
s_lshl_b32 s64, s64, 19
s_add_u32 s40, s6, s64
s_addc_u32 s41, s7, 0
s_mov_b32 s42, 524288
s_mov_b32 s43, 0x20000
s_add_u32 s44, s8, s64
s_addc_u32 s45, s9, 0
s_mov_b32 s46, 524288
s_mov_b32 s47, 0x20000
s_bfe_u32 s64, s77, 0x20001
s_lshl2_add_u32 s64, s65, s64
s_cmp_eq_u32 s64, 0
s_cselect_b32 s77, 0x76543210, s77
s_cmp_eq_u32 s64, 1
s_cselect_b32 s77, 0x47650321, s77
s_cmp_eq_u32 s64, 2
s_cselect_b32 s77, 0x54761032, s77
s_cmp_eq_u32 s64, 3
s_cselect_b32 s77, 0x65472103, s77
s_cmp_eq_u32 s64, 4
s_cselect_b32 s77, 0x76543210, s77
s_cmp_eq_u32 s64, 5
s_cselect_b32 s77, 0x73654021, s77
s_cmp_eq_u32 s64, 6
s_cselect_b32 s77, 0x74365102, s77
s_cmp_eq_u32 s64, 7
s_cselect_b32 s77, 0x75436210, s77
s_cmp_eq_u32 s64, 8
s_cselect_b32 s77, 0x76543210, s77
s_cmp_eq_u32 s64, 9
s_cselect_b32 s77, 0x67254301, s77
s_cmp_eq_u32 s64, 10
s_cselect_b32 s77, 0x76325410, s77
s_cmp_eq_u32 s64, 11
s_cselect_b32 s77, 0x67432501, s77
s_cmp_eq_u32 s64, 12
s_cselect_b32 s77, 0x76543210, s77
s_cmp_eq_u32 s64, 13
s_cselect_b32 s77, 0x57614320, s77
s_cmp_eq_u32 s64, 14
s_cselect_b32 s77, 0x65721430, s77
s_cmp_eq_u32 s64, 15
s_cselect_b32 s77, 0x76532140, s77
s_waitcnt vmcnt(19)
s_barrier
ds_read_b64_tr_b16 v[80:81], v232 offset:0
ds_read_b64_tr_b16 v[82:83], v232 offset:1024
ds_read_b64_tr_b16 v[84:85], v233 offset:0
s_add_u32 s66, s62, 3
s_and_b32 s66, s66, 7
s_lshl_b32 s66, s66, 20
s_add_u32 m0, s57, 24576
s_nop 0
buffer_load_dwordx4 v228, s[36:39], s66 offen offset:0 lds
ds_read_b64_tr_b16 v[86:87], v233 offset:1024
ds_read_b128 v[32:35], v168 offset:32768
ds_read_b128 v[36:39], v169 offset:32768
ds_read_b128 v[40:43], v170 offset:32768
ds_read_b64_tr_b16 v[88:89], v234 offset:0
ds_read_b64_tr_b16 v[90:91], v234 offset:1024
ds_read_b64_tr_b16 v[92:93], v235 offset:0
buffer_load_dwordx4 v229, s[36:39], s66 offen offset:1024 lds
ds_read_b64_tr_b16 v[94:95], v235 offset:1024
ds_read_b128 v[44:47], v171 offset:32768
ds_read_b128 v[48:51], v172 offset:32768
ds_read_b128 v[52:55], v173 offset:32768
s_waitcnt lgkmcnt(7)
v_mfma_f32_16x16x32_bf16 v[96:99], v[80:83], v[32:35], 0
ds_read_b64_tr_b16 v[144:145], v236 offset:0
ds_read_b64_tr_b16 v[146:147], v236 offset:1024
buffer_load_dwordx4 v230, s[36:39], s66 offen offset:2048 lds
v_mfma_f32_16x16x32_bf16 v[100:103], v[84:87], v[32:35], 0
ds_read_b64_tr_b16 v[148:149], v237 offset:0
v_mfma_f32_16x16x32_bf16 v[104:107], v[80:83], v[36:39], 0
ds_read_b64_tr_b16 v[150:151], v237 offset:1024
v_mfma_f32_16x16x32_bf16 v[108:111], v[84:87], v[36:39], 0
ds_read_b128 v[56:59], v174 offset:32768
buffer_load_dwordx4 v231, s[36:39], s66 offen offset:3072 lds
v_mfma_f32_16x16x32_bf16 v[112:115], v[80:83], v[40:43], 0
ds_read_b128 v[60:63], v175 offset:32768
v_mfma_f32_16x16x32_bf16 v[116:119], v[84:87], v[40:43], 0
ds_read_b128 v[64:67], v176 offset:32768
s_waitcnt lgkmcnt(7)
v_mfma_f32_16x16x32_bf16 v[96:99], v[88:91], v[44:47], v[96:99]
ds_read_b64_tr_b16 v[152:153], v238 offset:0
ds_read_b64_tr_b16 v[154:155], v238 offset:1024
s_add_u32 m0, s57, 28672
s_add_u32 s67, s66, 131072
buffer_load_dwordx4 v228, s[36:39], s67 offen offset:0 lds
v_mfma_f32_16x16x32_bf16 v[100:103], v[92:95], v[44:47], v[100:103]
ds_read_b64_tr_b16 v[156:157], v239 offset:0
v_mfma_f32_16x16x32_bf16 v[104:107], v[88:91], v[48:51], v[104:107]
ds_read_b64_tr_b16 v[158:159], v239 offset:1024
v_mfma_f32_16x16x32_bf16 v[108:111], v[92:95], v[48:51], v[108:111]
ds_read_b128 v[68:71], v177 offset:32768
buffer_load_dwordx4 v229, s[36:39], s67 offen offset:1024 lds
v_mfma_f32_16x16x32_bf16 v[112:115], v[88:91], v[52:55], v[112:115]
ds_read_b128 v[72:75], v178 offset:32768
v_mfma_f32_16x16x32_bf16 v[116:119], v[92:95], v[52:55], v[116:119]
ds_read_b128 v[76:79], v179 offset:32768
s_waitcnt lgkmcnt(7)
v_mfma_f32_16x16x32_bf16 v[96:99], v[144:147], v[56:59], v[96:99]
buffer_load_dwordx4 v230, s[36:39], s67 offen offset:2048 lds
v_mfma_f32_16x16x32_bf16 v[100:103], v[148:151], v[56:59], v[100:103]
v_mfma_f32_16x16x32_bf16 v[104:107], v[144:147], v[60:63], v[104:107]
v_mfma_f32_16x16x32_bf16 v[108:111], v[148:151], v[60:63], v[108:111]
buffer_load_dwordx4 v231, s[36:39], s67 offen offset:3072 lds
v_mfma_f32_16x16x32_bf16 v[112:115], v[144:147], v[64:67], v[112:115]
v_mfma_f32_16x16x32_bf16 v[116:119], v[148:151], v[64:67], v[116:119]
s_waitcnt vmcnt(16)
s_waitcnt lgkmcnt(0)
s_barrier
v_mfma_f32_16x16x32_bf16 v[96:99], v[152:155], v[68:71], v[96:99]
ds_read_b64_tr_b16 v[80:81], v232 offset:8192
ds_read_b64_tr_b16 v[82:83], v232 offset:9216
ds_read_b64_tr_b16 v[84:85], v233 offset:8192
s_add_u32 m0, s57, 32768
s_add_u32 s65, s62, 2
s_and_b32 s65, s65, 7
s_lshl_b32 s65, s65, 8
buffer_load_dwordx4 v224, s[32:35], s65 offen offset:0 lds
v_mfma_f32_16x16x32_bf16 v[100:103], v[156:159], v[68:71], v[100:103]
ds_read_b64_tr_b16 v[86:87], v233 offset:9216
ds_read_b128 v[32:35], v168 offset:35840
v_mfma_f32_16x16x32_bf16 v[104:107], v[152:155], v[72:75], v[104:107]
ds_read_b128 v[36:39], v169 offset:35840
ds_read_b128 v[40:43], v170 offset:35840
v_mfma_f32_16x16x32_bf16 v[108:111], v[156:159], v[72:75], v[108:111]
ds_read_b64_tr_b16 v[88:89], v234 offset:8192
ds_read_b64_tr_b16 v[90:91], v234 offset:9216
ds_read_b64_tr_b16 v[92:93], v235 offset:8192
buffer_load_dwordx4 v225, s[32:35], s65 offen offset:1024 lds
v_mfma_f32_16x16x32_bf16 v[112:115], v[152:155], v[76:79], v[112:115]
ds_read_b64_tr_b16 v[94:95], v235 offset:9216
ds_read_b128 v[44:47], v171 offset:35840
v_mfma_f32_16x16x32_bf16 v[116:119], v[156:159], v[76:79], v[116:119]
ds_read_b128 v[48:51], v172 offset:35840
ds_read_b128 v[52:55], v173 offset:35840
buffer_load_dwordx4 v226, s[32:35], s65 offen offset:2048 lds
s_waitcnt lgkmcnt(7)
v_mfma_f32_16x16x32_bf16 v[96:99], v[80:83], v[32:35], v[96:99]
ds_read_b64_tr_b16 v[144:145], v236 offset:8192
ds_read_b64_tr_b16 v[146:147], v236 offset:9216
v_mfma_f32_16x16x32_bf16 v[100:103], v[84:87], v[32:35], v[100:103]
ds_read_b64_tr_b16 v[148:149], v237 offset:8192
s_add_u32 s66, s62, 4
s_and_b32 s66, s66, 7
s_lshl_b32 s66, s66, 20
s_add_u32 m0, s57, 0
s_nop 0
buffer_load_dwordx4 v228, s[36:39], s66 offen offset:0 lds
v_mfma_f32_16x16x32_bf16 v[104:107], v[80:83], v[36:39], v[104:107]
ds_read_b64_tr_b16 v[150:151], v237 offset:9216
v_mfma_f32_16x16x32_bf16 v[108:111], v[84:87], v[36:39], v[108:111]
ds_read_b128 v[56:59], v174 offset:35840
buffer_load_dwordx4 v229, s[36:39], s66 offen offset:1024 lds
v_mfma_f32_16x16x32_bf16 v[112:115], v[80:83], v[40:43], v[112:115]
ds_read_b128 v[60:63], v175 offset:35840
v_mfma_f32_16x16x32_bf16 v[116:119], v[84:87], v[40:43], v[116:119]
ds_read_b128 v[64:67], v176 offset:35840
buffer_load_dwordx4 v230, s[36:39], s66 offen offset:2048 lds
s_waitcnt lgkmcnt(7)
v_mfma_f32_16x16x32_bf16 v[96:99], v[88:91], v[44:47], v[96:99]
ds_read_b64_tr_b16 v[152:153], v238 offset:8192
ds_read_b64_tr_b16 v[154:155], v238 offset:9216
v_mfma_f32_16x16x32_bf16 v[100:103], v[92:95], v[44:47], v[100:103]
ds_read_b64_tr_b16 v[156:157], v239 offset:8192
v_mfma_f32_16x16x32_bf16 v[104:107], v[88:91], v[48:51], v[104:107]
ds_read_b64_tr_b16 v[158:159], v239 offset:9216
buffer_load_dwordx4 v231, s[36:39], s66 offen offset:3072 lds
v_mfma_f32_16x16x32_bf16 v[108:111], v[92:95], v[48:51], v[108:111]
ds_read_b128 v[68:71], v177 offset:35840
v_mfma_f32_16x16x32_bf16 v[112:115], v[88:91], v[52:55], v[112:115]
ds_read_b128 v[72:75], v178 offset:35840
s_add_u32 m0, s57, 4096
s_add_u32 s67, s66, 131072
buffer_load_dwordx4 v228, s[36:39], s67 offen offset:0 lds
v_mfma_f32_16x16x32_bf16 v[116:119], v[92:95], v[52:55], v[116:119]
ds_read_b128 v[76:79], v179 offset:35840
s_waitcnt lgkmcnt(7)
v_mfma_f32_16x16x32_bf16 v[96:99], v[144:147], v[56:59], v[96:99]
buffer_load_dwordx4 v229, s[36:39], s67 offen offset:1024 lds
v_mfma_f32_16x16x32_bf16 v[100:103], v[148:151], v[56:59], v[100:103]
v_mfma_f32_16x16x32_bf16 v[104:107], v[144:147], v[60:63], v[104:107]
buffer_load_dwordx4 v230, s[36:39], s67 offen offset:2048 lds
v_mfma_f32_16x16x32_bf16 v[108:111], v[148:151], v[60:63], v[108:111]
v_mfma_f32_16x16x32_bf16 v[112:115], v[144:147], v[64:67], v[112:115]
buffer_load_dwordx4 v231, s[36:39], s67 offen offset:3072 lds
v_mfma_f32_16x16x32_bf16 v[116:119], v[148:151], v[64:67], v[116:119]
s_waitcnt vmcnt(19)
s_waitcnt vmcnt(8)
s_waitcnt lgkmcnt(0)
s_barrier
v_mfma_f32_16x16x32_bf16 v[96:99], v[152:155], v[68:71], v[96:99]
ds_read_b64_tr_b16 v[80:81], v232 offset:16384
ds_read_b64_tr_b16 v[82:83], v232 offset:17408
ds_read_b64_tr_b16 v[84:85], v233 offset:16384
s_add_u32 m0, s57, 35840
s_add_u32 s65, s62, 3
s_and_b32 s65, s65, 7
s_lshl_b32 s65, s65, 8
buffer_load_dwordx4 v224, s[32:35], s65 offen offset:0 lds
v_mfma_f32_16x16x32_bf16 v[100:103], v[156:159], v[68:71], v[100:103]
ds_read_b64_tr_b16 v[86:87], v233 offset:17408
ds_read_b128 v[32:35], v168 offset:32768
v_mfma_f32_16x16x32_bf16 v[104:107], v[152:155], v[72:75], v[104:107]
ds_read_b128 v[36:39], v169 offset:32768
ds_read_b128 v[40:43], v170 offset:32768
v_mfma_f32_16x16x32_bf16 v[108:111], v[156:159], v[72:75], v[108:111]
ds_read_b64_tr_b16 v[88:89], v234 offset:16384
ds_read_b64_tr_b16 v[90:91], v234 offset:17408
ds_read_b64_tr_b16 v[92:93], v235 offset:16384
buffer_load_dwordx4 v225, s[32:35], s65 offen offset:1024 lds
v_mfma_f32_16x16x32_bf16 v[112:115], v[152:155], v[76:79], v[112:115]
ds_read_b64_tr_b16 v[94:95], v235 offset:17408
ds_read_b128 v[44:47], v171 offset:32768
v_mfma_f32_16x16x32_bf16 v[116:119], v[156:159], v[76:79], v[116:119]
ds_read_b128 v[48:51], v172 offset:32768
ds_read_b128 v[52:55], v173 offset:32768
buffer_load_dwordx4 v226, s[32:35], s65 offen offset:2048 lds
s_waitcnt lgkmcnt(7)
v_mfma_f32_16x16x32_bf16 v[96:99], v[80:83], v[32:35], v[96:99]
ds_read_b64_tr_b16 v[144:145], v236 offset:16384
ds_read_b64_tr_b16 v[146:147], v236 offset:17408
v_mfma_f32_16x16x32_bf16 v[100:103], v[84:87], v[32:35], v[100:103]
ds_read_b64_tr_b16 v[148:149], v237 offset:16384
s_add_u32 s66, s62, 5
s_and_b32 s66, s66, 7
s_lshl_b32 s66, s66, 20
s_add_u32 m0, s57, 8192
s_nop 0
buffer_load_dwordx4 v228, s[36:39], s66 offen offset:0 lds
v_mfma_f32_16x16x32_bf16 v[104:107], v[80:83], v[36:39], v[104:107]
ds_read_b64_tr_b16 v[150:151], v237 offset:17408
v_mfma_f32_16x16x32_bf16 v[108:111], v[84:87], v[36:39], v[108:111]
ds_read_b128 v[56:59], v174 offset:32768
buffer_load_dwordx4 v229, s[36:39], s66 offen offset:1024 lds
v_mfma_f32_16x16x32_bf16 v[112:115], v[80:83], v[40:43], v[112:115]
ds_read_b128 v[60:63], v175 offset:32768
v_mfma_f32_16x16x32_bf16 v[116:119], v[84:87], v[40:43], v[116:119]
ds_read_b128 v[64:67], v176 offset:32768
buffer_load_dwordx4 v230, s[36:39], s66 offen offset:2048 lds
s_waitcnt lgkmcnt(7)
v_mfma_f32_16x16x32_bf16 v[96:99], v[88:91], v[44:47], v[96:99]
ds_read_b64_tr_b16 v[152:153], v238 offset:16384
ds_read_b64_tr_b16 v[154:155], v238 offset:17408
v_mfma_f32_16x16x32_bf16 v[100:103], v[92:95], v[44:47], v[100:103]
ds_read_b64_tr_b16 v[156:157], v239 offset:16384
v_mfma_f32_16x16x32_bf16 v[104:107], v[88:91], v[48:51], v[104:107]
ds_read_b64_tr_b16 v[158:159], v239 offset:17408
buffer_load_dwordx4 v231, s[36:39], s66 offen offset:3072 lds
v_mfma_f32_16x16x32_bf16 v[108:111], v[92:95], v[48:51], v[108:111]
ds_read_b128 v[68:71], v177 offset:32768
v_mfma_f32_16x16x32_bf16 v[112:115], v[88:91], v[52:55], v[112:115]
ds_read_b128 v[72:75], v178 offset:32768
s_add_u32 m0, s57, 12288
s_add_u32 s67, s66, 131072
buffer_load_dwordx4 v228, s[36:39], s67 offen offset:0 lds
v_mfma_f32_16x16x32_bf16 v[116:119], v[92:95], v[52:55], v[116:119]
ds_read_b128 v[76:79], v179 offset:32768
s_waitcnt lgkmcnt(7)
v_mfma_f32_16x16x32_bf16 v[96:99], v[144:147], v[56:59], v[96:99]
buffer_load_dwordx4 v229, s[36:39], s67 offen offset:1024 lds
v_mfma_f32_16x16x32_bf16 v[100:103], v[148:151], v[56:59], v[100:103]
v_mfma_f32_16x16x32_bf16 v[104:107], v[144:147], v[60:63], v[104:107]
buffer_load_dwordx4 v230, s[36:39], s67 offen offset:2048 lds
v_mfma_f32_16x16x32_bf16 v[108:111], v[148:151], v[60:63], v[108:111]
v_mfma_f32_16x16x32_bf16 v[112:115], v[144:147], v[64:67], v[112:115]
buffer_load_dwordx4 v231, s[36:39], s67 offen offset:3072 lds
v_mfma_f32_16x16x32_bf16 v[116:119], v[148:151], v[64:67], v[116:119]
s_waitcnt vmcnt(8)
s_waitcnt lgkmcnt(0)
s_barrier
v_mfma_f32_16x16x32_bf16 v[96:99], v[152:155], v[68:71], v[96:99]
ds_read_b64_tr_b16 v[80:81], v232 offset:24576
ds_read_b64_tr_b16 v[82:83], v232 offset:25600
ds_read_b64_tr_b16 v[84:85], v233 offset:24576
s_add_u32 m0, s57, 32768
s_add_u32 s65, s62, 4
s_and_b32 s65, s65, 7
s_lshl_b32 s65, s65, 8
buffer_load_dwordx4 v224, s[32:35], s65 offen offset:0 lds
v_mfma_f32_16x16x32_bf16 v[100:103], v[156:159], v[68:71], v[100:103]
ds_read_b64_tr_b16 v[86:87], v233 offset:25600
ds_read_b128 v[32:35], v168 offset:35840
v_mfma_f32_16x16x32_bf16 v[104:107], v[152:155], v[72:75], v[104:107]
ds_read_b128 v[36:39], v169 offset:35840
ds_read_b128 v[40:43], v170 offset:35840
v_mfma_f32_16x16x32_bf16 v[108:111], v[156:159], v[72:75], v[108:111]
ds_read_b64_tr_b16 v[88:89], v234 offset:24576
ds_read_b64_tr_b16 v[90:91], v234 offset:25600
ds_read_b64_tr_b16 v[92:93], v235 offset:24576
buffer_load_dwordx4 v225, s[32:35], s65 offen offset:1024 lds
v_mfma_f32_16x16x32_bf16 v[112:115], v[152:155], v[76:79], v[112:115]
ds_read_b64_tr_b16 v[94:95], v235 offset:25600
ds_read_b128 v[44:47], v171 offset:35840
v_mfma_f32_16x16x32_bf16 v[116:119], v[156:159], v[76:79], v[116:119]
ds_read_b128 v[48:51], v172 offset:35840
ds_read_b128 v[52:55], v173 offset:35840
buffer_load_dwordx4 v226, s[32:35], s65 offen offset:2048 lds
s_waitcnt lgkmcnt(7)
v_mfma_f32_16x16x32_bf16 v[96:99], v[80:83], v[32:35], v[96:99]
ds_read_b64_tr_b16 v[144:145], v236 offset:24576
ds_read_b64_tr_b16 v[146:147], v236 offset:25600
v_mfma_f32_16x16x32_bf16 v[100:103], v[84:87], v[32:35], v[100:103]
ds_read_b64_tr_b16 v[148:149], v237 offset:24576
s_add_u32 s66, s62, 6
s_and_b32 s66, s66, 7
s_lshl_b32 s66, s66, 20
s_add_u32 m0, s57, 16384
s_nop 0
buffer_load_dwordx4 v228, s[36:39], s66 offen offset:0 lds
v_mfma_f32_16x16x32_bf16 v[104:107], v[80:83], v[36:39], v[104:107]
ds_read_b64_tr_b16 v[150:151], v237 offset:25600
v_mfma_f32_16x16x32_bf16 v[108:111], v[84:87], v[36:39], v[108:111]
ds_read_b128 v[56:59], v174 offset:35840
buffer_load_dwordx4 v229, s[36:39], s66 offen offset:1024 lds
v_mfma_f32_16x16x32_bf16 v[112:115], v[80:83], v[40:43], v[112:115]
ds_read_b128 v[60:63], v175 offset:35840
v_mfma_f32_16x16x32_bf16 v[116:119], v[84:87], v[40:43], v[116:119]
ds_read_b128 v[64:67], v176 offset:35840
buffer_load_dwordx4 v230, s[36:39], s66 offen offset:2048 lds
s_waitcnt lgkmcnt(7)
v_mfma_f32_16x16x32_bf16 v[96:99], v[88:91], v[44:47], v[96:99]
ds_read_b64_tr_b16 v[152:153], v238 offset:24576
ds_read_b64_tr_b16 v[154:155], v238 offset:25600
v_mfma_f32_16x16x32_bf16 v[100:103], v[92:95], v[44:47], v[100:103]
ds_read_b64_tr_b16 v[156:157], v239 offset:24576
v_mfma_f32_16x16x32_bf16 v[104:107], v[88:91], v[48:51], v[104:107]
ds_read_b64_tr_b16 v[158:159], v239 offset:25600
buffer_load_dwordx4 v231, s[36:39], s66 offen offset:3072 lds
v_mfma_f32_16x16x32_bf16 v[108:111], v[92:95], v[48:51], v[108:111]
ds_read_b128 v[68:71], v177 offset:35840
v_mfma_f32_16x16x32_bf16 v[112:115], v[88:91], v[52:55], v[112:115]
ds_read_b128 v[72:75], v178 offset:35840
s_add_u32 m0, s57, 20480
s_add_u32 s67, s66, 131072
buffer_load_dwordx4 v228, s[36:39], s67 offen offset:0 lds
v_mfma_f32_16x16x32_bf16 v[116:119], v[92:95], v[52:55], v[116:119]
ds_read_b128 v[76:79], v179 offset:35840
s_waitcnt lgkmcnt(7)
v_mfma_f32_16x16x32_bf16 v[96:99], v[144:147], v[56:59], v[96:99]
buffer_load_dwordx4 v229, s[36:39], s67 offen offset:1024 lds
v_mfma_f32_16x16x32_bf16 v[100:103], v[148:151], v[56:59], v[100:103]
v_mfma_f32_16x16x32_bf16 v[104:107], v[144:147], v[60:63], v[104:107]
buffer_load_dwordx4 v230, s[36:39], s67 offen offset:2048 lds
v_mfma_f32_16x16x32_bf16 v[108:111], v[148:151], v[60:63], v[108:111]
v_mfma_f32_16x16x32_bf16 v[112:115], v[144:147], v[64:67], v[112:115]
buffer_load_dwordx4 v231, s[36:39], s67 offen offset:3072 lds
v_mfma_f32_16x16x32_bf16 v[116:119], v[148:151], v[64:67], v[116:119]
s_waitcnt vmcnt(8)
s_waitcnt lgkmcnt(0)
s_barrier
v_mfma_f32_16x16x32_bf16 v[96:99], v[152:155], v[68:71], v[96:99]
ds_read_b64_tr_b16 v[80:81], v232 offset:0
ds_read_b64_tr_b16 v[82:83], v232 offset:1024
ds_read_b64_tr_b16 v[84:85], v233 offset:0
s_add_u32 m0, s57, 35840
s_add_u32 s65, s62, 5
s_and_b32 s65, s65, 7
s_lshl_b32 s65, s65, 8
buffer_load_dwordx4 v224, s[32:35], s65 offen offset:0 lds
v_mfma_f32_16x16x32_bf16 v[100:103], v[156:159], v[68:71], v[100:103]
ds_read_b64_tr_b16 v[86:87], v233 offset:1024
ds_read_b128 v[32:35], v168 offset:32768
v_mfma_f32_16x16x32_bf16 v[104:107], v[152:155], v[72:75], v[104:107]
ds_read_b128 v[36:39], v169 offset:32768
ds_read_b128 v[40:43], v170 offset:32768
v_mfma_f32_16x16x32_bf16 v[108:111], v[156:159], v[72:75], v[108:111]
ds_read_b64_tr_b16 v[88:89], v234 offset:0
ds_read_b64_tr_b16 v[90:91], v234 offset:1024
ds_read_b64_tr_b16 v[92:93], v235 offset:0
buffer_load_dwordx4 v225, s[32:35], s65 offen offset:1024 lds
v_mfma_f32_16x16x32_bf16 v[112:115], v[152:155], v[76:79], v[112:115]
ds_read_b64_tr_b16 v[94:95], v235 offset:1024
ds_read_b128 v[44:47], v171 offset:32768
v_mfma_f32_16x16x32_bf16 v[116:119], v[156:159], v[76:79], v[116:119]
ds_read_b128 v[48:51], v172 offset:32768
ds_read_b128 v[52:55], v173 offset:32768
buffer_load_dwordx4 v226, s[32:35], s65 offen offset:2048 lds
s_waitcnt lgkmcnt(7)
v_mfma_f32_16x16x32_bf16 v[96:99], v[80:83], v[32:35], v[96:99]
ds_read_b64_tr_b16 v[144:145], v236 offset:0
ds_read_b64_tr_b16 v[146:147], v236 offset:1024
v_mfma_f32_16x16x32_bf16 v[100:103], v[84:87], v[32:35], v[100:103]
ds_read_b64_tr_b16 v[148:149], v237 offset:0
s_add_u32 s66, s62, 7
s_and_b32 s66, s66, 7
s_lshl_b32 s66, s66, 20
s_add_u32 m0, s57, 24576
s_nop 0
buffer_load_dwordx4 v228, s[36:39], s66 offen offset:0 lds
v_mfma_f32_16x16x32_bf16 v[104:107], v[80:83], v[36:39], v[104:107]
ds_read_b64_tr_b16 v[150:151], v237 offset:1024
v_mfma_f32_16x16x32_bf16 v[108:111], v[84:87], v[36:39], v[108:111]
ds_read_b128 v[56:59], v174 offset:32768
buffer_load_dwordx4 v229, s[36:39], s66 offen offset:1024 lds
v_mfma_f32_16x16x32_bf16 v[112:115], v[80:83], v[40:43], v[112:115]
ds_read_b128 v[60:63], v175 offset:32768
v_mfma_f32_16x16x32_bf16 v[116:119], v[84:87], v[40:43], v[116:119]
ds_read_b128 v[64:67], v176 offset:32768
buffer_load_dwordx4 v230, s[36:39], s66 offen offset:2048 lds
s_waitcnt lgkmcnt(7)
v_mfma_f32_16x16x32_bf16 v[96:99], v[88:91], v[44:47], v[96:99]
ds_read_b64_tr_b16 v[152:153], v238 offset:0
ds_read_b64_tr_b16 v[154:155], v238 offset:1024
v_mfma_f32_16x16x32_bf16 v[100:103], v[92:95], v[44:47], v[100:103]
ds_read_b64_tr_b16 v[156:157], v239 offset:0
v_mfma_f32_16x16x32_bf16 v[104:107], v[88:91], v[48:51], v[104:107]
ds_read_b64_tr_b16 v[158:159], v239 offset:1024
buffer_load_dwordx4 v231, s[36:39], s66 offen offset:3072 lds
v_mfma_f32_16x16x32_bf16 v[108:111], v[92:95], v[48:51], v[108:111]
ds_read_b128 v[68:71], v177 offset:32768
v_mfma_f32_16x16x32_bf16 v[112:115], v[88:91], v[52:55], v[112:115]
ds_read_b128 v[72:75], v178 offset:32768
s_add_u32 m0, s57, 28672
s_add_u32 s67, s66, 131072
buffer_load_dwordx4 v228, s[36:39], s67 offen offset:0 lds
v_mfma_f32_16x16x32_bf16 v[116:119], v[92:95], v[52:55], v[116:119]
ds_read_b128 v[76:79], v179 offset:32768
s_waitcnt lgkmcnt(7)
v_mfma_f32_16x16x32_bf16 v[96:99], v[144:147], v[56:59], v[96:99]
buffer_load_dwordx4 v229, s[36:39], s67 offen offset:1024 lds
v_mfma_f32_16x16x32_bf16 v[100:103], v[148:151], v[56:59], v[100:103]
v_mfma_f32_16x16x32_bf16 v[104:107], v[144:147], v[60:63], v[104:107]
buffer_load_dwordx4 v230, s[36:39], s67 offen offset:2048 lds
v_mfma_f32_16x16x32_bf16 v[108:111], v[148:151], v[60:63], v[108:111]
v_mfma_f32_16x16x32_bf16 v[112:115], v[144:147], v[64:67], v[112:115]
buffer_load_dwordx4 v231, s[36:39], s67 offen offset:3072 lds
v_mfma_f32_16x16x32_bf16 v[116:119], v[148:151], v[64:67], v[116:119]
s_waitcnt vmcnt(8)
s_waitcnt lgkmcnt(0)
s_barrier
v_mfma_f32_16x16x32_bf16 v[96:99], v[152:155], v[68:71], v[96:99]
ds_read_b64_tr_b16 v[80:81], v232 offset:8192
ds_read_b64_tr_b16 v[82:83], v232 offset:9216
ds_read_b64_tr_b16 v[84:85], v233 offset:8192
s_add_u32 m0, s57, 32768
s_add_u32 s65, s62, 6
s_and_b32 s65, s65, 7
s_lshl_b32 s65, s65, 8
buffer_load_dwordx4 v224, s[32:35], s65 offen offset:0 lds
v_mfma_f32_16x16x32_bf16 v[100:103], v[156:159], v[68:71], v[100:103]
ds_read_b64_tr_b16 v[86:87], v233 offset:9216
ds_read_b128 v[32:35], v168 offset:35840
v_mfma_f32_16x16x32_bf16 v[104:107], v[152:155], v[72:75], v[104:107]
ds_read_b128 v[36:39], v169 offset:35840
ds_read_b128 v[40:43], v170 offset:35840
v_mfma_f32_16x16x32_bf16 v[108:111], v[156:159], v[72:75], v[108:111]
ds_read_b64_tr_b16 v[88:89], v234 offset:8192
ds_read_b64_tr_b16 v[90:91], v234 offset:9216
ds_read_b64_tr_b16 v[92:93], v235 offset:8192
buffer_load_dwordx4 v225, s[32:35], s65 offen offset:1024 lds
v_mfma_f32_16x16x32_bf16 v[112:115], v[152:155], v[76:79], v[112:115]
ds_read_b64_tr_b16 v[94:95], v235 offset:9216
ds_read_b128 v[44:47], v171 offset:35840
v_mfma_f32_16x16x32_bf16 v[116:119], v[156:159], v[76:79], v[116:119]
ds_read_b128 v[48:51], v172 offset:35840
ds_read_b128 v[52:55], v173 offset:35840
buffer_load_dwordx4 v226, s[32:35], s65 offen offset:2048 lds
s_waitcnt lgkmcnt(7)
v_mfma_f32_16x16x32_bf16 v[96:99], v[80:83], v[32:35], v[96:99]
ds_read_b64_tr_b16 v[144:145], v236 offset:8192
ds_read_b64_tr_b16 v[146:147], v236 offset:9216
v_mfma_f32_16x16x32_bf16 v[100:103], v[84:87], v[32:35], v[100:103]
ds_read_b64_tr_b16 v[148:149], v237 offset:8192
s_bfe_u32 s66, s77, 0x30000
s_lshl_b32 s66, s66, 20
s_add_u32 m0, s57, 0
s_nop 0
buffer_load_dwordx4 v228, s[16:19], s66 offen offset:0 lds
v_mfma_f32_16x16x32_bf16 v[104:107], v[80:83], v[36:39], v[104:107]
ds_read_b64_tr_b16 v[150:151], v237 offset:9216
v_mfma_f32_16x16x32_bf16 v[108:111], v[84:87], v[36:39], v[108:111]
ds_read_b128 v[56:59], v174 offset:35840
buffer_load_dwordx4 v229, s[16:19], s66 offen offset:1024 lds
v_mfma_f32_16x16x32_bf16 v[112:115], v[80:83], v[40:43], v[112:115]
ds_read_b128 v[60:63], v175 offset:35840
v_mfma_f32_16x16x32_bf16 v[116:119], v[84:87], v[40:43], v[116:119]
ds_read_b128 v[64:67], v176 offset:35840
buffer_load_dwordx4 v230, s[16:19], s66 offen offset:2048 lds
s_waitcnt lgkmcnt(7)
v_mfma_f32_16x16x32_bf16 v[96:99], v[88:91], v[44:47], v[96:99]
ds_read_b64_tr_b16 v[152:153], v238 offset:8192
ds_read_b64_tr_b16 v[154:155], v238 offset:9216
v_mfma_f32_16x16x32_bf16 v[100:103], v[92:95], v[44:47], v[100:103]
ds_read_b64_tr_b16 v[156:157], v239 offset:8192
v_mfma_f32_16x16x32_bf16 v[104:107], v[88:91], v[48:51], v[104:107]
ds_read_b64_tr_b16 v[158:159], v239 offset:9216
buffer_load_dwordx4 v231, s[16:19], s66 offen offset:3072 lds
v_mfma_f32_16x16x32_bf16 v[108:111], v[92:95], v[48:51], v[108:111]
ds_read_b128 v[68:71], v177 offset:35840
v_mfma_f32_16x16x32_bf16 v[112:115], v[88:91], v[52:55], v[112:115]
ds_read_b128 v[72:75], v178 offset:35840
s_add_u32 m0, s57, 4096
s_add_u32 s67, s66, 131072
buffer_load_dwordx4 v228, s[16:19], s67 offen offset:0 lds
v_mfma_f32_16x16x32_bf16 v[116:119], v[92:95], v[52:55], v[116:119]
ds_read_b128 v[76:79], v179 offset:35840
s_waitcnt lgkmcnt(7)
v_mfma_f32_16x16x32_bf16 v[96:99], v[144:147], v[56:59], v[96:99]
buffer_load_dwordx4 v229, s[16:19], s67 offen offset:1024 lds
v_mfma_f32_16x16x32_bf16 v[100:103], v[148:151], v[56:59], v[100:103]
v_mfma_f32_16x16x32_bf16 v[104:107], v[144:147], v[60:63], v[104:107]
buffer_load_dwordx4 v230, s[16:19], s67 offen offset:2048 lds
v_mfma_f32_16x16x32_bf16 v[108:111], v[148:151], v[60:63], v[108:111]
v_mfma_f32_16x16x32_bf16 v[112:115], v[144:147], v[64:67], v[112:115]
buffer_load_dwordx4 v231, s[16:19], s67 offen offset:3072 lds
v_mfma_f32_16x16x32_bf16 v[116:119], v[148:151], v[64:67], v[116:119]
s_waitcnt vmcnt(8)
s_waitcnt lgkmcnt(0)
s_barrier
v_mfma_f32_16x16x32_bf16 v[96:99], v[152:155], v[68:71], v[96:99]
ds_read_b64_tr_b16 v[80:81], v232 offset:16384
ds_read_b64_tr_b16 v[82:83], v232 offset:17408
ds_read_b64_tr_b16 v[84:85], v233 offset:16384
s_add_u32 m0, s57, 35840
s_add_u32 s65, s62, 7
s_and_b32 s65, s65, 7
s_lshl_b32 s65, s65, 8
buffer_load_dwordx4 v224, s[32:35], s65 offen offset:0 lds
v_mfma_f32_16x16x32_bf16 v[100:103], v[156:159], v[68:71], v[100:103]
ds_read_b64_tr_b16 v[86:87], v233 offset:17408
ds_read_b128 v[32:35], v168 offset:32768
v_mfma_f32_16x16x32_bf16 v[104:107], v[152:155], v[72:75], v[104:107]
ds_read_b128 v[36:39], v169 offset:32768
ds_read_b128 v[40:43], v170 offset:32768
v_mfma_f32_16x16x32_bf16 v[108:111], v[156:159], v[72:75], v[108:111]
ds_read_b64_tr_b16 v[88:89], v234 offset:16384
ds_read_b64_tr_b16 v[90:91], v234 offset:17408
ds_read_b64_tr_b16 v[92:93], v235 offset:16384
buffer_load_dwordx4 v225, s[32:35], s65 offen offset:1024 lds
v_mfma_f32_16x16x32_bf16 v[112:115], v[152:155], v[76:79], v[112:115]
ds_read_b64_tr_b16 v[94:95], v235 offset:17408
ds_read_b128 v[44:47], v171 offset:32768
v_mfma_f32_16x16x32_bf16 v[116:119], v[156:159], v[76:79], v[116:119]
ds_read_b128 v[48:51], v172 offset:32768
ds_read_b128 v[52:55], v173 offset:32768
buffer_load_dwordx4 v226, s[32:35], s65 offen offset:2048 lds
s_waitcnt lgkmcnt(7)
v_mfma_f32_16x16x32_bf16 v[96:99], v[80:83], v[32:35], v[96:99]
ds_read_b64_tr_b16 v[144:145], v236 offset:16384
ds_read_b64_tr_b16 v[146:147], v236 offset:17408
v_mfma_f32_16x16x32_bf16 v[100:103], v[84:87], v[32:35], v[100:103]
ds_read_b64_tr_b16 v[148:149], v237 offset:16384
s_bfe_u32 s66, s77, 0x30000
s_lshl_b32 s66, s66, 20
s_add_u32 s66, s66, 256
s_add_u32 m0, s57, 8192
s_nop 0
buffer_load_dwordx4 v228, s[16:19], s66 offen offset:0 lds
v_mfma_f32_16x16x32_bf16 v[104:107], v[80:83], v[36:39], v[104:107]
ds_read_b64_tr_b16 v[150:151], v237 offset:17408
v_mfma_f32_16x16x32_bf16 v[108:111], v[84:87], v[36:39], v[108:111]
ds_read_b128 v[56:59], v174 offset:32768
buffer_load_dwordx4 v229, s[16:19], s66 offen offset:1024 lds
v_mfma_f32_16x16x32_bf16 v[112:115], v[80:83], v[40:43], v[112:115]
ds_read_b128 v[60:63], v175 offset:32768
v_mfma_f32_16x16x32_bf16 v[116:119], v[84:87], v[40:43], v[116:119]
ds_read_b128 v[64:67], v176 offset:32768
buffer_load_dwordx4 v230, s[16:19], s66 offen offset:2048 lds
s_waitcnt lgkmcnt(7)
v_mfma_f32_16x16x32_bf16 v[96:99], v[88:91], v[44:47], v[96:99]
ds_read_b64_tr_b16 v[152:153], v238 offset:16384
ds_read_b64_tr_b16 v[154:155], v238 offset:17408
v_mfma_f32_16x16x32_bf16 v[100:103], v[92:95], v[44:47], v[100:103]
ds_read_b64_tr_b16 v[156:157], v239 offset:16384
v_mfma_f32_16x16x32_bf16 v[104:107], v[88:91], v[48:51], v[104:107]
ds_read_b64_tr_b16 v[158:159], v239 offset:17408
buffer_load_dwordx4 v231, s[16:19], s66 offen offset:3072 lds
v_mfma_f32_16x16x32_bf16 v[108:111], v[92:95], v[48:51], v[108:111]
ds_read_b128 v[68:71], v177 offset:32768
v_mfma_f32_16x16x32_bf16 v[112:115], v[88:91], v[52:55], v[112:115]
ds_read_b128 v[72:75], v178 offset:32768
s_add_u32 m0, s57, 12288
s_add_u32 s67, s66, 131072
buffer_load_dwordx4 v228, s[16:19], s67 offen offset:0 lds
v_mfma_f32_16x16x32_bf16 v[116:119], v[92:95], v[52:55], v[116:119]
ds_read_b128 v[76:79], v179 offset:32768
s_waitcnt lgkmcnt(7)
v_mfma_f32_16x16x32_bf16 v[96:99], v[144:147], v[56:59], v[96:99]
buffer_load_dwordx4 v229, s[16:19], s67 offen offset:1024 lds
v_mfma_f32_16x16x32_bf16 v[100:103], v[148:151], v[56:59], v[100:103]
v_mfma_f32_16x16x32_bf16 v[104:107], v[144:147], v[60:63], v[104:107]
buffer_load_dwordx4 v230, s[16:19], s67 offen offset:2048 lds
v_mfma_f32_16x16x32_bf16 v[108:111], v[148:151], v[60:63], v[108:111]
v_mfma_f32_16x16x32_bf16 v[112:115], v[144:147], v[64:67], v[112:115]
buffer_load_dwordx4 v231, s[16:19], s67 offen offset:3072 lds
v_mfma_f32_16x16x32_bf16 v[116:119], v[148:151], v[64:67], v[116:119]
s_waitcnt vmcnt(8)
s_waitcnt lgkmcnt(0)
s_barrier
v_mfma_f32_16x16x32_bf16 v[96:99], v[152:155], v[68:71], v[96:99]
ds_read_b64_tr_b16 v[80:81], v232 offset:24576
ds_read_b64_tr_b16 v[82:83], v232 offset:25600
ds_read_b64_tr_b16 v[84:85], v233 offset:24576
s_add_u32 m0, s57, 32768
s_bfe_u32 s65, s77, 0x30000
s_lshl_b32 s65, s65, 8
buffer_load_dwordx4 v224, s[52:55], s65 offen offset:0 lds
v_mfma_f32_16x16x32_bf16 v[100:103], v[156:159], v[68:71], v[100:103]
ds_read_b64_tr_b16 v[86:87], v233 offset:25600
ds_read_b128 v[32:35], v168 offset:35840
v_mfma_f32_16x16x32_bf16 v[104:107], v[152:155], v[72:75], v[104:107]
ds_read_b128 v[36:39], v169 offset:35840
ds_read_b128 v[40:43], v170 offset:35840
v_mfma_f32_16x16x32_bf16 v[108:111], v[156:159], v[72:75], v[108:111]
ds_read_b64_tr_b16 v[88:89], v234 offset:24576
ds_read_b64_tr_b16 v[90:91], v234 offset:25600
ds_read_b64_tr_b16 v[92:93], v235 offset:24576
buffer_load_dwordx4 v225, s[52:55], s65 offen offset:1024 lds
v_mfma_f32_16x16x32_bf16 v[112:115], v[152:155], v[76:79], v[112:115]
ds_read_b64_tr_b16 v[94:95], v235 offset:25600
ds_read_b128 v[44:47], v171 offset:35840
v_mfma_f32_16x16x32_bf16 v[116:119], v[156:159], v[76:79], v[116:119]
ds_read_b128 v[48:51], v172 offset:35840
ds_read_b128 v[52:55], v173 offset:35840
buffer_load_dwordx4 v226, s[52:55], s65 offen offset:2048 lds
s_waitcnt lgkmcnt(7)
v_mfma_f32_16x16x32_bf16 v[96:99], v[80:83], v[32:35], v[96:99]
ds_read_b64_tr_b16 v[144:145], v236 offset:24576
ds_read_b64_tr_b16 v[146:147], v236 offset:25600
v_mfma_f32_16x16x32_bf16 v[100:103], v[84:87], v[32:35], v[100:103]
ds_read_b64_tr_b16 v[148:149], v237 offset:24576
s_bfe_u32 s66, s77, 0x30004
s_lshl_b32 s66, s66, 20
s_add_u32 m0, s57, 16384
s_nop 0
buffer_load_dwordx4 v228, s[16:19], s66 offen offset:0 lds
v_mfma_f32_16x16x32_bf16 v[104:107], v[80:83], v[36:39], v[104:107]
ds_read_b64_tr_b16 v[150:151], v237 offset:25600
v_mfma_f32_16x16x32_bf16 v[108:111], v[84:87], v[36:39], v[108:111]
ds_read_b128 v[56:59], v174 offset:35840
buffer_load_dwordx4 v229, s[16:19], s66 offen offset:1024 lds
v_mfma_f32_16x16x32_bf16 v[112:115], v[80:83], v[40:43], v[112:115]
ds_read_b128 v[60:63], v175 offset:35840
v_mfma_f32_16x16x32_bf16 v[116:119], v[84:87], v[40:43], v[116:119]
ds_read_b128 v[64:67], v176 offset:35840
buffer_load_dwordx4 v230, s[16:19], s66 offen offset:2048 lds
s_waitcnt lgkmcnt(7)
v_mfma_f32_16x16x32_bf16 v[96:99], v[88:91], v[44:47], v[96:99]
ds_read_b64_tr_b16 v[152:153], v238 offset:24576
ds_read_b64_tr_b16 v[154:155], v238 offset:25600
v_mfma_f32_16x16x32_bf16 v[100:103], v[92:95], v[44:47], v[100:103]
ds_read_b64_tr_b16 v[156:157], v239 offset:24576
v_mfma_f32_16x16x32_bf16 v[104:107], v[88:91], v[48:51], v[104:107]
ds_read_b64_tr_b16 v[158:159], v239 offset:25600
buffer_load_dwordx4 v231, s[16:19], s66 offen offset:3072 lds
v_mfma_f32_16x16x32_bf16 v[108:111], v[92:95], v[48:51], v[108:111]
ds_read_b128 v[68:71], v177 offset:35840
v_mfma_f32_16x16x32_bf16 v[112:115], v[88:91], v[52:55], v[112:115]
ds_read_b128 v[72:75], v178 offset:35840
s_add_u32 m0, s57, 20480
s_add_u32 s67, s66, 131072
buffer_load_dwordx4 v228, s[16:19], s67 offen offset:0 lds
v_mfma_f32_16x16x32_bf16 v[116:119], v[92:95], v[52:55], v[116:119]
ds_read_b128 v[76:79], v179 offset:35840
s_waitcnt lgkmcnt(7)
v_mfma_f32_16x16x32_bf16 v[96:99], v[144:147], v[56:59], v[96:99]
buffer_load_dwordx4 v229, s[16:19], s67 offen offset:1024 lds
v_mfma_f32_16x16x32_bf16 v[100:103], v[148:151], v[56:59], v[100:103]
v_mfma_f32_16x16x32_bf16 v[104:107], v[144:147], v[60:63], v[104:107]
buffer_load_dwordx4 v230, s[16:19], s67 offen offset:2048 lds
v_mfma_f32_16x16x32_bf16 v[108:111], v[148:151], v[60:63], v[108:111]
v_mfma_f32_16x16x32_bf16 v[112:115], v[144:147], v[64:67], v[112:115]
buffer_load_dwordx4 v231, s[16:19], s67 offen offset:3072 lds
v_mfma_f32_16x16x32_bf16 v[116:119], v[148:151], v[64:67], v[116:119]
s_waitcnt lgkmcnt(0)
v_mfma_f32_16x16x32_bf16 v[96:99], v[152:155], v[68:71], v[96:99]
v_mfma_f32_16x16x32_bf16 v[100:103], v[156:159], v[68:71], v[100:103]
v_mfma_f32_16x16x32_bf16 v[104:107], v[152:155], v[72:75], v[104:107]
v_mfma_f32_16x16x32_bf16 v[108:111], v[156:159], v[72:75], v[108:111]
v_mfma_f32_16x16x32_bf16 v[112:115], v[152:155], v[76:79], v[112:115]
v_mfma_f32_16x16x32_bf16 v[116:119], v[156:159], v[76:79], v[116:119]
s_mov_b32 s64, 0x3e0293ee
s_mov_b32 s65, 0x3e0293ee
s_nop 0
v_pk_mul_f32 v[96:97], v[96:97], s[64:65]
v_pk_mul_f32 v[98:99], v[98:99], s[64:65]
v_pk_mul_f32 v[100:101], v[100:101], s[64:65]
v_pk_mul_f32 v[102:103], v[102:103], s[64:65]
v_pk_mul_f32 v[104:105], v[104:105], s[64:65]
v_pk_mul_f32 v[106:107], v[106:107], s[64:65]
v_pk_mul_f32 v[108:109], v[108:109], s[64:65]
v_pk_mul_f32 v[110:111], v[110:111], s[64:65]
v_pk_mul_f32 v[112:113], v[112:113], s[64:65]
v_pk_mul_f32 v[114:115], v[114:115], s[64:65]
v_pk_mul_f32 v[116:117], v[116:117], s[64:65]
v_pk_mul_f32 v[118:119], v[118:119], s[64:65]
v_cvt_pk_bf16_f32 v96, v96, v97
v_cvt_pk_bf16_f32 v97, v98, v99
v_cvt_pk_bf16_f32 v98, v100, v101
v_cvt_pk_bf16_f32 v99, v102, v103
v_cvt_pk_bf16_f32 v100, v104, v105
v_cvt_pk_bf16_f32 v101, v106, v107
v_cvt_pk_bf16_f32 v102, v108, v109
v_cvt_pk_bf16_f32 v103, v110, v111
v_cvt_pk_bf16_f32 v104, v112, v113
v_cvt_pk_bf16_f32 v105, v114, v115
v_cvt_pk_bf16_f32 v106, v116, v117
v_cvt_pk_bf16_f32 v107, v118, v119
v_permlane32_swap_b32 v96, v98
v_permlane32_swap_b32 v97, v99
v_permlane32_swap_b32 v100, v102
v_permlane32_swap_b32 v101, v103
v_permlane32_swap_b32 v104, v106
v_permlane32_swap_b32 v105, v107
v_permlane16_swap_b32 v96, v98
v_permlane16_swap_b32 v97, v99
v_permlane16_swap_b32 v100, v102
v_permlane16_swap_b32 v101, v103
v_permlane16_swap_b32 v104, v106
v_permlane16_swap_b32 v105, v107
s_lshl_b32 s64, s60, 5
s_add_u32 s64, s64, s61
s_mul_i32 s64, s64, 12288
s_add_u32 s64, s64, 8388608
s_add_u32 s32, s28, s64
s_addc_u32 s33, s29, 0
s_mov_b32 s34, 12288
s_mov_b32 s35, 0x20000
s_lshl_b32 s65, s56, 10
buffer_store_dwordx4 v[96:99], v213, s[32:35], s65 offen sc1 nt
s_add_u32 s65, s65, 4096
buffer_store_dwordx4 v[100:103], v213, s[32:35], s65 offen sc1 nt
s_add_u32 s65, s65, 4096
buffer_store_dwordx4 v[104:107], v213, s[32:35], s65 offen sc1 nt
v_mov_b32 v248, 0
global_load_dword v248, v248, s[26:27] sc1
s_lshl_b32 s64, s60, 5
s_add_u32 s64, s64, s61
s_add_u32 s64, s64, 0
s_lshl_b32 s64, s64, 5
s_add_u32 s64, s64, s56
s_lshl_b32 s64, s64, 2
v_mov_b32 v216, s64
v_mov_b32 v217, 1
s_and_b32 s64, s59, 15
s_cmp_eq_u32 s64, 0
s_cselect_b32 s96, 0x76543210, s96
s_cselect_b32 s97, 0xfedcba98, s97
s_cmp_eq_u32 s64, 1
s_cselect_b32 s96, 0x76543210, s96
s_cselect_b32 s97, 0xfedcba98, s97
s_cmp_eq_u32 s64, 2
s_cselect_b32 s96, 0x76543210, s96
s_cselect_b32 s97, 0xfedcba98, s97
s_cmp_eq_u32 s64, 3
s_cselect_b32 s96, 0x76543210, s96
s_cselect_b32 s97, 0xfedcba98, s97
s_cmp_eq_u32 s64, 4
s_cselect_b32 s96, 0x86453120, s96
s_cselect_b32 s97, 0xfdecab97, s97
s_cmp_eq_u32 s64, 5
s_cselect_b32 s96, 0x67534201, s96
s_cselect_b32 s97, 0xfecdb9a8, s97
s_cmp_eq_u32 s64, 6
s_cselect_b32 s96, 0x75642310, s96
s_cselect_b32 s97, 0xefdbca89, s97
s_cmp_eq_u32 s64, 7
s_cselect_b32 s96, 0x86453120, s96
s_cselect_b32 s97, 0xfdecab97, s97
s_cmp_eq_u32 s64, 8
s_cselect_b32 s96, 0x76543210, s96
s_cselect_b32 s97, 0xfedcba98, s97
s_cmp_eq_u32 s64, 9
s_cselect_b32 s96, 0x76543210, s96
s_cselect_b32 s97, 0xfedcba98, s97
s_cmp_eq_u32 s64, 10
s_cselect_b32 s96, 0x76543210, s96
s_cselect_b32 s97, 0xfedcba98, s97
s_cmp_eq_u32 s64, 11
s_cselect_b32 s96, 0x76543210, s96
s_cselect_b32 s97, 0xfedcba98, s97
s_cmp_eq_u32 s64, 12
s_cselect_b32 s96, 0x86453120, s96
s_cselect_b32 s97, 0xfdecab97, s97
s_cmp_eq_u32 s64, 13
s_cselect_b32 s96, 0x67534201, s96
s_cselect_b32 s97, 0xfecdb9a8, s97
s_cmp_eq_u32 s64, 14
s_cselect_b32 s96, 0x75642310, s96
s_cselect_b32 s97, 0xefdbca89, s97
s_cmp_eq_u32 s64, 15
s_cselect_b32 s96, 0x86453120, s96
s_cselect_b32 s97, 0xfdecab97, s97
s_and_b32 s64, s59, 3
s_lshl2_add_u32 s64, s64, s58
s_and_b32 s64, s64, 15
s_mul_i32 s64, s64, 0x11111111
s_xor_b32 s96, s96, s64
s_xor_b32 s97, s97, s64
s_mov_b32 s60, s30
s_mov_b32 s61, s78
s_lshl_b32 s64, s60, 5
s_add_u32 s64, s64, s61
s_mul_i32 s64, s64, 12288
s_add_u32 s48, s28, s64
s_addc_u32 s49, s29, 0
s_mov_b32 s50, 24576
s_mov_b32 s51, 0x20000
s_waitcnt vmcnt(12)
s_barrier
ds_read_b64_tr_b16 v[80:81], v232 offset:0
ds_read_b64_tr_b16 v[82:83], v232 offset:1024
ds_read_b64_tr_b16 v[84:85], v233 offset:0
s_add_u32 m0, s57, 35840
s_bfe_u32 s65, s77, 0x30004
s_lshl_b32 s65, s65, 8
buffer_load_dwordx4 v224, s[52:55], s65 offen offset:0 lds
ds_read_b64_tr_b16 v[86:87], v233 offset:1024
ds_read_b128 v[32:35], v168 offset:32768
ds_read_b128 v[36:39], v169 offset:32768
ds_read_b128 v[40:43], v170 offset:32768
ds_read_b64_tr_b16 v[88:89], v234 offset:0
ds_read_b64_tr_b16 v[90:91], v234 offset:1024
ds_read_b64_tr_b16 v[92:93], v235 offset:0
buffer_load_dwordx4 v225, s[52:55], s65 offen offset:1024 lds
ds_read_b64_tr_b16 v[94:95], v235 offset:1024
ds_read_b128 v[44:47], v171 offset:32768
ds_read_b128 v[48:51], v172 offset:32768
ds_read_b128 v[52:55], v173 offset:32768
buffer_load_dwordx4 v226, s[52:55], s65 offen offset:2048 lds
s_waitcnt lgkmcnt(7)
v_mfma_f32_16x16x32_bf16 v[96:99], v[80:83], v[32:35], 0
ds_read_b64_tr_b16 v[144:145], v236 offset:0
ds_read_b64_tr_b16 v[146:147], v236 offset:1024
v_mfma_f32_16x16x32_bf16 v[100:103], v[84:87], v[32:35], 0
ds_read_b64_tr_b16 v[148:149], v237 offset:0
s_bfe_u32 s66, s77, 0x30004
s_lshl_b32 s66, s66, 20
s_add_u32 s66, s66, 256
s_add_u32 m0, s57, 24576
s_nop 0
buffer_load_dwordx4 v228, s[16:19], s66 offen offset:0 lds
v_mfma_f32_16x16x32_bf16 v[104:107], v[80:83], v[36:39], 0
ds_read_b64_tr_b16 v[150:151], v237 offset:1024
v_mfma_f32_16x16x32_bf16 v[108:111], v[84:87], v[36:39], 0
ds_read_b128 v[56:59], v174 offset:32768
buffer_load_dwordx4 v229, s[16:19], s66 offen offset:1024 lds
v_mfma_f32_16x16x32_bf16 v[112:115], v[80:83], v[40:43], 0
ds_read_b128 v[60:63], v175 offset:32768
v_mfma_f32_16x16x32_bf16 v[116:119], v[84:87], v[40:43], 0
ds_read_b128 v[64:67], v176 offset:32768
buffer_load_dwordx4 v230, s[16:19], s66 offen offset:2048 lds
s_waitcnt lgkmcnt(7)
v_mfma_f32_16x16x32_bf16 v[96:99], v[88:91], v[44:47], v[96:99]
ds_read_b64_tr_b16 v[152:153], v238 offset:0
ds_read_b64_tr_b16 v[154:155], v238 offset:1024
v_mfma_f32_16x16x32_bf16 v[100:103], v[92:95], v[44:47], v[100:103]
ds_read_b64_tr_b16 v[156:157], v239 offset:0
v_mfma_f32_16x16x32_bf16 v[104:107], v[88:91], v[48:51], v[104:107]
ds_read_b64_tr_b16 v[158:159], v239 offset:1024
buffer_load_dwordx4 v231, s[16:19], s66 offen offset:3072 lds
v_mfma_f32_16x16x32_bf16 v[108:111], v[92:95], v[48:51], v[108:111]
ds_read_b128 v[68:71], v177 offset:32768
v_mfma_f32_16x16x32_bf16 v[112:115], v[88:91], v[52:55], v[112:115]
ds_read_b128 v[72:75], v178 offset:32768
s_add_u32 m0, s57, 28672
s_add_u32 s67, s66, 131072
buffer_load_dwordx4 v228, s[16:19], s67 offen offset:0 lds
v_mfma_f32_16x16x32_bf16 v[116:119], v[92:95], v[52:55], v[116:119]
ds_read_b128 v[76:79], v179 offset:32768
s_waitcnt lgkmcnt(7)
v_mfma_f32_16x16x32_bf16 v[96:99], v[144:147], v[56:59], v[96:99]
buffer_load_dwordx4 v229, s[16:19], s67 offen offset:1024 lds
v_mfma_f32_16x16x32_bf16 v[100:103], v[148:151], v[56:59], v[100:103]
v_mfma_f32_16x16x32_bf16 v[104:107], v[144:147], v[60:63], v[104:107]
buffer_load_dwordx4 v230, s[16:19], s67 offen offset:2048 lds
v_mfma_f32_16x16x32_bf16 v[108:111], v[148:151], v[60:63], v[108:111]
v_mfma_f32_16x16x32_bf16 v[112:115], v[144:147], v[64:67], v[112:115]
buffer_load_dwordx4 v231, s[16:19], s67 offen offset:3072 lds
v_mfma_f32_16x16x32_bf16 v[116:119], v[148:151], v[64:67], v[116:119]
s_waitcnt lgkmcnt(0)
s_barrier
v_mfma_f32_16x16x32_bf16 v[96:99], v[152:155], v[68:71], v[96:99]
ds_read_b64_tr_b16 v[80:81], v232 offset:8192
ds_read_b64_tr_b16 v[82:83], v232 offset:9216
s_bfe_u32 s66, s77, 0x30008
s_lshl_b32 s66, s66, 20
s_add_u32 m0, s57, 0
s_nop 0
buffer_load_dwordx4 v228, s[16:19], s66 offen offset:0 lds
v_mfma_f32_16x16x32_bf16 v[100:103], v[156:159], v[68:71], v[100:103]
ds_read_b64_tr_b16 v[84:85], v233 offset:8192
v_mfma_f32_16x16x32_bf16 v[104:107], v[152:155], v[72:75], v[104:107]
ds_read_b64_tr_b16 v[86:87], v233 offset:9216
v_mfma_f32_16x16x32_bf16 v[108:111], v[156:159], v[72:75], v[108:111]
ds_read_b64_tr_b16 v[88:89], v234 offset:8192
ds_read_b64_tr_b16 v[90:91], v234 offset:9216
buffer_load_dwordx4 v229, s[16:19], s66 offen offset:1024 lds
v_mfma_f32_16x16x32_bf16 v[112:115], v[152:155], v[76:79], v[112:115]
ds_read_b64_tr_b16 v[92:93], v235 offset:8192
v_mfma_f32_16x16x32_bf16 v[116:119], v[156:159], v[76:79], v[116:119]
ds_read_b64_tr_b16 v[94:95], v235 offset:9216
s_waitcnt lgkmcnt(4)
v_mfma_f32_16x16x32_bf16 v[120:123], v[80:83], v[32:35], 0
ds_read_b64_tr_b16 v[144:145], v236 offset:8192
buffer_load_dwordx4 v230, s[16:19], s66 offen offset:2048 lds
v_mfma_f32_16x16x32_bf16 v[124:127], v[84:87], v[32:35], 0
ds_read_b64_tr_b16 v[146:147], v236 offset:9216
v_mfma_f32_16x16x32_bf16 v[128:131], v[80:83], v[36:39], 0
v_mfma_f32_16x16x32_bf16 v[132:135], v[84:87], v[36:39], 0
ds_read_b64_tr_b16 v[148:149], v237 offset:8192
buffer_load_dwordx4 v231, s[16:19], s66 offen offset:3072 lds
v_mfma_f32_16x16x32_bf16 v[136:139], v[80:83], v[40:43], 0
ds_read_b64_tr_b16 v[150:151], v237 offset:9216
v_mfma_f32_16x16x32_bf16 v[140:143], v[84:87], v[40:43], 0
s_waitcnt lgkmcnt(4)
v_mfma_f32_16x16x32_bf16 v[120:123], v[88:91], v[44:47], v[120:123]
ds_read_b64_tr_b16 v[152:153], v238 offset:8192
s_add_u32 m0, s57, 4096
s_add_u32 s67, s66, 131072
buffer_load_dwordx4 v228, s[16:19], s67 offen offset:0 lds
v_mfma_f32_16x16x32_bf16 v[124:127], v[92:95], v[44:47], v[124:127]
ds_read_b64_tr_b16 v[154:155], v238 offset:9216
v_mfma_f32_16x16x32_bf16 v[128:131], v[88:91], v[48:51], v[128:131]
v_mfma_f32_16x16x32_bf16 v[132:135], v[92:95], v[48:51], v[132:135]
ds_read_b64_tr_b16 v[156:157], v239 offset:8192
buffer_load_dwordx4 v229, s[16:19], s67 offen offset:1024 lds
v_mfma_f32_16x16x32_bf16 v[136:139], v[88:91], v[52:55], v[136:139]
ds_read_b64_tr_b16 v[158:159], v239 offset:9216
v_mfma_f32_16x16x32_bf16 v[140:143], v[92:95], v[52:55], v[140:143]
s_waitcnt lgkmcnt(4)
v_mfma_f32_16x16x32_bf16 v[120:123], v[144:147], v[56:59], v[120:123]
buffer_load_dwordx4 v230, s[16:19], s67 offen offset:2048 lds
v_mfma_f32_16x16x32_bf16 v[124:127], v[148:151], v[56:59], v[124:127]
v_mfma_f32_16x16x32_bf16 v[128:131], v[144:147], v[60:63], v[128:131]
v_mfma_f32_16x16x32_bf16 v[132:135], v[148:151], v[60:63], v[132:135]
buffer_load_dwordx4 v231, s[16:19], s67 offen offset:3072 lds
v_mfma_f32_16x16x32_bf16 v[136:139], v[144:147], v[64:67], v[136:139]
v_mfma_f32_16x16x32_bf16 v[140:143], v[148:151], v[64:67], v[140:143]
s_waitcnt vmcnt(23)
s_waitcnt vmcnt(16)
s_waitcnt lgkmcnt(0)
s_barrier
v_mfma_f32_16x16x32_bf16 v[120:123], v[152:155], v[68:71], v[120:123]
ds_read_b64_tr_b16 v[80:81], v232 offset:16384
ds_read_b64_tr_b16 v[82:83], v232 offset:17408
ds_read_b64_tr_b16 v[84:85], v233 offset:16384
s_add_u32 m0, s57, 32768
s_bfe_u32 s65, s77, 0x30008
s_lshl_b32 s65, s65, 8
buffer_load_dwordx4 v224, s[52:55], s65 offen offset:0 lds
v_mfma_f32_16x16x32_bf16 v[124:127], v[156:159], v[68:71], v[124:127]
ds_read_b64_tr_b16 v[86:87], v233 offset:17408
ds_read_b128 v[32:35], v168 offset:35840
v_mfma_f32_16x16x32_bf16 v[128:131], v[152:155], v[72:75], v[128:131]
ds_read_b128 v[36:39], v169 offset:35840
ds_read_b128 v[40:43], v170 offset:35840
v_mfma_f32_16x16x32_bf16 v[132:135], v[156:159], v[72:75], v[132:135]
ds_read_b64_tr_b16 v[88:89], v234 offset:16384
ds_read_b64_tr_b16 v[90:91], v234 offset:17408
ds_read_b64_tr_b16 v[92:93], v235 offset:16384
buffer_load_dwordx4 v225, s[52:55], s65 offen offset:1024 lds
v_mfma_f32_16x16x32_bf16 v[136:139], v[152:155], v[76:79], v[136:139]
ds_read_b64_tr_b16 v[94:95], v235 offset:17408
ds_read_b128 v[44:47], v171 offset:35840
v_mfma_f32_16x16x32_bf16 v[140:143], v[156:159], v[76:79], v[140:143]
ds_read_b128 v[48:51], v172 offset:35840
ds_read_b128 v[52:55], v173 offset:35840
buffer_load_dwordx4 v226, s[52:55], s65 offen offset:2048 lds
s_waitcnt lgkmcnt(7)
v_mfma_f32_16x16x32_bf16 v[96:99], v[80:83], v[32:35], v[96:99]
ds_read_b64_tr_b16 v[144:145], v236 offset:16384
ds_read_b64_tr_b16 v[146:147], v236 offset:17408
v_mfma_f32_16x16x32_bf16 v[100:103], v[84:87], v[32:35], v[100:103]
ds_read_b64_tr_b16 v[148:149], v237 offset:16384
s_bfe_u32 s66, s77, 0x30008
s_lshl_b32 s66, s66, 20
s_add_u32 s66, s66, 256
s_add_u32 m0, s57, 8192
s_nop 0
buffer_load_dwordx4 v228, s[16:19], s66 offen offset:0 lds
v_mfma_f32_16x16x32_bf16 v[104:107], v[80:83], v[36:39], v[104:107]
ds_read_b64_tr_b16 v[150:151], v237 offset:17408
v_mfma_f32_16x16x32_bf16 v[108:111], v[84:87], v[36:39], v[108:111]
ds_read_b128 v[56:59], v174 offset:35840
buffer_load_dwordx4 v229, s[16:19], s66 offen offset:1024 lds
v_mfma_f32_16x16x32_bf16 v[112:115], v[80:83], v[40:43], v[112:115]
ds_read_b128 v[60:63], v175 offset:35840
v_mfma_f32_16x16x32_bf16 v[116:119], v[84:87], v[40:43], v[116:119]
ds_read_b128 v[64:67], v176 offset:35840
buffer_load_dwordx4 v230, s[16:19], s66 offen offset:2048 lds
s_waitcnt lgkmcnt(7)
v_mfma_f32_16x16x32_bf16 v[96:99], v[88:91], v[44:47], v[96:99]
ds_read_b64_tr_b16 v[152:153], v238 offset:16384
ds_read_b64_tr_b16 v[154:155], v238 offset:17408
v_mfma_f32_16x16x32_bf16 v[100:103], v[92:95], v[44:47], v[100:103]
ds_read_b64_tr_b16 v[156:157], v239 offset:16384
v_mfma_f32_16x16x32_bf16 v[104:107], v[88:91], v[48:51], v[104:107]
ds_read_b64_tr_b16 v[158:159], v239 offset:17408
buffer_load_dwordx4 v231, s[16:19], s66 offen offset:3072 lds
v_mfma_f32_16x16x32_bf16 v[108:111], v[92:95], v[48:51], v[108:111]
ds_read_b128 v[68:71], v177 offset:35840
v_mfma_f32_16x16x32_bf16 v[112:115], v[88:91], v[52:55], v[112:115]
ds_read_b128 v[72:75], v178 offset:35840
s_add_u32 m0, s57, 12288
s_add_u32 s67, s66, 131072
buffer_load_dwordx4 v228, s[16:19], s67 offen offset:0 lds
v_mfma_f32_16x16x32_bf16 v[116:119], v[92:95], v[52:55], v[116:119]
ds_read_b128 v[76:79], v179 offset:35840
s_waitcnt lgkmcnt(7)
v_mfma_f32_16x16x32_bf16 v[96:99], v[144:147], v[56:59], v[96:99]
buffer_load_dwordx4 v229, s[16:19], s67 offen offset:1024 lds
v_mfma_f32_16x16x32_bf16 v[100:103], v[148:151], v[56:59], v[100:103]
v_mfma_f32_16x16x32_bf16 v[104:107], v[144:147], v[60:63], v[104:107]
buffer_load_dwordx4 v230, s[16:19], s67 offen offset:2048 lds
v_mfma_f32_16x16x32_bf16 v[108:111], v[148:151], v[60:63], v[108:111]
v_mfma_f32_16x16x32_bf16 v[112:115], v[144:147], v[64:67], v[112:115]
buffer_load_dwordx4 v231, s[16:19], s67 offen offset:3072 lds
v_mfma_f32_16x16x32_bf16 v[116:119], v[148:151], v[64:67], v[116:119]
s_waitcnt vmcnt(19)
s_waitcnt lgkmcnt(0)
s_barrier
s_mov_b32 s31, 0x200000
ic_11:
v_readfirstlane_b32 s64, v248
s_nop 0
s_cmp_lg_u32 s64, 0
s_cbranch_scc1 icok_12
s_sleep 8
v_mov_b32 v248, 0
global_load_dword v248, v248, s[26:27] sc1
s_waitcnt vmcnt(0)
s_sub_u32 s31, s31, 1
s_cbranch_scc0 ic_11
icok_12:
s_mov_b64 exec, 1
global_store_dword v216, v217, s[98:99] sc1
s_mov_b64 exec, -1
v_mfma_f32_16x16x32_bf16 v[96:99], v[152:155], v[68:71], v[96:99]
ds_read_b64_tr_b16 v[80:81], v232 offset:24576
ds_read_b64_tr_b16 v[82:83], v232 offset:25600
s_bfe_u32 s66, s77, 0x3000c
s_lshl_b32 s66, s66, 20
s_add_u32 m0, s57, 16384
s_nop 0
buffer_load_dwordx4 v228, s[16:19], s66 offen offset:0 lds
v_mfma_f32_16x16x32_bf16 v[100:103], v[156:159], v[68:71], v[100:103]
ds_read_b64_tr_b16 v[84:85], v233 offset:24576
v_mfma_f32_16x16x32_bf16 v[104:107], v[152:155], v[72:75], v[104:107]
ds_read_b64_tr_b16 v[86:87], v233 offset:25600
v_mfma_f32_16x16x32_bf16 v[108:111], v[156:159], v[72:75], v[108:111]
ds_read_b64_tr_b16 v[88:89], v234 offset:24576
ds_read_b64_tr_b16 v[90:91], v234 offset:25600
buffer_load_dwordx4 v229, s[16:19], s66 offen offset:1024 lds
v_mfma_f32_16x16x32_bf16 v[112:115], v[152:155], v[76:79], v[112:115]
ds_read_b64_tr_b16 v[92:93], v235 offset:24576
v_mfma_f32_16x16x32_bf16 v[116:119], v[156:159], v[76:79], v[116:119]
ds_read_b64_tr_b16 v[94:95], v235 offset:25600
s_waitcnt lgkmcnt(4)
v_mfma_f32_16x16x32_bf16 v[120:123], v[80:83], v[32:35], v[120:123]
ds_read_b64_tr_b16 v[144:145], v236 offset:24576
buffer_load_dwordx4 v230, s[16:19], s66 offen offset:2048 lds
v_mfma_f32_16x16x32_bf16 v[124:127], v[84:87], v[32:35], v[124:127]
ds_read_b64_tr_b16 v[146:147], v236 offset:25600
v_mfma_f32_16x16x32_bf16 v[128:131], v[80:83], v[36:39], v[128:131]
v_mfma_f32_16x16x32_bf16 v[132:135], v[84:87], v[36:39], v[132:135]
ds_read_b64_tr_b16 v[148:149], v237 offset:24576
buffer_load_dwordx4 v231, s[16:19], s66 offen offset:3072 lds
v_mfma_f32_16x16x32_bf16 v[136:139], v[80:83], v[40:43], v[136:139]
ds_read_b64_tr_b16 v[150:151], v237 offset:25600
v_mfma_f32_16x16x32_bf16 v[140:143], v[84:87], v[40:43], v[140:143]
s_waitcnt lgkmcnt(4)
v_mfma_f32_16x16x32_bf16 v[120:123], v[88:91], v[44:47], v[120:123]
ds_read_b64_tr_b16 v[152:153], v238 offset:24576
s_add_u32 m0, s57, 20480
s_add_u32 s67, s66, 131072
buffer_load_dwordx4 v228, s[16:19], s67 offen offset:0 lds
v_mfma_f32_16x16x32_bf16 v[124:127], v[92:95], v[44:47], v[124:127]
ds_read_b64_tr_b16 v[154:155], v238 offset:25600
v_mfma_f32_16x16x32_bf16 v[128:131], v[88:91], v[48:51], v[128:131]
v_mfma_f32_16x16x32_bf16 v[132:135], v[92:95], v[48:51], v[132:135]
ds_read_b64_tr_b16 v[156:157], v239 offset:24576
buffer_load_dwordx4 v229, s[16:19], s67 offen offset:1024 lds
v_mfma_f32_16x16x32_bf16 v[136:139], v[88:91], v[52:55], v[136:139]
ds_read_b64_tr_b16 v[158:159], v239 offset:25600
v_mfma_f32_16x16x32_bf16 v[140:143], v[92:95], v[52:55], v[140:143]
s_waitcnt lgkmcnt(4)
v_mfma_f32_16x16x32_bf16 v[120:123], v[144:147], v[56:59], v[120:123]
buffer_load_dwordx4 v230, s[16:19], s67 offen offset:2048 lds
v_mfma_f32_16x16x32_bf16 v[124:127], v[148:151], v[56:59], v[124:127]
v_mfma_f32_16x16x32_bf16 v[128:131], v[144:147], v[60:63], v[128:131]
v_mfma_f32_16x16x32_bf16 v[132:135], v[148:151], v[60:63], v[132:135]
buffer_load_dwordx4 v231, s[16:19], s67 offen offset:3072 lds
v_mfma_f32_16x16x32_bf16 v[136:139], v[144:147], v[64:67], v[136:139]
v_mfma_f32_16x16x32_bf16 v[140:143], v[148:151], v[64:67], v[140:143]
s_waitcnt vmcnt(19)
s_waitcnt vmcnt(16)
s_waitcnt lgkmcnt(0)
s_barrier
v_mfma_f32_16x16x32_bf16 v[120:123], v[152:155], v[68:71], v[120:123]
ds_read_b64_tr_b16 v[80:81], v232 offset:0
ds_read_b64_tr_b16 v[82:83], v232 offset:1024
ds_read_b64_tr_b16 v[84:85], v233 offset:0
s_add_u32 m0, s57, 35840
s_bfe_u32 s65, s77, 0x3000c
s_lshl_b32 s65, s65, 8
buffer_load_dwordx4 v224, s[52:55], s65 offen offset:0 lds
v_mfma_f32_16x16x32_bf16 v[124:127], v[156:159], v[68:71], v[124:127]
ds_read_b64_tr_b16 v[86:87], v233 offset:1024
ds_read_b128 v[32:35], v168 offset:32768
v_mfma_f32_16x16x32_bf16 v[128:131], v[152:155], v[72:75], v[128:131]
ds_read_b128 v[36:39], v169 offset:32768
ds_read_b128 v[40:43], v170 offset:32768
v_mfma_f32_16x16x32_bf16 v[132:135], v[156:159], v[72:75], v[132:135]
ds_read_b64_tr_b16 v[88:89], v234 offset:0
ds_read_b64_tr_b16 v[90:91], v234 offset:1024
ds_read_b64_tr_b16 v[92:93], v235 offset:0
buffer_load_dwordx4 v225, s[52:55], s65 offen offset:1024 lds
v_mfma_f32_16x16x32_bf16 v[136:139], v[152:155], v[76:79], v[136:139]
ds_read_b64_tr_b16 v[94:95], v235 offset:1024
ds_read_b128 v[44:47], v171 offset:32768
v_mfma_f32_16x16x32_bf16 v[140:143], v[156:159], v[76:79], v[140:143]
ds_read_b128 v[48:51], v172 offset:32768
ds_read_b128 v[52:55], v173 offset:32768
buffer_load_dwordx4 v226, s[52:55], s65 offen offset:2048 lds
s_waitcnt lgkmcnt(7)
v_mfma_f32_16x16x32_bf16 v[96:99], v[80:83], v[32:35], v[96:99]
ds_read_b64_tr_b16 v[144:145], v236 offset:0
ds_read_b64_tr_b16 v[146:147], v236 offset:1024
v_mfma_f32_16x16x32_bf16 v[100:103], v[84:87], v[32:35], v[100:103]
ds_read_b64_tr_b16 v[148:149], v237 offset:0
s_bfe_u32 s66, s77, 0x3000c
s_lshl_b32 s66, s66, 20
s_add_u32 s66, s66, 256
s_add_u32 m0, s57, 24576
s_nop 0
buffer_load_dwordx4 v228, s[16:19], s66 offen offset:0 lds
v_mfma_f32_16x16x32_bf16 v[104:107], v[80:83], v[36:39], v[104:107]
ds_read_b64_tr_b16 v[150:151], v237 offset:1024
v_mfma_f32_16x16x32_bf16 v[108:111], v[84:87], v[36:39], v[108:111]
ds_read_b128 v[56:59], v174 offset:32768
buffer_load_dwordx4 v229, s[16:19], s66 offen offset:1024 lds
v_mfma_f32_16x16x32_bf16 v[112:115], v[80:83], v[40:43], v[112:115]
ds_read_b128 v[60:63], v175 offset:32768
v_mfma_f32_16x16x32_bf16 v[116:119], v[84:87], v[40:43], v[116:119]
ds_read_b128 v[64:67], v176 offset:32768
buffer_load_dwordx4 v230, s[16:19], s66 offen offset:2048 lds
s_waitcnt lgkmcnt(7)
v_mfma_f32_16x16x32_bf16 v[96:99], v[88:91], v[44:47], v[96:99]
ds_read_b64_tr_b16 v[152:153], v238 offset:0
ds_read_b64_tr_b16 v[154:155], v238 offset:1024
v_mfma_f32_16x16x32_bf16 v[100:103], v[92:95], v[44:47], v[100:103]
ds_read_b64_tr_b16 v[156:157], v239 offset:0
v_mfma_f32_16x16x32_bf16 v[104:107], v[88:91], v[48:51], v[104:107]
ds_read_b64_tr_b16 v[158:159], v239 offset:1024
buffer_load_dwordx4 v231, s[16:19], s66 offen offset:3072 lds
v_mfma_f32_16x16x32_bf16 v[108:111], v[92:95], v[48:51], v[108:111]
ds_read_b128 v[68:71], v177 offset:32768
v_mfma_f32_16x16x32_bf16 v[112:115], v[88:91], v[52:55], v[112:115]
ds_read_b128 v[72:75], v178 offset:32768
s_add_u32 m0, s57, 28672
s_add_u32 s67, s66, 131072
buffer_load_dwordx4 v228, s[16:19], s67 offen offset:0 lds
v_mfma_f32_16x16x32_bf16 v[116:119], v[92:95], v[52:55], v[116:119]
ds_read_b128 v[76:79], v179 offset:32768
s_waitcnt lgkmcnt(7)
v_mfma_f32_16x16x32_bf16 v[96:99], v[144:147], v[56:59], v[96:99]
buffer_load_dwordx4 v229, s[16:19], s67 offen offset:1024 lds
v_mfma_f32_16x16x32_bf16 v[100:103], v[148:151], v[56:59], v[100:103]
v_mfma_f32_16x16x32_bf16 v[104:107], v[144:147], v[60:63], v[104:107]
buffer_load_dwordx4 v230, s[16:19], s67 offen offset:2048 lds
v_mfma_f32_16x16x32_bf16 v[108:111], v[148:151], v[60:63], v[108:111]
v_mfma_f32_16x16x32_bf16 v[112:115], v[144:147], v[64:67], v[112:115]
buffer_load_dwordx4 v231, s[16:19], s67 offen offset:3072 lds
v_mfma_f32_16x16x32_bf16 v[116:119], v[148:151], v[64:67], v[116:119]
s_waitcnt vmcnt(19)
s_waitcnt lgkmcnt(0)
s_barrier
v_mfma_f32_16x16x32_bf16 v[96:99], v[152:155], v[68:71], v[96:99]
ds_read_b64_tr_b16 v[80:81], v232 offset:8192
ds_read_b64_tr_b16 v[82:83], v232 offset:9216
s_bfe_u32 s66, s77, 0x30010
s_lshl_b32 s66, s66, 20
s_add_u32 m0, s57, 0
s_nop 0
buffer_load_dwordx4 v228, s[16:19], s66 offen offset:0 lds
v_mfma_f32_16x16x32_bf16 v[100:103], v[156:159], v[68:71], v[100:103]
ds_read_b64_tr_b16 v[84:85], v233 offset:8192
v_mfma_f32_16x16x32_bf16 v[104:107], v[152:155], v[72:75], v[104:107]
ds_read_b64_tr_b16 v[86:87], v233 offset:9216
v_mfma_f32_16x16x32_bf16 v[108:111], v[156:159], v[72:75], v[108:111]
ds_read_b64_tr_b16 v[88:89], v234 offset:8192
ds_read_b64_tr_b16 v[90:91], v234 offset:9216
buffer_load_dwordx4 v229, s[16:19], s66 offen offset:1024 lds
v_mfma_f32_16x16x32_bf16 v[112:115], v[152:155], v[76:79], v[112:115]
ds_read_b64_tr_b16 v[92:93], v235 offset:8192
v_mfma_f32_16x16x32_bf16 v[116:119], v[156:159], v[76:79], v[116:119]
ds_read_b64_tr_b16 v[94:95], v235 offset:9216
s_waitcnt lgkmcnt(4)
v_mfma_f32_16x16x32_bf16 v[120:123], v[80:83], v[32:35], v[120:123]
ds_read_b64_tr_b16 v[144:145], v236 offset:8192
buffer_load_dwordx4 v230, s[16:19], s66 offen offset:2048 lds
v_mfma_f32_16x16x32_bf16 v[124:127], v[84:87], v[32:35], v[124:127]
ds_read_b64_tr_b16 v[146:147], v236 offset:9216
v_mfma_f32_16x16x32_bf16 v[128:131], v[80:83], v[36:39], v[128:131]
v_mfma_f32_16x16x32_bf16 v[132:135], v[84:87], v[36:39], v[132:135]
ds_read_b64_tr_b16 v[148:149], v237 offset:8192
buffer_load_dwordx4 v231, s[16:19], s66 offen offset:3072 lds
v_mfma_f32_16x16x32_bf16 v[136:139], v[80:83], v[40:43], v[136:139]
ds_read_b64_tr_b16 v[150:151], v237 offset:9216
v_mfma_f32_16x16x32_bf16 v[140:143], v[84:87], v[40:43], v[140:143]
s_waitcnt lgkmcnt(4)
v_mfma_f32_16x16x32_bf16 v[120:123], v[88:91], v[44:47], v[120:123]
ds_read_b64_tr_b16 v[152:153], v238 offset:8192
s_add_u32 m0, s57, 4096
s_add_u32 s67, s66, 131072
buffer_load_dwordx4 v228, s[16:19], s67 offen offset:0 lds
v_mfma_f32_16x16x32_bf16 v[124:127], v[92:95], v[44:47], v[124:127]
ds_read_b64_tr_b16 v[154:155], v238 offset:9216
v_mfma_f32_16x16x32_bf16 v[128:131], v[88:91], v[48:51], v[128:131]
v_mfma_f32_16x16x32_bf16 v[132:135], v[92:95], v[48:51], v[132:135]
ds_read_b64_tr_b16 v[156:157], v239 offset:8192
buffer_load_dwordx4 v229, s[16:19], s67 offen offset:1024 lds
v_mfma_f32_16x16x32_bf16 v[136:139], v[88:91], v[52:55], v[136:139]
ds_read_b64_tr_b16 v[158:159], v239 offset:9216
v_mfma_f32_16x16x32_bf16 v[140:143], v[92:95], v[52:55], v[140:143]
s_waitcnt lgkmcnt(4)
v_mfma_f32_16x16x32_bf16 v[120:123], v[144:147], v[56:59], v[120:123]
buffer_load_dwordx4 v230, s[16:19], s67 offen offset:2048 lds
v_mfma_f32_16x16x32_bf16 v[124:127], v[148:151], v[56:59], v[124:127]
v_mfma_f32_16x16x32_bf16 v[128:131], v[144:147], v[60:63], v[128:131]
v_mfma_f32_16x16x32_bf16 v[132:135], v[148:151], v[60:63], v[132:135]
buffer_load_dwordx4 v231, s[16:19], s67 offen offset:3072 lds
v_mfma_f32_16x16x32_bf16 v[136:139], v[144:147], v[64:67], v[136:139]
v_mfma_f32_16x16x32_bf16 v[140:143], v[148:151], v[64:67], v[140:143]
s_waitcnt vmcnt(19)
s_waitcnt vmcnt(16)
s_waitcnt lgkmcnt(0)
s_barrier
v_mfma_f32_16x16x32_bf16 v[120:123], v[152:155], v[68:71], v[120:123]
ds_read_b64_tr_b16 v[80:81], v232 offset:16384
ds_read_b64_tr_b16 v[82:83], v232 offset:17408
ds_read_b64_tr_b16 v[84:85], v233 offset:16384
s_add_u32 m0, s57, 32768
s_bfe_u32 s65, s77, 0x30010
s_lshl_b32 s65, s65, 8
buffer_load_dwordx4 v224, s[52:55], s65 offen offset:0 lds
v_mfma_f32_16x16x32_bf16 v[124:127], v[156:159], v[68:71], v[124:127]
ds_read_b64_tr_b16 v[86:87], v233 offset:17408
ds_read_b128 v[32:35], v168 offset:35840
v_mfma_f32_16x16x32_bf16 v[128:131], v[152:155], v[72:75], v[128:131]
ds_read_b128 v[36:39], v169 offset:35840
ds_read_b128 v[40:43], v170 offset:35840
v_mfma_f32_16x16x32_bf16 v[132:135], v[156:159], v[72:75], v[132:135]
ds_read_b64_tr_b16 v[88:89], v234 offset:16384
ds_read_b64_tr_b16 v[90:91], v234 offset:17408
ds_read_b64_tr_b16 v[92:93], v235 offset:16384
buffer_load_dwordx4 v225, s[52:55], s65 offen offset:1024 lds
v_mfma_f32_16x16x32_bf16 v[136:139], v[152:155], v[76:79], v[136:139]
ds_read_b64_tr_b16 v[94:95], v235 offset:17408
ds_read_b128 v[44:47], v171 offset:35840
v_mfma_f32_16x16x32_bf16 v[140:143], v[156:159], v[76:79], v[140:143]
ds_read_b128 v[48:51], v172 offset:35840
ds_read_b128 v[52:55], v173 offset:35840
buffer_load_dwordx4 v226, s[52:55], s65 offen offset:2048 lds
s_waitcnt lgkmcnt(7)
v_mfma_f32_16x16x32_bf16 v[96:99], v[80:83], v[32:35], v[96:99]
ds_read_b64_tr_b16 v[144:145], v236 offset:16384
ds_read_b64_tr_b16 v[146:147], v236 offset:17408
v_mfma_f32_16x16x32_bf16 v[100:103], v[84:87], v[32:35], v[100:103]
ds_read_b64_tr_b16 v[148:149], v237 offset:16384
s_bfe_u32 s66, s77, 0x30010
s_lshl_b32 s66, s66, 20
s_add_u32 s66, s66, 256
s_add_u32 m0, s57, 8192
s_nop 0
buffer_load_dwordx4 v228, s[16:19], s66 offen offset:0 lds
v_mfma_f32_16x16x32_bf16 v[104:107], v[80:83], v[36:39], v[104:107]
ds_read_b64_tr_b16 v[150:151], v237 offset:17408
v_mfma_f32_16x16x32_bf16 v[108:111], v[84:87], v[36:39], v[108:111]
ds_read_b128 v[56:59], v174 offset:35840
buffer_load_dwordx4 v229, s[16:19], s66 offen offset:1024 lds
v_mfma_f32_16x16x32_bf16 v[112:115], v[80:83], v[40:43], v[112:115]
ds_read_b128 v[60:63], v175 offset:35840
v_mfma_f32_16x16x32_bf16 v[116:119], v[84:87], v[40:43], v[116:119]
ds_read_b128 v[64:67], v176 offset:35840
buffer_load_dwordx4 v230, s[16:19], s66 offen offset:2048 lds
s_waitcnt lgkmcnt(7)
v_mfma_f32_16x16x32_bf16 v[96:99], v[88:91], v[44:47], v[96:99]
ds_read_b64_tr_b16 v[152:153], v238 offset:16384
ds_read_b64_tr_b16 v[154:155], v238 offset:17408
v_mfma_f32_16x16x32_bf16 v[100:103], v[92:95], v[44:47], v[100:103]
ds_read_b64_tr_b16 v[156:157], v239 offset:16384
v_mfma_f32_16x16x32_bf16 v[104:107], v[88:91], v[48:51], v[104:107]
ds_read_b64_tr_b16 v[158:159], v239 offset:17408
buffer_load_dwordx4 v231, s[16:19], s66 offen offset:3072 lds
v_mfma_f32_16x16x32_bf16 v[108:111], v[92:95], v[48:51], v[108:111]
ds_read_b128 v[68:71], v177 offset:35840
v_mfma_f32_16x16x32_bf16 v[112:115], v[88:91], v[52:55], v[112:115]
ds_read_b128 v[72:75], v178 offset:35840
s_add_u32 m0, s57, 12288
s_add_u32 s67, s66, 131072
buffer_load_dwordx4 v228, s[16:19], s67 offen offset:0 lds
v_mfma_f32_16x16x32_bf16 v[116:119], v[92:95], v[52:55], v[116:119]
ds_read_b128 v[76:79], v179 offset:35840
s_waitcnt lgkmcnt(7)
v_mfma_f32_16x16x32_bf16 v[96:99], v[144:147], v[56:59], v[96:99]
buffer_load_dwordx4 v229, s[16:19], s67 offen offset:1024 lds
v_mfma_f32_16x16x32_bf16 v[100:103], v[148:151], v[56:59], v[100:103]
v_mfma_f32_16x16x32_bf16 v[104:107], v[144:147], v[60:63], v[104:107]
buffer_load_dwordx4 v230, s[16:19], s67 offen offset:2048 lds
v_mfma_f32_16x16x32_bf16 v[108:111], v[148:151], v[60:63], v[108:111]
v_mfma_f32_16x16x32_bf16 v[112:115], v[144:147], v[64:67], v[112:115]
buffer_load_dwordx4 v231, s[16:19], s67 offen offset:3072 lds
v_mfma_f32_16x16x32_bf16 v[116:119], v[148:151], v[64:67], v[116:119]
s_waitcnt vmcnt(19)
s_waitcnt lgkmcnt(0)
s_barrier
v_mfma_f32_16x16x32_bf16 v[96:99], v[152:155], v[68:71], v[96:99]
ds_read_b64_tr_b16 v[80:81], v232 offset:24576
ds_read_b64_tr_b16 v[82:83], v232 offset:25600
s_bfe_u32 s66, s77, 0x30014
s_lshl_b32 s66, s66, 20
s_add_u32 m0, s57, 16384
s_nop 0
buffer_load_dwordx4 v228, s[16:19], s66 offen offset:0 lds
v_mfma_f32_16x16x32_bf16 v[100:103], v[156:159], v[68:71], v[100:103]
ds_read_b64_tr_b16 v[84:85], v233 offset:24576
v_mfma_f32_16x16x32_bf16 v[104:107], v[152:155], v[72:75], v[104:107]
ds_read_b64_tr_b16 v[86:87], v233 offset:25600
v_mfma_f32_16x16x32_bf16 v[108:111], v[156:159], v[72:75], v[108:111]
ds_read_b64_tr_b16 v[88:89], v234 offset:24576
ds_read_b64_tr_b16 v[90:91], v234 offset:25600
buffer_load_dwordx4 v229, s[16:19], s66 offen offset:1024 lds
v_mfma_f32_16x16x32_bf16 v[112:115], v[152:155], v[76:79], v[112:115]
ds_read_b64_tr_b16 v[92:93], v235 offset:24576
v_mfma_f32_16x16x32_bf16 v[116:119], v[156:159], v[76:79], v[116:119]
ds_read_b64_tr_b16 v[94:95], v235 offset:25600
s_waitcnt lgkmcnt(4)
v_mfma_f32_16x16x32_bf16 v[120:123], v[80:83], v[32:35], v[120:123]
ds_read_b64_tr_b16 v[144:145], v236 offset:24576
buffer_load_dwordx4 v230, s[16:19], s66 offen offset:2048 lds
v_mfma_f32_16x16x32_bf16 v[124:127], v[84:87], v[32:35], v[124:127]
ds_read_b64_tr_b16 v[146:147], v236 offset:25600
v_mfma_f32_16x16x32_bf16 v[128:131], v[80:83], v[36:39], v[128:131]
v_mfma_f32_16x16x32_bf16 v[132:135], v[84:87], v[36:39], v[132:135]
ds_read_b64_tr_b16 v[148:149], v237 offset:24576
buffer_load_dwordx4 v231, s[16:19], s66 offen offset:3072 lds
v_mfma_f32_16x16x32_bf16 v[136:139], v[80:83], v[40:43], v[136:139]
ds_read_b64_tr_b16 v[150:151], v237 offset:25600
v_mfma_f32_16x16x32_bf16 v[140:143], v[84:87], v[40:43], v[140:143]
s_waitcnt lgkmcnt(4)
v_mfma_f32_16x16x32_bf16 v[120:123], v[88:91], v[44:47], v[120:123]
ds_read_b64_tr_b16 v[152:153], v238 offset:24576
s_add_u32 m0, s57, 20480
s_add_u32 s67, s66, 131072
buffer_load_dwordx4 v228, s[16:19], s67 offen offset:0 lds
v_mfma_f32_16x16x32_bf16 v[124:127], v[92:95], v[44:47], v[124:127]
ds_read_b64_tr_b16 v[154:155], v238 offset:25600
v_mfma_f32_16x16x32_bf16 v[128:131], v[88:91], v[48:51], v[128:131]
v_mfma_f32_16x16x32_bf16 v[132:135], v[92:95], v[48:51], v[132:135]
ds_read_b64_tr_b16 v[156:157], v239 offset:24576
buffer_load_dwordx4 v229, s[16:19], s67 offen offset:1024 lds
v_mfma_f32_16x16x32_bf16 v[136:139], v[88:91], v[52:55], v[136:139]
ds_read_b64_tr_b16 v[158:159], v239 offset:25600
v_mfma_f32_16x16x32_bf16 v[140:143], v[92:95], v[52:55], v[140:143]
s_waitcnt lgkmcnt(4)
v_mfma_f32_16x16x32_bf16 v[120:123], v[144:147], v[56:59], v[120:123]
buffer_load_dwordx4 v230, s[16:19], s67 offen offset:2048 lds
v_mfma_f32_16x16x32_bf16 v[124:127], v[148:151], v[56:59], v[124:127]
v_mfma_f32_16x16x32_bf16 v[128:131], v[144:147], v[60:63], v[128:131]
v_mfma_f32_16x16x32_bf16 v[132:135], v[148:151], v[60:63], v[132:135]
buffer_load_dwordx4 v231, s[16:19], s67 offen offset:3072 lds
v_mfma_f32_16x16x32_bf16 v[136:139], v[144:147], v[64:67], v[136:139]
v_mfma_f32_16x16x32_bf16 v[140:143], v[148:151], v[64:67], v[140:143]
s_waitcnt vmcnt(19)
s_waitcnt vmcnt(16)
s_waitcnt lgkmcnt(0)
s_barrier
v_mfma_f32_16x16x32_bf16 v[120:123], v[152:155], v[68:71], v[120:123]
ds_read_b64_tr_b16 v[80:81], v232 offset:0
ds_read_b64_tr_b16 v[82:83], v232 offset:1024
ds_read_b64_tr_b16 v[84:85], v233 offset:0
s_add_u32 m0, s57, 35840
s_bfe_u32 s65, s77, 0x30014
s_lshl_b32 s65, s65, 8
buffer_load_dwordx4 v224, s[52:55], s65 offen offset:0 lds
v_mfma_f32_16x16x32_bf16 v[124:127], v[156:159], v[68:71], v[124:127]
ds_read_b64_tr_b16 v[86:87], v233 offset:1024
ds_read_b128 v[32:35], v168 offset:32768
v_mfma_f32_16x16x32_bf16 v[128:131], v[152:155], v[72:75], v[128:131]
ds_read_b128 v[36:39], v169 offset:32768
ds_read_b128 v[40:43], v170 offset:32768
v_mfma_f32_16x16x32_bf16 v[132:135], v[156:159], v[72:75], v[132:135]
ds_read_b64_tr_b16 v[88:89], v234 offset:0
ds_read_b64_tr_b16 v[90:91], v234 offset:1024
ds_read_b64_tr_b16 v[92:93], v235 offset:0
buffer_load_dwordx4 v225, s[52:55], s65 offen offset:1024 lds
v_mfma_f32_16x16x32_bf16 v[136:139], v[152:155], v[76:79], v[136:139]
ds_read_b64_tr_b16 v[94:95], v235 offset:1024
ds_read_b128 v[44:47], v171 offset:32768
v_mfma_f32_16x16x32_bf16 v[140:143], v[156:159], v[76:79], v[140:143]
ds_read_b128 v[48:51], v172 offset:32768
ds_read_b128 v[52:55], v173 offset:32768
buffer_load_dwordx4 v226, s[52:55], s65 offen offset:2048 lds
s_waitcnt lgkmcnt(7)
v_mfma_f32_16x16x32_bf16 v[96:99], v[80:83], v[32:35], v[96:99]
ds_read_b64_tr_b16 v[144:145], v236 offset:0
ds_read_b64_tr_b16 v[146:147], v236 offset:1024
v_mfma_f32_16x16x32_bf16 v[100:103], v[84:87], v[32:35], v[100:103]
ds_read_b64_tr_b16 v[148:149], v237 offset:0
s_bfe_u32 s66, s77, 0x30014
s_lshl_b32 s66, s66, 20
s_add_u32 s66, s66, 256
s_add_u32 m0, s57, 24576
s_nop 0
buffer_load_dwordx4 v228, s[16:19], s66 offen offset:0 lds
v_mfma_f32_16x16x32_bf16 v[104:107], v[80:83], v[36:39], v[104:107]
ds_read_b64_tr_b16 v[150:151], v237 offset:1024
v_mfma_f32_16x16x32_bf16 v[108:111], v[84:87], v[36:39], v[108:111]
ds_read_b128 v[56:59], v174 offset:32768
buffer_load_dwordx4 v229, s[16:19], s66 offen offset:1024 lds
v_mfma_f32_16x16x32_bf16 v[112:115], v[80:83], v[40:43], v[112:115]
ds_read_b128 v[60:63], v175 offset:32768
v_mfma_f32_16x16x32_bf16 v[116:119], v[84:87], v[40:43], v[116:119]
ds_read_b128 v[64:67], v176 offset:32768
buffer_load_dwordx4 v230, s[16:19], s66 offen offset:2048 lds
s_waitcnt lgkmcnt(7)
v_mfma_f32_16x16x32_bf16 v[96:99], v[88:91], v[44:47], v[96:99]
ds_read_b64_tr_b16 v[152:153], v238 offset:0
ds_read_b64_tr_b16 v[154:155], v238 offset:1024
v_mfma_f32_16x16x32_bf16 v[100:103], v[92:95], v[44:47], v[100:103]
ds_read_b64_tr_b16 v[156:157], v239 offset:0
v_mfma_f32_16x16x32_bf16 v[104:107], v[88:91], v[48:51], v[104:107]
ds_read_b64_tr_b16 v[158:159], v239 offset:1024
buffer_load_dwordx4 v231, s[16:19], s66 offen offset:3072 lds
v_mfma_f32_16x16x32_bf16 v[108:111], v[92:95], v[48:51], v[108:111]
ds_read_b128 v[68:71], v177 offset:32768
v_mfma_f32_16x16x32_bf16 v[112:115], v[88:91], v[52:55], v[112:115]
ds_read_b128 v[72:75], v178 offset:32768
s_add_u32 m0, s57, 28672
s_add_u32 s67, s66, 131072
buffer_load_dwordx4 v228, s[16:19], s67 offen offset:0 lds
v_mfma_f32_16x16x32_bf16 v[116:119], v[92:95], v[52:55], v[116:119]
ds_read_b128 v[76:79], v179 offset:32768
s_waitcnt lgkmcnt(7)
v_mfma_f32_16x16x32_bf16 v[96:99], v[144:147], v[56:59], v[96:99]
buffer_load_dwordx4 v229, s[16:19], s67 offen offset:1024 lds
v_mfma_f32_16x16x32_bf16 v[100:103], v[148:151], v[56:59], v[100:103]
v_mfma_f32_16x16x32_bf16 v[104:107], v[144:147], v[60:63], v[104:107]
buffer_load_dwordx4 v230, s[16:19], s67 offen offset:2048 lds
v_mfma_f32_16x16x32_bf16 v[108:111], v[148:151], v[60:63], v[108:111]
v_mfma_f32_16x16x32_bf16 v[112:115], v[144:147], v[64:67], v[112:115]
buffer_load_dwordx4 v231, s[16:19], s67 offen offset:3072 lds
v_mfma_f32_16x16x32_bf16 v[116:119], v[148:151], v[64:67], v[116:119]
s_waitcnt vmcnt(19)
s_waitcnt lgkmcnt(0)
s_barrier
v_mfma_f32_16x16x32_bf16 v[96:99], v[152:155], v[68:71], v[96:99]
ds_read_b64_tr_b16 v[80:81], v232 offset:8192
ds_read_b64_tr_b16 v[82:83], v232 offset:9216
s_bfe_u32 s66, s77, 0x30018
s_lshl_b32 s66, s66, 20
s_add_u32 m0, s57, 0
s_nop 0
buffer_load_dwordx4 v228, s[16:19], s66 offen offset:0 lds
v_mfma_f32_16x16x32_bf16 v[100:103], v[156:159], v[68:71], v[100:103]
ds_read_b64_tr_b16 v[84:85], v233 offset:8192
v_mfma_f32_16x16x32_bf16 v[104:107], v[152:155], v[72:75], v[104:107]
ds_read_b64_tr_b16 v[86:87], v233 offset:9216
v_mfma_f32_16x16x32_bf16 v[108:111], v[156:159], v[72:75], v[108:111]
ds_read_b64_tr_b16 v[88:89], v234 offset:8192
ds_read_b64_tr_b16 v[90:91], v234 offset:9216
buffer_load_dwordx4 v229, s[16:19], s66 offen offset:1024 lds
v_mfma_f32_16x16x32_bf16 v[112:115], v[152:155], v[76:79], v[112:115]
ds_read_b64_tr_b16 v[92:93], v235 offset:8192
v_mfma_f32_16x16x32_bf16 v[116:119], v[156:159], v[76:79], v[116:119]
ds_read_b64_tr_b16 v[94:95], v235 offset:9216
s_waitcnt lgkmcnt(4)
v_mfma_f32_16x16x32_bf16 v[120:123], v[80:83], v[32:35], v[120:123]
ds_read_b64_tr_b16 v[144:145], v236 offset:8192
buffer_load_dwordx4 v230, s[16:19], s66 offen offset:2048 lds
v_mfma_f32_16x16x32_bf16 v[124:127], v[84:87], v[32:35], v[124:127]
ds_read_b64_tr_b16 v[146:147], v236 offset:9216
v_mfma_f32_16x16x32_bf16 v[128:131], v[80:83], v[36:39], v[128:131]
v_mfma_f32_16x16x32_bf16 v[132:135], v[84:87], v[36:39], v[132:135]
ds_read_b64_tr_b16 v[148:149], v237 offset:8192
buffer_load_dwordx4 v231, s[16:19], s66 offen offset:3072 lds
v_mfma_f32_16x16x32_bf16 v[136:139], v[80:83], v[40:43], v[136:139]
ds_read_b64_tr_b16 v[150:151], v237 offset:9216
v_mfma_f32_16x16x32_bf16 v[140:143], v[84:87], v[40:43], v[140:143]
s_waitcnt lgkmcnt(4)
v_mfma_f32_16x16x32_bf16 v[120:123], v[88:91], v[44:47], v[120:123]
ds_read_b64_tr_b16 v[152:153], v238 offset:8192
s_add_u32 m0, s57, 4096
s_add_u32 s67, s66, 131072
buffer_load_dwordx4 v228, s[16:19], s67 offen offset:0 lds
v_mfma_f32_16x16x32_bf16 v[124:127], v[92:95], v[44:47], v[124:127]
ds_read_b64_tr_b16 v[154:155], v238 offset:9216
v_mfma_f32_16x16x32_bf16 v[128:131], v[88:91], v[48:51], v[128:131]
v_mfma_f32_16x16x32_bf16 v[132:135], v[92:95], v[48:51], v[132:135]
ds_read_b64_tr_b16 v[156:157], v239 offset:8192
buffer_load_dwordx4 v229, s[16:19], s67 offen offset:1024 lds
v_mfma_f32_16x16x32_bf16 v[136:139], v[88:91], v[52:55], v[136:139]
ds_read_b64_tr_b16 v[158:159], v239 offset:9216
v_mfma_f32_16x16x32_bf16 v[140:143], v[92:95], v[52:55], v[140:143]
s_waitcnt lgkmcnt(4)
v_mfma_f32_16x16x32_bf16 v[120:123], v[144:147], v[56:59], v[120:123]
buffer_load_dwordx4 v230, s[16:19], s67 offen offset:2048 lds
v_mfma_f32_16x16x32_bf16 v[124:127], v[148:151], v[56:59], v[124:127]
v_mfma_f32_16x16x32_bf16 v[128:131], v[144:147], v[60:63], v[128:131]
v_mfma_f32_16x16x32_bf16 v[132:135], v[148:151], v[60:63], v[132:135]
buffer_load_dwordx4 v231, s[16:19], s67 offen offset:3072 lds
v_mfma_f32_16x16x32_bf16 v[136:139], v[144:147], v[64:67], v[136:139]
v_mfma_f32_16x16x32_bf16 v[140:143], v[148:151], v[64:67], v[140:143]
s_waitcnt vmcnt(19)
s_waitcnt vmcnt(16)
s_waitcnt lgkmcnt(0)
s_barrier
v_mfma_f32_16x16x32_bf16 v[120:123], v[152:155], v[68:71], v[120:123]
ds_read_b64_tr_b16 v[80:81], v232 offset:16384
ds_read_b64_tr_b16 v[82:83], v232 offset:17408
ds_read_b64_tr_b16 v[84:85], v233 offset:16384
s_add_u32 m0, s57, 32768
s_bfe_u32 s65, s77, 0x30018
s_lshl_b32 s65, s65, 8
buffer_load_dwordx4 v224, s[52:55], s65 offen offset:0 lds
v_mfma_f32_16x16x32_bf16 v[124:127], v[156:159], v[68:71], v[124:127]
ds_read_b64_tr_b16 v[86:87], v233 offset:17408
ds_read_b128 v[32:35], v168 offset:35840
v_mfma_f32_16x16x32_bf16 v[128:131], v[152:155], v[72:75], v[128:131]
ds_read_b128 v[36:39], v169 offset:35840
ds_read_b128 v[40:43], v170 offset:35840
v_mfma_f32_16x16x32_bf16 v[132:135], v[156:159], v[72:75], v[132:135]
ds_read_b64_tr_b16 v[88:89], v234 offset:16384
ds_read_b64_tr_b16 v[90:91], v234 offset:17408
ds_read_b64_tr_b16 v[92:93], v235 offset:16384
buffer_load_dwordx4 v225, s[52:55], s65 offen offset:1024 lds
v_mfma_f32_16x16x32_bf16 v[136:139], v[152:155], v[76:79], v[136:139]
ds_read_b64_tr_b16 v[94:95], v235 offset:17408
ds_read_b128 v[44:47], v171 offset:35840
v_mfma_f32_16x16x32_bf16 v[140:143], v[156:159], v[76:79], v[140:143]
ds_read_b128 v[48:51], v172 offset:35840
ds_read_b128 v[52:55], v173 offset:35840
buffer_load_dwordx4 v226, s[52:55], s65 offen offset:2048 lds
s_waitcnt lgkmcnt(7)
v_mfma_f32_16x16x32_bf16 v[96:99], v[80:83], v[32:35], v[96:99]
ds_read_b64_tr_b16 v[144:145], v236 offset:16384
ds_read_b64_tr_b16 v[146:147], v236 offset:17408
v_mfma_f32_16x16x32_bf16 v[100:103], v[84:87], v[32:35], v[100:103]
ds_read_b64_tr_b16 v[148:149], v237 offset:16384
s_bfe_u32 s66, s77, 0x30018
s_lshl_b32 s66, s66, 20
s_add_u32 s66, s66, 256
s_add_u32 m0, s57, 8192
s_nop 0
buffer_load_dwordx4 v228, s[16:19], s66 offen offset:0 lds
v_mfma_f32_16x16x32_bf16 v[104:107], v[80:83], v[36:39], v[104:107]
ds_read_b64_tr_b16 v[150:151], v237 offset:17408
v_mfma_f32_16x16x32_bf16 v[108:111], v[84:87], v[36:39], v[108:111]
ds_read_b128 v[56:59], v174 offset:35840
buffer_load_dwordx4 v229, s[16:19], s66 offen offset:1024 lds
v_mfma_f32_16x16x32_bf16 v[112:115], v[80:83], v[40:43], v[112:115]
ds_read_b128 v[60:63], v175 offset:35840
v_mfma_f32_16x16x32_bf16 v[116:119], v[84:87], v[40:43], v[116:119]
ds_read_b128 v[64:67], v176 offset:35840
buffer_load_dwordx4 v230, s[16:19], s66 offen offset:2048 lds
s_waitcnt lgkmcnt(7)
v_mfma_f32_16x16x32_bf16 v[96:99], v[88:91], v[44:47], v[96:99]
ds_read_b64_tr_b16 v[152:153], v238 offset:16384
ds_read_b64_tr_b16 v[154:155], v238 offset:17408
v_mfma_f32_16x16x32_bf16 v[100:103], v[92:95], v[44:47], v[100:103]
ds_read_b64_tr_b16 v[156:157], v239 offset:16384
v_mfma_f32_16x16x32_bf16 v[104:107], v[88:91], v[48:51], v[104:107]
ds_read_b64_tr_b16 v[158:159], v239 offset:17408
buffer_load_dwordx4 v231, s[16:19], s66 offen offset:3072 lds
v_mfma_f32_16x16x32_bf16 v[108:111], v[92:95], v[48:51], v[108:111]
ds_read_b128 v[68:71], v177 offset:35840
v_mfma_f32_16x16x32_bf16 v[112:115], v[88:91], v[52:55], v[112:115]
ds_read_b128 v[72:75], v178 offset:35840
s_add_u32 m0, s57, 12288
s_add_u32 s67, s66, 131072
buffer_load_dwordx4 v228, s[16:19], s67 offen offset:0 lds
v_mfma_f32_16x16x32_bf16 v[116:119], v[92:95], v[52:55], v[116:119]
ds_read_b128 v[76:79], v179 offset:35840
s_waitcnt lgkmcnt(7)
v_mfma_f32_16x16x32_bf16 v[96:99], v[144:147], v[56:59], v[96:99]
buffer_load_dwordx4 v229, s[16:19], s67 offen offset:1024 lds
v_mfma_f32_16x16x32_bf16 v[100:103], v[148:151], v[56:59], v[100:103]
v_mfma_f32_16x16x32_bf16 v[104:107], v[144:147], v[60:63], v[104:107]
buffer_load_dwordx4 v230, s[16:19], s67 offen offset:2048 lds
v_mfma_f32_16x16x32_bf16 v[108:111], v[148:151], v[60:63], v[108:111]
v_mfma_f32_16x16x32_bf16 v[112:115], v[144:147], v[64:67], v[112:115]
buffer_load_dwordx4 v231, s[16:19], s67 offen offset:3072 lds
v_mfma_f32_16x16x32_bf16 v[116:119], v[148:151], v[64:67], v[116:119]
s_waitcnt vmcnt(19)
s_waitcnt lgkmcnt(0)
s_barrier
v_mfma_f32_16x16x32_bf16 v[96:99], v[152:155], v[68:71], v[96:99]
ds_read_b64_tr_b16 v[80:81], v232 offset:24576
ds_read_b64_tr_b16 v[82:83], v232 offset:25600
s_bfe_u32 s66, s77, 0x3001c
s_lshl_b32 s66, s66, 20
s_add_u32 m0, s57, 16384
s_nop 0
buffer_load_dwordx4 v228, s[16:19], s66 offen offset:0 lds
v_mfma_f32_16x16x32_bf16 v[100:103], v[156:159], v[68:71], v[100:103]
ds_read_b64_tr_b16 v[84:85], v233 offset:24576
v_mfma_f32_16x16x32_bf16 v[104:107], v[152:155], v[72:75], v[104:107]
ds_read_b64_tr_b16 v[86:87], v233 offset:25600
v_mfma_f32_16x16x32_bf16 v[108:111], v[156:159], v[72:75], v[108:111]
ds_read_b64_tr_b16 v[88:89], v234 offset:24576
ds_read_b64_tr_b16 v[90:91], v234 offset:25600
buffer_load_dwordx4 v229, s[16:19], s66 offen offset:1024 lds
v_mfma_f32_16x16x32_bf16 v[112:115], v[152:155], v[76:79], v[112:115]
ds_read_b64_tr_b16 v[92:93], v235 offset:24576
v_mfma_f32_16x16x32_bf16 v[116:119], v[156:159], v[76:79], v[116:119]
ds_read_b64_tr_b16 v[94:95], v235 offset:25600
s_waitcnt lgkmcnt(4)
v_mfma_f32_16x16x32_bf16 v[120:123], v[80:83], v[32:35], v[120:123]
ds_read_b64_tr_b16 v[144:145], v236 offset:24576
buffer_load_dwordx4 v230, s[16:19], s66 offen offset:2048 lds
v_mfma_f32_16x16x32_bf16 v[124:127], v[84:87], v[32:35], v[124:127]
ds_read_b64_tr_b16 v[146:147], v236 offset:25600
v_mfma_f32_16x16x32_bf16 v[128:131], v[80:83], v[36:39], v[128:131]
v_mfma_f32_16x16x32_bf16 v[132:135], v[84:87], v[36:39], v[132:135]
ds_read_b64_tr_b16 v[148:149], v237 offset:24576
buffer_load_dwordx4 v231, s[16:19], s66 offen offset:3072 lds
v_mfma_f32_16x16x32_bf16 v[136:139], v[80:83], v[40:43], v[136:139]
ds_read_b64_tr_b16 v[150:151], v237 offset:25600
v_mfma_f32_16x16x32_bf16 v[140:143], v[84:87], v[40:43], v[140:143]
s_waitcnt lgkmcnt(4)
v_mfma_f32_16x16x32_bf16 v[120:123], v[88:91], v[44:47], v[120:123]
ds_read_b64_tr_b16 v[152:153], v238 offset:24576
s_add_u32 m0, s57, 20480
s_add_u32 s67, s66, 131072
buffer_load_dwordx4 v228, s[16:19], s67 offen offset:0 lds
v_mfma_f32_16x16x32_bf16 v[124:127], v[92:95], v[44:47], v[124:127]
ds_read_b64_tr_b16 v[154:155], v238 offset:25600
v_mfma_f32_16x16x32_bf16 v[128:131], v[88:91], v[48:51], v[128:131]
v_mfma_f32_16x16x32_bf16 v[132:135], v[92:95], v[48:51], v[132:135]
ds_read_b64_tr_b16 v[156:157], v239 offset:24576
buffer_load_dwordx4 v229, s[16:19], s67 offen offset:1024 lds
v_mfma_f32_16x16x32_bf16 v[136:139], v[88:91], v[52:55], v[136:139]
ds_read_b64_tr_b16 v[158:159], v239 offset:25600
v_mfma_f32_16x16x32_bf16 v[140:143], v[92:95], v[52:55], v[140:143]
s_waitcnt lgkmcnt(4)
v_mfma_f32_16x16x32_bf16 v[120:123], v[144:147], v[56:59], v[120:123]
buffer_load_dwordx4 v230, s[16:19], s67 offen offset:2048 lds
v_mfma_f32_16x16x32_bf16 v[124:127], v[148:151], v[56:59], v[124:127]
v_mfma_f32_16x16x32_bf16 v[128:131], v[144:147], v[60:63], v[128:131]
v_mfma_f32_16x16x32_bf16 v[132:135], v[148:151], v[60:63], v[132:135]
buffer_load_dwordx4 v231, s[16:19], s67 offen offset:3072 lds
v_mfma_f32_16x16x32_bf16 v[136:139], v[144:147], v[64:67], v[136:139]
v_mfma_f32_16x16x32_bf16 v[140:143], v[148:151], v[64:67], v[140:143]
s_waitcnt vmcnt(19)
s_waitcnt vmcnt(16)
s_waitcnt lgkmcnt(0)
s_barrier
v_mfma_f32_16x16x32_bf16 v[120:123], v[152:155], v[68:71], v[120:123]
ds_read_b64_tr_b16 v[80:81], v232 offset:0
ds_read_b64_tr_b16 v[82:83], v232 offset:1024
ds_read_b64_tr_b16 v[84:85], v233 offset:0
s_add_u32 m0, s57, 35840
s_bfe_u32 s65, s77, 0x3001c
s_lshl_b32 s65, s65, 8
buffer_load_dwordx4 v224, s[52:55], s65 offen offset:0 lds
v_mfma_f32_16x16x32_bf16 v[124:127], v[156:159], v[68:71], v[124:127]
ds_read_b64_tr_b16 v[86:87], v233 offset:1024
ds_read_b128 v[32:35], v168 offset:32768
v_mfma_f32_16x16x32_bf16 v[128:131], v[152:155], v[72:75], v[128:131]
ds_read_b128 v[36:39], v169 offset:32768
ds_read_b128 v[40:43], v170 offset:32768
v_mfma_f32_16x16x32_bf16 v[132:135], v[156:159], v[72:75], v[132:135]
ds_read_b64_tr_b16 v[88:89], v234 offset:0
ds_read_b64_tr_b16 v[90:91], v234 offset:1024
ds_read_b64_tr_b16 v[92:93], v235 offset:0
buffer_load_dwordx4 v225, s[52:55], s65 offen offset:1024 lds
v_mfma_f32_16x16x32_bf16 v[136:139], v[152:155], v[76:79], v[136:139]
ds_read_b64_tr_b16 v[94:95], v235 offset:1024
ds_read_b128 v[44:47], v171 offset:32768
v_mfma_f32_16x16x32_bf16 v[140:143], v[156:159], v[76:79], v[140:143]
ds_read_b128 v[48:51], v172 offset:32768
ds_read_b128 v[52:55], v173 offset:32768
buffer_load_dwordx4 v226, s[52:55], s65 offen offset:2048 lds
s_waitcnt lgkmcnt(7)
v_mfma_f32_16x16x32_bf16 v[96:99], v[80:83], v[32:35], v[96:99]
ds_read_b64_tr_b16 v[144:145], v236 offset:0
ds_read_b64_tr_b16 v[146:147], v236 offset:1024
v_mfma_f32_16x16x32_bf16 v[100:103], v[84:87], v[32:35], v[100:103]
ds_read_b64_tr_b16 v[148:149], v237 offset:0
s_bfe_u32 s66, s77, 0x3001c
s_lshl_b32 s66, s66, 20
s_add_u32 s66, s66, 256
s_add_u32 m0, s57, 24576
s_nop 0
buffer_load_dwordx4 v228, s[16:19], s66 offen offset:0 lds
v_mfma_f32_16x16x32_bf16 v[104:107], v[80:83], v[36:39], v[104:107]
ds_read_b64_tr_b16 v[150:151], v237 offset:1024
v_mfma_f32_16x16x32_bf16 v[108:111], v[84:87], v[36:39], v[108:111]
ds_read_b128 v[56:59], v174 offset:32768
buffer_load_dwordx4 v229, s[16:19], s66 offen offset:1024 lds
v_mfma_f32_16x16x32_bf16 v[112:115], v[80:83], v[40:43], v[112:115]
ds_read_b128 v[60:63], v175 offset:32768
v_mfma_f32_16x16x32_bf16 v[116:119], v[84:87], v[40:43], v[116:119]
ds_read_b128 v[64:67], v176 offset:32768
buffer_load_dwordx4 v230, s[16:19], s66 offen offset:2048 lds
s_waitcnt lgkmcnt(7)
v_mfma_f32_16x16x32_bf16 v[96:99], v[88:91], v[44:47], v[96:99]
ds_read_b64_tr_b16 v[152:153], v238 offset:0
ds_read_b64_tr_b16 v[154:155], v238 offset:1024
v_mfma_f32_16x16x32_bf16 v[100:103], v[92:95], v[44:47], v[100:103]
ds_read_b64_tr_b16 v[156:157], v239 offset:0
v_mfma_f32_16x16x32_bf16 v[104:107], v[88:91], v[48:51], v[104:107]
ds_read_b64_tr_b16 v[158:159], v239 offset:1024
buffer_load_dwordx4 v231, s[16:19], s66 offen offset:3072 lds
v_mfma_f32_16x16x32_bf16 v[108:111], v[92:95], v[48:51], v[108:111]
ds_read_b128 v[68:71], v177 offset:32768
v_mfma_f32_16x16x32_bf16 v[112:115], v[88:91], v[52:55], v[112:115]
ds_read_b128 v[72:75], v178 offset:32768
s_add_u32 m0, s57, 28672
s_add_u32 s67, s66, 131072
buffer_load_dwordx4 v228, s[16:19], s67 offen offset:0 lds
v_mfma_f32_16x16x32_bf16 v[116:119], v[92:95], v[52:55], v[116:119]
ds_read_b128 v[76:79], v179 offset:32768
s_waitcnt lgkmcnt(7)
v_mfma_f32_16x16x32_bf16 v[96:99], v[144:147], v[56:59], v[96:99]
buffer_load_dwordx4 v229, s[16:19], s67 offen offset:1024 lds
v_mfma_f32_16x16x32_bf16 v[100:103], v[148:151], v[56:59], v[100:103]
v_mfma_f32_16x16x32_bf16 v[104:107], v[144:147], v[60:63], v[104:107]
buffer_load_dwordx4 v230, s[16:19], s67 offen offset:2048 lds
v_mfma_f32_16x16x32_bf16 v[108:111], v[148:151], v[60:63], v[108:111]
v_mfma_f32_16x16x32_bf16 v[112:115], v[144:147], v[64:67], v[112:115]
buffer_load_dwordx4 v231, s[16:19], s67 offen offset:3072 lds
v_mfma_f32_16x16x32_bf16 v[116:119], v[148:151], v[64:67], v[116:119]
s_waitcnt vmcnt(19)
s_waitcnt lgkmcnt(0)
s_barrier
v_mfma_f32_16x16x32_bf16 v[96:99], v[152:155], v[68:71], v[96:99]
ds_read_b64_tr_b16 v[80:81], v232 offset:8192
ds_read_b64_tr_b16 v[82:83], v232 offset:9216
s_mov_b32 s70, 0
s_and_b32 s71, s96, 15
s_lshr_b64 s[96:97], s[96:97], 4
s_lshl_b32 s71, s71, 15
s_add_u32 s70, s70, 1
s_add_u32 m0, s57, 0
s_nop 0
buffer_load_dwordx4 v2, s[40:43], s71 offen offset:0 lds
v_mfma_f32_16x16x32_bf16 v[100:103], v[156:159], v[68:71], v[100:103]
ds_read_b64_tr_b16 v[84:85], v233 offset:8192
v_mfma_f32_16x16x32_bf16 v[104:107], v[152:155], v[72:75], v[104:107]
ds_read_b64_tr_b16 v[86:87], v233 offset:9216
v_mfma_f32_16x16x32_bf16 v[108:111], v[156:159], v[72:75], v[108:111]
ds_read_b64_tr_b16 v[88:89], v234 offset:8192
ds_read_b64_tr_b16 v[90:91], v234 offset:9216
buffer_load_dwordx4 v3, s[40:43], s71 offen offset:1024 lds
v_mfma_f32_16x16x32_bf16 v[112:115], v[152:155], v[76:79], v[112:115]
ds_read_b64_tr_b16 v[92:93], v235 offset:8192
v_mfma_f32_16x16x32_bf16 v[116:119], v[156:159], v[76:79], v[116:119]
ds_read_b64_tr_b16 v[94:95], v235 offset:9216
s_waitcnt lgkmcnt(4)
v_mfma_f32_16x16x32_bf16 v[120:123], v[80:83], v[32:35], v[120:123]
ds_read_b64_tr_b16 v[144:145], v236 offset:8192
buffer_load_dwordx4 v4, s[40:43], s71 offen offset:2048 lds
v_mfma_f32_16x16x32_bf16 v[124:127], v[84:87], v[32:35], v[124:127]
ds_read_b64_tr_b16 v[146:147], v236 offset:9216
v_mfma_f32_16x16x32_bf16 v[128:131], v[80:83], v[36:39], v[128:131]
v_mfma_f32_16x16x32_bf16 v[132:135], v[84:87], v[36:39], v[132:135]
ds_read_b64_tr_b16 v[148:149], v237 offset:8192
buffer_load_dwordx4 v5, s[40:43], s71 offen offset:3072 lds
v_mfma_f32_16x16x32_bf16 v[136:139], v[80:83], v[40:43], v[136:139]
ds_read_b64_tr_b16 v[150:151], v237 offset:9216
v_mfma_f32_16x16x32_bf16 v[140:143], v[84:87], v[40:43], v[140:143]
s_waitcnt lgkmcnt(4)
v_mfma_f32_16x16x32_bf16 v[120:123], v[88:91], v[44:47], v[120:123]
ds_read_b64_tr_b16 v[152:153], v238 offset:8192
s_add_u32 m0, s57, 4096
s_add_u32 s67, s71, 16384
buffer_load_dwordx4 v2, s[40:43], s67 offen offset:0 lds
v_mfma_f32_16x16x32_bf16 v[124:127], v[92:95], v[44:47], v[124:127]
ds_read_b64_tr_b16 v[154:155], v238 offset:9216
v_mfma_f32_16x16x32_bf16 v[128:131], v[88:91], v[48:51], v[128:131]
v_mfma_f32_16x16x32_bf16 v[132:135], v[92:95], v[48:51], v[132:135]
ds_read_b64_tr_b16 v[156:157], v239 offset:8192
buffer_load_dwordx4 v3, s[40:43], s67 offen offset:1024 lds
v_mfma_f32_16x16x32_bf16 v[136:139], v[88:91], v[52:55], v[136:139]
ds_read_b64_tr_b16 v[158:159], v239 offset:9216
v_mfma_f32_16x16x32_bf16 v[140:143], v[92:95], v[52:55], v[140:143]
s_waitcnt lgkmcnt(4)
v_mfma_f32_16x16x32_bf16 v[120:123], v[144:147], v[56:59], v[120:123]
buffer_load_dwordx4 v4, s[40:43], s67 offen offset:2048 lds
v_mfma_f32_16x16x32_bf16 v[124:127], v[148:151], v[56:59], v[124:127]
v_mfma_f32_16x16x32_bf16 v[128:131], v[144:147], v[60:63], v[128:131]
v_mfma_f32_16x16x32_bf16 v[132:135], v[148:151], v[60:63], v[132:135]
buffer_load_dwordx4 v5, s[40:43], s67 offen offset:3072 lds
v_mfma_f32_16x16x32_bf16 v[136:139], v[144:147], v[64:67], v[136:139]
v_mfma_f32_16x16x32_bf16 v[140:143], v[148:151], v[64:67], v[140:143]
s_waitcnt vmcnt(19)
s_waitcnt vmcnt(16)
s_waitcnt lgkmcnt(0)
s_barrier
v_mfma_f32_16x16x32_bf16 v[120:123], v[152:155], v[68:71], v[120:123]
ds_read_b64_tr_b16 v[80:81], v232 offset:16384
ds_read_b64_tr_b16 v[82:83], v232 offset:17408
ds_read_b64_tr_b16 v[84:85], v233 offset:16384
s_add_u32 m0, s57, 8192
s_nop 0
buffer_load_dwordx4 v6, s[44:47], s71 offen offset:0 lds
v_mfma_f32_16x16x32_bf16 v[124:127], v[156:159], v[68:71], v[124:127]
ds_read_b64_tr_b16 v[86:87], v233 offset:17408
ds_read_b128 v[32:35], v168 offset:35840
v_mfma_f32_16x16x32_bf16 v[128:131], v[152:155], v[72:75], v[128:131]
ds_read_b128 v[36:39], v169 offset:35840
ds_read_b128 v[40:43], v170 offset:35840
v_mfma_f32_16x16x32_bf16 v[132:135], v[156:159], v[72:75], v[132:135]
ds_read_b64_tr_b16 v[88:89], v234 offset:16384
ds_read_b64_tr_b16 v[90:91], v234 offset:17408
ds_read_b64_tr_b16 v[92:93], v235 offset:16384
buffer_load_dwordx4 v7, s[44:47], s71 offen offset:1024 lds
v_mfma_f32_16x16x32_bf16 v[136:139], v[152:155], v[76:79], v[136:139]
ds_read_b64_tr_b16 v[94:95], v235 offset:17408
ds_read_b128 v[44:47], v171 offset:35840
v_mfma_f32_16x16x32_bf16 v[140:143], v[156:159], v[76:79], v[140:143]
ds_read_b128 v[48:51], v172 offset:35840
ds_read_b128 v[52:55], v173 offset:35840
s_waitcnt lgkmcnt(7)
v_mfma_f32_16x16x32_bf16 v[96:99], v[80:83], v[32:35], v[96:99]
ds_read_b64_tr_b16 v[144:145], v236 offset:16384
ds_read_b64_tr_b16 v[146:147], v236 offset:17408
buffer_load_dwordx4 v8, s[44:47], s71 offen offset:2048 lds
v_mfma_f32_16x16x32_bf16 v[100:103], v[84:87], v[32:35], v[100:103]
ds_read_b64_tr_b16 v[148:149], v237 offset:16384
v_mfma_f32_16x16x32_bf16 v[104:107], v[80:83], v[36:39], v[104:107]
ds_read_b64_tr_b16 v[150:151], v237 offset:17408
v_mfma_f32_16x16x32_bf16 v[108:111], v[84:87], v[36:39], v[108:111]
ds_read_b128 v[56:59], v174 offset:35840
buffer_load_dwordx4 v9, s[44:47], s71 offen offset:3072 lds
v_mfma_f32_16x16x32_bf16 v[112:115], v[80:83], v[40:43], v[112:115]
ds_read_b128 v[60:63], v175 offset:35840
v_mfma_f32_16x16x32_bf16 v[116:119], v[84:87], v[40:43], v[116:119]
ds_read_b128 v[64:67], v176 offset:35840
s_waitcnt lgkmcnt(7)
v_mfma_f32_16x16x32_bf16 v[96:99], v[88:91], v[44:47], v[96:99]
ds_read_b64_tr_b16 v[152:153], v238 offset:16384
ds_read_b64_tr_b16 v[154:155], v238 offset:17408
s_add_u32 m0, s57, 12288
s_add_u32 s67, s71, 16384
buffer_load_dwordx4 v6, s[44:47], s67 offen offset:0 lds
v_mfma_f32_16x16x32_bf16 v[100:103], v[92:95], v[44:47], v[100:103]
ds_read_b64_tr_b16 v[156:157], v239 offset:16384
v_mfma_f32_16x16x32_bf16 v[104:107], v[88:91], v[48:51], v[104:107]
ds_read_b64_tr_b16 v[158:159], v239 offset:17408
v_mfma_f32_16x16x32_bf16 v[108:111], v[92:95], v[48:51], v[108:111]
ds_read_b128 v[68:71], v177 offset:35840
buffer_load_dwordx4 v7, s[44:47], s67 offen offset:1024 lds
v_mfma_f32_16x16x32_bf16 v[112:115], v[88:91], v[52:55], v[112:115]
ds_read_b128 v[72:75], v178 offset:35840
v_mfma_f32_16x16x32_bf16 v[116:119], v[92:95], v[52:55], v[116:119]
ds_read_b128 v[76:79], v179 offset:35840
s_waitcnt lgkmcnt(7)
v_mfma_f32_16x16x32_bf16 v[96:99], v[144:147], v[56:59], v[96:99]
buffer_load_dwordx4 v8, s[44:47], s67 offen offset:2048 lds
v_mfma_f32_16x16x32_bf16 v[100:103], v[148:151], v[56:59], v[100:103]
v_mfma_f32_16x16x32_bf16 v[104:107], v[144:147], v[60:63], v[104:107]
v_mfma_f32_16x16x32_bf16 v[108:111], v[148:151], v[60:63], v[108:111]
buffer_load_dwordx4 v9, s[44:47], s67 offen offset:3072 lds
v_mfma_f32_16x16x32_bf16 v[112:115], v[144:147], v[64:67], v[112:115]
v_mfma_f32_16x16x32_bf16 v[116:119], v[148:151], v[64:67], v[116:119]
s_waitcnt vmcnt(16)
s_waitcnt lgkmcnt(0)
s_barrier
v_mfma_f32_16x16x32_bf16 v[96:99], v[152:155], v[68:71], v[96:99]
ds_read_b64_tr_b16 v[80:81], v232 offset:24576
ds_read_b64_tr_b16 v[82:83], v232 offset:25600
s_and_b32 s72, s96, 15
s_lshr_b64 s[96:97], s[96:97], 4
s_lshl_b32 s72, s72, 15
s_add_u32 s70, s70, 1
s_add_u32 m0, s57, 16384
s_nop 0
buffer_load_dwordx4 v2, s[40:43], s72 offen offset:0 lds
v_mfma_f32_16x16x32_bf16 v[100:103], v[156:159], v[68:71], v[100:103]
ds_read_b64_tr_b16 v[84:85], v233 offset:24576
v_mfma_f32_16x16x32_bf16 v[104:107], v[152:155], v[72:75], v[104:107]
ds_read_b64_tr_b16 v[86:87], v233 offset:25600
v_mfma_f32_16x16x32_bf16 v[108:111], v[156:159], v[72:75], v[108:111]
ds_read_b64_tr_b16 v[88:89], v234 offset:24576
ds_read_b64_tr_b16 v[90:91], v234 offset:25600
buffer_load_dwordx4 v3, s[40:43], s72 offen offset:1024 lds
v_mfma_f32_16x16x32_bf16 v[112:115], v[152:155], v[76:79], v[112:115]
ds_read_b64_tr_b16 v[92:93], v235 offset:24576
v_mfma_f32_16x16x32_bf16 v[116:119], v[156:159], v[76:79], v[116:119]
ds_read_b64_tr_b16 v[94:95], v235 offset:25600
s_waitcnt lgkmcnt(4)
v_mfma_f32_16x16x32_bf16 v[120:123], v[80:83], v[32:35], v[120:123]
ds_read_b64_tr_b16 v[144:145], v236 offset:24576
buffer_load_dwordx4 v4, s[40:43], s72 offen offset:2048 lds
v_mfma_f32_16x16x32_bf16 v[124:127], v[84:87], v[32:35], v[124:127]
ds_read_b64_tr_b16 v[146:147], v236 offset:25600
v_mfma_f32_16x16x32_bf16 v[128:131], v[80:83], v[36:39], v[128:131]
v_mfma_f32_16x16x32_bf16 v[132:135], v[84:87], v[36:39], v[132:135]
ds_read_b64_tr_b16 v[148:149], v237 offset:24576
buffer_load_dwordx4 v5, s[40:43], s72 offen offset:3072 lds
v_mfma_f32_16x16x32_bf16 v[136:139], v[80:83], v[40:43], v[136:139]
ds_read_b64_tr_b16 v[150:151], v237 offset:25600
v_mfma_f32_16x16x32_bf16 v[140:143], v[84:87], v[40:43], v[140:143]
s_waitcnt lgkmcnt(4)
v_mfma_f32_16x16x32_bf16 v[120:123], v[88:91], v[44:47], v[120:123]
ds_read_b64_tr_b16 v[152:153], v238 offset:24576
s_add_u32 m0, s57, 20480
s_add_u32 s67, s72, 16384
buffer_load_dwordx4 v2, s[40:43], s67 offen offset:0 lds
v_mfma_f32_16x16x32_bf16 v[124:127], v[92:95], v[44:47], v[124:127]
ds_read_b64_tr_b16 v[154:155], v238 offset:25600
v_mfma_f32_16x16x32_bf16 v[128:131], v[88:91], v[48:51], v[128:131]
v_mfma_f32_16x16x32_bf16 v[132:135], v[92:95], v[48:51], v[132:135]
ds_read_b64_tr_b16 v[156:157], v239 offset:24576
buffer_load_dwordx4 v3, s[40:43], s67 offen offset:1024 lds
v_mfma_f32_16x16x32_bf16 v[136:139], v[88:91], v[52:55], v[136:139]
ds_read_b64_tr_b16 v[158:159], v239 offset:25600
v_mfma_f32_16x16x32_bf16 v[140:143], v[92:95], v[52:55], v[140:143]
s_waitcnt lgkmcnt(4)
v_mfma_f32_16x16x32_bf16 v[120:123], v[144:147], v[56:59], v[120:123]
buffer_load_dwordx4 v4, s[40:43], s67 offen offset:2048 lds
v_mfma_f32_16x16x32_bf16 v[124:127], v[148:151], v[56:59], v[124:127]
v_mfma_f32_16x16x32_bf16 v[128:131], v[144:147], v[60:63], v[128:131]
v_mfma_f32_16x16x32_bf16 v[132:135], v[148:151], v[60:63], v[132:135]
buffer_load_dwordx4 v5, s[40:43], s67 offen offset:3072 lds
v_mfma_f32_16x16x32_bf16 v[136:139], v[144:147], v[64:67], v[136:139]
v_mfma_f32_16x16x32_bf16 v[140:143], v[148:151], v[64:67], v[140:143]
s_waitcnt lgkmcnt(0)
v_mfma_f32_16x16x32_bf16 v[120:123], v[152:155], v[68:71], v[120:123]
v_mfma_f32_16x16x32_bf16 v[124:127], v[156:159], v[68:71], v[124:127]
v_mfma_f32_16x16x32_bf16 v[128:131], v[152:155], v[72:75], v[128:131]
v_mfma_f32_16x16x32_bf16 v[132:135], v[156:159], v[72:75], v[132:135]
v_mfma_f32_16x16x32_bf16 v[136:139], v[152:155], v[76:79], v[136:139]
v_mfma_f32_16x16x32_bf16 v[140:143], v[156:159], v[76:79], v[140:143]
s_mov_b32 s64, 0x3e0293ee
s_mov_b32 s65, 0x3e0293ee
v_pk_mul_f32 v[96:97], v[96:97], s[64:65]
v_pk_mul_f32 v[98:99], v[98:99], s[64:65]
v_pk_mul_f32 v[100:101], v[100:101], s[64:65]
v_pk_mul_f32 v[102:103], v[102:103], s[64:65]
v_pk_mul_f32 v[104:105], v[104:105], s[64:65]
v_pk_mul_f32 v[106:107], v[106:107], s[64:65]
v_pk_mul_f32 v[108:109], v[108:109], s[64:65]
v_pk_mul_f32 v[110:111], v[110:111], s[64:65]
v_pk_mul_f32 v[112:113], v[112:113], s[64:65]
v_pk_mul_f32 v[114:115], v[114:115], s[64:65]
v_pk_mul_f32 v[116:117], v[116:117], s[64:65]
v_pk_mul_f32 v[118:119], v[118:119], s[64:65]
v_pk_mul_f32 v[120:121], v[120:121], s[64:65]
v_pk_mul_f32 v[122:123], v[122:123], s[64:65]
v_pk_mul_f32 v[124:125], v[124:125], s[64:65]
v_pk_mul_f32 v[126:127], v[126:127], s[64:65]
v_pk_mul_f32 v[128:129], v[128:129], s[64:65]
v_pk_mul_f32 v[130:131], v[130:131], s[64:65]
v_pk_mul_f32 v[132:133], v[132:133], s[64:65]
v_pk_mul_f32 v[134:135], v[134:135], s[64:65]
v_pk_mul_f32 v[136:137], v[136:137], s[64:65]
v_pk_mul_f32 v[138:139], v[138:139], s[64:65]
v_pk_mul_f32 v[140:141], v[140:141], s[64:65]
v_pk_mul_f32 v[142:143], v[142:143], s[64:65]
v_cvt_pk_bf16_f32 v96, v96, v97
v_cvt_pk_bf16_f32 v97, v98, v99
v_cvt_pk_bf16_f32 v98, v100, v101
v_cvt_pk_bf16_f32 v99, v102, v103
v_cvt_pk_bf16_f32 v100, v104, v105
v_cvt_pk_bf16_f32 v101, v106, v107
v_cvt_pk_bf16_f32 v102, v108, v109
v_cvt_pk_bf16_f32 v103, v110, v111
v_cvt_pk_bf16_f32 v104, v112, v113
v_cvt_pk_bf16_f32 v105, v114, v115
v_cvt_pk_bf16_f32 v106, v116, v117
v_cvt_pk_bf16_f32 v107, v118, v119
v_cvt_pk_bf16_f32 v108, v120, v121
v_cvt_pk_bf16_f32 v109, v122, v123
v_cvt_pk_bf16_f32 v110, v124, v125
v_cvt_pk_bf16_f32 v111, v126, v127
v_cvt_pk_bf16_f32 v112, v128, v129
v_cvt_pk_bf16_f32 v113, v130, v131
v_cvt_pk_bf16_f32 v114, v132, v133
v_cvt_pk_bf16_f32 v115, v134, v135
v_cvt_pk_bf16_f32 v116, v136, v137
v_cvt_pk_bf16_f32 v117, v138, v139
v_cvt_pk_bf16_f32 v118, v140, v141
v_cvt_pk_bf16_f32 v119, v142, v143
v_permlane32_swap_b32 v96, v98
v_permlane32_swap_b32 v97, v99
v_permlane32_swap_b32 v100, v102
v_permlane32_swap_b32 v101, v103
v_permlane32_swap_b32 v104, v106
v_permlane32_swap_b32 v105, v107
v_permlane32_swap_b32 v108, v110
v_permlane32_swap_b32 v109, v111
v_permlane32_swap_b32 v112, v114
v_permlane32_swap_b32 v113, v115
v_permlane32_swap_b32 v116, v118
v_permlane32_swap_b32 v117, v119
v_permlane16_swap_b32 v96, v98
v_permlane16_swap_b32 v97, v99
v_permlane16_swap_b32 v100, v102
v_permlane16_swap_b32 v101, v103
v_permlane16_swap_b32 v104, v106
v_permlane16_swap_b32 v105, v107
v_permlane16_swap_b32 v108, v110
v_permlane16_swap_b32 v109, v111
v_permlane16_swap_b32 v112, v114
v_permlane16_swap_b32 v113, v115
v_permlane16_swap_b32 v116, v118
v_permlane16_swap_b32 v117, v119
s_lshl_b32 s64, s60, 5
s_add_u32 s64, s64, s61
s_add_u32 s64, s64, 256
s_lshl_b32 s64, s64, 5
s_add_u32 s64, s64, s56
s_lshl_b32 s64, s64, 2
v_mov_b32 v216, s64
v_mov_b32 v217, 1
s_bfe_u32 s64, s59, 0x20002
s_lshl_b32 s65, s64, 21
s_lshl_b32 s64, s64, 19
s_cmp_ge_u32 s58, 4
s_cselect_b32 s64, s64, s65
s_cselect_b32 s66, 21, 18
s_cselect_b32 s12, s22, s12
s_cselect_b32 s13, s23, s13
s_and_b32 s65, s59, 3
s_lshl2_add_u32 s65, s65, s56
s_lshl_b32 s65, s65, 14
s_add_u32 s64, s64, s65
s_and_b32 s65, s58, 3
s_lshl_b32 s65, s65, 9
s_add_u32 s64, s64, s65
v_bfe_u32 v220, v1, 2, 3
v_lshl_add_u32 v220, v220, 11, s64
v_and_b32 v221, 3, v1
v_lshl_add_u32 v220, v221, 7, v220
v_lshrrev_b32 v221, 5, v1
v_lshl_add_u32 v220, v221, s66, v220
ds_write_b128 v200, v[96:99] offset:32768
ds_write_b128 v200, v[100:103] offset:33792
ds_write_b128 v200, v[104:107] offset:34816
ds_write_b128 v200, v[108:111] offset:35840
ds_write_b128 v200, v[112:115] offset:36864
ds_write_b128 v200, v[116:119] offset:37888
s_waitcnt lgkmcnt(0)
s_barrier
ds_read_b128 a[192:195], v207 offset:0
ds_read_b128 a[196:199], v207 offset:40960
ds_read_b128 a[200:203], v208 offset:0
ds_read_b128 a[204:207], v208 offset:40960
ds_read_b128 a[208:211], v207 offset:1024
ds_read_b128 a[212:215], v207 offset:41984
ds_read_b128 a[216:219], v208 offset:1024
ds_read_b128 a[220:223], v208 offset:41984
ds_read_b128 a[224:227], v207 offset:2048
ds_read_b128 a[228:231], v207 offset:43008
ds_read_b128 a[232:235], v208 offset:2048
ds_read_b128 a[236:239], v208 offset:43008
ds_read_b128 a[240:243], v207 offset:3072
ds_read_b128 a[244:247], v207 offset:44032
ds_read_b128 a[248:251], v208 offset:3072
ds_read_b128 a[252:255], v208 offset:44032
ds_read_b128 v[168:171], v207 offset:4096
ds_read_b128 v[172:175], v207 offset:45056
ds_read_b128 v[176:179], v208 offset:4096
ds_read_b128 v[180:183], v208 offset:45056
ds_read_b128 v[184:187], v207 offset:5120
ds_read_b128 v[188:191], v207 offset:46080
ds_read_b128 v[192:195], v208 offset:5120
ds_read_b128 v[196:199], v208 offset:46080
v_mov_b32 v128, 0
v_mov_b32 v129, 0
v_mov_b32 v130, 0
v_mov_b32 v131, 0
v_mov_b32 v132, 0
v_mov_b32 v133, 0
v_mov_b32 v134, 0
v_mov_b32 v135, 0
v_mov_b32 v136, 0
v_mov_b32 v137, 0
v_mov_b32 v138, 0
v_mov_b32 v139, 0
v_mov_b32 v140, 0
v_mov_b32 v141, 0
v_mov_b32 v142, 0
v_mov_b32 v143, 0
s_add_u32 m0, s57, 24576
s_nop 0
buffer_load_dwordx4 v6, s[44:47], s72 offen offset:0 lds
v_mfma_f32_32x32x16_bf16 a[0:15], v[128:131], v[128:131], 0
buffer_load_dwordx4 v7, s[44:47], s72 offen offset:1024 lds
v_mfma_f32_32x32x16_bf16 a[16:31], v[128:131], v[128:131], 0
buffer_load_dwordx4 v8, s[44:47], s72 offen offset:2048 lds
v_mfma_f32_32x32x16_bf16 a[32:47], v[128:131], v[128:131], 0
buffer_load_dwordx4 v9, s[44:47], s72 offen offset:3072 lds
v_mfma_f32_32x32x16_bf16 a[48:63], v[128:131], v[128:131], 0
s_add_u32 m0, s57, 28672
s_add_u32 s67, s72, 16384
buffer_load_dwordx4 v6, s[44:47], s67 offen offset:0 lds
v_mfma_f32_32x32x16_bf16 a[64:79], v[128:131], v[128:131], 0
buffer_load_dwordx4 v7, s[44:47], s67 offen offset:1024 lds
v_mfma_f32_32x32x16_bf16 a[80:95], v[128:131], v[128:131], 0
buffer_load_dwordx4 v8, s[44:47], s67 offen offset:2048 lds
v_mfma_f32_32x32x16_bf16 a[96:111], v[128:131], v[128:131], 0
buffer_load_dwordx4 v9, s[44:47], s67 offen offset:3072 lds
v_mfma_f32_32x32x16_bf16 a[112:127], v[128:131], v[128:131], 0
v_mfma_f32_32x32x16_bf16 a[128:143], v[128:131], v[128:131], 0
v_mfma_f32_32x32x16_bf16 a[144:159], v[128:131], v[128:131], 0
v_mfma_f32_32x32x16_bf16 a[160:175], v[128:131], v[128:131], 0
v_mfma_f32_32x32x16_bf16 a[176:191], v[128:131], v[128:131], 0
v_mov_b32 v144, 0
v_mov_b32 v145, 0
v_mov_b32 v146, 0
v_mov_b32 v147, 0
v_mov_b32 v148, 0
v_mov_b32 v149, 0
v_mov_b32 v150, 0
v_mov_b32 v151, 0
v_mov_b32 v152, 0
v_mov_b32 v153, 0
v_mov_b32 v154, 0
v_mov_b32 v155, 0
v_mov_b32 v156, 0
v_mov_b32 v157, 0
v_mov_b32 v158, 0
v_mov_b32 v159, 0
v_mov_b32 v160, 0
v_mov_b32 v161, 0
v_mov_b32 v162, 0
v_mov_b32 v163, 0
v_mov_b32 v164, 0
v_mov_b32 v165, 0
v_mov_b32 v166, 0
v_mov_b32 v167, 0
v_mov_b32 v22, 0
v_mov_b32 v23, 0
v_mov_b32 v24, 0
v_mov_b32 v25, 0
v_mov_b32 v26, 0
v_mov_b32 v27, 0
v_mov_b32 v28, 0
v_mov_b32 v29, 0
v_mov_b32 v224, 0
v_mov_b32 v225, 0
v_mov_b32 v226, 0
v_mov_b32 v227, 0
v_mov_b32 v228, 0
v_mov_b32 v229, 0
v_mov_b32 v230, 0
v_mov_b32 v231, 0
v_mov_b32 v232, 0
v_mov_b32 v233, 0
v_mov_b32 v234, 0
v_mov_b32 v235, 0
v_mov_b32 v236, 0
v_mov_b32 v237, 0
v_mov_b32 v238, 0
v_mov_b32 v239, 0
v_mov_b32 v252, 0x3f803f80
v_mov_b32 v253, 0x3f803f80
v_mov_b32 v254, 0x3f803f80
v_mov_b32 v255, 0x3f803f80
s_mov_b32 s68, 0xff800000
s_mov_b32 s69, 0xff800000
s_mov_b32 s73, 0
s_waitcnt vmcnt(24)
ds_read_b128 v[32:35], v10 offset:0
ds_read_b128 v[36:39], v10 offset:4096
ds_read_b128 v[40:43], v11 offset:0
ds_read_b128 v[44:47], v11 offset:4096
ds_read_b128 v[48:51], v12 offset:0
ds_read_b128 v[52:55], v12 offset:4096
ds_read_b128 v[56:59], v13 offset:0
ds_read_b128 v[60:63], v13 offset:4096
s_waitcnt lgkmcnt(0)
v_mfma_f32_16x16x32_bf16 v[96:99], v[32:35], a[192:195], v[144:147]
v_mfma_f32_16x16x32_bf16 v[104:107], v[32:35], a[208:211], v[148:151]
v_mfma_f32_16x16x32_bf16 v[100:103], v[36:39], a[192:195], v[144:147]
v_mfma_f32_16x16x32_bf16 v[108:111], v[36:39], a[208:211], v[148:151]
v_mfma_f32_16x16x32_bf16 v[96:99], v[40:43], a[196:199], v[96:99]
v_mfma_f32_16x16x32_bf16 v[104:107], v[40:43], a[212:215], v[104:107]
v_mfma_f32_16x16x32_bf16 v[100:103], v[44:47], a[196:199], v[100:103]
v_mfma_f32_16x16x32_bf16 v[108:111], v[44:47], a[212:215], v[108:111]
v_mfma_f32_16x16x32_bf16 v[96:99], v[48:51], a[200:203], v[96:99]
v_mfma_f32_16x16x32_bf16 v[104:107], v[48:51], a[216:219], v[104:107]
v_mfma_f32_16x16x32_bf16 v[100:103], v[52:55], a[200:203], v[100:103]
v_mfma_f32_16x16x32_bf16 v[108:111], v[52:55], a[216:219], v[108:111]
v_mfma_f32_16x16x32_bf16 v[96:99], v[56:59], a[204:207], v[96:99]
v_mfma_f32_16x16x32_bf16 v[104:107], v[56:59], a[220:223], v[104:107]
v_mfma_f32_16x16x32_bf16 v[100:103], v[60:63], a[204:207], v[100:103]
v_mfma_f32_16x16x32_bf16 v[108:111], v[60:63], a[220:223], v[108:111]
s_nop 4
v_max3_f32 v30, v96, v97, v98
s_nop 0
v_max3_f32 v30, v30, v99, v100
v_max3_f32 v30, v30, v101, v102
v_max3_f32 v30, v30, v103, v104
v_max3_f32 v30, v30, v105, v106
v_max3_f32 v30, v30, v107, v108
v_max3_f32 v30, v30, v109, v110
v_max_f32 v30, v30, v111
v_cmp_lt_f32 vcc, s68, v30
.p2align 3
A_loop:
v_mfma_f32_16x16x32_bf16 v[112:115], v[32:35], a[224:227], v[152:155]
s_cbranch_vccnz A_rare0
A_ret0:
s_and_b32 s71, s96, 15
s_lshr_b64 s[96:97], s[96:97], 4
v_mfma_f32_16x16x32_bf16 v[120:123], v[32:35], a[240:243], v[156:159]
s_lshl_b32 s71, s71, 15
s_add_u32 s70, s70, 1
v_mfma_f32_16x16x32_bf16 v[116:119], v[36:39], a[224:227], v[152:155]
s_add_u32 m0, s57, 0
v_mfma_f32_16x16x32_bf16 v[124:127], v[36:39], a[240:243], v[156:159]
buffer_load_dwordx4 v2, s[40:43], s71 offen offset:0 lds
v_mfma_f32_16x16x32_bf16 v[112:115], v[40:43], a[228:231], v[112:115]
v_exp_f32 v96, v96
v_mfma_f32_16x16x32_bf16 v[120:123], v[40:43], a[244:247], v[120:123]
v_exp_f32 v97, v97
v_mfma_f32_16x16x32_bf16 v[116:119], v[44:47], a[228:231], v[116:119]
v_exp_f32 v98, v98
v_mfma_f32_16x16x32_bf16 v[124:127], v[44:47], a[244:247], v[124:127]
buffer_load_dwordx4 v3, s[40:43], s71 offen offset:1024 lds
v_mfma_f32_16x16x32_bf16 v[112:115], v[48:51], a[232:235], v[112:115]
v_cvt_pk_bf16_f32 v128, v96, v97
v_exp_f32 v99, v99
v_mfma_f32_16x16x32_bf16 v[120:123], v[48:51], a[248:251], v[120:123]
v_exp_f32 v100, v100
v_mfma_f32_16x16x32_bf16 v[116:119], v[52:55], a[232:235], v[116:119]
v_cvt_pk_bf16_f32 v129, v98, v99
v_exp_f32 v101, v101
v_mfma_f32_16x16x32_bf16 v[124:127], v[52:55], a[248:251], v[124:127]
buffer_load_dwordx4 v4, s[40:43], s71 offen offset:2048 lds
v_mfma_f32_16x16x32_bf16 v[112:115], v[56:59], a[236:239], v[112:115]
v_exp_f32 v102, v102
v_mfma_f32_16x16x32_bf16 v[120:123], v[56:59], a[252:255], v[120:123]
v_cvt_pk_bf16_f32 v130, v100, v101
v_exp_f32 v103, v103
v_mfma_f32_16x16x32_bf16 v[116:119], v[60:63], a[236:239], v[116:119]
v_exp_f32 v104, v104
v_cvt_pk_bf16_f32 v131, v102, v103
v_mfma_f32_16x16x32_bf16 v[124:127], v[60:63], a[252:255], v[124:127]
buffer_load_dwordx4 v5, s[40:43], s71 offen offset:3072 lds
v_mfma_f32_16x16x32_bf16 a[128:131], v[64:67], v[136:139], a[128:131]
v_exp_f32 v105, v105
v_mfma_f32_16x16x32_bf16 a[160:163], v[64:67], v[140:143], a[160:163]
v_exp_f32 v106, v106
v_mfma_f32_16x16x32_bf16 a[132:135], v[68:71], v[136:139], a[132:135]
s_add_u32 m0, s57, 4096
s_add_u32 s67, s71, 16384
v_mfma_f32_16x16x32_bf16 a[164:167], v[68:71], v[140:143], a[164:167]
buffer_load_dwordx4 v2, s[40:43], s67 offen offset:0 lds
v_mfma_f32_16x16x32_bf16 a[136:139], v[72:75], v[136:139], a[136:139]
v_max3_f32 v30, v112, v113, v114
v_max3_f32 v30, v30, v115, v116
v_mfma_f32_16x16x32_bf16 a[168:171], v[72:75], v[140:143], a[168:171]
v_cvt_pk_bf16_f32 v132, v104, v105
v_max3_f32 v30, v30, v117, v118
v_mfma_f32_16x16x32_bf16 a[140:143], v[76:79], v[136:139], a[140:143]
v_exp_f32 v107, v107
v_mfma_f32_16x16x32_bf16 a[172:175], v[76:79], v[140:143], a[172:175]
buffer_load_dwordx4 v3, s[40:43], s67 offen offset:1024 lds
v_mfma_f32_16x16x32_bf16 a[144:147], v[80:83], v[136:139], a[144:147]
v_exp_f32 v108, v108
v_mfma_f32_16x16x32_bf16 a[176:179], v[80:83], v[140:143], a[176:179]
v_cvt_pk_bf16_f32 v133, v106, v107
v_max3_f32 v30, v30, v119, v120
v_mfma_f32_16x16x32_bf16 a[148:151], v[84:87], v[136:139], a[148:151]
v_exp_f32 v109, v109
v_max3_f32 v30, v30, v121, v122
v_mfma_f32_16x16x32_bf16 a[180:183], v[84:87], v[140:143], a[180:183]
buffer_load_dwordx4 v4, s[40:43], s67 offen offset:2048 lds
v_mfma_f32_16x16x32_bf16 a[152:155], v[88:91], v[136:139], a[152:155]
v_max3_f32 v30, v30, v123, v124
v_max3_f32 v30, v30, v125, v126
v_mfma_f32_16x16x32_bf16 a[184:187], v[88:91], v[140:143], a[184:187]
v_exp_f32 v110, v110
v_mfma_f32_16x16x32_bf16 a[156:159], v[92:95], v[136:139], a[156:159]
v_exp_f32 v111, v111
v_mfma_f32_16x16x32_bf16 a[188:191], v[92:95], v[140:143], a[188:191]
buffer_load_dwordx4 v5, s[40:43], s67 offen offset:3072 lds
v_mfma_f32_16x16x32_bf16 v[232:235], v[252:255], v[136:139], v[232:235]
v_cvt_pk_bf16_f32 v134, v108, v109
v_max_f32 v30, v30, v127
v_mfma_f32_16x16x32_bf16 v[236:239], v[252:255], v[140:143], v[236:239]
v_cvt_pk_bf16_f32 v135, v110, v111
v_cmp_lt_f32 vcc, s68, v30
s_waitcnt vmcnt(24)
v_mfma_f32_16x16x32_bf16 v[96:99], v[32:35], v[168:171], v[160:163]
s_cbranch_vccnz A_rare1
A_ret1:
ds_read_b64_tr_b16 v[64:65], v14 offset:8192
v_mfma_f32_16x16x32_bf16 v[104:107], v[32:35], v[184:187], v[164:167]
ds_read_b64_tr_b16 v[66:67], v14 offset:12288
v_mfma_f32_16x16x32_bf16 v[100:103], v[36:39], v[168:171], v[160:163]
ds_read_b64_tr_b16 v[68:69], v15 offset:8192
v_exp_f32 v112, v112
v_mfma_f32_16x16x32_bf16 v[108:111], v[36:39], v[184:187], v[164:167]
ds_read_b64_tr_b16 v[70:71], v15 offset:12288
v_exp_f32 v113, v113
v_mfma_f32_16x16x32_bf16 v[96:99], v[40:43], v[172:175], v[96:99]
ds_read_b64_tr_b16 v[72:73], v16 offset:8192
v_exp_f32 v114, v114
v_mfma_f32_16x16x32_bf16 v[104:107], v[40:43], v[188:191], v[104:107]
ds_read_b64_tr_b16 v[74:75], v16 offset:12288
v_cvt_pk_bf16_f32 v136, v112, v113
v_mfma_f32_16x16x32_bf16 v[100:103], v[44:47], v[172:175], v[100:103]
ds_read_b64_tr_b16 v[76:77], v17 offset:8192
v_exp_f32 v115, v115
v_mfma_f32_16x16x32_bf16 v[108:111], v[44:47], v[188:191], v[108:111]
ds_read_b64_tr_b16 v[78:79], v17 offset:12288
v_exp_f32 v116, v116
v_mfma_f32_16x16x32_bf16 v[96:99], v[48:51], v[176:179], v[96:99]
ds_read_b64_tr_b16 v[80:81], v18 offset:8192
v_cvt_pk_bf16_f32 v137, v114, v115
v_mfma_f32_16x16x32_bf16 v[104:107], v[48:51], v[192:195], v[104:107]
ds_read_b64_tr_b16 v[82:83], v18 offset:12288
v_exp_f32 v117, v117
v_mfma_f32_16x16x32_bf16 v[100:103], v[52:55], v[176:179], v[100:103]
ds_read_b64_tr_b16 v[84:85], v19 offset:8192
v_exp_f32 v118, v118
v_mfma_f32_16x16x32_bf16 v[108:111], v[52:55], v[192:195], v[108:111]
ds_read_b64_tr_b16 v[86:87], v19 offset:12288
v_cvt_pk_bf16_f32 v138, v116, v117
v_mfma_f32_16x16x32_bf16 v[96:99], v[56:59], v[180:183], v[96:99]
ds_read_b64_tr_b16 v[88:89], v20 offset:8192
v_exp_f32 v119, v119
v_mfma_f32_16x16x32_bf16 v[104:107], v[56:59], v[196:199], v[104:107]
ds_read_b64_tr_b16 v[90:91], v20 offset:12288
v_exp_f32 v120, v120
v_mfma_f32_16x16x32_bf16 v[100:103], v[60:63], v[180:183], v[100:103]
ds_read_b64_tr_b16 v[92:93], v21 offset:8192
v_cvt_pk_bf16_f32 v139, v118, v119
v_mfma_f32_16x16x32_bf16 v[108:111], v[60:63], v[196:199], v[108:111]
ds_read_b64_tr_b16 v[94:95], v21 offset:12288
s_waitcnt vmcnt(16)
s_waitcnt lgkmcnt(12)
v_mfma_f32_16x16x32_bf16 a[0:3], v[64:67], v[128:131], a[0:3]
ds_read_b128 v[32:35], v10 offset:16384
v_exp_f32 v121, v121
v_mfma_f32_16x16x32_bf16 a[32:35], v[64:67], v[132:135], a[32:35]
v_exp_f32 v122, v122
v_mfma_f32_16x16x32_bf16 a[4:7], v[68:71], v[128:131], a[4:7]
ds_read_b128 v[36:39], v10 offset:20480
v_cvt_pk_bf16_f32 v140, v120, v121
v_mfma_f32_16x16x32_bf16 a[36:39], v[68:71], v[132:135], a[36:39]
v_exp_f32 v123, v123
s_waitcnt lgkmcnt(10)
v_mfma_f32_16x16x32_bf16 a[8:11], v[72:75], v[128:131], a[8:11]
ds_read_b128 v[40:43], v11 offset:16384
v_max3_f32 v30, v96, v97, v98
v_mfma_f32_16x16x32_bf16 a[40:43], v[72:75], v[132:135], a[40:43]
v_exp_f32 v124, v124
v_mfma_f32_16x16x32_bf16 a[12:15], v[76:79], v[128:131], a[12:15]
ds_read_b128 v[44:47], v11 offset:20480
v_max3_f32 v30, v30, v99, v100
v_mfma_f32_16x16x32_bf16 a[44:47], v[76:79], v[132:135], a[44:47]
v_max3_f32 v30, v30, v101, v102
s_waitcnt lgkmcnt(8)
v_mfma_f32_16x16x32_bf16 a[16:19], v[80:83], v[128:131], a[16:19]
ds_read_b128 v[48:51], v12 offset:16384
v_max3_f32 v30, v30, v103, v104
v_mfma_f32_16x16x32_bf16 a[48:51], v[80:83], v[132:135], a[48:51]
v_cvt_pk_bf16_f32 v141, v122, v123
v_max3_f32 v30, v30, v105, v106
v_mfma_f32_16x16x32_bf16 a[20:23], v[84:87], v[128:131], a[20:23]
ds_read_b128 v[52:55], v12 offset:20480
v_max3_f32 v30, v30, v107, v108
v_mfma_f32_16x16x32_bf16 a[52:55], v[84:87], v[132:135], a[52:55]
v_max3_f32 v30, v30, v109, v110
s_waitcnt lgkmcnt(6)
v_mfma_f32_16x16x32_bf16 a[24:27], v[88:91], v[128:131], a[24:27]
ds_read_b128 v[56:59], v13 offset:16384
v_max_f32 v30, v30, v111
v_mfma_f32_16x16x32_bf16 a[56:59], v[88:91], v[132:135], a[56:59]
v_exp_f32 v125, v125
v_mfma_f32_16x16x32_bf16 a[28:31], v[92:95], v[128:131], a[28:31]
ds_read_b128 v[60:63], v13 offset:20480
v_cmp_lt_f32 vcc, s68, v30
v_mfma_f32_16x16x32_bf16 a[60:63], v[92:95], v[132:135], a[60:63]
v_exp_f32 v126, v126
v_mfma_f32_16x16x32_bf16 v[22:25], v[252:255], v[128:131], v[22:25]
v_exp_f32 v127, v127
v_mfma_f32_16x16x32_bf16 v[26:29], v[252:255], v[132:135], v[26:29]
v_cvt_pk_bf16_f32 v142, v124, v125
v_cvt_pk_bf16_f32 v143, v126, v127
s_barrier
s_waitcnt lgkmcnt(6)
v_mfma_f32_16x16x32_bf16 v[112:115], v[32:35], a[192:195], v[144:147]
s_cbranch_vccnz A_rare2
A_ret2:
s_add_u32 m0, s57, 8192
v_mfma_f32_16x16x32_bf16 v[120:123], v[32:35], a[208:211], v[148:151]
buffer_load_dwordx4 v6, s[44:47], s71 offen offset:0 lds
v_mfma_f32_16x16x32_bf16 v[116:119], v[36:39], a[192:195], v[144:147]
v_exp_f32 v96, v96
v_mfma_f32_16x16x32_bf16 v[124:127], v[36:39], a[208:211], v[148:151]
v_exp_f32 v97, v97
s_waitcnt lgkmcnt(4)
v_mfma_f32_16x16x32_bf16 v[112:115], v[40:43], a[196:199], v[112:115]
v_exp_f32 v98, v98
v_mfma_f32_16x16x32_bf16 v[120:123], v[40:43], a[212:215], v[120:123]
buffer_load_dwordx4 v7, s[44:47], s71 offen offset:1024 lds
s_mov_b32 s68, 0x41000000
s_mov_b32 s69, 0
v_mfma_f32_16x16x32_bf16 v[116:119], v[44:47], a[196:199], v[116:119]
v_cvt_pk_bf16_f32 v128, v96, v97
v_exp_f32 v99, v99
v_mfma_f32_16x16x32_bf16 v[124:127], v[44:47], a[212:215], v[124:127]
v_exp_f32 v100, v100
s_waitcnt lgkmcnt(2)
v_mfma_f32_16x16x32_bf16 v[112:115], v[48:51], a[200:203], v[112:115]
v_cvt_pk_bf16_f32 v129, v98, v99
v_exp_f32 v101, v101
v_mfma_f32_16x16x32_bf16 v[120:123], v[48:51], a[216:219], v[120:123]
buffer_load_dwordx4 v8, s[44:47], s71 offen offset:2048 lds
v_mfma_f32_16x16x32_bf16 v[116:119], v[52:55], a[200:203], v[116:119]
v_exp_f32 v102, v102
v_mfma_f32_16x16x32_bf16 v[124:127], v[52:55], a[216:219], v[124:127]
v_cvt_pk_bf16_f32 v130, v100, v101
s_waitcnt lgkmcnt(0)
v_mfma_f32_16x16x32_bf16 v[112:115], v[56:59], a[204:207], v[112:115]
v_exp_f32 v103, v103
v_mfma_f32_16x16x32_bf16 v[120:123], v[56:59], a[220:223], v[120:123]
buffer_load_dwordx4 v9, s[44:47], s71 offen offset:3072 lds
v_mfma_f32_16x16x32_bf16 v[116:119], v[60:63], a[204:207], v[116:119]
v_exp_f32 v104, v104
v_mfma_f32_16x16x32_bf16 v[124:127], v[60:63], a[220:223], v[124:127]
v_cvt_pk_bf16_f32 v131, v102, v103
v_mfma_f32_16x16x32_bf16 a[64:67], v[64:67], v[136:139], a[64:67]
v_exp_f32 v105, v105
v_mfma_f32_16x16x32_bf16 a[96:99], v[64:67], v[140:143], a[96:99]
s_add_u32 m0, s57, 12288
s_add_u32 s67, s71, 16384
v_mfma_f32_16x16x32_bf16 a[68:71], v[68:71], v[136:139], a[68:71]
buffer_load_dwordx4 v6, s[44:47], s67 offen offset:0 lds
v_mfma_f32_16x16x32_bf16 a[100:103], v[68:71], v[140:143], a[100:103]
v_exp_f32 v106, v106
v_mfma_f32_16x16x32_bf16 a[72:75], v[72:75], v[136:139], a[72:75]
v_max3_f32 v30, v112, v113, v114
v_max3_f32 v30, v30, v115, v116
v_mfma_f32_16x16x32_bf16 a[104:107], v[72:75], v[140:143], a[104:107]
v_max3_f32 v30, v30, v117, v118
v_max3_f32 v30, v30, v119, v120
v_mfma_f32_16x16x32_bf16 a[76:79], v[76:79], v[136:139], a[76:79]
buffer_load_dwordx4 v7, s[44:47], s67 offen offset:1024 lds
v_mfma_f32_16x16x32_bf16 a[108:111], v[76:79], v[140:143], a[108:111]
v_cvt_pk_bf16_f32 v132, v104, v105
v_max3_f32 v30, v30, v121, v122
v_mfma_f32_16x16x32_bf16 a[80:83], v[80:83], v[136:139], a[80:83]
v_exp_f32 v107, v107
v_mfma_f32_16x16x32_bf16 a[112:115], v[80:83], v[140:143], a[112:115]
v_exp_f32 v108, v108
v_max3_f32 v30, v30, v123, v124
v_mfma_f32_16x16x32_bf16 a[84:87], v[84:87], v[136:139], a[84:87]
buffer_load_dwordx4 v8, s[44:47], s67 offen offset:2048 lds
v_mfma_f32_16x16x32_bf16 a[116:119], v[84:87], v[140:143], a[116:119]
v_cvt_pk_bf16_f32 v133, v106, v107
v_max3_f32 v30, v30, v125, v126
v_mfma_f32_16x16x32_bf16 a[88:91], v[88:91], v[136:139], a[88:91]
v_exp_f32 v109, v109
v_mfma_f32_16x16x32_bf16 a[120:123], v[88:91], v[140:143], a[120:123]
v_exp_f32 v110, v110
v_mfma_f32_16x16x32_bf16 a[92:95], v[92:95], v[136:139], a[92:95]
v_exp_f32 v111, v111
v_mfma_f32_16x16x32_bf16 a[124:127], v[92:95], v[140:143], a[124:127]
buffer_load_dwordx4 v9, s[44:47], s67 offen offset:3072 lds
v_mfma_f32_16x16x32_bf16 v[224:227], v[252:255], v[136:139], v[224:227]
v_cvt_pk_bf16_f32 v134, v108, v109
v_max_f32 v30, v30, v127
v_mfma_f32_16x16x32_bf16 v[228:231], v[252:255], v[140:143], v[228:231]
v_cvt_pk_bf16_f32 v135, v110, v111
v_cmp_lt_f32 vcc, s68, v30
v_mfma_f32_16x16x32_bf16 v[96:99], v[32:35], a[224:227], v[152:155]
s_cbranch_vccnz A_rare3
A_ret3:
s_and_b32 s72, s96, 15
s_lshr_b64 s[96:97], s[96:97], 4
v_mfma_f32_16x16x32_bf16 v[104:107], v[32:35], a[240:243], v[156:159]
s_lshl_b32 s72, s72, 15
s_add_u32 s70, s70, 1
v_mfma_f32_16x16x32_bf16 v[100:103], v[36:39], a[224:227], v[152:155]
s_add_u32 m0, s57, 16384
v_mfma_f32_16x16x32_bf16 v[108:111], v[36:39], a[240:243], v[156:159]
buffer_load_dwordx4 v2, s[40:43], s72 offen offset:0 lds
v_mfma_f32_16x16x32_bf16 v[96:99], v[40:43], a[228:231], v[96:99]
v_exp_f32 v112, v112
v_mfma_f32_16x16x32_bf16 v[104:107], v[40:43], a[244:247], v[104:107]
v_exp_f32 v113, v113
v_mfma_f32_16x16x32_bf16 v[100:103], v[44:47], a[228:231], v[100:103]
v_exp_f32 v114, v114
v_mfma_f32_16x16x32_bf16 v[108:111], v[44:47], a[244:247], v[108:111]
buffer_load_dwordx4 v3, s[40:43], s72 offen offset:1024 lds
v_mfma_f32_16x16x32_bf16 v[96:99], v[48:51], a[232:235], v[96:99]
v_cvt_pk_bf16_f32 v136, v112, v113
v_exp_f32 v115, v115
v_mfma_f32_16x16x32_bf16 v[104:107], v[48:51], a[248:251], v[104:107]
v_exp_f32 v116, v116
v_mfma_f32_16x16x32_bf16 v[100:103], v[52:55], a[232:235], v[100:103]
v_cvt_pk_bf16_f32 v137, v114, v115
v_exp_f32 v117, v117
v_mfma_f32_16x16x32_bf16 v[108:111], v[52:55], a[248:251], v[108:111]
buffer_load_dwordx4 v4, s[40:43], s72 offen offset:2048 lds
v_mfma_f32_16x16x32_bf16 v[96:99], v[56:59], a[236:239], v[96:99]
v_exp_f32 v118, v118
v_mfma_f32_16x16x32_bf16 v[104:107], v[56:59], a[252:255], v[104:107]
v_cvt_pk_bf16_f32 v138, v116, v117
v_exp_f32 v119, v119
v_mfma_f32_16x16x32_bf16 v[100:103], v[60:63], a[236:239], v[100:103]
v_exp_f32 v120, v120
v_cvt_pk_bf16_f32 v139, v118, v119
v_mfma_f32_16x16x32_bf16 v[108:111], v[60:63], a[252:255], v[108:111]
buffer_load_dwordx4 v5, s[40:43], s72 offen offset:3072 lds
v_mfma_f32_16x16x32_bf16 a[128:131], v[64:67], v[128:131], a[128:131]
v_exp_f32 v121, v121
v_mfma_f32_16x16x32_bf16 a[160:163], v[64:67], v[132:135], a[160:163]
v_exp_f32 v122, v122
v_mfma_f32_16x16x32_bf16 a[132:135], v[68:71], v[128:131], a[132:135]
s_add_u32 m0, s57, 20480
s_add_u32 s67, s72, 16384
v_mfma_f32_16x16x32_bf16 a[164:167], v[68:71], v[132:135], a[164:167]
buffer_load_dwordx4 v2, s[40:43], s67 offen offset:0 lds
v_mfma_f32_16x16x32_bf16 a[136:139], v[72:75], v[128:131], a[136:139]
v_max3_f32 v30, v96, v97, v98
v_max3_f32 v30, v30, v99, v100
v_mfma_f32_16x16x32_bf16 a[168:171], v[72:75], v[132:135], a[168:171]
v_cvt_pk_bf16_f32 v140, v120, v121
v_max3_f32 v30, v30, v101, v102
v_mfma_f32_16x16x32_bf16 a[140:143], v[76:79], v[128:131], a[140:143]
v_exp_f32 v123, v123
v_mfma_f32_16x16x32_bf16 a[172:175], v[76:79], v[132:135], a[172:175]
buffer_load_dwordx4 v3, s[40:43], s67 offen offset:1024 lds
v_mfma_f32_16x16x32_bf16 a[144:147], v[80:83], v[128:131], a[144:147]
v_exp_f32 v124, v124
v_mfma_f32_16x16x32_bf16 a[176:179], v[80:83], v[132:135], a[176:179]
v_cvt_pk_bf16_f32 v141, v122, v123
v_max3_f32 v30, v30, v103, v104
v_mfma_f32_16x16x32_bf16 a[148:151], v[84:87], v[128:131], a[148:151]
v_exp_f32 v125, v125
v_max3_f32 v30, v30, v105, v106
v_mfma_f32_16x16x32_bf16 a[180:183], v[84:87], v[132:135], a[180:183]
buffer_load_dwordx4 v4, s[40:43], s67 offen offset:2048 lds
v_mfma_f32_16x16x32_bf16 a[152:155], v[88:91], v[128:131], a[152:155]
v_max3_f32 v30, v30, v107, v108
v_max3_f32 v30, v30, v109, v110
v_mfma_f32_16x16x32_bf16 a[184:187], v[88:91], v[132:135], a[184:187]
v_exp_f32 v126, v126
v_mfma_f32_16x16x32_bf16 a[156:159], v[92:95], v[128:131], a[156:159]
v_exp_f32 v127, v127
v_mfma_f32_16x16x32_bf16 a[188:191], v[92:95], v[132:135], a[188:191]
buffer_load_dwordx4 v5, s[40:43], s67 offen offset:3072 lds
v_mfma_f32_16x16x32_bf16 v[232:235], v[252:255], v[128:131], v[232:235]
v_cvt_pk_bf16_f32 v142, v124, v125
v_max_f32 v30, v30, v111
v_mfma_f32_16x16x32_bf16 v[236:239], v[252:255], v[132:135], v[236:239]
v_cvt_pk_bf16_f32 v143, v126, v127
v_cmp_lt_f32 vcc, s68, v30
s_waitcnt vmcnt(24)
v_mfma_f32_16x16x32_bf16 v[112:115], v[32:35], v[168:171], v[160:163]
s_cbranch_vccnz A_rare4
A_ret4:
ds_read_b64_tr_b16 v[64:65], v14 offset:24576
v_mfma_f32_16x16x32_bf16 v[120:123], v[32:35], v[184:187], v[164:167]
ds_read_b64_tr_b16 v[66:67], v14 offset:28672
v_mfma_f32_16x16x32_bf16 v[116:119], v[36:39], v[168:171], v[160:163]
ds_read_b64_tr_b16 v[68:69], v15 offset:24576
v_exp_f32 v96, v96
v_mfma_f32_16x16x32_bf16 v[124:127], v[36:39], v[184:187], v[164:167]
ds_read_b64_tr_b16 v[70:71], v15 offset:28672
v_exp_f32 v97, v97
v_mfma_f32_16x16x32_bf16 v[112:115], v[40:43], v[172:175], v[112:115]
ds_read_b64_tr_b16 v[72:73], v16 offset:24576
v_exp_f32 v98, v98
v_mfma_f32_16x16x32_bf16 v[120:123], v[40:43], v[188:191], v[120:123]
ds_read_b64_tr_b16 v[74:75], v16 offset:28672
v_cvt_pk_bf16_f32 v128, v96, v97
v_mfma_f32_16x16x32_bf16 v[116:119], v[44:47], v[172:175], v[116:119]
ds_read_b64_tr_b16 v[76:77], v17 offset:24576
v_exp_f32 v99, v99
v_mfma_f32_16x16x32_bf16 v[124:127], v[44:47], v[188:191], v[124:127]
ds_read_b64_tr_b16 v[78:79], v17 offset:28672
v_exp_f32 v100, v100
v_mfma_f32_16x16x32_bf16 v[112:115], v[48:51], v[176:179], v[112:115]
ds_read_b64_tr_b16 v[80:81], v18 offset:24576
v_cvt_pk_bf16_f32 v129, v98, v99
v_mfma_f32_16x16x32_bf16 v[120:123], v[48:51], v[192:195], v[120:123]
ds_read_b64_tr_b16 v[82:83], v18 offset:28672
v_exp_f32 v101, v101
v_mfma_f32_16x16x32_bf16 v[116:119], v[52:55], v[176:179], v[116:119]
ds_read_b64_tr_b16 v[84:85], v19 offset:24576
v_exp_f32 v102, v102
v_mfma_f32_16x16x32_bf16 v[124:127], v[52:55], v[192:195], v[124:127]
ds_read_b64_tr_b16 v[86:87], v19 offset:28672
v_cvt_pk_bf16_f32 v130, v100, v101
v_mfma_f32_16x16x32_bf16 v[112:115], v[56:59], v[180:183], v[112:115]
ds_read_b64_tr_b16 v[88:89], v20 offset:24576
v_exp_f32 v103, v103
v_mfma_f32_16x16x32_bf16 v[120:123], v[56:59], v[196:199], v[120:123]
ds_read_b64_tr_b16 v[90:91], v20 offset:28672
v_exp_f32 v104, v104
v_mfma_f32_16x16x32_bf16 v[116:119], v[60:63], v[180:183], v[116:119]
ds_read_b64_tr_b16 v[92:93], v21 offset:24576
v_cvt_pk_bf16_f32 v131, v102, v103
v_mfma_f32_16x16x32_bf16 v[124:127], v[60:63], v[196:199], v[124:127]
ds_read_b64_tr_b16 v[94:95], v21 offset:28672
s_waitcnt vmcnt(16)
s_waitcnt lgkmcnt(12)
v_mfma_f32_16x16x32_bf16 a[0:3], v[64:67], v[136:139], a[0:3]
ds_read_b128 v[32:35], v10 offset:0
v_exp_f32 v105, v105
v_mfma_f32_16x16x32_bf16 a[32:35], v[64:67], v[140:143], a[32:35]
v_exp_f32 v106, v106
v_mfma_f32_16x16x32_bf16 a[4:7], v[68:71], v[136:139], a[4:7]
ds_read_b128 v[36:39], v10 offset:4096
v_cvt_pk_bf16_f32 v132, v104, v105
v_mfma_f32_16x16x32_bf16 a[36:39], v[68:71], v[140:143], a[36:39]
v_exp_f32 v107, v107
s_waitcnt lgkmcnt(10)
v_mfma_f32_16x16x32_bf16 a[8:11], v[72:75], v[136:139], a[8:11]
ds_read_b128 v[40:43], v11 offset:0
v_max3_f32 v30, v112, v113, v114
v_mfma_f32_16x16x32_bf16 a[40:43], v[72:75], v[140:143], a[40:43]
v_exp_f32 v108, v108
v_mfma_f32_16x16x32_bf16 a[12:15], v[76:79], v[136:139], a[12:15]
ds_read_b128 v[44:47], v11 offset:4096
v_max3_f32 v30, v30, v115, v116
v_mfma_f32_16x16x32_bf16 a[44:47], v[76:79], v[140:143], a[44:47]
v_max3_f32 v30, v30, v117, v118
s_waitcnt lgkmcnt(8)
v_mfma_f32_16x16x32_bf16 a[16:19], v[80:83], v[136:139], a[16:19]
ds_read_b128 v[48:51], v12 offset:0
v_max3_f32 v30, v30, v119, v120
v_mfma_f32_16x16x32_bf16 a[48:51], v[80:83], v[140:143], a[48:51]
v_cvt_pk_bf16_f32 v133, v106, v107
v_max3_f32 v30, v30, v121, v122
v_mfma_f32_16x16x32_bf16 a[20:23], v[84:87], v[136:139], a[20:23]
ds_read_b128 v[52:55], v12 offset:4096
v_max3_f32 v30, v30, v123, v124
v_mfma_f32_16x16x32_bf16 a[52:55], v[84:87], v[140:143], a[52:55]
v_max3_f32 v30, v30, v125, v126
s_waitcnt lgkmcnt(6)
v_mfma_f32_16x16x32_bf16 a[24:27], v[88:91], v[136:139], a[24:27]
ds_read_b128 v[56:59], v13 offset:0
v_max_f32 v30, v30, v127
v_mfma_f32_16x16x32_bf16 a[56:59], v[88:91], v[140:143], a[56:59]
v_exp_f32 v109, v109
v_mfma_f32_16x16x32_bf16 a[28:31], v[92:95], v[136:139], a[28:31]
ds_read_b128 v[60:63], v13 offset:4096
v_cmp_lt_f32 vcc, s68, v30
v_mfma_f32_16x16x32_bf16 a[60:63], v[92:95], v[140:143], a[60:63]
v_exp_f32 v110, v110
v_mfma_f32_16x16x32_bf16 v[22:25], v[252:255], v[136:139], v[22:25]
v_exp_f32 v111, v111
v_mfma_f32_16x16x32_bf16 v[26:29], v[252:255], v[140:143], v[26:29]
v_cvt_pk_bf16_f32 v134, v108, v109
v_cvt_pk_bf16_f32 v135, v110, v111
s_barrier
s_waitcnt lgkmcnt(6)
v_mfma_f32_16x16x32_bf16 v[96:99], v[32:35], a[192:195], v[144:147]
s_cbranch_vccnz A_rare5
A_ret5:
s_add_u32 m0, s57, 24576
v_mfma_f32_16x16x32_bf16 v[104:107], v[32:35], a[208:211], v[148:151]
buffer_load_dwordx4 v6, s[44:47], s72 offen offset:0 lds
v_mfma_f32_16x16x32_bf16 v[100:103], v[36:39], a[192:195], v[144:147]
v_exp_f32 v112, v112
v_mfma_f32_16x16x32_bf16 v[108:111], v[36:39], a[208:211], v[148:151]
v_exp_f32 v113, v113
s_waitcnt lgkmcnt(4)
v_mfma_f32_16x16x32_bf16 v[96:99], v[40:43], a[196:199], v[96:99]
v_exp_f32 v114, v114
v_mfma_f32_16x16x32_bf16 v[104:107], v[40:43], a[212:215], v[104:107]
buffer_load_dwordx4 v7, s[44:47], s72 offen offset:1024 lds
v_mfma_f32_16x16x32_bf16 v[100:103], v[44:47], a[196:199], v[100:103]
v_cvt_pk_bf16_f32 v136, v112, v113
v_exp_f32 v115, v115
v_mfma_f32_16x16x32_bf16 v[108:111], v[44:47], a[212:215], v[108:111]
v_exp_f32 v116, v116
s_waitcnt lgkmcnt(2)
v_mfma_f32_16x16x32_bf16 v[96:99], v[48:51], a[200:203], v[96:99]
v_cvt_pk_bf16_f32 v137, v114, v115
v_exp_f32 v117, v117
v_mfma_f32_16x16x32_bf16 v[104:107], v[48:51], a[216:219], v[104:107]
buffer_load_dwordx4 v8, s[44:47], s72 offen offset:2048 lds
v_mfma_f32_16x16x32_bf16 v[100:103], v[52:55], a[200:203], v[100:103]
v_exp_f32 v118, v118
v_mfma_f32_16x16x32_bf16 v[108:111], v[52:55], a[216:219], v[108:111]
v_cvt_pk_bf16_f32 v138, v116, v117
s_waitcnt lgkmcnt(0)
v_mfma_f32_16x16x32_bf16 v[96:99], v[56:59], a[204:207], v[96:99]
v_exp_f32 v119, v119
v_mfma_f32_16x16x32_bf16 v[104:107], v[56:59], a[220:223], v[104:107]
buffer_load_dwordx4 v9, s[44:47], s72 offen offset:3072 lds
v_mfma_f32_16x16x32_bf16 v[100:103], v[60:63], a[204:207], v[100:103]
v_exp_f32 v120, v120
v_mfma_f32_16x16x32_bf16 v[108:111], v[60:63], a[220:223], v[108:111]
v_cvt_pk_bf16_f32 v139, v118, v119
v_exp_f32 v121, v121
v_mfma_f32_16x16x32_bf16 a[64:67], v[64:67], v[128:131], a[64:67]
v_exp_f32 v122, v122
v_cvt_pk_bf16_f32 v140, v120, v121
v_mfma_f32_16x16x32_bf16 a[96:99], v[64:67], v[132:135], a[96:99]
s_add_u32 m0, s57, 28672
s_add_u32 s67, s72, 16384
v_mfma_f32_16x16x32_bf16 a[68:71], v[68:71], v[128:131], a[68:71]
buffer_load_dwordx4 v6, s[44:47], s67 offen offset:0 lds
v_mfma_f32_16x16x32_bf16 a[100:103], v[68:71], v[132:135], a[100:103]
v_exp_f32 v123, v123
v_mfma_f32_16x16x32_bf16 a[72:75], v[72:75], v[128:131], a[72:75]
v_max3_f32 v30, v96, v97, v98
v_max3_f32 v30, v30, v99, v100
v_mfma_f32_16x16x32_bf16 a[104:107], v[72:75], v[132:135], a[104:107]
v_max3_f32 v30, v30, v101, v102
v_max3_f32 v30, v30, v103, v104
v_mfma_f32_16x16x32_bf16 a[76:79], v[76:79], v[128:131], a[76:79]
buffer_load_dwordx4 v7, s[44:47], s67 offen offset:1024 lds
v_mfma_f32_16x16x32_bf16 a[108:111], v[76:79], v[132:135], a[108:111]
v_exp_f32 v124, v124
v_mfma_f32_16x16x32_bf16 a[80:83], v[80:83], v[128:131], a[80:83]
v_cvt_pk_bf16_f32 v141, v122, v123
v_max3_f32 v30, v30, v105, v106
v_mfma_f32_16x16x32_bf16 a[112:115], v[80:83], v[132:135], a[112:115]
v_exp_f32 v125, v125
v_mfma_f32_16x16x32_bf16 a[84:87], v[84:87], v[128:131], a[84:87]
buffer_load_dwordx4 v8, s[44:47], s67 offen offset:2048 lds
v_mfma_f32_16x16x32_bf16 a[116:119], v[84:87], v[132:135], a[116:119]
v_max3_f32 v30, v30, v107, v108
v_max3_f32 v30, v30, v109, v110
v_mfma_f32_16x16x32_bf16 a[88:91], v[88:91], v[128:131], a[88:91]
v_exp_f32 v126, v126
v_mfma_f32_16x16x32_bf16 a[120:123], v[88:91], v[132:135], a[120:123]
v_exp_f32 v127, v127
v_mfma_f32_16x16x32_bf16 a[92:95], v[92:95], v[128:131], a[92:95]
v_cvt_pk_bf16_f32 v142, v124, v125
v_max_f32 v30, v30, v111
v_mfma_f32_16x16x32_bf16 a[124:127], v[92:95], v[132:135], a[124:127]
buffer_load_dwordx4 v9, s[44:47], s67 offen offset:3072 lds
v_mfma_f32_16x16x32_bf16 v[224:227], v[252:255], v[128:131], v[224:227]
s_add_u32 s73, s73, 1
s_cmp_lt_u32 s73, 7
v_mfma_f32_16x16x32_bf16 v[228:231], v[252:255], v[132:135], v[228:231]
v_cvt_pk_bf16_f32 v143, v126, v127
v_cmp_lt_f32 vcc, s68, v30
s_cbranch_scc1 A_loop
v_mfma_f32_16x16x32_bf16 v[112:115], v[32:35], a[224:227], v[152:155]
s_cbranch_vccnz A_rare0z
A_ret0z:
v_mfma_f32_16x16x32_bf16 v[120:123], v[32:35], a[240:243], v[156:159]
v_exp_f32 v96, v96
v_mfma_f32_16x16x32_bf16 v[116:119], v[36:39], a[224:227], v[152:155]
v_exp_f32 v97, v97
v_mfma_f32_16x16x32_bf16 v[124:127], v[36:39], a[240:243], v[156:159]
v_exp_f32 v98, v98
v_mfma_f32_16x16x32_bf16 v[112:115], v[40:43], a[228:231], v[112:115]
v_cvt_pk_bf16_f32 v128, v96, v97
v_mfma_f32_16x16x32_bf16 v[120:123], v[40:43], a[244:247], v[120:123]
v_exp_f32 v99, v99
v_mfma_f32_16x16x32_bf16 v[116:119], v[44:47], a[228:231], v[116:119]
v_exp_f32 v100, v100
v_mfma_f32_16x16x32_bf16 v[124:127], v[44:47], a[244:247], v[124:127]
v_cvt_pk_bf16_f32 v129, v98, v99
v_mfma_f32_16x16x32_bf16 v[112:115], v[48:51], a[232:235], v[112:115]
v_exp_f32 v101, v101
v_mfma_f32_16x16x32_bf16 v[120:123], v[48:51], a[248:251], v[120:123]
v_exp_f32 v102, v102
v_mfma_f32_16x16x32_bf16 v[116:119], v[52:55], a[232:235], v[116:119]
v_cvt_pk_bf16_f32 v130, v100, v101
v_mfma_f32_16x16x32_bf16 v[124:127], v[52:55], a[248:251], v[124:127]
v_exp_f32 v103, v103
v_mfma_f32_16x16x32_bf16 v[112:115], v[56:59], a[236:239], v[112:115]
v_exp_f32 v104, v104
v_mfma_f32_16x16x32_bf16 v[120:123], v[56:59], a[252:255], v[120:123]
v_cvt_pk_bf16_f32 v131, v102, v103
v_mfma_f32_16x16x32_bf16 v[116:119], v[60:63], a[236:239], v[116:119]
v_exp_f32 v105, v105
v_mfma_f32_16x16x32_bf16 v[124:127], v[60:63], a[252:255], v[124:127]
v_exp_f32 v106, v106
v_mfma_f32_16x16x32_bf16 a[128:131], v[64:67], v[136:139], a[128:131]
v_cvt_pk_bf16_f32 v132, v104, v105
v_mfma_f32_16x16x32_bf16 a[160:163], v[64:67], v[140:143], a[160:163]
v_exp_f32 v107, v107
v_mfma_f32_16x16x32_bf16 a[132:135], v[68:71], v[136:139], a[132:135]
v_exp_f32 v108, v108
v_mfma_f32_16x16x32_bf16 a[164:167], v[68:71], v[140:143], a[164:167]
v_cvt_pk_bf16_f32 v133, v106, v107
v_mfma_f32_16x16x32_bf16 a[136:139], v[72:75], v[136:139], a[136:139]
v_max3_f32 v30, v112, v113, v114
v_mfma_f32_16x16x32_bf16 a[168:171], v[72:75], v[140:143], a[168:171]
v_max3_f32 v30, v30, v115, v116
v_mfma_f32_16x16x32_bf16 a[140:143], v[76:79], v[136:139], a[140:143]
v_max3_f32 v30, v30, v117, v118
v_mfma_f32_16x16x32_bf16 a[172:175], v[76:79], v[140:143], a[172:175]
v_max3_f32 v30, v30, v119, v120
v_mfma_f32_16x16x32_bf16 a[144:147], v[80:83], v[136:139], a[144:147]
v_max3_f32 v30, v30, v121, v122
v_mfma_f32_16x16x32_bf16 a[176:179], v[80:83], v[140:143], a[176:179]
v_max3_f32 v30, v30, v123, v124
v_mfma_f32_16x16x32_bf16 a[148:151], v[84:87], v[136:139], a[148:151]
v_max3_f32 v30, v30, v125, v126
v_mfma_f32_16x16x32_bf16 a[180:183], v[84:87], v[140:143], a[180:183]
v_max_f32 v30, v30, v127
v_mfma_f32_16x16x32_bf16 a[152:155], v[88:91], v[136:139], a[152:155]
v_cmp_lt_f32 vcc, s68, v30
v_mfma_f32_16x16x32_bf16 a[184:187], v[88:91], v[140:143], a[184:187]
v_exp_f32 v109, v109
v_mfma_f32_16x16x32_bf16 a[156:159], v[92:95], v[136:139], a[156:159]
v_exp_f32 v110, v110
v_mfma_f32_16x16x32_bf16 a[188:191], v[92:95], v[140:143], a[188:191]
v_exp_f32 v111, v111
v_mfma_f32_16x16x32_bf16 v[232:235], v[252:255], v[136:139], v[232:235]
v_cvt_pk_bf16_f32 v134, v108, v109
v_mfma_f32_16x16x32_bf16 v[236:239], v[252:255], v[140:143], v[236:239]
v_cvt_pk_bf16_f32 v135, v110, v111
s_waitcnt vmcnt(16)
v_mfma_f32_16x16x32_bf16 v[96:99], v[32:35], v[168:171], v[160:163]
s_cbranch_vccnz A_rare1z
A_ret1z:
ds_read_b64_tr_b16 v[64:65], v14 offset:8192
v_mfma_f32_16x16x32_bf16 v[104:107], v[32:35], v[184:187], v[164:167]
ds_read_b64_tr_b16 v[66:67], v14 offset:12288
v_mfma_f32_16x16x32_bf16 v[100:103], v[36:39], v[168:171], v[160:163]
ds_read_b64_tr_b16 v[68:69], v15 offset:8192
v_exp_f32 v112, v112
v_mfma_f32_16x16x32_bf16 v[108:111], v[36:39], v[184:187], v[164:167]
ds_read_b64_tr_b16 v[70:71], v15 offset:12288
v_exp_f32 v113, v113
v_mfma_f32_16x16x32_bf16 v[96:99], v[40:43], v[172:175], v[96:99]
ds_read_b64_tr_b16 v[72:73], v16 offset:8192
v_exp_f32 v114, v114
v_mfma_f32_16x16x32_bf16 v[104:107], v[40:43], v[188:191], v[104:107]
ds_read_b64_tr_b16 v[74:75], v16 offset:12288
v_cvt_pk_bf16_f32 v136, v112, v113
v_mfma_f32_16x16x32_bf16 v[100:103], v[44:47], v[172:175], v[100:103]
ds_read_b64_tr_b16 v[76:77], v17 offset:8192
v_exp_f32 v115, v115
v_mfma_f32_16x16x32_bf16 v[108:111], v[44:47], v[188:191], v[108:111]
ds_read_b64_tr_b16 v[78:79], v17 offset:12288
v_exp_f32 v116, v116
v_mfma_f32_16x16x32_bf16 v[96:99], v[48:51], v[176:179], v[96:99]
ds_read_b64_tr_b16 v[80:81], v18 offset:8192
v_cvt_pk_bf16_f32 v137, v114, v115
v_mfma_f32_16x16x32_bf16 v[104:107], v[48:51], v[192:195], v[104:107]
ds_read_b64_tr_b16 v[82:83], v18 offset:12288
v_exp_f32 v117, v117
v_mfma_f32_16x16x32_bf16 v[100:103], v[52:55], v[176:179], v[100:103]
ds_read_b64_tr_b16 v[84:85], v19 offset:8192
v_exp_f32 v118, v118
v_mfma_f32_16x16x32_bf16 v[108:111], v[52:55], v[192:195], v[108:111]
ds_read_b64_tr_b16 v[86:87], v19 offset:12288
v_cvt_pk_bf16_f32 v138, v116, v117
v_mfma_f32_16x16x32_bf16 v[96:99], v[56:59], v[180:183], v[96:99]
ds_read_b64_tr_b16 v[88:89], v20 offset:8192
v_exp_f32 v119, v119
v_mfma_f32_16x16x32_bf16 v[104:107], v[56:59], v[196:199], v[104:107]
ds_read_b64_tr_b16 v[90:91], v20 offset:12288
v_exp_f32 v120, v120
v_mfma_f32_16x16x32_bf16 v[100:103], v[60:63], v[180:183], v[100:103]
ds_read_b64_tr_b16 v[92:93], v21 offset:8192
v_cvt_pk_bf16_f32 v139, v118, v119
v_mfma_f32_16x16x32_bf16 v[108:111], v[60:63], v[196:199], v[108:111]
ds_read_b64_tr_b16 v[94:95], v21 offset:12288
s_waitcnt vmcnt(8)
s_waitcnt lgkmcnt(12)
v_mfma_f32_16x16x32_bf16 a[0:3], v[64:67], v[128:131], a[0:3]
ds_read_b128 v[32:35], v10 offset:16384
v_exp_f32 v121, v121
v_mfma_f32_16x16x32_bf16 a[32:35], v[64:67], v[132:135], a[32:35]
v_exp_f32 v122, v122
v_mfma_f32_16x16x32_bf16 a[4:7], v[68:71], v[128:131], a[4:7]
ds_read_b128 v[36:39], v10 offset:20480
v_cvt_pk_bf16_f32 v140, v120, v121
v_mfma_f32_16x16x32_bf16 a[36:39], v[68:71], v[132:135], a[36:39]
v_exp_f32 v123, v123
s_waitcnt lgkmcnt(10)
v_mfma_f32_16x16x32_bf16 a[8:11], v[72:75], v[128:131], a[8:11]
ds_read_b128 v[40:43], v11 offset:16384
v_max3_f32 v30, v96, v97, v98
v_mfma_f32_16x16x32_bf16 a[40:43], v[72:75], v[132:135], a[40:43]
v_exp_f32 v124, v124
v_mfma_f32_16x16x32_bf16 a[12:15], v[76:79], v[128:131], a[12:15]
ds_read_b128 v[44:47], v11 offset:20480
v_max3_f32 v30, v30, v99, v100
v_mfma_f32_16x16x32_bf16 a[44:47], v[76:79], v[132:135], a[44:47]
v_max3_f32 v30, v30, v101, v102
s_waitcnt lgkmcnt(8)
v_mfma_f32_16x16x32_bf16 a[16:19], v[80:83], v[128:131], a[16:19]
ds_read_b128 v[48:51], v12 offset:16384
v_max3_f32 v30, v30, v103, v104
v_mfma_f32_16x16x32_bf16 a[48:51], v[80:83], v[132:135], a[48:51]
v_cvt_pk_bf16_f32 v141, v122, v123
v_max3_f32 v30, v30, v105, v106
v_mfma_f32_16x16x32_bf16 a[20:23], v[84:87], v[128:131], a[20:23]
ds_read_b128 v[52:55], v12 offset:20480
v_max3_f32 v30, v30, v107, v108
v_mfma_f32_16x16x32_bf16 a[52:55], v[84:87], v[132:135], a[52:55]
v_exp_f32 v125, v125
s_waitcnt lgkmcnt(6)
v_mfma_f32_16x16x32_bf16 a[24:27], v[88:91], v[128:131], a[24:27]
ds_read_b128 v[56:59], v13 offset:16384
v_max3_f32 v30, v30, v109, v110
v_mfma_f32_16x16x32_bf16 a[56:59], v[88:91], v[132:135], a[56:59]
v_exp_f32 v126, v126
v_mfma_f32_16x16x32_bf16 a[28:31], v[92:95], v[128:131], a[28:31]
ds_read_b128 v[60:63], v13 offset:20480
v_max_f32 v30, v30, v111
v_mfma_f32_16x16x32_bf16 a[60:63], v[92:95], v[132:135], a[60:63]
v_exp_f32 v127, v127
v_mfma_f32_16x16x32_bf16 v[22:25], v[252:255], v[128:131], v[22:25]
v_cvt_pk_bf16_f32 v142, v124, v125
v_cvt_pk_bf16_f32 v143, v126, v127
v_mfma_f32_16x16x32_bf16 v[26:29], v[252:255], v[132:135], v[26:29]
v_cmp_lt_f32 vcc, s68, v30
s_waitcnt lgkmcnt(6)
v_mfma_f32_16x16x32_bf16 v[112:115], v[32:35], a[192:195], v[144:147]
s_cbranch_vccnz A_rare2z
A_ret2z:
v_mfma_f32_16x16x32_bf16 v[120:123], v[32:35], a[208:211], v[148:151]
v_exp_f32 v96, v96
v_mfma_f32_16x16x32_bf16 v[116:119], v[36:39], a[192:195], v[144:147]
v_exp_f32 v97, v97
v_mfma_f32_16x16x32_bf16 v[124:127], v[36:39], a[208:211], v[148:151]
s_waitcnt lgkmcnt(4)
v_mfma_f32_16x16x32_bf16 v[112:115], v[40:43], a[196:199], v[112:115]
v_exp_f32 v98, v98
v_mfma_f32_16x16x32_bf16 v[120:123], v[40:43], a[212:215], v[120:123]
v_cvt_pk_bf16_f32 v128, v96, v97
v_mfma_f32_16x16x32_bf16 v[116:119], v[44:47], a[196:199], v[116:119]
v_exp_f32 v99, v99
v_mfma_f32_16x16x32_bf16 v[124:127], v[44:47], a[212:215], v[124:127]
s_waitcnt lgkmcnt(2)
v_mfma_f32_16x16x32_bf16 v[112:115], v[48:51], a[200:203], v[112:115]
v_exp_f32 v100, v100
v_mfma_f32_16x16x32_bf16 v[120:123], v[48:51], a[216:219], v[120:123]
v_cvt_pk_bf16_f32 v129, v98, v99
v_mfma_f32_16x16x32_bf16 v[116:119], v[52:55], a[200:203], v[116:119]
v_exp_f32 v101, v101
v_mfma_f32_16x16x32_bf16 v[124:127], v[52:55], a[216:219], v[124:127]
s_waitcnt lgkmcnt(0)
v_mfma_f32_16x16x32_bf16 v[112:115], v[56:59], a[204:207], v[112:115]
v_exp_f32 v102, v102
v_mfma_f32_16x16x32_bf16 v[120:123], v[56:59], a[220:223], v[120:123]
v_cvt_pk_bf16_f32 v130, v100, v101
v_mfma_f32_16x16x32_bf16 v[116:119], v[60:63], a[204:207], v[116:119]
v_exp_f32 v103, v103
v_mfma_f32_16x16x32_bf16 v[124:127], v[60:63], a[220:223], v[124:127]
v_exp_f32 v104, v104
v_mfma_f32_16x16x32_bf16 a[64:67], v[64:67], v[136:139], a[64:67]
v_cvt_pk_bf16_f32 v131, v102, v103
v_mfma_f32_16x16x32_bf16 a[96:99], v[64:67], v[140:143], a[96:99]
v_exp_f32 v105, v105
v_mfma_f32_16x16x32_bf16 a[68:71], v[68:71], v[136:139], a[68:71]
v_exp_f32 v106, v106
v_mfma_f32_16x16x32_bf16 a[100:103], v[68:71], v[140:143], a[100:103]
v_cvt_pk_bf16_f32 v132, v104, v105
v_mfma_f32_16x16x32_bf16 a[72:75], v[72:75], v[136:139], a[72:75]
v_max3_f32 v30, v112, v113, v114
v_mfma_f32_16x16x32_bf16 a[104:107], v[72:75], v[140:143], a[104:107]
v_max3_f32 v30, v30, v115, v116
v_mfma_f32_16x16x32_bf16 a[76:79], v[76:79], v[136:139], a[76:79]
v_max3_f32 v30, v30, v117, v118
v_mfma_f32_16x16x32_bf16 a[108:111], v[76:79], v[140:143], a[108:111]
v_max3_f32 v30, v30, v119, v120
v_mfma_f32_16x16x32_bf16 a[80:83], v[80:83], v[136:139], a[80:83]
v_max3_f32 v30, v30, v121, v122
v_max3_f32 v30, v30, v123, v124
v_mfma_f32_16x16x32_bf16 a[112:115], v[80:83], v[140:143], a[112:115]
v_exp_f32 v107, v107
v_mfma_f32_16x16x32_bf16 a[84:87], v[84:87], v[136:139], a[84:87]
v_exp_f32 v108, v108
v_mfma_f32_16x16x32_bf16 a[116:119], v[84:87], v[140:143], a[116:119]
v_cvt_pk_bf16_f32 v133, v106, v107
v_max3_f32 v30, v30, v125, v126
v_mfma_f32_16x16x32_bf16 a[88:91], v[88:91], v[136:139], a[88:91]
v_exp_f32 v109, v109
v_mfma_f32_16x16x32_bf16 a[120:123], v[88:91], v[140:143], a[120:123]
v_exp_f32 v110, v110
v_mfma_f32_16x16x32_bf16 a[92:95], v[92:95], v[136:139], a[92:95]
v_exp_f32 v111, v111
v_mfma_f32_16x16x32_bf16 a[124:127], v[92:95], v[140:143], a[124:127]
v_cvt_pk_bf16_f32 v134, v108, v109
v_max_f32 v30, v30, v127
v_mfma_f32_16x16x32_bf16 v[224:227], v[252:255], v[136:139], v[224:227]
v_cvt_pk_bf16_f32 v135, v110, v111
v_cmp_lt_f32 vcc, s68, v30
v_mfma_f32_16x16x32_bf16 v[228:231], v[252:255], v[140:143], v[228:231]
v_mfma_f32_16x16x32_bf16 v[96:99], v[32:35], a[224:227], v[152:155]
s_cbranch_vccnz A_rare3z
A_ret3z:
v_mfma_f32_16x16x32_bf16 v[104:107], v[32:35], a[240:243], v[156:159]
v_exp_f32 v112, v112
v_mfma_f32_16x16x32_bf16 v[100:103], v[36:39], a[224:227], v[152:155]
v_exp_f32 v113, v113
v_mfma_f32_16x16x32_bf16 v[108:111], v[36:39], a[240:243], v[156:159]
v_exp_f32 v114, v114
v_mfma_f32_16x16x32_bf16 v[96:99], v[40:43], a[228:231], v[96:99]
v_cvt_pk_bf16_f32 v136, v112, v113
v_mfma_f32_16x16x32_bf16 v[104:107], v[40:43], a[244:247], v[104:107]
v_exp_f32 v115, v115
v_mfma_f32_16x16x32_bf16 v[100:103], v[44:47], a[228:231], v[100:103]
v_exp_f32 v116, v116
v_mfma_f32_16x16x32_bf16 v[108:111], v[44:47], a[244:247], v[108:111]
v_cvt_pk_bf16_f32 v137, v114, v115
v_mfma_f32_16x16x32_bf16 v[96:99], v[48:51], a[232:235], v[96:99]
v_exp_f32 v117, v117
v_mfma_f32_16x16x32_bf16 v[104:107], v[48:51], a[248:251], v[104:107]
v_exp_f32 v118, v118
v_mfma_f32_16x16x32_bf16 v[100:103], v[52:55], a[232:235], v[100:103]
v_cvt_pk_bf16_f32 v138, v116, v117
v_mfma_f32_16x16x32_bf16 v[108:111], v[52:55], a[248:251], v[108:111]
v_exp_f32 v119, v119
v_mfma_f32_16x16x32_bf16 v[96:99], v[56:59], a[236:239], v[96:99]
v_exp_f32 v120, v120
v_mfma_f32_16x16x32_bf16 v[104:107], v[56:59], a[252:255], v[104:107]
v_cvt_pk_bf16_f32 v139, v118, v119
v_mfma_f32_16x16x32_bf16 v[100:103], v[60:63], a[236:239], v[100:103]
v_exp_f32 v121, v121
v_mfma_f32_16x16x32_bf16 v[108:111], v[60:63], a[252:255], v[108:111]
v_exp_f32 v122, v122
v_mfma_f32_16x16x32_bf16 a[128:131], v[64:67], v[128:131], a[128:131]
v_cvt_pk_bf16_f32 v140, v120, v121
v_mfma_f32_16x16x32_bf16 a[160:163], v[64:67], v[132:135], a[160:163]
v_exp_f32 v123, v123
v_mfma_f32_16x16x32_bf16 a[132:135], v[68:71], v[128:131], a[132:135]
v_exp_f32 v124, v124
v_mfma_f32_16x16x32_bf16 a[164:167], v[68:71], v[132:135], a[164:167]
v_cvt_pk_bf16_f32 v141, v122, v123
v_mfma_f32_16x16x32_bf16 a[136:139], v[72:75], v[128:131], a[136:139]
v_max3_f32 v30, v96, v97, v98
v_mfma_f32_16x16x32_bf16 a[168:171], v[72:75], v[132:135], a[168:171]
v_max3_f32 v30, v30, v99, v100
v_mfma_f32_16x16x32_bf16 a[140:143], v[76:79], v[128:131], a[140:143]
v_max3_f32 v30, v30, v101, v102
v_mfma_f32_16x16x32_bf16 a[172:175], v[76:79], v[132:135], a[172:175]
v_max3_f32 v30, v30, v103, v104
v_mfma_f32_16x16x32_bf16 a[144:147], v[80:83], v[128:131], a[144:147]
v_max3_f32 v30, v30, v105, v106
v_mfma_f32_16x16x32_bf16 a[176:179], v[80:83], v[132:135], a[176:179]
v_max3_f32 v30, v30, v107, v108
v_mfma_f32_16x16x32_bf16 a[148:151], v[84:87], v[128:131], a[148:151]
v_max3_f32 v30, v30, v109, v110
v_mfma_f32_16x16x32_bf16 a[180:183], v[84:87], v[132:135], a[180:183]
v_max_f32 v30, v30, v111
v_cmp_lt_f32 vcc, s68, v30
v_mfma_f32_16x16x32_bf16 a[152:155], v[88:91], v[128:131], a[152:155]
v_exp_f32 v125, v125
v_mfma_f32_16x16x32_bf16 a[184:187], v[88:91], v[132:135], a[184:187]
v_exp_f32 v126, v126
v_mfma_f32_16x16x32_bf16 a[156:159], v[92:95], v[128:131], a[156:159]
v_exp_f32 v127, v127
v_mfma_f32_16x16x32_bf16 a[188:191], v[92:95], v[132:135], a[188:191]
v_cvt_pk_bf16_f32 v142, v124, v125
v_mfma_f32_16x16x32_bf16 v[232:235], v[252:255], v[128:131], v[232:235]
v_cvt_pk_bf16_f32 v143, v126, v127
v_mfma_f32_16x16x32_bf16 v[236:239], v[252:255], v[132:135], v[236:239]
s_waitcnt vmcnt(0)
v_mfma_f32_16x16x32_bf16 v[112:115], v[32:35], v[168:171], v[160:163]
s_cbranch_vccnz A_rare4z
A_ret4z:
ds_read_b64_tr_b16 v[64:65], v14 offset:24576
v_mfma_f32_16x16x32_bf16 v[120:123], v[32:35], v[184:187], v[164:167]
ds_read_b64_tr_b16 v[66:67], v14 offset:28672
v_mfma_f32_16x16x32_bf16 v[116:119], v[36:39], v[168:171], v[160:163]
ds_read_b64_tr_b16 v[68:69], v15 offset:24576
v_mfma_f32_16x16x32_bf16 v[124:127], v[36:39], v[184:187], v[164:167]
ds_read_b64_tr_b16 v[70:71], v15 offset:28672
v_mfma_f32_16x16x32_bf16 v[112:115], v[40:43], v[172:175], v[112:115]
ds_read_b64_tr_b16 v[72:73], v16 offset:24576
v_exp_f32 v96, v96
v_mfma_f32_16x16x32_bf16 v[120:123], v[40:43], v[188:191], v[120:123]
ds_read_b64_tr_b16 v[74:75], v16 offset:28672
v_exp_f32 v97, v97
v_mfma_f32_16x16x32_bf16 v[116:119], v[44:47], v[172:175], v[116:119]
ds_read_b64_tr_b16 v[76:77], v17 offset:24576
v_exp_f32 v98, v98
v_mfma_f32_16x16x32_bf16 v[124:127], v[44:47], v[188:191], v[124:127]
ds_read_b64_tr_b16 v[78:79], v17 offset:28672
v_cvt_pk_bf16_f32 v128, v96, v97
v_mfma_f32_16x16x32_bf16 v[112:115], v[48:51], v[176:179], v[112:115]
ds_read_b64_tr_b16 v[80:81], v18 offset:24576
v_mfma_f32_16x16x32_bf16 v[120:123], v[48:51], v[192:195], v[120:123]
ds_read_b64_tr_b16 v[82:83], v18 offset:28672
v_exp_f32 v99, v99
v_mfma_f32_16x16x32_bf16 v[116:119], v[52:55], v[176:179], v[116:119]
ds_read_b64_tr_b16 v[84:85], v19 offset:24576
v_exp_f32 v100, v100
v_mfma_f32_16x16x32_bf16 v[124:127], v[52:55], v[192:195], v[124:127]
ds_read_b64_tr_b16 v[86:87], v19 offset:28672
v_cvt_pk_bf16_f32 v129, v98, v99
v_mfma_f32_16x16x32_bf16 v[112:115], v[56:59], v[180:183], v[112:115]
ds_read_b64_tr_b16 v[88:89], v20 offset:24576
v_exp_f32 v101, v101
v_mfma_f32_16x16x32_bf16 v[120:123], v[56:59], v[196:199], v[120:123]
ds_read_b64_tr_b16 v[90:91], v20 offset:28672
v_exp_f32 v102, v102
v_mfma_f32_16x16x32_bf16 v[116:119], v[60:63], v[180:183], v[116:119]
ds_read_b64_tr_b16 v[92:93], v21 offset:24576
v_cvt_pk_bf16_f32 v130, v100, v101
v_mfma_f32_16x16x32_bf16 v[124:127], v[60:63], v[196:199], v[124:127]
ds_read_b64_tr_b16 v[94:95], v21 offset:28672
s_waitcnt lgkmcnt(12)
v_mfma_f32_16x16x32_bf16 a[0:3], v[64:67], v[136:139], a[0:3]
v_exp_f32 v103, v103
v_mfma_f32_16x16x32_bf16 a[32:35], v[64:67], v[140:143], a[32:35]
v_exp_f32 v104, v104
v_mfma_f32_16x16x32_bf16 a[4:7], v[68:71], v[136:139], a[4:7]
v_cvt_pk_bf16_f32 v131, v102, v103
v_mfma_f32_16x16x32_bf16 a[36:39], v[68:71], v[140:143], a[36:39]
v_exp_f32 v105, v105
s_waitcnt lgkmcnt(8)
v_mfma_f32_16x16x32_bf16 a[8:11], v[72:75], v[136:139], a[8:11]
v_max3_f32 v30, v112, v113, v114
v_max3_f32 v30, v30, v115, v116
v_mfma_f32_16x16x32_bf16 a[40:43], v[72:75], v[140:143], a[40:43]
v_exp_f32 v106, v106
v_mfma_f32_16x16x32_bf16 a[12:15], v[76:79], v[136:139], a[12:15]
v_cvt_pk_bf16_f32 v132, v104, v105
v_max3_f32 v30, v30, v117, v118
v_mfma_f32_16x16x32_bf16 a[44:47], v[76:79], v[140:143], a[44:47]
v_max3_f32 v30, v30, v119, v120
s_waitcnt lgkmcnt(4)
v_mfma_f32_16x16x32_bf16 a[16:19], v[80:83], v[136:139], a[16:19]
v_exp_f32 v107, v107
v_mfma_f32_16x16x32_bf16 a[48:51], v[80:83], v[140:143], a[48:51]
v_exp_f32 v108, v108
v_mfma_f32_16x16x32_bf16 a[20:23], v[84:87], v[136:139], a[20:23]
v_cvt_pk_bf16_f32 v133, v106, v107
v_max3_f32 v30, v30, v121, v122
v_mfma_f32_16x16x32_bf16 a[52:55], v[84:87], v[140:143], a[52:55]
v_max3_f32 v30, v30, v123, v124
s_waitcnt lgkmcnt(0)
v_mfma_f32_16x16x32_bf16 a[24:27], v[88:91], v[136:139], a[24:27]
v_exp_f32 v109, v109
v_mfma_f32_16x16x32_bf16 a[56:59], v[88:91], v[140:143], a[56:59]
v_exp_f32 v110, v110
v_mfma_f32_16x16x32_bf16 a[28:31], v[92:95], v[136:139], a[28:31]
v_exp_f32 v111, v111
v_mfma_f32_16x16x32_bf16 a[60:63], v[92:95], v[140:143], a[60:63]
v_cvt_pk_bf16_f32 v134, v108, v109
v_max3_f32 v30, v30, v125, v126
v_mfma_f32_16x16x32_bf16 v[22:25], v[252:255], v[136:139], v[22:25]
v_cvt_pk_bf16_f32 v135, v110, v111
v_max_f32 v30, v30, v127
v_mfma_f32_16x16x32_bf16 v[26:29], v[252:255], v[140:143], v[26:29]
v_cmp_lt_f32 vcc, s68, v30
v_mfma_f32_16x16x32_bf16 a[64:67], v[64:67], v[128:131], a[64:67]
s_cbranch_vccnz A_rare5z
A_ret5z:
v_exp_f32 v112, v112
v_mfma_f32_16x16x32_bf16 a[96:99], v[64:67], v[132:135], a[96:99]
v_exp_f32 v113, v113
v_exp_f32 v114, v114
v_mfma_f32_16x16x32_bf16 a[68:71], v[68:71], v[128:131], a[68:71]
v_cvt_pk_bf16_f32 v136, v112, v113
v_exp_f32 v115, v115
v_mfma_f32_16x16x32_bf16 a[100:103], v[68:71], v[132:135], a[100:103]
v_exp_f32 v116, v116
v_cvt_pk_bf16_f32 v137, v114, v115
v_mfma_f32_16x16x32_bf16 a[72:75], v[72:75], v[128:131], a[72:75]
ds_write_b128 v200, a[8:11] offset:0
v_exp_f32 v117, v117
v_mfma_f32_16x16x32_bf16 a[104:107], v[72:75], v[132:135], a[104:107]
ds_write_b128 v200, a[12:15] offset:1024
v_exp_f32 v118, v118
v_mfma_f32_16x16x32_bf16 a[76:79], v[76:79], v[128:131], a[76:79]
ds_write_b128 v200, a[16:19] offset:2048
v_cvt_pk_bf16_f32 v138, v116, v117
v_mfma_f32_16x16x32_bf16 a[108:111], v[76:79], v[132:135], a[108:111]
ds_write_b128 v200, a[20:23] offset:3072
v_exp_f32 v119, v119
v_mfma_f32_16x16x32_bf16 a[80:83], v[80:83], v[128:131], a[80:83]
ds_write_b128 v200, a[24:27] offset:4096
v_exp_f32 v120, v120
v_mfma_f32_16x16x32_bf16 a[112:115], v[80:83], v[132:135], a[112:115]
ds_write_b128 v200, a[28:31] offset:5120
v_cvt_pk_bf16_f32 v139, v118, v119
v_mfma_f32_16x16x32_bf16 a[84:87], v[84:87], v[128:131], a[84:87]
ds_write_b128 v200, a[40:43] offset:6144
v_exp_f32 v121, v121
v_mfma_f32_16x16x32_bf16 a[116:119], v[84:87], v[132:135], a[116:119]
ds_write_b128 v200, a[44:47] offset:7168
v_exp_f32 v122, v122
v_mfma_f32_16x16x32_bf16 a[88:91], v[88:91], v[128:131], a[88:91]
ds_write_b128 v200, a[48:51] offset:8192
v_cvt_pk_bf16_f32 v140, v120, v121
v_exp_f32 v123, v123
v_mfma_f32_16x16x32_bf16 a[120:123], v[88:91], v[132:135], a[120:123]
ds_write_b128 v200, a[52:55] offset:9216
v_exp_f32 v124, v124
v_mfma_f32_16x16x32_bf16 a[92:95], v[92:95], v[128:131], a[92:95]
ds_write_b128 v200, a[56:59] offset:10240
v_cvt_pk_bf16_f32 v141, v122, v123
v_exp_f32 v125, v125
v_mfma_f32_16x16x32_bf16 a[124:127], v[92:95], v[132:135], a[124:127]
ds_write_b128 v200, a[60:63] offset:11264
v_exp_f32 v126, v126
v_mfma_f32_16x16x32_bf16 v[224:227], v[252:255], v[128:131], v[224:227]
v_exp_f32 v127, v127
v_cvt_pk_bf16_f32 v142, v124, v125
v_mfma_f32_16x16x32_bf16 v[228:231], v[252:255], v[132:135], v[228:231]
global_load_dword v221, v220, s[12:13]
v_cvt_pk_bf16_f32 v143, v126, v127
v_mfma_f32_16x16x32_bf16 v[232:235], v[252:255], v[136:139], v[232:235]
s_nop 0
v_mfma_f32_16x16x32_bf16 v[236:239], v[252:255], v[140:143], v[236:239]
v_mfma_f32_16x16x32_bf16 a[128:131], v[64:67], v[136:139], a[128:131]
v_mfma_f32_16x16x32_bf16 a[160:163], v[64:67], v[140:143], a[160:163]
v_mfma_f32_16x16x32_bf16 a[132:135], v[68:71], v[136:139], a[132:135]
ds_write_b128 v200, a[72:75] offset:12288
v_mfma_f32_16x16x32_bf16 a[164:167], v[68:71], v[140:143], a[164:167]
ds_write_b128 v200, a[76:79] offset:13312
v_mfma_f32_16x16x32_bf16 a[136:139], v[72:75], v[136:139], a[136:139]
ds_write_b128 v200, a[80:83] offset:14336
v_mfma_f32_16x16x32_bf16 a[168:171], v[72:75], v[140:143], a[168:171]
ds_write_b128 v200, a[84:87] offset:15360
v_mfma_f32_16x16x32_bf16 a[140:143], v[76:79], v[136:139], a[140:143]
ds_write_b128 v200, a[88:91] offset:16384
v_mfma_f32_16x16x32_bf16 a[172:175], v[76:79], v[140:143], a[172:175]
ds_write_b128 v200, a[92:95] offset:17408
v_mfma_f32_16x16x32_bf16 a[144:147], v[80:83], v[136:139], a[144:147]
ds_write_b128 v200, a[104:107] offset:18432
v_mfma_f32_16x16x32_bf16 a[176:179], v[80:83], v[140:143], a[176:179]
ds_write_b128 v200, a[108:111] offset:19456
v_mfma_f32_16x16x32_bf16 a[148:151], v[84:87], v[136:139], a[148:151]
ds_write_b128 v200, a[112:115] offset:20480
v_mfma_f32_16x16x32_bf16 a[180:183], v[84:87], v[140:143], a[180:183]
ds_write_b128 v200, a[116:119] offset:21504
v_mfma_f32_16x16x32_bf16 a[152:155], v[88:91], v[136:139], a[152:155]
ds_write_b128 v200, a[120:123] offset:22528
v_mfma_f32_16x16x32_bf16 a[184:187], v[88:91], v[140:143], a[184:187]
ds_write_b128 v200, a[124:127] offset:23552
v_mfma_f32_16x16x32_bf16 a[156:159], v[92:95], v[136:139], a[156:159]
v_mfma_f32_16x16x32_bf16 a[188:191], v[92:95], v[140:143], a[188:191]
v_mov_b32 v145, v22
v_mov_b32 v149, v26
v_mov_b32 v153, v224
v_mov_b32 v157, v228
v_mov_b32 v161, v232
v_mov_b32 v165, v236
ds_write_b64 v209, v[144:145] offset:36864
ds_write_b64 v209, v[148:149] offset:37376
ds_write_b64 v209, v[152:153] offset:37888
ds_write_b64 v209, v[156:157] offset:38400
ds_write_b64 v209, v[160:161] offset:38912
ds_write_b64 v209, v[164:165] offset:39424
ds_write_b128 v200, a[168:171] offset:30720
ds_write_b128 v200, a[172:175] offset:31744
ds_write_b128 v200, a[176:179] offset:32768
ds_write_b128 v200, a[180:183] offset:33792
ds_write_b128 v200, a[184:187] offset:34816
ds_write_b128 v200, a[188:191] offset:35840
v_accvgpr_read_b32 v136, a160
v_accvgpr_read_b32 v137, a161
v_accvgpr_read_b32 v138, a162
v_accvgpr_read_b32 v139, a163
v_accvgpr_read_b32 v140, a164
v_accvgpr_read_b32 v141, a165
v_accvgpr_read_b32 v142, a166
v_accvgpr_read_b32 v143, a167
ds_write_b128 v200, a[136:139] offset:24576
ds_write_b128 v200, a[140:143] offset:25600
ds_write_b128 v200, a[144:147] offset:26624
ds_write_b128 v200, a[148:151] offset:27648
ds_write_b128 v200, a[152:155] offset:28672
ds_write_b128 v200, a[156:159] offset:29696
v_accvgpr_read_b32 v128, a128
v_accvgpr_read_b32 v129, a129
v_accvgpr_read_b32 v130, a130
v_accvgpr_read_b32 v131, a131
v_accvgpr_read_b32 v132, a132
v_accvgpr_read_b32 v133, a133
v_accvgpr_read_b32 v134, a134
v_accvgpr_read_b32 v135, a135
v_accvgpr_read_b32 v120, a96
v_accvgpr_read_b32 v121, a97
v_accvgpr_read_b32 v122, a98
v_accvgpr_read_b32 v123, a99
v_accvgpr_read_b32 v124, a100
v_accvgpr_read_b32 v125, a101
v_accvgpr_read_b32 v126, a102
v_accvgpr_read_b32 v127, a103
v_accvgpr_read_b32 v112, a64
v_accvgpr_read_b32 v113, a65
v_accvgpr_read_b32 v114, a66
v_accvgpr_read_b32 v115, a67
v_accvgpr_read_b32 v116, a68
v_accvgpr_read_b32 v117, a69
v_accvgpr_read_b32 v118, a70
v_accvgpr_read_b32 v119, a71
v_accvgpr_read_b32 v104, a32
v_accvgpr_read_b32 v105, a33
v_accvgpr_read_b32 v106, a34
v_accvgpr_read_b32 v107, a35
v_accvgpr_read_b32 v108, a36
v_accvgpr_read_b32 v109, a37
v_accvgpr_read_b32 v110, a38
v_accvgpr_read_b32 v111, a39
v_accvgpr_read_b32 v96, a0
v_accvgpr_read_b32 v97, a1
v_accvgpr_read_b32 v98, a2
v_accvgpr_read_b32 v99, a3
v_accvgpr_read_b32 v100, a4
v_accvgpr_read_b32 v101, a5
v_accvgpr_read_b32 v102, a6
v_accvgpr_read_b32 v103, a7
s_lshl_b32 s65, s56, 10
s_waitcnt lgkmcnt(0)
s_barrier
ds_read_b64 v[146:147], v210 offset:36864
ds_read_b64 v[168:169], v211 offset:36864
ds_read_b64 v[170:171], v212 offset:36864
ds_read_b64 v[150:151], v210 offset:37376
ds_read_b64 v[172:173], v211 offset:37376
ds_read_b64 v[174:175], v212 offset:37376
ds_read_b64 v[154:155], v210 offset:37888
ds_read_b64 v[176:177], v211 offset:37888
ds_read_b64 v[178:179], v212 offset:37888
ds_read_b64 v[158:159], v210 offset:38400
ds_read_b64 v[180:181], v211 offset:38400
ds_read_b64 v[182:183], v212 offset:38400
ds_read_b64 v[162:163], v210 offset:38912
ds_read_b64 v[184:185], v211 offset:38912
ds_read_b64 v[186:187], v212 offset:38912
ds_read_b64 v[166:167], v210 offset:39424
ds_read_b64 v[188:189], v211 offset:39424
ds_read_b64 v[190:191], v212 offset:39424
ds_read_b128 v[32:35], v201 offset:0
ds_read_b128 v[36:39], v201 offset:1024
ds_read_b128 v[40:43], v202 offset:2048
ds_read_b128 v[44:47], v202 offset:3072
ds_read_b128 v[48:51], v203 offset:4096
ds_read_b128 v[52:55], v203 offset:5120
ds_read_b128 v[56:59], v201 offset:6144
ds_read_b128 v[60:63], v201 offset:7168
ds_read_b128 v[64:67], v202 offset:8192
ds_read_b128 v[68:71], v202 offset:9216
ds_read_b128 v[72:75], v203 offset:10240
ds_read_b128 v[76:79], v203 offset:11264
s_waitcnt lgkmcnt(12)
v_min3_f32 v240, v144, v146, v168
v_min3_f32 v241, v148, v150, v172
v_min3_f32 v242, v152, v154, v176
v_min3_f32 v243, v156, v158, v180
v_min3_f32 v244, v160, v162, v184
v_min3_f32 v245, v164, v166, v188
v_min_f32 v240, v240, v170
v_min_f32 v241, v241, v174
v_min_f32 v242, v242, v178
v_min_f32 v243, v243, v182
v_min_f32 v244, v244, v186
v_min_f32 v245, v245, v190
v_sub_f32 v144, v240, v144
v_sub_f32 v146, v240, v146
v_sub_f32 v168, v240, v168
v_sub_f32 v170, v240, v170
v_sub_f32 v148, v241, v148
v_sub_f32 v150, v241, v150
v_sub_f32 v172, v241, v172
v_sub_f32 v174, v241, v174
v_sub_f32 v152, v242, v152
v_sub_f32 v154, v242, v154
v_sub_f32 v176, v242, v176
v_sub_f32 v178, v242, v178
v_sub_f32 v156, v243, v156
v_sub_f32 v158, v243, v158
v_sub_f32 v180, v243, v180
v_sub_f32 v182, v243, v182
v_sub_f32 v160, v244, v160
v_sub_f32 v162, v244, v162
v_sub_f32 v184, v244, v184
v_sub_f32 v186, v244, v186
v_sub_f32 v164, v245, v164
v_sub_f32 v166, v245, v166
v_sub_f32 v188, v245, v188
v_sub_f32 v190, v245, v190
v_exp_f32 v144, v144
v_exp_f32 v146, v146
v_exp_f32 v168, v168
v_exp_f32 v170, v170
v_exp_f32 v148, v148
v_exp_f32 v150, v150
v_exp_f32 v172, v172
v_exp_f32 v174, v174
v_exp_f32 v152, v152
v_exp_f32 v154, v154
v_exp_f32 v176, v176
v_exp_f32 v178, v178
v_exp_f32 v156, v156
v_exp_f32 v158, v158
v_exp_f32 v180, v180
v_exp_f32 v182, v182
v_exp_f32 v160, v160
v_exp_f32 v162, v162
v_exp_f32 v184, v184
v_exp_f32 v186, v186
v_exp_f32 v164, v164
v_exp_f32 v166, v166
v_exp_f32 v188, v188
v_exp_f32 v190, v190
v_mul_f32 v240, v144, v145
v_fmac_f32 v240, v146, v147
v_fmac_f32 v240, v168, v169
v_fmac_f32 v240, v170, v171
v_mul_f32 v241, v148, v149
v_fmac_f32 v241, v150, v151
v_fmac_f32 v241, v172, v173
v_fmac_f32 v241, v174, v175
v_mul_f32 v242, v152, v153
v_fmac_f32 v242, v154, v155
v_fmac_f32 v242, v176, v177
v_fmac_f32 v242, v178, v179
v_mul_f32 v243, v156, v157
v_fmac_f32 v243, v158, v159
v_fmac_f32 v243, v180, v181
v_fmac_f32 v243, v182, v183
v_mul_f32 v244, v160, v161
v_fmac_f32 v244, v162, v163
v_fmac_f32 v244, v184, v185
v_fmac_f32 v244, v186, v187
v_mul_f32 v245, v164, v165
v_fmac_f32 v245, v166, v167
v_fmac_f32 v245, v188, v189
v_fmac_f32 v245, v190, v191
v_rcp_f32 v240, v240
v_rcp_f32 v241, v241
v_rcp_f32 v242, v242
v_rcp_f32 v243, v243
v_rcp_f32 v244, v244
v_rcp_f32 v245, v245
v_mul_f32 v144, v144, v240
v_mul_f32 v146, v146, v240
v_mul_f32 v168, v168, v240
v_mul_f32 v170, v170, v240
v_pk_mul_f32 v[96:97], v[96:97], v[144:145] op_sel_hi:[1,0]
v_pk_mul_f32 v[98:99], v[98:99], v[144:145] op_sel_hi:[1,0]
v_pk_mul_f32 v[100:101], v[100:101], v[144:145] op_sel_hi:[1,0]
v_pk_mul_f32 v[102:103], v[102:103], v[144:145] op_sel_hi:[1,0]
s_waitcnt lgkmcnt(6)
v_pk_fma_f32 v[96:97], v[32:33], v[146:147], v[96:97] op_sel_hi:[1,0,1]
v_pk_fma_f32 v[98:99], v[34:35], v[146:147], v[98:99] op_sel_hi:[1,0,1]
v_pk_fma_f32 v[100:101], v[36:37], v[146:147], v[100:101] op_sel_hi:[1,0,1]
v_pk_fma_f32 v[102:103], v[38:39], v[146:147], v[102:103] op_sel_hi:[1,0,1]
v_pk_fma_f32 v[96:97], v[40:41], v[168:169], v[96:97] op_sel_hi:[1,0,1]
v_pk_fma_f32 v[98:99], v[42:43], v[168:169], v[98:99] op_sel_hi:[1,0,1]
v_pk_fma_f32 v[100:101], v[44:45], v[168:169], v[100:101] op_sel_hi:[1,0,1]
v_pk_fma_f32 v[102:103], v[46:47], v[168:169], v[102:103] op_sel_hi:[1,0,1]
v_pk_fma_f32 v[96:97], v[48:49], v[170:171], v[96:97] op_sel_hi:[1,0,1]
v_pk_fma_f32 v[98:99], v[50:51], v[170:171], v[98:99] op_sel_hi:[1,0,1]
v_pk_fma_f32 v[100:101], v[52:53], v[170:171], v[100:101] op_sel_hi:[1,0,1]
v_pk_fma_f32 v[102:103], v[54:55], v[170:171], v[102:103] op_sel_hi:[1,0,1]
ds_read_b128 v[32:35], v201 offset:12288
ds_read_b128 v[36:39], v201 offset:13312
ds_read_b128 v[40:43], v202 offset:14336
ds_read_b128 v[44:47], v202 offset:15360
ds_read_b128 v[48:51], v203 offset:16384
ds_read_b128 v[52:55], v203 offset:17408
v_cvt_pk_bf16_f32 v96, v96, v97
v_cvt_pk_bf16_f32 v97, v98, v99
v_cvt_pk_bf16_f32 v98, v100, v101
v_cvt_pk_bf16_f32 v99, v102, v103
buffer_store_dwordx4 v[96:99], v213, s[48:51], s65 offen sc1 nt
s_add_u32 s65, s65, 4096
v_mul_f32 v148, v148, v241
v_mul_f32 v150, v150, v241
v_mul_f32 v172, v172, v241
v_mul_f32 v174, v174, v241
v_pk_mul_f32 v[104:105], v[104:105], v[148:149] op_sel_hi:[1,0]
v_pk_mul_f32 v[106:107], v[106:107], v[148:149] op_sel_hi:[1,0]
v_pk_mul_f32 v[108:109], v[108:109], v[148:149] op_sel_hi:[1,0]
v_pk_mul_f32 v[110:111], v[110:111], v[148:149] op_sel_hi:[1,0]
s_waitcnt lgkmcnt(6)
v_pk_fma_f32 v[104:105], v[56:57], v[150:151], v[104:105] op_sel_hi:[1,0,1]
v_pk_fma_f32 v[106:107], v[58:59], v[150:151], v[106:107] op_sel_hi:[1,0,1]
v_pk_fma_f32 v[108:109], v[60:61], v[150:151], v[108:109] op_sel_hi:[1,0,1]
v_pk_fma_f32 v[110:111], v[62:63], v[150:151], v[110:111] op_sel_hi:[1,0,1]
v_pk_fma_f32 v[104:105], v[64:65], v[172:173], v[104:105] op_sel_hi:[1,0,1]
v_pk_fma_f32 v[106:107], v[66:67], v[172:173], v[106:107] op_sel_hi:[1,0,1]
v_pk_fma_f32 v[108:109], v[68:69], v[172:173], v[108:109] op_sel_hi:[1,0,1]
v_pk_fma_f32 v[110:111], v[70:71], v[172:173], v[110:111] op_sel_hi:[1,0,1]
v_pk_fma_f32 v[104:105], v[72:73], v[174:175], v[104:105] op_sel_hi:[1,0,1]
v_pk_fma_f32 v[106:107], v[74:75], v[174:175], v[106:107] op_sel_hi:[1,0,1]
v_pk_fma_f32 v[108:109], v[76:77], v[174:175], v[108:109] op_sel_hi:[1,0,1]
v_pk_fma_f32 v[110:111], v[78:79], v[174:175], v[110:111] op_sel_hi:[1,0,1]
ds_read_b128 v[56:59], v201 offset:18432
ds_read_b128 v[60:63], v201 offset:19456
ds_read_b128 v[64:67], v202 offset:20480
ds_read_b128 v[68:71], v202 offset:21504
ds_read_b128 v[72:75], v203 offset:22528
ds_read_b128 v[76:79], v203 offset:23552
v_cvt_pk_bf16_f32 v104, v104, v105
v_cvt_pk_bf16_f32 v105, v106, v107
v_cvt_pk_bf16_f32 v106, v108, v109
v_cvt_pk_bf16_f32 v107, v110, v111
buffer_store_dwordx4 v[104:107], v213, s[48:51], s65 offen sc1 nt
s_add_u32 s65, s65, 4096
v_mul_f32 v152, v152, v242
v_mul_f32 v154, v154, v242
v_mul_f32 v176, v176, v242
v_mul_f32 v178, v178, v242
v_pk_mul_f32 v[112:113], v[112:113], v[152:153] op_sel_hi:[1,0]
v_pk_mul_f32 v[114:115], v[114:115], v[152:153] op_sel_hi:[1,0]
v_pk_mul_f32 v[116:117], v[116:117], v[152:153] op_sel_hi:[1,0]
v_pk_mul_f32 v[118:119], v[118:119], v[152:153] op_sel_hi:[1,0]
s_waitcnt lgkmcnt(6)
v_pk_fma_f32 v[112:113], v[32:33], v[154:155], v[112:113] op_sel_hi:[1,0,1]
v_pk_fma_f32 v[114:115], v[34:35], v[154:155], v[114:115] op_sel_hi:[1,0,1]
v_pk_fma_f32 v[116:117], v[36:37], v[154:155], v[116:117] op_sel_hi:[1,0,1]
v_pk_fma_f32 v[118:119], v[38:39], v[154:155], v[118:119] op_sel_hi:[1,0,1]
v_pk_fma_f32 v[112:113], v[40:41], v[176:177], v[112:113] op_sel_hi:[1,0,1]
v_pk_fma_f32 v[114:115], v[42:43], v[176:177], v[114:115] op_sel_hi:[1,0,1]
v_pk_fma_f32 v[116:117], v[44:45], v[176:177], v[116:117] op_sel_hi:[1,0,1]
v_pk_fma_f32 v[118:119], v[46:47], v[176:177], v[118:119] op_sel_hi:[1,0,1]
v_pk_fma_f32 v[112:113], v[48:49], v[178:179], v[112:113] op_sel_hi:[1,0,1]
v_pk_fma_f32 v[114:115], v[50:51], v[178:179], v[114:115] op_sel_hi:[1,0,1]
v_pk_fma_f32 v[116:117], v[52:53], v[178:179], v[116:117] op_sel_hi:[1,0,1]
v_pk_fma_f32 v[118:119], v[54:55], v[178:179], v[118:119] op_sel_hi:[1,0,1]
ds_read_b128 v[32:35], v201 offset:24576
ds_read_b128 v[36:39], v201 offset:25600
ds_read_b128 v[40:43], v202 offset:26624
ds_read_b128 v[44:47], v202 offset:27648
ds_read_b128 v[48:51], v203 offset:28672
ds_read_b128 v[52:55], v203 offset:29696
v_cvt_pk_bf16_f32 v112, v112, v113
v_cvt_pk_bf16_f32 v113, v114, v115
v_cvt_pk_bf16_f32 v114, v116, v117
v_cvt_pk_bf16_f32 v115, v118, v119
buffer_store_dwordx4 v[112:115], v213, s[48:51], s65 offen sc1 nt
s_add_u32 s65, s65, 4096
v_mul_f32 v156, v156, v243
v_mul_f32 v158, v158, v243
v_mul_f32 v180, v180, v243
v_mul_f32 v182, v182, v243
v_pk_mul_f32 v[120:121], v[120:121], v[156:157] op_sel_hi:[1,0]
v_pk_mul_f32 v[122:123], v[122:123], v[156:157] op_sel_hi:[1,0]
v_pk_mul_f32 v[124:125], v[124:125], v[156:157] op_sel_hi:[1,0]
v_pk_mul_f32 v[126:127], v[126:127], v[156:157] op_sel_hi:[1,0]
s_waitcnt lgkmcnt(6)
v_pk_fma_f32 v[120:121], v[56:57], v[158:159], v[120:121] op_sel_hi:[1,0,1]
v_pk_fma_f32 v[122:123], v[58:59], v[158:159], v[122:123] op_sel_hi:[1,0,1]
v_pk_fma_f32 v[124:125], v[60:61], v[158:159], v[124:125] op_sel_hi:[1,0,1]
v_pk_fma_f32 v[126:127], v[62:63], v[158:159], v[126:127] op_sel_hi:[1,0,1]
v_pk_fma_f32 v[120:121], v[64:65], v[180:181], v[120:121] op_sel_hi:[1,0,1]
v_pk_fma_f32 v[122:123], v[66:67], v[180:181], v[122:123] op_sel_hi:[1,0,1]
v_pk_fma_f32 v[124:125], v[68:69], v[180:181], v[124:125] op_sel_hi:[1,0,1]
v_pk_fma_f32 v[126:127], v[70:71], v[180:181], v[126:127] op_sel_hi:[1,0,1]
v_pk_fma_f32 v[120:121], v[72:73], v[182:183], v[120:121] op_sel_hi:[1,0,1]
v_pk_fma_f32 v[122:123], v[74:75], v[182:183], v[122:123] op_sel_hi:[1,0,1]
v_pk_fma_f32 v[124:125], v[76:77], v[182:183], v[124:125] op_sel_hi:[1,0,1]
v_pk_fma_f32 v[126:127], v[78:79], v[182:183], v[126:127] op_sel_hi:[1,0,1]
ds_read_b128 v[56:59], v201 offset:30720
ds_read_b128 v[60:63], v201 offset:31744
ds_read_b128 v[64:67], v202 offset:32768
ds_read_b128 v[68:71], v202 offset:33792
ds_read_b128 v[72:75], v203 offset:34816
ds_read_b128 v[76:79], v203 offset:35840
v_cvt_pk_bf16_f32 v120, v120, v121
v_cvt_pk_bf16_f32 v121, v122, v123
v_cvt_pk_bf16_f32 v122, v124, v125
v_cvt_pk_bf16_f32 v123, v126, v127
buffer_store_dwordx4 v[120:123], v213, s[48:51], s65 offen sc1 nt
s_add_u32 s65, s65, 4096
v_mul_f32 v160, v160, v244
v_mul_f32 v162, v162, v244
v_mul_f32 v184, v184, v244
v_mul_f32 v186, v186, v244
v_pk_mul_f32 v[128:129], v[128:129], v[160:161] op_sel_hi:[1,0]
v_pk_mul_f32 v[130:131], v[130:131], v[160:161] op_sel_hi:[1,0]
v_pk_mul_f32 v[132:133], v[132:133], v[160:161] op_sel_hi:[1,0]
v_pk_mul_f32 v[134:135], v[134:135], v[160:161] op_sel_hi:[1,0]
s_waitcnt lgkmcnt(6)
v_pk_fma_f32 v[128:129], v[32:33], v[162:163], v[128:129] op_sel_hi:[1,0,1]
v_pk_fma_f32 v[130:131], v[34:35], v[162:163], v[130:131] op_sel_hi:[1,0,1]
v_pk_fma_f32 v[132:133], v[36:37], v[162:163], v[132:133] op_sel_hi:[1,0,1]
v_pk_fma_f32 v[134:135], v[38:39], v[162:163], v[134:135] op_sel_hi:[1,0,1]
v_pk_fma_f32 v[128:129], v[40:41], v[184:185], v[128:129] op_sel_hi:[1,0,1]
v_pk_fma_f32 v[130:131], v[42:43], v[184:185], v[130:131] op_sel_hi:[1,0,1]
v_pk_fma_f32 v[132:133], v[44:45], v[184:185], v[132:133] op_sel_hi:[1,0,1]
v_pk_fma_f32 v[134:135], v[46:47], v[184:185], v[134:135] op_sel_hi:[1,0,1]
v_pk_fma_f32 v[128:129], v[48:49], v[186:187], v[128:129] op_sel_hi:[1,0,1]
v_pk_fma_f32 v[130:131], v[50:51], v[186:187], v[130:131] op_sel_hi:[1,0,1]
v_pk_fma_f32 v[132:133], v[52:53], v[186:187], v[132:133] op_sel_hi:[1,0,1]
v_pk_fma_f32 v[134:135], v[54:55], v[186:187], v[134:135] op_sel_hi:[1,0,1]
v_cvt_pk_bf16_f32 v128, v128, v129
v_cvt_pk_bf16_f32 v129, v130, v131
v_cvt_pk_bf16_f32 v130, v132, v133
v_cvt_pk_bf16_f32 v131, v134, v135
buffer_store_dwordx4 v[128:131], v213, s[48:51], s65 offen sc1 nt
s_add_u32 s65, s65, 4096
v_mul_f32 v164, v164, v245
v_mul_f32 v166, v166, v245
v_mul_f32 v188, v188, v245
v_mul_f32 v190, v190, v245
v_pk_mul_f32 v[136:137], v[136:137], v[164:165] op_sel_hi:[1,0]
v_pk_mul_f32 v[138:139], v[138:139], v[164:165] op_sel_hi:[1,0]
v_pk_mul_f32 v[140:141], v[140:141], v[164:165] op_sel_hi:[1,0]
v_pk_mul_f32 v[142:143], v[142:143], v[164:165] op_sel_hi:[1,0]
s_waitcnt lgkmcnt(0)
v_pk_fma_f32 v[136:137], v[56:57], v[166:167], v[136:137] op_sel_hi:[1,0,1]
v_pk_fma_f32 v[138:139], v[58:59], v[166:167], v[138:139] op_sel_hi:[1,0,1]
v_pk_fma_f32 v[140:141], v[60:61], v[166:167], v[140:141] op_sel_hi:[1,0,1]
v_pk_fma_f32 v[142:143], v[62:63], v[166:167], v[142:143] op_sel_hi:[1,0,1]
v_pk_fma_f32 v[136:137], v[64:65], v[188:189], v[136:137] op_sel_hi:[1,0,1]
v_pk_fma_f32 v[138:139], v[66:67], v[188:189], v[138:139] op_sel_hi:[1,0,1]
v_pk_fma_f32 v[140:141], v[68:69], v[188:189], v[140:141] op_sel_hi:[1,0,1]
v_pk_fma_f32 v[142:143], v[70:71], v[188:189], v[142:143] op_sel_hi:[1,0,1]
v_pk_fma_f32 v[136:137], v[72:73], v[190:191], v[136:137] op_sel_hi:[1,0,1]
v_pk_fma_f32 v[138:139], v[74:75], v[190:191], v[138:139] op_sel_hi:[1,0,1]
v_pk_fma_f32 v[140:141], v[76:77], v[190:191], v[140:141] op_sel_hi:[1,0,1]
v_pk_fma_f32 v[142:143], v[78:79], v[190:191], v[142:143] op_sel_hi:[1,0,1]
v_cvt_pk_bf16_f32 v136, v136, v137
v_cvt_pk_bf16_f32 v137, v138, v139
v_cvt_pk_bf16_f32 v138, v140, v141
v_cvt_pk_bf16_f32 v139, v142, v143
buffer_store_dwordx4 v[136:139], v213, s[48:51], s65 offen sc1 nt
v_lshrrev_b32 v11, 3, v1
v_and_b32 v12, 7, v1
v_and_b32 v13, 6, v11
v_xor_b32 v13, v13, v12
v_lshlrev_b32 v13, 4, v13
v_lshl_add_u32 v13, v11, 11, v13
v_add_u32 v2, 0, v13
v_add_u32 v3, 15360, v13
v_add_u32 v4, 30720, v13
v_add_u32 v5, 46080, v13
v_lshlrev_b32 v10, 4, v1
v_lshrrev_b32 v12, 2, v1
v_lshlrev_b32 v11, 7, v12
v_and_b32 v13, 3, v1
v_lshl_add_u32 v11, v13, 3, v11
v_add_u32 v11, s57, v11
v_bfe_u32 v12, v12, 1, 2
s_add_u32 s65, s56, 0
s_and_b32 s65, s65, 3
v_xor_b32 v13, s65, v12
v_lshl_add_u32 v6, v13, 5, v11
s_add_u32 s65, s56, 1
s_and_b32 s65, s65, 3
v_xor_b32 v13, s65, v12
v_lshl_add_u32 v7, v13, 5, v11
s_add_u32 s65, s56, 2
s_and_b32 s65, s65, 3
v_xor_b32 v13, s65, v12
v_lshl_add_u32 v8, v13, 5, v11
s_add_u32 s65, s56, 3
s_and_b32 s65, s65, 3
v_xor_b32 v13, s65, v12
v_lshl_add_u32 v9, v13, 5, v11
s_and_b32 s64, s59, 3
s_bfe_u32 s65, s59, 0x20002
s_add_u32 s62, s64, s65
s_and_b32 s30, s64, 2
s_add_u32 s30, s30, s64
s_and_b32 s78, s58, 3
s_lshl2_add_u32 s78, s78, s65
s_mov_b32 s76, 0
s_waitcnt lgkmcnt(0)
s_barrier
s_cmp_ge_u32 s58, 4
s_cbranch_scc1 L_partB
s_lshl_b32 s64, s78, 7
s_add_u32 s36, s12, s64
s_addc_u32 s37, s13, 0
s_sub_u32 s38, 8388608, s64
s_mov_b32 s39, 0x20000
s_mul_i32 s64, s30, 393216
s_add_u32 s32, s28, s64
s_addc_u32 s33, s29, 0
s_mov_b32 s34, 1179648
s_mov_b32 s35, 0x20000
s_mul_i32 s64, s30, 196608
s_lshl_b32 s65, s78, 7
s_add_u32 s64, s64, s65
s_add_u32 s52, s24, s64
s_addc_u32 s53, s25, 0
s_sub_u32 s54, 1572864, s64
s_mov_b32 s55, 0x20000
s_mov_b32 s68, 0
s_lshl3_add_u32 s68, s56, s68
s_lshl_b32 s68, s68, 2
s_add_u32 s71, s62, 0
s_and_b32 s71, s71, 3
s_add_u32 s71, s71, s68
s_lshl_b32 s71, s71, 16
s_add_u32 m0, s57, 0
s_nop 0
buffer_load_dwordx4 v2, s[36:39], s71 offen offset:0 lds
buffer_load_dwordx4 v3, s[36:39], s71 offen offset:1024 lds
buffer_load_dwordx4 v4, s[36:39], s71 offen offset:2048 lds
buffer_load_dwordx4 v5, s[36:39], s71 offen offset:3072 lds
s_add_u32 s71, s62, 1
s_and_b32 s71, s71, 3
s_add_u32 s71, s71, s68
s_lshl_b32 s71, s71, 16
s_add_u32 m0, s57, 4096
s_nop 0
buffer_load_dwordx4 v2, s[36:39], s71 offen offset:0 lds
buffer_load_dwordx4 v3, s[36:39], s71 offen offset:1024 lds
buffer_load_dwordx4 v4, s[36:39], s71 offen offset:2048 lds
buffer_load_dwordx4 v5, s[36:39], s71 offen offset:3072 lds
s_waitcnt vmcnt(8)
v_mov_b32 v248, 1
v_mov_b32 v249, 1
v_mov_b32 v250, 1
v_mov_b32 v251, 1
s_barrier
s_cmp_lg_u32 s56, 0
s_cbranch_scc1 nosig_13
s_mov_b64 exec, 1
global_store_dwordx4 v216, v[248:251], s[98:99] sc1
s_mov_b64 exec, -1
nosig_13:
s_add_u32 s71, s62, 2
s_and_b32 s71, s71, 3
s_add_u32 s71, s71, s68
s_lshl_b32 s71, s71, 16
s_add_u32 m0, s57, 8192
s_nop 0
buffer_load_dwordx4 v2, s[36:39], s71 offen offset:0 lds
buffer_load_dwordx4 v3, s[36:39], s71 offen offset:1024 lds
buffer_load_dwordx4 v4, s[36:39], s71 offen offset:2048 lds
buffer_load_dwordx4 v5, s[36:39], s71 offen offset:3072 lds
s_add_u32 s71, s62, 3
s_and_b32 s71, s71, 3
s_add_u32 s71, s71, s68
s_lshl_b32 s71, s71, 16
s_add_u32 m0, s57, 12288
s_nop 0
buffer_load_dwordx4 v2, s[36:39], s71 offen offset:0 lds
buffer_load_dwordx4 v3, s[36:39], s71 offen offset:1024 lds
buffer_load_dwordx4 v4, s[36:39], s71 offen offset:2048 lds
buffer_load_dwordx4 v5, s[36:39], s71 offen offset:3072 lds
s_mov_b32 s68, 1
s_lshl3_add_u32 s68, s56, s68
s_lshl_b32 s68, s68, 2
s_add_u32 s71, s62, 0
s_and_b32 s71, s71, 3
s_add_u32 s71, s71, s68
s_lshl_b32 s71, s71, 16
s_add_u32 m0, s57, 16384
s_nop 0
buffer_load_dwordx4 v2, s[36:39], s71 offen offset:0 lds
buffer_load_dwordx4 v3, s[36:39], s71 offen offset:1024 lds
buffer_load_dwordx4 v4, s[36:39], s71 offen offset:2048 lds
buffer_load_dwordx4 v5, s[36:39], s71 offen offset:3072 lds
v_lshrrev_b32 v11, 1, v1
v_add_u32 v11, s62, v11
v_and_b32 v11, 3, v11
s_lshl2_add_u32 s64, s30, s56
s_lshl3_add_u32 s64, s64, 0
s_add_u32 s64, s64, 256
v_lshl_add_u32 v11, v11, 1, s64
v_and_b32 v12, 1, v1
v_lshl_add_u32 v11, v12, 6, v11
v_lshlrev_b32 v11, 7, v11
v_lshrrev_b32 v240, 5, v1
v_lshlrev_b32 v240, 1, v240
v_xor_b32 v240, v240, v1
s_add_u32 s65, s56, 0
s_and_b32 s65, s65, 3
s_lshl_b32 s64, s65, 2
v_xor_b32 v241, s64, v240
s_lshl_b32 s65, s65, 10
s_add_u32 s65, s65, s57
v_lshl_add_u32 v233, v241, 4, s65
s_add_u32 s65, s56, 1
s_and_b32 s65, s65, 3
s_lshl_b32 s64, s65, 2
v_xor_b32 v241, s64, v240
s_lshl_b32 s65, s65, 10
s_add_u32 s65, s65, s57
v_lshl_add_u32 v234, v241, 4, s65
s_add_u32 s65, s56, 2
s_and_b32 s65, s65, 3
s_lshl_b32 s64, s65, 2
v_xor_b32 v241, s64, v240
s_lshl_b32 s65, s65, 10
s_add_u32 s65, s65, s57
v_lshl_add_u32 v235, v241, 4, s65
s_add_u32 s65, s56, 3
s_and_b32 s65, s65, 3
s_lshl_b32 s64, s65, 2
v_xor_b32 v241, s64, v240
s_lshl_b32 s65, s65, 10
s_add_u32 s65, s65, s57
v_lshl_add_u32 v236, v241, 4, s65
s_mul_i32 s64, s56, 24
v_and_b32 v240, 7, v1
v_lshrrev_b32 v241, 3, v1
v_add3_u32 v241, v241, s64, 0
v_lshlrev_b32 v242, 1, v240
v_xor_b32 v242, v242, v241
v_and_b32 v242, 15, v242
v_lshlrev_b32 v242, 4, v242
v_lshl_add_u32 v242, v240, 9, v242
v_lshrrev_b32 v243, 4, v241
v_lshl_add_u32 v224, v243, 12, v242
v_add_u32 v225, 81920, v224
s_and_b32 s65, s56, 2
s_mul_i32 s65, s65, 24
v_add_u32 v241, s65, v241
v_lshlrev_b32 v241, 12, v241
v_lshl_add_u32 v230, v240, 4, v241
v_lshrrev_b32 v241, 3, v1
v_add3_u32 v241, v241, s64, 8
v_lshlrev_b32 v242, 1, v240
v_xor_b32 v242, v242, v241
v_and_b32 v242, 15, v242
v_lshlrev_b32 v242, 4, v242
v_lshl_add_u32 v242, v240, 9, v242
v_lshrrev_b32 v243, 4, v241
v_lshl_add_u32 v226, v243, 12, v242
v_add_u32 v227, 81920, v226
s_and_b32 s65, s56, 2
s_mul_i32 s65, s65, 24
v_add_u32 v241, s65, v241
v_lshlrev_b32 v241, 12, v241
v_lshl_add_u32 v231, v240, 4, v241
v_lshrrev_b32 v241, 3, v1
v_add3_u32 v241, v241, s64, 16
v_lshlrev_b32 v242, 1, v240
v_xor_b32 v242, v242, v241
v_and_b32 v242, 15, v242
v_lshlrev_b32 v242, 4, v242
v_lshl_add_u32 v242, v240, 9, v242
v_lshrrev_b32 v243, 4, v241
v_lshl_add_u32 v228, v243, 12, v242
v_add_u32 v229, 81920, v228
s_and_b32 s65, s56, 2
s_mul_i32 s65, s65, 24
v_add_u32 v241, s65, v241
v_lshlrev_b32 v241, 12, v241
v_lshl_add_u32 v232, v240, 4, v241
s_mov_b32 s31, 0x200000
poll_14:
s_mov_b64 exec, 0xff
global_load_dwordx4 v[12:15], v11, s[98:99] sc1
s_mov_b64 exec, -1
pollw_16:
s_waitcnt vmcnt(0)
v_min3_u32 v12, v12, v13, v14
v_min_u32 v12, v12, v15
v_cmp_ne_u32 vcc, 0, v12
s_nop 0
s_andn2_b32 s64, 0xff, vcc_lo
s_cbranch_scc0 polled_15
s_sleep 4
s_sub_u32 s31, s31, 1
s_cbranch_scc0 poll_14
polled_15:
s_mov_b32 s69, 0
s_lshl3_add_u32 s69, s56, s69
s_mul_i32 s69, s69, 12
s_add_u32 s72, s62, 0
s_and_b32 s72, s72, 3
s_add_u32 s72, s72, s69
s_lshl_b32 s72, s72, 10
buffer_load_dwordx4 a[0:3], v10, s[32:35], s72 offen offset:0 sc1
s_add_u32 s67, s72, 4096
buffer_load_dwordx4 a[4:7], v10, s[32:35], s67 offen offset:0 sc1
s_add_u32 s67, s72, 8192
buffer_load_dwordx4 a[8:11], v10, s[32:35], s67 offen offset:0 sc1
s_add_u32 s67, s72, 786432
buffer_load_dwordx4 a[12:15], v10, s[32:35], s67 offen offset:0 sc1
s_add_u32 s67, s72, 790528
buffer_load_dwordx4 a[16:19], v10, s[32:35], s67 offen offset:0 sc1
s_add_u32 s67, s72, 794624
buffer_load_dwordx4 a[20:23], v10, s[32:35], s67 offen offset:0 sc1
s_add_u32 s72, s62, 1
s_and_b32 s72, s72, 3
s_add_u32 s72, s72, s69
s_lshl_b32 s72, s72, 10
buffer_load_dwordx4 a[24:27], v10, s[32:35], s72 offen offset:0 sc1
s_add_u32 s67, s72, 4096
buffer_load_dwordx4 a[28:31], v10, s[32:35], s67 offen offset:0 sc1
s_add_u32 s67, s72, 8192
buffer_load_dwordx4 a[32:35], v10, s[32:35], s67 offen offset:0 sc1
s_add_u32 s67, s72, 786432
buffer_load_dwordx4 a[36:39], v10, s[32:35], s67 offen offset:0 sc1
s_add_u32 s67, s72, 790528
buffer_load_dwordx4 a[40:43], v10, s[32:35], s67 offen offset:0 sc1
s_add_u32 s67, s72, 794624
buffer_load_dwordx4 a[44:47], v10, s[32:35], s67 offen offset:0 sc1
s_add_u32 s72, s62, 2
s_and_b32 s72, s72, 3
s_add_u32 s72, s72, s69
s_lshl_b32 s72, s72, 10
buffer_load_dwordx4 a[48:51], v10, s[32:35], s72 offen offset:0 sc1
s_add_u32 s67, s72, 4096
buffer_load_dwordx4 a[52:55], v10, s[32:35], s67 offen offset:0 sc1
s_add_u32 s67, s72, 8192
buffer_load_dwordx4 a[56:59], v10, s[32:35], s67 offen offset:0 sc1
s_add_u32 s67, s72, 786432
buffer_load_dwordx4 a[60:63], v10, s[32:35], s67 offen offset:0 sc1
s_add_u32 s67, s72, 790528
buffer_load_dwordx4 a[64:67], v10, s[32:35], s67 offen offset:0 sc1
s_add_u32 s67, s72, 794624
buffer_load_dwordx4 a[68:71], v10, s[32:35], s67 offen offset:0 sc1
s_add_u32 s72, s62, 3
s_and_b32 s72, s72, 3
s_add_u32 s72, s72, s69
s_lshl_b32 s72, s72, 10
buffer_load_dwordx4 a[72:75], v10, s[32:35], s72 offen offset:0 sc1
s_add_u32 s67, s72, 4096
buffer_load_dwordx4 a[76:79], v10, s[32:35], s67 offen offset:0 sc1
s_add_u32 s67, s72, 8192
buffer_load_dwordx4 a[80:83], v10, s[32:35], s67 offen offset:0 sc1
s_add_u32 s67, s72, 786432
buffer_load_dwordx4 a[84:87], v10, s[32:35], s67 offen offset:0 sc1
s_add_u32 s67, s72, 790528
buffer_load_dwordx4 a[88:91], v10, s[32:35], s67 offen offset:0 sc1
s_add_u32 s67, s72, 794624
buffer_load_dwordx4 a[92:95], v10, s[32:35], s67 offen offset:0 sc1
s_mov_b32 s69, 1
s_lshl3_add_u32 s69, s56, s69
s_mul_i32 s69, s69, 12
s_add_u32 s72, s62, 0
s_and_b32 s72, s72, 3
s_add_u32 s72, s72, s69
s_lshl_b32 s72, s72, 10
buffer_load_dwordx4 a[96:99], v10, s[32:35], s72 offen offset:0 sc1
s_add_u32 s67, s72, 4096
buffer_load_dwordx4 a[100:103], v10, s[32:35], s67 offen offset:0 sc1
s_add_u32 s67, s72, 8192
buffer_load_dwordx4 a[104:107], v10, s[32:35], s67 offen offset:0 sc1
s_add_u32 s67, s72, 786432
buffer_load_dwordx4 a[108:111], v10, s[32:35], s67 offen offset:0 sc1
s_add_u32 s67, s72, 790528
buffer_load_dwordx4 a[112:115], v10, s[32:35], s67 offen offset:0 sc1
s_add_u32 s67, s72, 794624
buffer_load_dwordx4 a[116:119], v10, s[32:35], s67 offen offset:0 sc1
s_waitcnt vmcnt(24)
ds_read_b64_tr_b16 v[112:113], v6 offset:0
ds_read_b64_tr_b16 v[114:115], v6 offset:2048
ds_read_b64_tr_b16 v[116:117], v7 offset:0
ds_read_b64_tr_b16 v[118:119], v7 offset:2048
ds_read_b64_tr_b16 v[120:121], v8 offset:0
ds_read_b64_tr_b16 v[122:123], v8 offset:2048
ds_read_b64_tr_b16 v[124:125], v9 offset:0
ds_read_b64_tr_b16 v[126:127], v9 offset:2048
s_waitcnt lgkmcnt(0)
s_waitcnt vmcnt(18)
v_mfma_f32_16x16x32_bf16 v[16:19], v[112:115], a[0:3], 0
s_add_u32 s71, s62, 1
s_and_b32 s71, s71, 3
s_add_u32 s71, s71, s68
s_lshl_b32 s71, s71, 16
s_add_u32 m0, s57, 20480
s_nop 0
buffer_load_dwordx4 v2, s[36:39], s71 offen offset:0 lds
v_mfma_f32_16x16x32_bf16 v[20:23], v[112:115], a[4:7], 0
ds_read_b64_tr_b16 v[128:129], v6 offset:4096
v_mfma_f32_16x16x32_bf16 v[24:27], v[112:115], a[8:11], 0
v_mfma_f32_16x16x32_bf16 v[64:67], v[112:115], a[12:15], 0
ds_read_b64_tr_b16 v[130:131], v6 offset:6144
buffer_load_dwordx4 v3, s[36:39], s71 offen offset:1024 lds
v_mfma_f32_16x16x32_bf16 v[68:71], v[112:115], a[16:19], 0
v_mfma_f32_16x16x32_bf16 v[72:75], v[112:115], a[20:23], 0
ds_read_b64_tr_b16 v[132:133], v7 offset:4096
buffer_load_dwordx4 v4, s[36:39], s71 offen offset:2048 lds
v_mfma_f32_16x16x32_bf16 v[28:31], v[116:119], a[0:3], 0
v_mfma_f32_16x16x32_bf16 v[32:35], v[116:119], a[4:7], 0
ds_read_b64_tr_b16 v[134:135], v7 offset:6144
buffer_load_dwordx4 v5, s[36:39], s71 offen offset:3072 lds
v_mfma_f32_16x16x32_bf16 v[36:39], v[116:119], a[8:11], 0
v_mfma_f32_16x16x32_bf16 v[76:79], v[116:119], a[12:15], 0
ds_read_b64_tr_b16 v[136:137], v8 offset:4096
s_add_u32 s72, s62, 1
s_and_b32 s72, s72, 3
s_add_u32 s72, s72, s69
s_lshl_b32 s72, s72, 10
buffer_load_dwordx4 a[120:123], v10, s[32:35], s72 offen offset:0 sc1
v_mfma_f32_16x16x32_bf16 v[80:83], v[116:119], a[16:19], 0
v_mfma_f32_16x16x32_bf16 v[84:87], v[116:119], a[20:23], 0
ds_read_b64_tr_b16 v[138:139], v8 offset:6144
s_add_u32 s67, s72, 4096
buffer_load_dwordx4 a[124:127], v10, s[32:35], s67 offen offset:0 sc1
v_mfma_f32_16x16x32_bf16 v[40:43], v[120:123], a[0:3], 0
v_mfma_f32_16x16x32_bf16 v[44:47], v[120:123], a[4:7], 0
ds_read_b64_tr_b16 v[140:141], v9 offset:4096
v_mfma_f32_16x16x32_bf16 v[48:51], v[120:123], a[8:11], 0
s_add_u32 s67, s72, 8192
buffer_load_dwordx4 a[128:131], v10, s[32:35], s67 offen offset:0 sc1
v_mfma_f32_16x16x32_bf16 v[88:91], v[120:123], a[12:15], 0
ds_read_b64_tr_b16 v[142:143], v9 offset:6144
v_mfma_f32_16x16x32_bf16 v[92:95], v[120:123], a[16:19], 0
s_add_u32 s67, s72, 786432
buffer_load_dwordx4 a[132:135], v10, s[32:35], s67 offen offset:0 sc1
v_mfma_f32_16x16x32_bf16 v[96:99], v[120:123], a[20:23], 0
v_mfma_f32_16x16x32_bf16 v[52:55], v[124:127], a[0:3], 0
s_add_u32 s67, s72, 790528
buffer_load_dwordx4 a[136:139], v10, s[32:35], s67 offen offset:0 sc1
v_mfma_f32_16x16x32_bf16 v[56:59], v[124:127], a[4:7], 0
v_mfma_f32_16x16x32_bf16 v[60:63], v[124:127], a[8:11], 0
s_add_u32 s67, s72, 794624
buffer_load_dwordx4 a[140:143], v10, s[32:35], s67 offen offset:0 sc1
v_mfma_f32_16x16x32_bf16 v[100:103], v[124:127], a[12:15], 0
v_mfma_f32_16x16x32_bf16 v[104:107], v[124:127], a[16:19], 0
v_add_u32 v220, 524288, v220
global_load_dword v221, v220, s[12:13]
v_mfma_f32_16x16x32_bf16 v[108:111], v[124:127], a[20:23], 0
s_waitcnt lgkmcnt(0)
s_waitcnt vmcnt(23)
v_mfma_f32_16x16x32_bf16 v[16:19], v[128:131], a[24:27], v[16:19]
s_add_u32 s71, s62, 2
s_and_b32 s71, s71, 3
s_add_u32 s71, s71, s68
s_lshl_b32 s71, s71, 16
s_add_u32 m0, s57, 24576
s_nop 0
buffer_load_dwordx4 v2, s[36:39], s71 offen offset:0 lds
v_mfma_f32_16x16x32_bf16 v[20:23], v[128:131], a[28:31], v[20:23]
ds_read_b64_tr_b16 v[112:113], v6 offset:8192
v_mfma_f32_16x16x32_bf16 v[24:27], v[128:131], a[32:35], v[24:27]
v_mfma_f32_16x16x32_bf16 v[64:67], v[128:131], a[36:39], v[64:67]
ds_read_b64_tr_b16 v[114:115], v6 offset:10240
buffer_load_dwordx4 v3, s[36:39], s71 offen offset:1024 lds
v_mfma_f32_16x16x32_bf16 v[68:71], v[128:131], a[40:43], v[68:71]
v_mfma_f32_16x16x32_bf16 v[72:75], v[128:131], a[44:47], v[72:75]
ds_read_b64_tr_b16 v[116:117], v7 offset:8192
buffer_load_dwordx4 v4, s[36:39], s71 offen offset:2048 lds
v_mfma_f32_16x16x32_bf16 v[28:31], v[132:135], a[24:27], v[28:31]
v_mfma_f32_16x16x32_bf16 v[32:35], v[132:135], a[28:31], v[32:35]
ds_read_b64_tr_b16 v[118:119], v7 offset:10240
v_mfma_f32_16x16x32_bf16 v[36:39], v[132:135], a[32:35], v[36:39]
buffer_load_dwordx4 v5, s[36:39], s71 offen offset:3072 lds
v_mfma_f32_16x16x32_bf16 v[76:79], v[132:135], a[36:39], v[76:79]
ds_read_b64_tr_b16 v[120:121], v8 offset:8192
v_mfma_f32_16x16x32_bf16 v[80:83], v[132:135], a[40:43], v[80:83]
s_add_u32 s72, s62, 2
s_and_b32 s72, s72, 3
s_add_u32 s72, s72, s69
s_lshl_b32 s72, s72, 10
buffer_load_dwordx4 a[144:147], v10, s[32:35], s72 offen offset:0 sc1
v_mfma_f32_16x16x32_bf16 v[84:87], v[132:135], a[44:47], v[84:87]
ds_read_b64_tr_b16 v[122:123], v8 offset:10240
v_mfma_f32_16x16x32_bf16 v[40:43], v[136:139], a[24:27], v[40:43]
s_add_u32 s67, s72, 4096
buffer_load_dwordx4 a[148:151], v10, s[32:35], s67 offen offset:0 sc1
v_mfma_f32_16x16x32_bf16 v[44:47], v[136:139], a[28:31], v[44:47]
ds_read_b64_tr_b16 v[124:125], v9 offset:8192
v_mfma_f32_16x16x32_bf16 v[48:51], v[136:139], a[32:35], v[48:51]
v_mfma_f32_16x16x32_bf16 v[88:91], v[136:139], a[36:39], v[88:91]
ds_read_b64_tr_b16 v[126:127], v9 offset:10240
s_add_u32 s67, s72, 8192
buffer_load_dwordx4 a[152:155], v10, s[32:35], s67 offen offset:0 sc1
v_mfma_f32_16x16x32_bf16 v[92:95], v[136:139], a[40:43], v[92:95]
v_mfma_f32_16x16x32_bf16 v[96:99], v[136:139], a[44:47], v[96:99]
s_add_u32 s67, s72, 786432
buffer_load_dwordx4 a[156:159], v10, s[32:35], s67 offen offset:0 sc1
v_mfma_f32_16x16x32_bf16 v[52:55], v[140:143], a[24:27], v[52:55]
v_mfma_f32_16x16x32_bf16 v[56:59], v[140:143], a[28:31], v[56:59]
v_mfma_f32_16x16x32_bf16 v[60:63], v[140:143], a[32:35], v[60:63]
s_add_u32 s67, s72, 790528
buffer_load_dwordx4 a[160:163], v10, s[32:35], s67 offen offset:0 sc1
v_mfma_f32_16x16x32_bf16 v[100:103], v[140:143], a[36:39], v[100:103]
v_mfma_f32_16x16x32_bf16 v[104:107], v[140:143], a[40:43], v[104:107]
s_add_u32 s67, s72, 794624
buffer_load_dwordx4 a[164:167], v10, s[32:35], s67 offen offset:0 sc1
v_mfma_f32_16x16x32_bf16 v[108:111], v[140:143], a[44:47], v[108:111]
s_waitcnt lgkmcnt(0)
s_waitcnt vmcnt(27)
v_mfma_f32_16x16x32_bf16 v[16:19], v[112:115], a[48:51], v[16:19]
s_add_u32 s71, s62, 3
s_and_b32 s71, s71, 3
s_add_u32 s71, s71, s68
s_lshl_b32 s71, s71, 16
s_add_u32 m0, s57, 28672
s_nop 0
buffer_load_dwordx4 v2, s[36:39], s71 offen offset:0 lds
v_mfma_f32_16x16x32_bf16 v[20:23], v[112:115], a[52:55], v[20:23]
ds_read_b64_tr_b16 v[128:129], v6 offset:12288
v_mfma_f32_16x16x32_bf16 v[24:27], v[112:115], a[56:59], v[24:27]
v_mfma_f32_16x16x32_bf16 v[64:67], v[112:115], a[60:63], v[64:67]
ds_read_b64_tr_b16 v[130:131], v6 offset:14336
buffer_load_dwordx4 v3, s[36:39], s71 offen offset:1024 lds
v_mfma_f32_16x16x32_bf16 v[68:71], v[112:115], a[64:67], v[68:71]
v_mfma_f32_16x16x32_bf16 v[72:75], v[112:115], a[68:71], v[72:75]
ds_read_b64_tr_b16 v[132:133], v7 offset:12288
buffer_load_dwordx4 v4, s[36:39], s71 offen offset:2048 lds
v_mfma_f32_16x16x32_bf16 v[28:31], v[116:119], a[48:51], v[28:31]
v_mfma_f32_16x16x32_bf16 v[32:35], v[116:119], a[52:55], v[32:35]
ds_read_b64_tr_b16 v[134:135], v7 offset:14336
v_mfma_f32_16x16x32_bf16 v[36:39], v[116:119], a[56:59], v[36:39]
buffer_load_dwordx4 v5, s[36:39], s71 offen offset:3072 lds
v_mfma_f32_16x16x32_bf16 v[76:79], v[116:119], a[60:63], v[76:79]
ds_read_b64_tr_b16 v[136:137], v8 offset:12288
v_mfma_f32_16x16x32_bf16 v[80:83], v[116:119], a[64:67], v[80:83]
s_add_u32 s72, s62, 3
s_and_b32 s72, s72, 3
s_add_u32 s72, s72, s69
s_lshl_b32 s72, s72, 10
buffer_load_dwordx4 a[168:171], v10, s[32:35], s72 offen offset:0 sc1
v_mfma_f32_16x16x32_bf16 v[84:87], v[116:119], a[68:71], v[84:87]
ds_read_b64_tr_b16 v[138:139], v8 offset:14336
v_mfma_f32_16x16x32_bf16 v[40:43], v[120:123], a[48:51], v[40:43]
s_add_u32 s67, s72, 4096
buffer_load_dwordx4 a[172:175], v10, s[32:35], s67 offen offset:0 sc1
v_mfma_f32_16x16x32_bf16 v[44:47], v[120:123], a[52:55], v[44:47]
ds_read_b64_tr_b16 v[140:141], v9 offset:12288
v_mfma_f32_16x16x32_bf16 v[48:51], v[120:123], a[56:59], v[48:51]
v_mfma_f32_16x16x32_bf16 v[88:91], v[120:123], a[60:63], v[88:91]
ds_read_b64_tr_b16 v[142:143], v9 offset:14336
s_add_u32 s67, s72, 8192
buffer_load_dwordx4 a[176:179], v10, s[32:35], s67 offen offset:0 sc1
v_mfma_f32_16x16x32_bf16 v[92:95], v[120:123], a[64:67], v[92:95]
v_mfma_f32_16x16x32_bf16 v[96:99], v[120:123], a[68:71], v[96:99]
s_add_u32 s67, s72, 786432
buffer_load_dwordx4 a[180:183], v10, s[32:35], s67 offen offset:0 sc1
v_mfma_f32_16x16x32_bf16 v[52:55], v[124:127], a[48:51], v[52:55]
v_mfma_f32_16x16x32_bf16 v[56:59], v[124:127], a[52:55], v[56:59]
v_mfma_f32_16x16x32_bf16 v[60:63], v[124:127], a[56:59], v[60:63]
s_add_u32 s67, s72, 790528
buffer_load_dwordx4 a[184:187], v10, s[32:35], s67 offen offset:0 sc1
v_mfma_f32_16x16x32_bf16 v[100:103], v[124:127], a[60:63], v[100:103]
v_mfma_f32_16x16x32_bf16 v[104:107], v[124:127], a[64:67], v[104:107]
s_add_u32 s67, s72, 794624
buffer_load_dwordx4 a[188:191], v10, s[32:35], s67 offen offset:0 sc1
v_mfma_f32_16x16x32_bf16 v[108:111], v[124:127], a[68:71], v[108:111]
s_waitcnt lgkmcnt(0)
s_waitcnt vmcnt(31)
v_mfma_f32_16x16x32_bf16 v[16:19], v[128:131], a[72:75], v[16:19]
s_mov_b32 s68, 2
s_lshl3_add_u32 s68, s56, s68
s_lshl_b32 s68, s68, 2
s_add_u32 s71, s62, 0
s_and_b32 s71, s71, 3
s_add_u32 s71, s71, s68
s_lshl_b32 s71, s71, 16
s_add_u32 m0, s57, 0
s_nop 0
buffer_load_dwordx4 v2, s[36:39], s71 offen offset:0 lds
v_mfma_f32_16x16x32_bf16 v[20:23], v[128:131], a[76:79], v[20:23]
ds_read_b64_tr_b16 v[112:113], v6 offset:16384
v_mfma_f32_16x16x32_bf16 v[24:27], v[128:131], a[80:83], v[24:27]
v_mfma_f32_16x16x32_bf16 v[64:67], v[128:131], a[84:87], v[64:67]
ds_read_b64_tr_b16 v[114:115], v6 offset:18432
buffer_load_dwordx4 v3, s[36:39], s71 offen offset:1024 lds
v_mfma_f32_16x16x32_bf16 v[68:71], v[128:131], a[88:91], v[68:71]
v_mfma_f32_16x16x32_bf16 v[72:75], v[128:131], a[92:95], v[72:75]
ds_read_b64_tr_b16 v[116:117], v7 offset:16384
buffer_load_dwordx4 v4, s[36:39], s71 offen offset:2048 lds
v_mfma_f32_16x16x32_bf16 v[28:31], v[132:135], a[72:75], v[28:31]
v_mfma_f32_16x16x32_bf16 v[32:35], v[132:135], a[76:79], v[32:35]
ds_read_b64_tr_b16 v[118:119], v7 offset:18432
v_mfma_f32_16x16x32_bf16 v[36:39], v[132:135], a[80:83], v[36:39]
buffer_load_dwordx4 v5, s[36:39], s71 offen offset:3072 lds
v_mfma_f32_16x16x32_bf16 v[76:79], v[132:135], a[84:87], v[76:79]
ds_read_b64_tr_b16 v[120:121], v8 offset:16384
v_mfma_f32_16x16x32_bf16 v[80:83], v[132:135], a[88:91], v[80:83]
s_mov_b32 s69, 2
s_lshl3_add_u32 s69, s56, s69
s_mul_i32 s69, s69, 12
s_add_u32 s72, s62, 0
s_and_b32 s72, s72, 3
s_add_u32 s72, s72, s69
s_lshl_b32 s72, s72, 10
buffer_load_dwordx4 a[0:3], v10, s[32:35], s72 offen offset:0 sc1
v_mfma_f32_16x16x32_bf16 v[84:87], v[132:135], a[92:95], v[84:87]
ds_read_b64_tr_b16 v[122:123], v8 offset:18432
v_mfma_f32_16x16x32_bf16 v[40:43], v[136:139], a[72:75], v[40:43]
s_add_u32 s67, s72, 4096
buffer_load_dwordx4 a[4:7], v10, s[32:35], s67 offen offset:0 sc1
v_mfma_f32_16x16x32_bf16 v[44:47], v[136:139], a[76:79], v[44:47]
ds_read_b64_tr_b16 v[124:125], v9 offset:16384
v_mfma_f32_16x16x32_bf16 v[48:51], v[136:139], a[80:83], v[48:51]
v_mfma_f32_16x16x32_bf16 v[88:91], v[136:139], a[84:87], v[88:91]
ds_read_b64_tr_b16 v[126:127], v9 offset:18432
s_add_u32 s67, s72, 8192
buffer_load_dwordx4 a[8:11], v10, s[32:35], s67 offen offset:0 sc1
v_mfma_f32_16x16x32_bf16 v[92:95], v[136:139], a[88:91], v[92:95]
v_mfma_f32_16x16x32_bf16 v[96:99], v[136:139], a[92:95], v[96:99]
s_add_u32 s67, s72, 786432
buffer_load_dwordx4 a[12:15], v10, s[32:35], s67 offen offset:0 sc1
v_mfma_f32_16x16x32_bf16 v[52:55], v[140:143], a[72:75], v[52:55]
v_mfma_f32_16x16x32_bf16 v[56:59], v[140:143], a[76:79], v[56:59]
v_mfma_f32_16x16x32_bf16 v[60:63], v[140:143], a[80:83], v[60:63]
s_add_u32 s67, s72, 790528
buffer_load_dwordx4 a[16:19], v10, s[32:35], s67 offen offset:0 sc1
v_mfma_f32_16x16x32_bf16 v[100:103], v[140:143], a[84:87], v[100:103]
v_mfma_f32_16x16x32_bf16 v[104:107], v[140:143], a[88:91], v[104:107]
s_add_u32 s67, s72, 794624
buffer_load_dwordx4 a[20:23], v10, s[32:35], s67 offen offset:0 sc1
v_mfma_f32_16x16x32_bf16 v[108:111], v[140:143], a[92:95], v[108:111]
s_waitcnt lgkmcnt(0)
s_waitcnt vmcnt(31)
v_mfma_f32_16x16x32_bf16 v[16:19], v[112:115], a[96:99], v[16:19]
s_add_u32 s71, s62, 1
s_and_b32 s71, s71, 3
s_add_u32 s71, s71, s68
s_lshl_b32 s71, s71, 16
s_add_u32 m0, s57, 4096
s_nop 0
buffer_load_dwordx4 v2, s[36:39], s71 offen offset:0 lds
v_mfma_f32_16x16x32_bf16 v[20:23], v[112:115], a[100:103], v[20:23]
ds_read_b64_tr_b16 v[128:129], v6 offset:20480
v_mfma_f32_16x16x32_bf16 v[24:27], v[112:115], a[104:107], v[24:27]
v_mfma_f32_16x16x32_bf16 v[64:67], v[112:115], a[108:111], v[64:67]
ds_read_b64_tr_b16 v[130:131], v6 offset:22528
buffer_load_dwordx4 v3, s[36:39], s71 offen offset:1024 lds
v_mfma_f32_16x16x32_bf16 v[68:71], v[112:115], a[112:115], v[68:71]
v_mfma_f32_16x16x32_bf16 v[72:75], v[112:115], a[116:119], v[72:75]
ds_read_b64_tr_b16 v[132:133], v7 offset:20480
buffer_load_dwordx4 v4, s[36:39], s71 offen offset:2048 lds
v_mfma_f32_16x16x32_bf16 v[28:31], v[116:119], a[96:99], v[28:31]
v_mfma_f32_16x16x32_bf16 v[32:35], v[116:119], a[100:103], v[32:35]
ds_read_b64_tr_b16 v[134:135], v7 offset:22528
v_mfma_f32_16x16x32_bf16 v[36:39], v[116:119], a[104:107], v[36:39]
buffer_load_dwordx4 v5, s[36:39], s71 offen offset:3072 lds
v_mfma_f32_16x16x32_bf16 v[76:79], v[116:119], a[108:111], v[76:79]
ds_read_b64_tr_b16 v[136:137], v8 offset:20480
v_mfma_f32_16x16x32_bf16 v[80:83], v[116:119], a[112:115], v[80:83]
s_add_u32 s72, s62, 1
s_and_b32 s72, s72, 3
s_add_u32 s72, s72, s69
s_lshl_b32 s72, s72, 10
buffer_load_dwordx4 a[24:27], v10, s[32:35], s72 offen offset:0 sc1
v_mfma_f32_16x16x32_bf16 v[84:87], v[116:119], a[116:119], v[84:87]
ds_read_b64_tr_b16 v[138:139], v8 offset:22528
v_mfma_f32_16x16x32_bf16 v[40:43], v[120:123], a[96:99], v[40:43]
s_add_u32 s67, s72, 4096
buffer_load_dwordx4 a[28:31], v10, s[32:35], s67 offen offset:0 sc1
v_mfma_f32_16x16x32_bf16 v[44:47], v[120:123], a[100:103], v[44:47]
ds_read_b64_tr_b16 v[140:141], v9 offset:20480
v_mfma_f32_16x16x32_bf16 v[48:51], v[120:123], a[104:107], v[48:51]
v_mfma_f32_16x16x32_bf16 v[88:91], v[120:123], a[108:111], v[88:91]
ds_read_b64_tr_b16 v[142:143], v9 offset:22528
s_add_u32 s67, s72, 8192
buffer_load_dwordx4 a[32:35], v10, s[32:35], s67 offen offset:0 sc1
v_mfma_f32_16x16x32_bf16 v[92:95], v[120:123], a[112:115], v[92:95]
v_mfma_f32_16x16x32_bf16 v[96:99], v[120:123], a[116:119], v[96:99]
s_add_u32 s67, s72, 786432
buffer_load_dwordx4 a[36:39], v10, s[32:35], s67 offen offset:0 sc1
v_mfma_f32_16x16x32_bf16 v[52:55], v[124:127], a[96:99], v[52:55]
v_mfma_f32_16x16x32_bf16 v[56:59], v[124:127], a[100:103], v[56:59]
v_mfma_f32_16x16x32_bf16 v[60:63], v[124:127], a[104:107], v[60:63]
s_add_u32 s67, s72, 790528
buffer_load_dwordx4 a[40:43], v10, s[32:35], s67 offen offset:0 sc1
v_mfma_f32_16x16x32_bf16 v[100:103], v[124:127], a[108:111], v[100:103]
v_mfma_f32_16x16x32_bf16 v[104:107], v[124:127], a[112:115], v[104:107]
s_add_u32 s67, s72, 794624
buffer_load_dwordx4 a[44:47], v10, s[32:35], s67 offen offset:0 sc1
v_mfma_f32_16x16x32_bf16 v[108:111], v[124:127], a[116:119], v[108:111]
s_waitcnt lgkmcnt(0)
s_waitcnt vmcnt(30)
v_mfma_f32_16x16x32_bf16 v[16:19], v[128:131], a[120:123], v[16:19]
s_add_u32 s71, s62, 2
s_and_b32 s71, s71, 3
s_add_u32 s71, s71, s68
s_lshl_b32 s71, s71, 16
s_add_u32 m0, s57, 8192
s_nop 0
buffer_load_dwordx4 v2, s[36:39], s71 offen offset:0 lds
v_mfma_f32_16x16x32_bf16 v[20:23], v[128:131], a[124:127], v[20:23]
ds_read_b64_tr_b16 v[112:113], v6 offset:24576
v_mfma_f32_16x16x32_bf16 v[24:27], v[128:131], a[128:131], v[24:27]
v_mfma_f32_16x16x32_bf16 v[64:67], v[128:131], a[132:135], v[64:67]
ds_read_b64_tr_b16 v[114:115], v6 offset:26624
buffer_load_dwordx4 v3, s[36:39], s71 offen offset:1024 lds
v_mfma_f32_16x16x32_bf16 v[68:71], v[128:131], a[136:139], v[68:71]
v_mfma_f32_16x16x32_bf16 v[72:75], v[128:131], a[140:143], v[72:75]
ds_read_b64_tr_b16 v[116:117], v7 offset:24576
buffer_load_dwordx4 v4, s[36:39], s71 offen offset:2048 lds
v_mfma_f32_16x16x32_bf16 v[28:31], v[132:135], a[120:123], v[28:31]
v_mfma_f32_16x16x32_bf16 v[32:35], v[132:135], a[124:127], v[32:35]
ds_read_b64_tr_b16 v[118:119], v7 offset:26624
v_mfma_f32_16x16x32_bf16 v[36:39], v[132:135], a[128:131], v[36:39]
buffer_load_dwordx4 v5, s[36:39], s71 offen offset:3072 lds
v_mfma_f32_16x16x32_bf16 v[76:79], v[132:135], a[132:135], v[76:79]
ds_read_b64_tr_b16 v[120:121], v8 offset:24576
v_mfma_f32_16x16x32_bf16 v[80:83], v[132:135], a[136:139], v[80:83]
s_add_u32 s72, s62, 2
s_and_b32 s72, s72, 3
s_add_u32 s72, s72, s69
s_lshl_b32 s72, s72, 10
buffer_load_dwordx4 a[48:51], v10, s[32:35], s72 offen offset:0 sc1
v_mfma_f32_16x16x32_bf16 v[84:87], v[132:135], a[140:143], v[84:87]
ds_read_b64_tr_b16 v[122:123], v8 offset:26624
v_mfma_f32_16x16x32_bf16 v[40:43], v[136:139], a[120:123], v[40:43]
s_add_u32 s67, s72, 4096
buffer_load_dwordx4 a[52:55], v10, s[32:35], s67 offen offset:0 sc1
v_mfma_f32_16x16x32_bf16 v[44:47], v[136:139], a[124:127], v[44:47]
ds_read_b64_tr_b16 v[124:125], v9 offset:24576
v_mfma_f32_16x16x32_bf16 v[48:51], v[136:139], a[128:131], v[48:51]
v_mfma_f32_16x16x32_bf16 v[88:91], v[136:139], a[132:135], v[88:91]
ds_read_b64_tr_b16 v[126:127], v9 offset:26624
s_add_u32 s67, s72, 8192
buffer_load_dwordx4 a[56:59], v10, s[32:35], s67 offen offset:0 sc1
v_mfma_f32_16x16x32_bf16 v[92:95], v[136:139], a[136:139], v[92:95]
v_mfma_f32_16x16x32_bf16 v[96:99], v[136:139], a[140:143], v[96:99]
s_add_u32 s67, s72, 786432
buffer_load_dwordx4 a[60:63], v10, s[32:35], s67 offen offset:0 sc1
v_mfma_f32_16x16x32_bf16 v[52:55], v[140:143], a[120:123], v[52:55]
v_mfma_f32_16x16x32_bf16 v[56:59], v[140:143], a[124:127], v[56:59]
v_mfma_f32_16x16x32_bf16 v[60:63], v[140:143], a[128:131], v[60:63]
s_add_u32 s67, s72, 790528
buffer_load_dwordx4 a[64:67], v10, s[32:35], s67 offen offset:0 sc1
v_mfma_f32_16x16x32_bf16 v[100:103], v[140:143], a[132:135], v[100:103]
v_mfma_f32_16x16x32_bf16 v[104:107], v[140:143], a[136:139], v[104:107]
s_add_u32 s67, s72, 794624
buffer_load_dwordx4 a[68:71], v10, s[32:35], s67 offen offset:0 sc1
v_mfma_f32_16x16x32_bf16 v[108:111], v[140:143], a[140:143], v[108:111]
s_waitcnt lgkmcnt(0)
s_waitcnt vmcnt(30)
v_mfma_f32_16x16x32_bf16 v[16:19], v[112:115], a[144:147], v[16:19]
s_add_u32 s71, s62, 3
s_and_b32 s71, s71, 3
s_add_u32 s71, s71, s68
s_lshl_b32 s71, s71, 16
s_add_u32 m0, s57, 12288
s_nop 0
buffer_load_dwordx4 v2, s[36:39], s71 offen offset:0 lds
v_mfma_f32_16x16x32_bf16 v[20:23], v[112:115], a[148:151], v[20:23]
ds_read_b64_tr_b16 v[128:129], v6 offset:28672
v_mfma_f32_16x16x32_bf16 v[24:27], v[112:115], a[152:155], v[24:27]
v_mfma_f32_16x16x32_bf16 v[64:67], v[112:115], a[156:159], v[64:67]
ds_read_b64_tr_b16 v[130:131], v6 offset:30720
buffer_load_dwordx4 v3, s[36:39], s71 offen offset:1024 lds
v_mfma_f32_16x16x32_bf16 v[68:71], v[112:115], a[160:163], v[68:71]
v_mfma_f32_16x16x32_bf16 v[72:75], v[112:115], a[164:167], v[72:75]
ds_read_b64_tr_b16 v[132:133], v7 offset:28672
buffer_load_dwordx4 v4, s[36:39], s71 offen offset:2048 lds
v_mfma_f32_16x16x32_bf16 v[28:31], v[116:119], a[144:147], v[28:31]
v_mfma_f32_16x16x32_bf16 v[32:35], v[116:119], a[148:151], v[32:35]
ds_read_b64_tr_b16 v[134:135], v7 offset:30720
v_mfma_f32_16x16x32_bf16 v[36:39], v[116:119], a[152:155], v[36:39]
buffer_load_dwordx4 v5, s[36:39], s71 offen offset:3072 lds
v_mfma_f32_16x16x32_bf16 v[76:79], v[116:119], a[156:159], v[76:79]
ds_read_b64_tr_b16 v[136:137], v8 offset:28672
v_mfma_f32_16x16x32_bf16 v[80:83], v[116:119], a[160:163], v[80:83]
s_add_u32 s72, s62, 3
s_and_b32 s72, s72, 3
s_add_u32 s72, s72, s69
s_lshl_b32 s72, s72, 10
buffer_load_dwordx4 a[72:75], v10, s[32:35], s72 offen offset:0 sc1
v_mfma_f32_16x16x32_bf16 v[84:87], v[116:119], a[164:167], v[84:87]
ds_read_b64_tr_b16 v[138:139], v8 offset:30720
v_mfma_f32_16x16x32_bf16 v[40:43], v[120:123], a[144:147], v[40:43]
s_add_u32 s67, s72, 4096
buffer_load_dwordx4 a[76:79], v10, s[32:35], s67 offen offset:0 sc1
v_mfma_f32_16x16x32_bf16 v[44:47], v[120:123], a[148:151], v[44:47]
ds_read_b64_tr_b16 v[140:141], v9 offset:28672
v_mfma_f32_16x16x32_bf16 v[48:51], v[120:123], a[152:155], v[48:51]
v_mfma_f32_16x16x32_bf16 v[88:91], v[120:123], a[156:159], v[88:91]
ds_read_b64_tr_b16 v[142:143], v9 offset:30720
s_add_u32 s67, s72, 8192
buffer_load_dwordx4 a[80:83], v10, s[32:35], s67 offen offset:0 sc1
v_mfma_f32_16x16x32_bf16 v[92:95], v[120:123], a[160:163], v[92:95]
v_mfma_f32_16x16x32_bf16 v[96:99], v[120:123], a[164:167], v[96:99]
s_add_u32 s67, s72, 786432
buffer_load_dwordx4 a[84:87], v10, s[32:35], s67 offen offset:0 sc1
v_mfma_f32_16x16x32_bf16 v[52:55], v[124:127], a[144:147], v[52:55]
v_mfma_f32_16x16x32_bf16 v[56:59], v[124:127], a[148:151], v[56:59]
v_mfma_f32_16x16x32_bf16 v[60:63], v[124:127], a[152:155], v[60:63]
s_add_u32 s67, s72, 790528
buffer_load_dwordx4 a[88:91], v10, s[32:35], s67 offen offset:0 sc1
v_mfma_f32_16x16x32_bf16 v[100:103], v[124:127], a[156:159], v[100:103]
v_mfma_f32_16x16x32_bf16 v[104:107], v[124:127], a[160:163], v[104:107]
s_add_u32 s67, s72, 794624
buffer_load_dwordx4 a[92:95], v10, s[32:35], s67 offen offset:0 sc1
v_mfma_f32_16x16x32_bf16 v[108:111], v[124:127], a[164:167], v[108:111]
s_waitcnt lgkmcnt(0)
s_waitcnt vmcnt(30)
v_mfma_f32_16x16x32_bf16 v[16:19], v[128:131], a[168:171], v[16:19]
s_mov_b32 s68, 3
s_lshl3_add_u32 s68, s56, s68
s_lshl_b32 s68, s68, 2
s_add_u32 s71, s62, 0
s_and_b32 s71, s71, 3
s_add_u32 s71, s71, s68
s_lshl_b32 s71, s71, 16
s_add_u32 m0, s57, 16384
s_nop 0
buffer_load_dwordx4 v2, s[36:39], s71 offen offset:0 lds
v_mfma_f32_16x16x32_bf16 v[20:23], v[128:131], a[172:175], v[20:23]
ds_read_b64_tr_b16 v[112:113], v6 offset:0
v_mfma_f32_16x16x32_bf16 v[24:27], v[128:131], a[176:179], v[24:27]
v_mfma_f32_16x16x32_bf16 v[64:67], v[128:131], a[180:183], v[64:67]
ds_read_b64_tr_b16 v[114:115], v6 offset:2048
buffer_load_dwordx4 v3, s[36:39], s71 offen offset:1024 lds
v_mfma_f32_16x16x32_bf16 v[68:71], v[128:131], a[184:187], v[68:71]
v_mfma_f32_16x16x32_bf16 v[72:75], v[128:131], a[188:191], v[72:75]
ds_read_b64_tr_b16 v[116:117], v7 offset:0
buffer_load_dwordx4 v4, s[36:39], s71 offen offset:2048 lds
v_mfma_f32_16x16x32_bf16 v[28:31], v[132:135], a[168:171], v[28:31]
v_mfma_f32_16x16x32_bf16 v[32:35], v[132:135], a[172:175], v[32:35]
ds_read_b64_tr_b16 v[118:119], v7 offset:2048
v_mfma_f32_16x16x32_bf16 v[36:39], v[132:135], a[176:179], v[36:39]
buffer_load_dwordx4 v5, s[36:39], s71 offen offset:3072 lds
v_mfma_f32_16x16x32_bf16 v[76:79], v[132:135], a[180:183], v[76:79]
ds_read_b64_tr_b16 v[120:121], v8 offset:0
v_mfma_f32_16x16x32_bf16 v[80:83], v[132:135], a[184:187], v[80:83]
s_mov_b32 s69, 3
s_lshl3_add_u32 s69, s56, s69
s_mul_i32 s69, s69, 12
s_add_u32 s72, s62, 0
s_and_b32 s72, s72, 3
s_add_u32 s72, s72, s69
s_lshl_b32 s72, s72, 10
buffer_load_dwordx4 a[96:99], v10, s[32:35], s72 offen offset:0 sc1
v_mfma_f32_16x16x32_bf16 v[84:87], v[132:135], a[188:191], v[84:87]
ds_read_b64_tr_b16 v[122:123], v8 offset:2048
v_mfma_f32_16x16x32_bf16 v[40:43], v[136:139], a[168:171], v[40:43]
s_add_u32 s67, s72, 4096
buffer_load_dwordx4 a[100:103], v10, s[32:35], s67 offen offset:0 sc1
v_mfma_f32_16x16x32_bf16 v[44:47], v[136:139], a[172:175], v[44:47]
ds_read_b64_tr_b16 v[124:125], v9 offset:0
v_mfma_f32_16x16x32_bf16 v[48:51], v[136:139], a[176:179], v[48:51]
v_mfma_f32_16x16x32_bf16 v[88:91], v[136:139], a[180:183], v[88:91]
ds_read_b64_tr_b16 v[126:127], v9 offset:2048
s_add_u32 s67, s72, 8192
buffer_load_dwordx4 a[104:107], v10, s[32:35], s67 offen offset:0 sc1
v_mfma_f32_16x16x32_bf16 v[92:95], v[136:139], a[184:187], v[92:95]
v_mfma_f32_16x16x32_bf16 v[96:99], v[136:139], a[188:191], v[96:99]
s_add_u32 s67, s72, 786432
buffer_load_dwordx4 a[108:111], v10, s[32:35], s67 offen offset:0 sc1
v_mfma_f32_16x16x32_bf16 v[52:55], v[140:143], a[168:171], v[52:55]
v_mfma_f32_16x16x32_bf16 v[56:59], v[140:143], a[172:175], v[56:59]
v_mfma_f32_16x16x32_bf16 v[60:63], v[140:143], a[176:179], v[60:63]
s_add_u32 s67, s72, 790528
buffer_load_dwordx4 a[112:115], v10, s[32:35], s67 offen offset:0 sc1
v_mfma_f32_16x16x32_bf16 v[100:103], v[140:143], a[180:183], v[100:103]
v_mfma_f32_16x16x32_bf16 v[104:107], v[140:143], a[184:187], v[104:107]
s_add_u32 s67, s72, 794624
buffer_load_dwordx4 a[116:119], v10, s[32:35], s67 offen offset:0 sc1
v_mfma_f32_16x16x32_bf16 v[108:111], v[140:143], a[188:191], v[108:111]
s_waitcnt lgkmcnt(0)
s_waitcnt vmcnt(30)
v_mfma_f32_16x16x32_bf16 v[16:19], v[112:115], a[0:3], v[16:19]
s_add_u32 s71, s62, 1
s_and_b32 s71, s71, 3
s_add_u32 s71, s71, s68
s_lshl_b32 s71, s71, 16
s_add_u32 m0, s57, 20480
s_nop 0
buffer_load_dwordx4 v2, s[36:39], s71 offen offset:0 lds
v_mfma_f32_16x16x32_bf16 v[20:23], v[112:115], a[4:7], v[20:23]
ds_read_b64_tr_b16 v[128:129], v6 offset:4096
v_mfma_f32_16x16x32_bf16 v[24:27], v[112:115], a[8:11], v[24:27]
v_mfma_f32_16x16x32_bf16 v[64:67], v[112:115], a[12:15], v[64:67]
ds_read_b64_tr_b16 v[130:131], v6 offset:6144
buffer_load_dwordx4 v3, s[36:39], s71 offen offset:1024 lds
v_mfma_f32_16x16x32_bf16 v[68:71], v[112:115], a[16:19], v[68:71]
v_mfma_f32_16x16x32_bf16 v[72:75], v[112:115], a[20:23], v[72:75]
ds_read_b64_tr_b16 v[132:133], v7 offset:4096
buffer_load_dwordx4 v4, s[36:39], s71 offen offset:2048 lds
v_mfma_f32_16x16x32_bf16 v[28:31], v[116:119], a[0:3], v[28:31]
v_mfma_f32_16x16x32_bf16 v[32:35], v[116:119], a[4:7], v[32:35]
ds_read_b64_tr_b16 v[134:135], v7 offset:6144
buffer_load_dwordx4 v5, s[36:39], s71 offen offset:3072 lds
v_mfma_f32_16x16x32_bf16 v[36:39], v[116:119], a[8:11], v[36:39]
v_mfma_f32_16x16x32_bf16 v[76:79], v[116:119], a[12:15], v[76:79]
ds_read_b64_tr_b16 v[136:137], v8 offset:4096
s_add_u32 s72, s62, 1
s_and_b32 s72, s72, 3
s_add_u32 s72, s72, s69
s_lshl_b32 s72, s72, 10
buffer_load_dwordx4 a[120:123], v10, s[32:35], s72 offen offset:0 sc1
v_mfma_f32_16x16x32_bf16 v[80:83], v[116:119], a[16:19], v[80:83]
v_mfma_f32_16x16x32_bf16 v[84:87], v[116:119], a[20:23], v[84:87]
ds_read_b64_tr_b16 v[138:139], v8 offset:6144
s_add_u32 s67, s72, 4096
buffer_load_dwordx4 a[124:127], v10, s[32:35], s67 offen offset:0 sc1
v_mfma_f32_16x16x32_bf16 v[40:43], v[120:123], a[0:3], v[40:43]
v_mfma_f32_16x16x32_bf16 v[44:47], v[120:123], a[4:7], v[44:47]
ds_read_b64_tr_b16 v[140:141], v9 offset:4096
v_mfma_f32_16x16x32_bf16 v[48:51], v[120:123], a[8:11], v[48:51]
s_add_u32 s67, s72, 8192
buffer_load_dwordx4 a[128:131], v10, s[32:35], s67 offen offset:0 sc1
v_mfma_f32_16x16x32_bf16 v[88:91], v[120:123], a[12:15], v[88:91]
ds_read_b64_tr_b16 v[142:143], v9 offset:6144
v_mfma_f32_16x16x32_bf16 v[92:95], v[120:123], a[16:19], v[92:95]
s_add_u32 s67, s72, 786432
buffer_load_dwordx4 a[132:135], v10, s[32:35], s67 offen offset:0 sc1
v_mfma_f32_16x16x32_bf16 v[96:99], v[120:123], a[20:23], v[96:99]
v_mfma_f32_16x16x32_bf16 v[52:55], v[124:127], a[0:3], v[52:55]
s_add_u32 s67, s72, 790528
buffer_load_dwordx4 a[136:139], v10, s[32:35], s67 offen offset:0 sc1
v_mfma_f32_16x16x32_bf16 v[56:59], v[124:127], a[4:7], v[56:59]
v_mfma_f32_16x16x32_bf16 v[60:63], v[124:127], a[8:11], v[60:63]
s_add_u32 s67, s72, 794624
buffer_load_dwordx4 a[140:143], v10, s[32:35], s67 offen offset:0 sc1
v_mfma_f32_16x16x32_bf16 v[100:103], v[124:127], a[12:15], v[100:103]
v_mfma_f32_16x16x32_bf16 v[104:107], v[124:127], a[16:19], v[104:107]
v_add_u32 v220, 524288, v220
global_load_dword v221, v220, s[12:13]
v_mfma_f32_16x16x32_bf16 v[108:111], v[124:127], a[20:23], v[108:111]
s_waitcnt lgkmcnt(0)
s_waitcnt vmcnt(31)
v_mfma_f32_16x16x32_bf16 v[16:19], v[128:131], a[24:27], v[16:19]
s_add_u32 s71, s62, 2
s_and_b32 s71, s71, 3
s_add_u32 s71, s71, s68
s_lshl_b32 s71, s71, 16
s_add_u32 m0, s57, 24576
s_nop 0
buffer_load_dwordx4 v2, s[36:39], s71 offen offset:0 lds
v_mfma_f32_16x16x32_bf16 v[20:23], v[128:131], a[28:31], v[20:23]
ds_read_b64_tr_b16 v[112:113], v6 offset:8192
v_mfma_f32_16x16x32_bf16 v[24:27], v[128:131], a[32:35], v[24:27]
v_mfma_f32_16x16x32_bf16 v[64:67], v[128:131], a[36:39], v[64:67]
ds_read_b64_tr_b16 v[114:115], v6 offset:10240
buffer_load_dwordx4 v3, s[36:39], s71 offen offset:1024 lds
v_mfma_f32_16x16x32_bf16 v[68:71], v[128:131], a[40:43], v[68:71]
v_mfma_f32_16x16x32_bf16 v[72:75], v[128:131], a[44:47], v[72:75]
ds_read_b64_tr_b16 v[116:117], v7 offset:8192
buffer_load_dwordx4 v4, s[36:39], s71 offen offset:2048 lds
v_mfma_f32_16x16x32_bf16 v[28:31], v[132:135], a[24:27], v[28:31]
v_mfma_f32_16x16x32_bf16 v[32:35], v[132:135], a[28:31], v[32:35]
ds_read_b64_tr_b16 v[118:119], v7 offset:10240
v_mfma_f32_16x16x32_bf16 v[36:39], v[132:135], a[32:35], v[36:39]
buffer_load_dwordx4 v5, s[36:39], s71 offen offset:3072 lds
v_mfma_f32_16x16x32_bf16 v[76:79], v[132:135], a[36:39], v[76:79]
ds_read_b64_tr_b16 v[120:121], v8 offset:8192
v_mfma_f32_16x16x32_bf16 v[80:83], v[132:135], a[40:43], v[80:83]
s_add_u32 s72, s62, 2
s_and_b32 s72, s72, 3
s_add_u32 s72, s72, s69
s_lshl_b32 s72, s72, 10
buffer_load_dwordx4 a[144:147], v10, s[32:35], s72 offen offset:0 sc1
v_mfma_f32_16x16x32_bf16 v[84:87], v[132:135], a[44:47], v[84:87]
ds_read_b64_tr_b16 v[122:123], v8 offset:10240
v_mfma_f32_16x16x32_bf16 v[40:43], v[136:139], a[24:27], v[40:43]
s_add_u32 s67, s72, 4096
buffer_load_dwordx4 a[148:151], v10, s[32:35], s67 offen offset:0 sc1
v_mfma_f32_16x16x32_bf16 v[44:47], v[136:139], a[28:31], v[44:47]
ds_read_b64_tr_b16 v[124:125], v9 offset:8192
v_mfma_f32_16x16x32_bf16 v[48:51], v[136:139], a[32:35], v[48:51]
v_mfma_f32_16x16x32_bf16 v[88:91], v[136:139], a[36:39], v[88:91]
ds_read_b64_tr_b16 v[126:127], v9 offset:10240
s_add_u32 s67, s72, 8192
buffer_load_dwordx4 a[152:155], v10, s[32:35], s67 offen offset:0 sc1
v_mfma_f32_16x16x32_bf16 v[92:95], v[136:139], a[40:43], v[92:95]
v_mfma_f32_16x16x32_bf16 v[96:99], v[136:139], a[44:47], v[96:99]
s_add_u32 s67, s72, 786432
buffer_load_dwordx4 a[156:159], v10, s[32:35], s67 offen offset:0 sc1
v_mfma_f32_16x16x32_bf16 v[52:55], v[140:143], a[24:27], v[52:55]
v_mfma_f32_16x16x32_bf16 v[56:59], v[140:143], a[28:31], v[56:59]
v_mfma_f32_16x16x32_bf16 v[60:63], v[140:143], a[32:35], v[60:63]
s_add_u32 s67, s72, 790528
buffer_load_dwordx4 a[160:163], v10, s[32:35], s67 offen offset:0 sc1
v_mfma_f32_16x16x32_bf16 v[100:103], v[140:143], a[36:39], v[100:103]
v_mfma_f32_16x16x32_bf16 v[104:107], v[140:143], a[40:43], v[104:107]
s_add_u32 s67, s72, 794624
buffer_load_dwordx4 a[164:167], v10, s[32:35], s67 offen offset:0 sc1
v_mfma_f32_16x16x32_bf16 v[108:111], v[140:143], a[44:47], v[108:111]
s_waitcnt lgkmcnt(0)
s_waitcnt vmcnt(31)
v_mfma_f32_16x16x32_bf16 v[16:19], v[112:115], a[48:51], v[16:19]
s_add_u32 s71, s62, 3
s_and_b32 s71, s71, 3
s_add_u32 s71, s71, s68
s_lshl_b32 s71, s71, 16
s_add_u32 m0, s57, 28672
s_nop 0
buffer_load_dwordx4 v2, s[36:39], s71 offen offset:0 lds
v_mfma_f32_16x16x32_bf16 v[20:23], v[112:115], a[52:55], v[20:23]
ds_read_b64_tr_b16 v[128:129], v6 offset:12288
v_mfma_f32_16x16x32_bf16 v[24:27], v[112:115], a[56:59], v[24:27]
v_mfma_f32_16x16x32_bf16 v[64:67], v[112:115], a[60:63], v[64:67]
ds_read_b64_tr_b16 v[130:131], v6 offset:14336
buffer_load_dwordx4 v3, s[36:39], s71 offen offset:1024 lds
v_mfma_f32_16x16x32_bf16 v[68:71], v[112:115], a[64:67], v[68:71]
v_mfma_f32_16x16x32_bf16 v[72:75], v[112:115], a[68:71], v[72:75]
ds_read_b64_tr_b16 v[132:133], v7 offset:12288
buffer_load_dwordx4 v4, s[36:39], s71 offen offset:2048 lds
v_mfma_f32_16x16x32_bf16 v[28:31], v[116:119], a[48:51], v[28:31]
v_mfma_f32_16x16x32_bf16 v[32:35], v[116:119], a[52:55], v[32:35]
ds_read_b64_tr_b16 v[134:135], v7 offset:14336
v_mfma_f32_16x16x32_bf16 v[36:39], v[116:119], a[56:59], v[36:39]
buffer_load_dwordx4 v5, s[36:39], s71 offen offset:3072 lds
v_mfma_f32_16x16x32_bf16 v[76:79], v[116:119], a[60:63], v[76:79]
ds_read_b64_tr_b16 v[136:137], v8 offset:12288
v_mfma_f32_16x16x32_bf16 v[80:83], v[116:119], a[64:67], v[80:83]
s_add_u32 s72, s62, 3
s_and_b32 s72, s72, 3
s_add_u32 s72, s72, s69
s_lshl_b32 s72, s72, 10
buffer_load_dwordx4 a[168:171], v10, s[32:35], s72 offen offset:0 sc1
v_mfma_f32_16x16x32_bf16 v[84:87], v[116:119], a[68:71], v[84:87]
ds_read_b64_tr_b16 v[138:139], v8 offset:14336
v_mfma_f32_16x16x32_bf16 v[40:43], v[120:123], a[48:51], v[40:43]
s_add_u32 s67, s72, 4096
buffer_load_dwordx4 a[172:175], v10, s[32:35], s67 offen offset:0 sc1
v_mfma_f32_16x16x32_bf16 v[44:47], v[120:123], a[52:55], v[44:47]
ds_read_b64_tr_b16 v[140:141], v9 offset:12288
v_mfma_f32_16x16x32_bf16 v[48:51], v[120:123], a[56:59], v[48:51]
v_mfma_f32_16x16x32_bf16 v[88:91], v[120:123], a[60:63], v[88:91]
ds_read_b64_tr_b16 v[142:143], v9 offset:14336
s_add_u32 s67, s72, 8192
buffer_load_dwordx4 a[176:179], v10, s[32:35], s67 offen offset:0 sc1
v_mfma_f32_16x16x32_bf16 v[92:95], v[120:123], a[64:67], v[92:95]
v_mfma_f32_16x16x32_bf16 v[96:99], v[120:123], a[68:71], v[96:99]
s_add_u32 s67, s72, 786432
buffer_load_dwordx4 a[180:183], v10, s[32:35], s67 offen offset:0 sc1
v_mfma_f32_16x16x32_bf16 v[52:55], v[124:127], a[48:51], v[52:55]
v_mfma_f32_16x16x32_bf16 v[56:59], v[124:127], a[52:55], v[56:59]
v_mfma_f32_16x16x32_bf16 v[60:63], v[124:127], a[56:59], v[60:63]
s_add_u32 s67, s72, 790528
buffer_load_dwordx4 a[184:187], v10, s[32:35], s67 offen offset:0 sc1
v_mfma_f32_16x16x32_bf16 v[100:103], v[124:127], a[60:63], v[100:103]
v_mfma_f32_16x16x32_bf16 v[104:107], v[124:127], a[64:67], v[104:107]
s_add_u32 s67, s72, 794624
buffer_load_dwordx4 a[188:191], v10, s[32:35], s67 offen offset:0 sc1
v_mfma_f32_16x16x32_bf16 v[108:111], v[124:127], a[68:71], v[108:111]
s_waitcnt lgkmcnt(0)
s_waitcnt vmcnt(31)
v_mfma_f32_16x16x32_bf16 v[16:19], v[128:131], a[72:75], v[16:19]
s_mov_b32 s68, 0
s_add_u32 s68, s68, 4
s_lshl3_add_u32 s68, s56, s68
s_lshl_b32 s68, s68, 2
s_add_u32 s71, s62, 0
s_and_b32 s71, s71, 3
s_add_u32 s71, s71, s68
s_lshl_b32 s71, s71, 16
s_add_u32 m0, s57, 0
s_nop 0
buffer_load_dwordx4 v2, s[36:39], s71 offen offset:0 lds
v_mfma_f32_16x16x32_bf16 v[20:23], v[128:131], a[76:79], v[20:23]
ds_read_b64_tr_b16 v[112:113], v6 offset:16384
v_mfma_f32_16x16x32_bf16 v[24:27], v[128:131], a[80:83], v[24:27]
v_mfma_f32_16x16x32_bf16 v[64:67], v[128:131], a[84:87], v[64:67]
ds_read_b64_tr_b16 v[114:115], v6 offset:18432
buffer_load_dwordx4 v3, s[36:39], s71 offen offset:1024 lds
v_mfma_f32_16x16x32_bf16 v[68:71], v[128:131], a[88:91], v[68:71]
v_mfma_f32_16x16x32_bf16 v[72:75], v[128:131], a[92:95], v[72:75]
ds_read_b64_tr_b16 v[116:117], v7 offset:16384
buffer_load_dwordx4 v4, s[36:39], s71 offen offset:2048 lds
v_mfma_f32_16x16x32_bf16 v[28:31], v[132:135], a[72:75], v[28:31]
v_mfma_f32_16x16x32_bf16 v[32:35], v[132:135], a[76:79], v[32:35]
ds_read_b64_tr_b16 v[118:119], v7 offset:18432
v_mfma_f32_16x16x32_bf16 v[36:39], v[132:135], a[80:83], v[36:39]
buffer_load_dwordx4 v5, s[36:39], s71 offen offset:3072 lds
v_mfma_f32_16x16x32_bf16 v[76:79], v[132:135], a[84:87], v[76:79]
ds_read_b64_tr_b16 v[120:121], v8 offset:16384
v_mfma_f32_16x16x32_bf16 v[80:83], v[132:135], a[88:91], v[80:83]
s_mov_b32 s69, 0
s_add_u32 s69, s69, 4
s_lshl3_add_u32 s69, s56, s69
s_mul_i32 s69, s69, 12
s_add_u32 s72, s62, 0
s_and_b32 s72, s72, 3
s_add_u32 s72, s72, s69
s_lshl_b32 s72, s72, 10
buffer_load_dwordx4 a[0:3], v10, s[32:35], s72 offen offset:0 sc1
v_mfma_f32_16x16x32_bf16 v[84:87], v[132:135], a[92:95], v[84:87]
ds_read_b64_tr_b16 v[122:123], v8 offset:18432
v_mfma_f32_16x16x32_bf16 v[40:43], v[136:139], a[72:75], v[40:43]
s_add_u32 s67, s72, 4096
buffer_load_dwordx4 a[4:7], v10, s[32:35], s67 offen offset:0 sc1
v_mfma_f32_16x16x32_bf16 v[44:47], v[136:139], a[76:79], v[44:47]
ds_read_b64_tr_b16 v[124:125], v9 offset:16384
v_mfma_f32_16x16x32_bf16 v[48:51], v[136:139], a[80:83], v[48:51]
v_mfma_f32_16x16x32_bf16 v[88:91], v[136:139], a[84:87], v[88:91]
ds_read_b64_tr_b16 v[126:127], v9 offset:18432
s_add_u32 s67, s72, 8192
buffer_load_dwordx4 a[8:11], v10, s[32:35], s67 offen offset:0 sc1
v_mfma_f32_16x16x32_bf16 v[92:95], v[136:139], a[88:91], v[92:95]
v_mfma_f32_16x16x32_bf16 v[96:99], v[136:139], a[92:95], v[96:99]
s_add_u32 s67, s72, 786432
buffer_load_dwordx4 a[12:15], v10, s[32:35], s67 offen offset:0 sc1
v_mfma_f32_16x16x32_bf16 v[52:55], v[140:143], a[72:75], v[52:55]
v_mfma_f32_16x16x32_bf16 v[56:59], v[140:143], a[76:79], v[56:59]
v_mfma_f32_16x16x32_bf16 v[60:63], v[140:143], a[80:83], v[60:63]
s_add_u32 s67, s72, 790528
buffer_load_dwordx4 a[16:19], v10, s[32:35], s67 offen offset:0 sc1
v_mfma_f32_16x16x32_bf16 v[100:103], v[140:143], a[84:87], v[100:103]
v_mfma_f32_16x16x32_bf16 v[104:107], v[140:143], a[88:91], v[104:107]
s_add_u32 s67, s72, 794624
buffer_load_dwordx4 a[20:23], v10, s[32:35], s67 offen offset:0 sc1
v_mfma_f32_16x16x32_bf16 v[108:111], v[140:143], a[92:95], v[108:111]
s_waitcnt lgkmcnt(0)
s_waitcnt vmcnt(31)
v_mfma_f32_16x16x32_bf16 v[16:19], v[112:115], a[96:99], v[16:19]
s_add_u32 s71, s62, 1
s_and_b32 s71, s71, 3
s_add_u32 s71, s71, s68
s_lshl_b32 s71, s71, 16
s_add_u32 m0, s57, 4096
s_nop 0
buffer_load_dwordx4 v2, s[36:39], s71 offen offset:0 lds
v_mfma_f32_16x16x32_bf16 v[20:23], v[112:115], a[100:103], v[20:23]
ds_read_b64_tr_b16 v[128:129], v6 offset:20480
v_mfma_f32_16x16x32_bf16 v[24:27], v[112:115], a[104:107], v[24:27]
v_mfma_f32_16x16x32_bf16 v[64:67], v[112:115], a[108:111], v[64:67]
ds_read_b64_tr_b16 v[130:131], v6 offset:22528
buffer_load_dwordx4 v3, s[36:39], s71 offen offset:1024 lds
v_mfma_f32_16x16x32_bf16 v[68:71], v[112:115], a[112:115], v[68:71]
v_mfma_f32_16x16x32_bf16 v[72:75], v[112:115], a[116:119], v[72:75]
ds_read_b64_tr_b16 v[132:133], v7 offset:20480
buffer_load_dwordx4 v4, s[36:39], s71 offen offset:2048 lds
v_mfma_f32_16x16x32_bf16 v[28:31], v[116:119], a[96:99], v[28:31]
v_mfma_f32_16x16x32_bf16 v[32:35], v[116:119], a[100:103], v[32:35]
ds_read_b64_tr_b16 v[134:135], v7 offset:22528
v_mfma_f32_16x16x32_bf16 v[36:39], v[116:119], a[104:107], v[36:39]
buffer_load_dwordx4 v5, s[36:39], s71 offen offset:3072 lds
v_mfma_f32_16x16x32_bf16 v[76:79], v[116:119], a[108:111], v[76:79]
ds_read_b64_tr_b16 v[136:137], v8 offset:20480
v_mfma_f32_16x16x32_bf16 v[80:83], v[116:119], a[112:115], v[80:83]
s_add_u32 s72, s62, 1
s_and_b32 s72, s72, 3
s_add_u32 s72, s72, s69
s_lshl_b32 s72, s72, 10
buffer_load_dwordx4 a[24:27], v10, s[32:35], s72 offen offset:0 sc1
v_mfma_f32_16x16x32_bf16 v[84:87], v[116:119], a[116:119], v[84:87]
ds_read_b64_tr_b16 v[138:139], v8 offset:22528
v_mfma_f32_16x16x32_bf16 v[40:43], v[120:123], a[96:99], v[40:43]
s_add_u32 s67, s72, 4096
buffer_load_dwordx4 a[28:31], v10, s[32:35], s67 offen offset:0 sc1
v_mfma_f32_16x16x32_bf16 v[44:47], v[120:123], a[100:103], v[44:47]
ds_read_b64_tr_b16 v[140:141], v9 offset:20480
v_mfma_f32_16x16x32_bf16 v[48:51], v[120:123], a[104:107], v[48:51]
v_mfma_f32_16x16x32_bf16 v[88:91], v[120:123], a[108:111], v[88:91]
ds_read_b64_tr_b16 v[142:143], v9 offset:22528
s_add_u32 s67, s72, 8192
buffer_load_dwordx4 a[32:35], v10, s[32:35], s67 offen offset:0 sc1
v_mfma_f32_16x16x32_bf16 v[92:95], v[120:123], a[112:115], v[92:95]
v_mfma_f32_16x16x32_bf16 v[96:99], v[120:123], a[116:119], v[96:99]
s_add_u32 s67, s72, 786432
buffer_load_dwordx4 a[36:39], v10, s[32:35], s67 offen offset:0 sc1
v_mfma_f32_16x16x32_bf16 v[52:55], v[124:127], a[96:99], v[52:55]
v_mfma_f32_16x16x32_bf16 v[56:59], v[124:127], a[100:103], v[56:59]
v_mfma_f32_16x16x32_bf16 v[60:63], v[124:127], a[104:107], v[60:63]
s_add_u32 s67, s72, 790528
buffer_load_dwordx4 a[40:43], v10, s[32:35], s67 offen offset:0 sc1
v_mfma_f32_16x16x32_bf16 v[100:103], v[124:127], a[108:111], v[100:103]
v_mfma_f32_16x16x32_bf16 v[104:107], v[124:127], a[112:115], v[104:107]
s_add_u32 s67, s72, 794624
buffer_load_dwordx4 a[44:47], v10, s[32:35], s67 offen offset:0 sc1
v_mfma_f32_16x16x32_bf16 v[108:111], v[124:127], a[116:119], v[108:111]
s_waitcnt lgkmcnt(0)
s_waitcnt vmcnt(30)
s_barrier
v_mfma_f32_16x16x32_bf16 v[16:19], v[128:131], a[120:123], v[16:19]
s_add_u32 s71, s62, 2
s_and_b32 s71, s71, 3
s_add_u32 s71, s71, s68
s_lshl_b32 s71, s71, 16
s_add_u32 m0, s57, 8192
s_nop 0
buffer_load_dwordx4 v2, s[36:39], s71 offen offset:0 lds
v_mfma_f32_16x16x32_bf16 v[20:23], v[128:131], a[124:127], v[20:23]
ds_read_b64_tr_b16 v[112:113], v6 offset:24576
v_mfma_f32_16x16x32_bf16 v[24:27], v[128:131], a[128:131], v[24:27]
v_mfma_f32_16x16x32_bf16 v[64:67], v[128:131], a[132:135], v[64:67]
ds_read_b64_tr_b16 v[114:115], v6 offset:26624
buffer_load_dwordx4 v3, s[36:39], s71 offen offset:1024 lds
v_mfma_f32_16x16x32_bf16 v[68:71], v[128:131], a[136:139], v[68:71]
v_mfma_f32_16x16x32_bf16 v[72:75], v[128:131], a[140:143], v[72:75]
ds_read_b64_tr_b16 v[116:117], v7 offset:24576
buffer_load_dwordx4 v4, s[36:39], s71 offen offset:2048 lds
v_mfma_f32_16x16x32_bf16 v[28:31], v[132:135], a[120:123], v[28:31]
v_mfma_f32_16x16x32_bf16 v[32:35], v[132:135], a[124:127], v[32:35]
ds_read_b64_tr_b16 v[118:119], v7 offset:26624
v_mfma_f32_16x16x32_bf16 v[36:39], v[132:135], a[128:131], v[36:39]
buffer_load_dwordx4 v5, s[36:39], s71 offen offset:3072 lds
v_mfma_f32_16x16x32_bf16 v[76:79], v[132:135], a[132:135], v[76:79]
ds_read_b64_tr_b16 v[120:121], v8 offset:24576
v_mfma_f32_16x16x32_bf16 v[80:83], v[132:135], a[136:139], v[80:83]
s_add_u32 s72, s62, 2
s_and_b32 s72, s72, 3
s_add_u32 s72, s72, s69
s_lshl_b32 s72, s72, 10
buffer_load_dwordx4 a[48:51], v10, s[32:35], s72 offen offset:0 sc1
v_mfma_f32_16x16x32_bf16 v[84:87], v[132:135], a[140:143], v[84:87]
ds_read_b64_tr_b16 v[122:123], v8 offset:26624
v_mfma_f32_16x16x32_bf16 v[40:43], v[136:139], a[120:123], v[40:43]
s_add_u32 s67, s72, 4096
buffer_load_dwordx4 a[52:55], v10, s[32:35], s67 offen offset:0 sc1
v_mfma_f32_16x16x32_bf16 v[44:47], v[136:139], a[124:127], v[44:47]
ds_read_b64_tr_b16 v[124:125], v9 offset:24576
v_mfma_f32_16x16x32_bf16 v[48:51], v[136:139], a[128:131], v[48:51]
v_mfma_f32_16x16x32_bf16 v[88:91], v[136:139], a[132:135], v[88:91]
ds_read_b64_tr_b16 v[126:127], v9 offset:26624
s_add_u32 s67, s72, 8192
buffer_load_dwordx4 a[56:59], v10, s[32:35], s67 offen offset:0 sc1
v_mfma_f32_16x16x32_bf16 v[92:95], v[136:139], a[136:139], v[92:95]
v_mfma_f32_16x16x32_bf16 v[96:99], v[136:139], a[140:143], v[96:99]
s_add_u32 s67, s72, 786432
buffer_load_dwordx4 a[60:63], v10, s[32:35], s67 offen offset:0 sc1
v_mfma_f32_16x16x32_bf16 v[52:55], v[140:143], a[120:123], v[52:55]
v_mfma_f32_16x16x32_bf16 v[56:59], v[140:143], a[124:127], v[56:59]
v_mfma_f32_16x16x32_bf16 v[60:63], v[140:143], a[128:131], v[60:63]
s_add_u32 s67, s72, 790528
buffer_load_dwordx4 a[64:67], v10, s[32:35], s67 offen offset:0 sc1
v_mfma_f32_16x16x32_bf16 v[100:103], v[140:143], a[132:135], v[100:103]
v_mfma_f32_16x16x32_bf16 v[104:107], v[140:143], a[136:139], v[104:107]
s_add_u32 s67, s72, 794624
buffer_load_dwordx4 a[68:71], v10, s[32:35], s67 offen offset:0 sc1
v_mfma_f32_16x16x32_bf16 v[108:111], v[140:143], a[140:143], v[108:111]
s_waitcnt lgkmcnt(0)
s_waitcnt vmcnt(30)
v_mfma_f32_16x16x32_bf16 v[16:19], v[112:115], a[144:147], v[16:19]
s_add_u32 s71, s62, 3
s_and_b32 s71, s71, 3
s_add_u32 s71, s71, s68
s_lshl_b32 s71, s71, 16
s_add_u32 m0, s57, 12288
s_nop 0
buffer_load_dwordx4 v2, s[36:39], s71 offen offset:0 lds
v_mfma_f32_16x16x32_bf16 v[20:23], v[112:115], a[148:151], v[20:23]
ds_read_b64_tr_b16 v[128:129], v6 offset:28672
v_mfma_f32_16x16x32_bf16 v[24:27], v[112:115], a[152:155], v[24:27]
v_mfma_f32_16x16x32_bf16 v[64:67], v[112:115], a[156:159], v[64:67]
ds_read_b64_tr_b16 v[130:131], v6 offset:30720
buffer_load_dwordx4 v3, s[36:39], s71 offen offset:1024 lds
v_mfma_f32_16x16x32_bf16 v[68:71], v[112:115], a[160:163], v[68:71]
v_mfma_f32_16x16x32_bf16 v[72:75], v[112:115], a[164:167], v[72:75]
ds_read_b64_tr_b16 v[132:133], v7 offset:28672
buffer_load_dwordx4 v4, s[36:39], s71 offen offset:2048 lds
v_mfma_f32_16x16x32_bf16 v[28:31], v[116:119], a[144:147], v[28:31]
v_mfma_f32_16x16x32_bf16 v[32:35], v[116:119], a[148:151], v[32:35]
ds_read_b64_tr_b16 v[134:135], v7 offset:30720
v_mfma_f32_16x16x32_bf16 v[36:39], v[116:119], a[152:155], v[36:39]
buffer_load_dwordx4 v5, s[36:39], s71 offen offset:3072 lds
v_mfma_f32_16x16x32_bf16 v[76:79], v[116:119], a[156:159], v[76:79]
ds_read_b64_tr_b16 v[136:137], v8 offset:28672
v_mfma_f32_16x16x32_bf16 v[80:83], v[116:119], a[160:163], v[80:83]
s_add_u32 s72, s62, 3
s_and_b32 s72, s72, 3
s_add_u32 s72, s72, s69
s_lshl_b32 s72, s72, 10
buffer_load_dwordx4 a[72:75], v10, s[32:35], s72 offen offset:0 sc1
v_mfma_f32_16x16x32_bf16 v[84:87], v[116:119], a[164:167], v[84:87]
ds_read_b64_tr_b16 v[138:139], v8 offset:30720
v_mfma_f32_16x16x32_bf16 v[40:43], v[120:123], a[144:147], v[40:43]
s_add_u32 s67, s72, 4096
buffer_load_dwordx4 a[76:79], v10, s[32:35], s67 offen offset:0 sc1
v_mfma_f32_16x16x32_bf16 v[44:47], v[120:123], a[148:151], v[44:47]
ds_read_b64_tr_b16 v[140:141], v9 offset:28672
v_mfma_f32_16x16x32_bf16 v[48:51], v[120:123], a[152:155], v[48:51]
v_mfma_f32_16x16x32_bf16 v[88:91], v[120:123], a[156:159], v[88:91]
ds_read_b64_tr_b16 v[142:143], v9 offset:30720
s_add_u32 s67, s72, 8192
buffer_load_dwordx4 a[80:83], v10, s[32:35], s67 offen offset:0 sc1
v_mfma_f32_16x16x32_bf16 v[92:95], v[120:123], a[160:163], v[92:95]
v_mfma_f32_16x16x32_bf16 v[96:99], v[120:123], a[164:167], v[96:99]
s_add_u32 s67, s72, 786432
buffer_load_dwordx4 a[84:87], v10, s[32:35], s67 offen offset:0 sc1
v_mfma_f32_16x16x32_bf16 v[52:55], v[124:127], a[144:147], v[52:55]
v_mfma_f32_16x16x32_bf16 v[56:59], v[124:127], a[148:151], v[56:59]
v_mfma_f32_16x16x32_bf16 v[60:63], v[124:127], a[152:155], v[60:63]
s_add_u32 s67, s72, 790528
buffer_load_dwordx4 a[88:91], v10, s[32:35], s67 offen offset:0 sc1
v_mfma_f32_16x16x32_bf16 v[100:103], v[124:127], a[156:159], v[100:103]
v_mfma_f32_16x16x32_bf16 v[104:107], v[124:127], a[160:163], v[104:107]
s_add_u32 s67, s72, 794624
buffer_load_dwordx4 a[92:95], v10, s[32:35], s67 offen offset:0 sc1
v_mfma_f32_16x16x32_bf16 v[108:111], v[124:127], a[164:167], v[108:111]
s_waitcnt lgkmcnt(0)
s_waitcnt vmcnt(30)
s_barrier
v_mfma_f32_16x16x32_bf16 v[16:19], v[128:131], a[168:171], v[16:19]
s_mov_b32 s68, 1
s_add_u32 s68, s68, 4
s_lshl3_add_u32 s68, s56, s68
s_lshl_b32 s68, s68, 2
s_add_u32 s71, s62, 0
s_and_b32 s71, s71, 3
s_add_u32 s71, s71, s68
s_lshl_b32 s71, s71, 16
s_add_u32 m0, s57, 16384
s_nop 0
buffer_load_dwordx4 v2, s[36:39], s71 offen offset:0 lds
v_mfma_f32_16x16x32_bf16 v[20:23], v[128:131], a[172:175], v[20:23]
ds_read_b64_tr_b16 v[112:113], v6 offset:0
v_mfma_f32_16x16x32_bf16 v[24:27], v[128:131], a[176:179], v[24:27]
v_mfma_f32_16x16x32_bf16 v[64:67], v[128:131], a[180:183], v[64:67]
ds_read_b64_tr_b16 v[114:115], v6 offset:2048
buffer_load_dwordx4 v3, s[36:39], s71 offen offset:1024 lds
v_mfma_f32_16x16x32_bf16 v[68:71], v[128:131], a[184:187], v[68:71]
v_mfma_f32_16x16x32_bf16 v[72:75], v[128:131], a[188:191], v[72:75]
ds_read_b64_tr_b16 v[116:117], v7 offset:0
buffer_load_dwordx4 v4, s[36:39], s71 offen offset:2048 lds
v_mfma_f32_16x16x32_bf16 v[28:31], v[132:135], a[168:171], v[28:31]
v_mfma_f32_16x16x32_bf16 v[32:35], v[132:135], a[172:175], v[32:35]
ds_read_b64_tr_b16 v[118:119], v7 offset:2048
v_mfma_f32_16x16x32_bf16 v[36:39], v[132:135], a[176:179], v[36:39]
buffer_load_dwordx4 v5, s[36:39], s71 offen offset:3072 lds
v_mfma_f32_16x16x32_bf16 v[76:79], v[132:135], a[180:183], v[76:79]
ds_read_b64_tr_b16 v[120:121], v8 offset:0
v_mfma_f32_16x16x32_bf16 v[80:83], v[132:135], a[184:187], v[80:83]
s_mov_b32 s69, 1
s_add_u32 s69, s69, 4
s_lshl3_add_u32 s69, s56, s69
s_mul_i32 s69, s69, 12
s_add_u32 s72, s62, 0
s_and_b32 s72, s72, 3
s_add_u32 s72, s72, s69
s_lshl_b32 s72, s72, 10
buffer_load_dwordx4 a[96:99], v10, s[32:35], s72 offen offset:0 sc1
v_mfma_f32_16x16x32_bf16 v[84:87], v[132:135], a[188:191], v[84:87]
ds_read_b64_tr_b16 v[122:123], v8 offset:2048
v_mfma_f32_16x16x32_bf16 v[40:43], v[136:139], a[168:171], v[40:43]
s_add_u32 s67, s72, 4096
buffer_load_dwordx4 a[100:103], v10, s[32:35], s67 offen offset:0 sc1
v_mfma_f32_16x16x32_bf16 v[44:47], v[136:139], a[172:175], v[44:47]
ds_read_b64_tr_b16 v[124:125], v9 offset:0
v_mfma_f32_16x16x32_bf16 v[48:51], v[136:139], a[176:179], v[48:51]
v_mfma_f32_16x16x32_bf16 v[88:91], v[136:139], a[180:183], v[88:91]
ds_read_b64_tr_b16 v[126:127], v9 offset:2048
s_add_u32 s67, s72, 8192
buffer_load_dwordx4 a[104:107], v10, s[32:35], s67 offen offset:0 sc1
v_mfma_f32_16x16x32_bf16 v[92:95], v[136:139], a[184:187], v[92:95]
v_mfma_f32_16x16x32_bf16 v[96:99], v[136:139], a[188:191], v[96:99]
s_add_u32 s67, s72, 786432
buffer_load_dwordx4 a[108:111], v10, s[32:35], s67 offen offset:0 sc1
v_mfma_f32_16x16x32_bf16 v[52:55], v[140:143], a[168:171], v[52:55]
v_mfma_f32_16x16x32_bf16 v[56:59], v[140:143], a[172:175], v[56:59]
v_mfma_f32_16x16x32_bf16 v[60:63], v[140:143], a[176:179], v[60:63]
s_add_u32 s67, s72, 790528
buffer_load_dwordx4 a[112:115], v10, s[32:35], s67 offen offset:0 sc1
v_mfma_f32_16x16x32_bf16 v[100:103], v[140:143], a[180:183], v[100:103]
v_mfma_f32_16x16x32_bf16 v[104:107], v[140:143], a[184:187], v[104:107]
s_add_u32 s67, s72, 794624
buffer_load_dwordx4 a[116:119], v10, s[32:35], s67 offen offset:0 sc1
v_mfma_f32_16x16x32_bf16 v[108:111], v[140:143], a[188:191], v[108:111]
s_waitcnt lgkmcnt(0)
s_waitcnt vmcnt(30)
v_mfma_f32_16x16x32_bf16 v[16:19], v[112:115], a[0:3], v[16:19]
s_add_u32 s71, s62, 1
s_and_b32 s71, s71, 3
s_add_u32 s71, s71, s68
s_lshl_b32 s71, s71, 16
s_add_u32 m0, s57, 20480
s_nop 0
buffer_load_dwordx4 v2, s[36:39], s71 offen offset:0 lds
v_mfma_f32_16x16x32_bf16 v[20:23], v[112:115], a[4:7], v[20:23]
ds_read_b64_tr_b16 v[128:129], v6 offset:4096
v_mfma_f32_16x16x32_bf16 v[24:27], v[112:115], a[8:11], v[24:27]
v_mfma_f32_16x16x32_bf16 v[64:67], v[112:115], a[12:15], v[64:67]
ds_read_b64_tr_b16 v[130:131], v6 offset:6144
buffer_load_dwordx4 v3, s[36:39], s71 offen offset:1024 lds
v_mfma_f32_16x16x32_bf16 v[68:71], v[112:115], a[16:19], v[68:71]
v_mfma_f32_16x16x32_bf16 v[72:75], v[112:115], a[20:23], v[72:75]
ds_read_b64_tr_b16 v[132:133], v7 offset:4096
buffer_load_dwordx4 v4, s[36:39], s71 offen offset:2048 lds
v_mfma_f32_16x16x32_bf16 v[28:31], v[116:119], a[0:3], v[28:31]
v_mfma_f32_16x16x32_bf16 v[32:35], v[116:119], a[4:7], v[32:35]
ds_read_b64_tr_b16 v[134:135], v7 offset:6144
buffer_load_dwordx4 v5, s[36:39], s71 offen offset:3072 lds
v_mfma_f32_16x16x32_bf16 v[36:39], v[116:119], a[8:11], v[36:39]
v_mfma_f32_16x16x32_bf16 v[76:79], v[116:119], a[12:15], v[76:79]
ds_read_b64_tr_b16 v[136:137], v8 offset:4096
s_add_u32 s72, s62, 1
s_and_b32 s72, s72, 3
s_add_u32 s72, s72, s69
s_lshl_b32 s72, s72, 10
buffer_load_dwordx4 a[120:123], v10, s[32:35], s72 offen offset:0 sc1
v_mfma_f32_16x16x32_bf16 v[80:83], v[116:119], a[16:19], v[80:83]
v_mfma_f32_16x16x32_bf16 v[84:87], v[116:119], a[20:23], v[84:87]
ds_read_b64_tr_b16 v[138:139], v8 offset:6144
s_add_u32 s67, s72, 4096
buffer_load_dwordx4 a[124:127], v10, s[32:35], s67 offen offset:0 sc1
v_mfma_f32_16x16x32_bf16 v[40:43], v[120:123], a[0:3], v[40:43]
v_mfma_f32_16x16x32_bf16 v[44:47], v[120:123], a[4:7], v[44:47]
ds_read_b64_tr_b16 v[140:141], v9 offset:4096
v_mfma_f32_16x16x32_bf16 v[48:51], v[120:123], a[8:11], v[48:51]
s_add_u32 s67, s72, 8192
buffer_load_dwordx4 a[128:131], v10, s[32:35], s67 offen offset:0 sc1
v_mfma_f32_16x16x32_bf16 v[88:91], v[120:123], a[12:15], v[88:91]
ds_read_b64_tr_b16 v[142:143], v9 offset:6144
v_mfma_f32_16x16x32_bf16 v[92:95], v[120:123], a[16:19], v[92:95]
s_add_u32 s67, s72, 786432
buffer_load_dwordx4 a[132:135], v10, s[32:35], s67 offen offset:0 sc1
v_mfma_f32_16x16x32_bf16 v[96:99], v[120:123], a[20:23], v[96:99]
v_mfma_f32_16x16x32_bf16 v[52:55], v[124:127], a[0:3], v[52:55]
s_add_u32 s67, s72, 790528
buffer_load_dwordx4 a[136:139], v10, s[32:35], s67 offen offset:0 sc1
v_mfma_f32_16x16x32_bf16 v[56:59], v[124:127], a[4:7], v[56:59]
v_mfma_f32_16x16x32_bf16 v[60:63], v[124:127], a[8:11], v[60:63]
s_add_u32 s67, s72, 794624
buffer_load_dwordx4 a[140:143], v10, s[32:35], s67 offen offset:0 sc1
v_mfma_f32_16x16x32_bf16 v[100:103], v[124:127], a[12:15], v[100:103]
v_mfma_f32_16x16x32_bf16 v[104:107], v[124:127], a[16:19], v[104:107]
v_add_u32 v220, 524288, v220
global_load_dword v221, v220, s[12:13]
v_mfma_f32_16x16x32_bf16 v[108:111], v[124:127], a[20:23], v[108:111]
s_waitcnt lgkmcnt(0)
s_waitcnt vmcnt(31)
s_barrier
v_mfma_f32_16x16x32_bf16 v[16:19], v[128:131], a[24:27], v[16:19]
s_add_u32 s71, s62, 2
s_and_b32 s71, s71, 3
s_add_u32 s71, s71, s68
s_lshl_b32 s71, s71, 16
s_add_u32 m0, s57, 24576
s_nop 0
buffer_load_dwordx4 v2, s[36:39], s71 offen offset:0 lds
v_mfma_f32_16x16x32_bf16 v[20:23], v[128:131], a[28:31], v[20:23]
ds_read_b64_tr_b16 v[112:113], v6 offset:8192
v_mfma_f32_16x16x32_bf16 v[24:27], v[128:131], a[32:35], v[24:27]
v_mfma_f32_16x16x32_bf16 v[64:67], v[128:131], a[36:39], v[64:67]
ds_read_b64_tr_b16 v[114:115], v6 offset:10240
buffer_load_dwordx4 v3, s[36:39], s71 offen offset:1024 lds
v_mfma_f32_16x16x32_bf16 v[68:71], v[128:131], a[40:43], v[68:71]
v_mfma_f32_16x16x32_bf16 v[72:75], v[128:131], a[44:47], v[72:75]
ds_read_b64_tr_b16 v[116:117], v7 offset:8192
buffer_load_dwordx4 v4, s[36:39], s71 offen offset:2048 lds
v_mfma_f32_16x16x32_bf16 v[28:31], v[132:135], a[24:27], v[28:31]
v_mfma_f32_16x16x32_bf16 v[32:35], v[132:135], a[28:31], v[32:35]
ds_read_b64_tr_b16 v[118:119], v7 offset:10240
v_mfma_f32_16x16x32_bf16 v[36:39], v[132:135], a[32:35], v[36:39]
buffer_load_dwordx4 v5, s[36:39], s71 offen offset:3072 lds
v_mfma_f32_16x16x32_bf16 v[76:79], v[132:135], a[36:39], v[76:79]
ds_read_b64_tr_b16 v[120:121], v8 offset:8192
v_mfma_f32_16x16x32_bf16 v[80:83], v[132:135], a[40:43], v[80:83]
s_add_u32 s72, s62, 2
s_and_b32 s72, s72, 3
s_add_u32 s72, s72, s69
s_lshl_b32 s72, s72, 10
buffer_load_dwordx4 a[144:147], v10, s[32:35], s72 offen offset:0 sc1
v_mfma_f32_16x16x32_bf16 v[84:87], v[132:135], a[44:47], v[84:87]
ds_read_b64_tr_b16 v[122:123], v8 offset:10240
v_mfma_f32_16x16x32_bf16 v[40:43], v[136:139], a[24:27], v[40:43]
s_add_u32 s67, s72, 4096
buffer_load_dwordx4 a[148:151], v10, s[32:35], s67 offen offset:0 sc1
v_mfma_f32_16x16x32_bf16 v[44:47], v[136:139], a[28:31], v[44:47]
ds_read_b64_tr_b16 v[124:125], v9 offset:8192
v_mfma_f32_16x16x32_bf16 v[48:51], v[136:139], a[32:35], v[48:51]
v_mfma_f32_16x16x32_bf16 v[88:91], v[136:139], a[36:39], v[88:91]
ds_read_b64_tr_b16 v[126:127], v9 offset:10240
s_add_u32 s67, s72, 8192
buffer_load_dwordx4 a[152:155], v10, s[32:35], s67 offen offset:0 sc1
v_mfma_f32_16x16x32_bf16 v[92:95], v[136:139], a[40:43], v[92:95]
v_mfma_f32_16x16x32_bf16 v[96:99], v[136:139], a[44:47], v[96:99]
s_add_u32 s67, s72, 786432
buffer_load_dwordx4 a[156:159], v10, s[32:35], s67 offen offset:0 sc1
v_mfma_f32_16x16x32_bf16 v[52:55], v[140:143], a[24:27], v[52:55]
v_mfma_f32_16x16x32_bf16 v[56:59], v[140:143], a[28:31], v[56:59]
v_mfma_f32_16x16x32_bf16 v[60:63], v[140:143], a[32:35], v[60:63]
s_add_u32 s67, s72, 790528
buffer_load_dwordx4 a[160:163], v10, s[32:35], s67 offen offset:0 sc1
v_mfma_f32_16x16x32_bf16 v[100:103], v[140:143], a[36:39], v[100:103]
v_mfma_f32_16x16x32_bf16 v[104:107], v[140:143], a[40:43], v[104:107]
s_add_u32 s67, s72, 794624
buffer_load_dwordx4 a[164:167], v10, s[32:35], s67 offen offset:0 sc1
v_mfma_f32_16x16x32_bf16 v[108:111], v[140:143], a[44:47], v[108:111]
s_waitcnt lgkmcnt(0)
s_waitcnt vmcnt(31)
v_mfma_f32_16x16x32_bf16 v[16:19], v[112:115], a[48:51], v[16:19]
s_add_u32 s71, s62, 3
s_and_b32 s71, s71, 3
s_add_u32 s71, s71, s68
s_lshl_b32 s71, s71, 16
s_add_u32 m0, s57, 28672
s_nop 0
buffer_load_dwordx4 v2, s[36:39], s71 offen offset:0 lds
v_mfma_f32_16x16x32_bf16 v[20:23], v[112:115], a[52:55], v[20:23]
ds_read_b64_tr_b16 v[128:129], v6 offset:12288
v_mfma_f32_16x16x32_bf16 v[24:27], v[112:115], a[56:59], v[24:27]
v_mfma_f32_16x16x32_bf16 v[64:67], v[112:115], a[60:63], v[64:67]
ds_read_b64_tr_b16 v[130:131], v6 offset:14336
buffer_load_dwordx4 v3, s[36:39], s71 offen offset:1024 lds
v_mfma_f32_16x16x32_bf16 v[68:71], v[112:115], a[64:67], v[68:71]
v_mfma_f32_16x16x32_bf16 v[72:75], v[112:115], a[68:71], v[72:75]
ds_read_b64_tr_b16 v[132:133], v7 offset:12288
buffer_load_dwordx4 v4, s[36:39], s71 offen offset:2048 lds
v_mfma_f32_16x16x32_bf16 v[28:31], v[116:119], a[48:51], v[28:31]
v_mfma_f32_16x16x32_bf16 v[32:35], v[116:119], a[52:55], v[32:35]
ds_read_b64_tr_b16 v[134:135], v7 offset:14336
v_mfma_f32_16x16x32_bf16 v[36:39], v[116:119], a[56:59], v[36:39]
buffer_load_dwordx4 v5, s[36:39], s71 offen offset:3072 lds
v_mfma_f32_16x16x32_bf16 v[76:79], v[116:119], a[60:63], v[76:79]
ds_read_b64_tr_b16 v[136:137], v8 offset:12288
v_mfma_f32_16x16x32_bf16 v[80:83], v[116:119], a[64:67], v[80:83]
s_add_u32 s72, s62, 3
s_and_b32 s72, s72, 3
s_add_u32 s72, s72, s69
s_lshl_b32 s72, s72, 10
buffer_load_dwordx4 a[168:171], v10, s[32:35], s72 offen offset:0 sc1
v_mfma_f32_16x16x32_bf16 v[84:87], v[116:119], a[68:71], v[84:87]
ds_read_b64_tr_b16 v[138:139], v8 offset:14336
v_mfma_f32_16x16x32_bf16 v[40:43], v[120:123], a[48:51], v[40:43]
s_add_u32 s67, s72, 4096
buffer_load_dwordx4 a[172:175], v10, s[32:35], s67 offen offset:0 sc1
v_mfma_f32_16x16x32_bf16 v[44:47], v[120:123], a[52:55], v[44:47]
ds_read_b64_tr_b16 v[140:141], v9 offset:12288
v_mfma_f32_16x16x32_bf16 v[48:51], v[120:123], a[56:59], v[48:51]
v_mfma_f32_16x16x32_bf16 v[88:91], v[120:123], a[60:63], v[88:91]
ds_read_b64_tr_b16 v[142:143], v9 offset:14336
s_add_u32 s67, s72, 8192
buffer_load_dwordx4 a[176:179], v10, s[32:35], s67 offen offset:0 sc1
v_mfma_f32_16x16x32_bf16 v[92:95], v[120:123], a[64:67], v[92:95]
v_mfma_f32_16x16x32_bf16 v[96:99], v[120:123], a[68:71], v[96:99]
s_add_u32 s67, s72, 786432
buffer_load_dwordx4 a[180:183], v10, s[32:35], s67 offen offset:0 sc1
v_mfma_f32_16x16x32_bf16 v[52:55], v[124:127], a[48:51], v[52:55]
v_mfma_f32_16x16x32_bf16 v[56:59], v[124:127], a[52:55], v[56:59]
v_mfma_f32_16x16x32_bf16 v[60:63], v[124:127], a[56:59], v[60:63]
s_add_u32 s67, s72, 790528
buffer_load_dwordx4 a[184:187], v10, s[32:35], s67 offen offset:0 sc1
v_mfma_f32_16x16x32_bf16 v[100:103], v[124:127], a[60:63], v[100:103]
v_mfma_f32_16x16x32_bf16 v[104:107], v[124:127], a[64:67], v[104:107]
s_add_u32 s67, s72, 794624
buffer_load_dwordx4 a[188:191], v10, s[32:35], s67 offen offset:0 sc1
v_mfma_f32_16x16x32_bf16 v[108:111], v[124:127], a[68:71], v[108:111]
s_waitcnt lgkmcnt(0)
s_waitcnt vmcnt(31)
s_barrier
v_mfma_f32_16x16x32_bf16 v[16:19], v[128:131], a[72:75], v[16:19]
s_mov_b32 s68, 2
s_add_u32 s68, s68, 4
s_lshl3_add_u32 s68, s56, s68
s_lshl_b32 s68, s68, 2
s_add_u32 s71, s62, 0
s_and_b32 s71, s71, 3
s_add_u32 s71, s71, s68
s_lshl_b32 s71, s71, 16
s_add_u32 m0, s57, 0
s_nop 0
buffer_load_dwordx4 v2, s[36:39], s71 offen offset:0 lds
v_mfma_f32_16x16x32_bf16 v[20:23], v[128:131], a[76:79], v[20:23]
ds_read_b64_tr_b16 v[112:113], v6 offset:16384
v_mfma_f32_16x16x32_bf16 v[24:27], v[128:131], a[80:83], v[24:27]
v_mfma_f32_16x16x32_bf16 v[64:67], v[128:131], a[84:87], v[64:67]
ds_read_b64_tr_b16 v[114:115], v6 offset:18432
buffer_load_dwordx4 v3, s[36:39], s71 offen offset:1024 lds
v_mfma_f32_16x16x32_bf16 v[68:71], v[128:131], a[88:91], v[68:71]
v_mfma_f32_16x16x32_bf16 v[72:75], v[128:131], a[92:95], v[72:75]
ds_read_b64_tr_b16 v[116:117], v7 offset:16384
buffer_load_dwordx4 v4, s[36:39], s71 offen offset:2048 lds
v_mfma_f32_16x16x32_bf16 v[28:31], v[132:135], a[72:75], v[28:31]
v_mfma_f32_16x16x32_bf16 v[32:35], v[132:135], a[76:79], v[32:35]
ds_read_b64_tr_b16 v[118:119], v7 offset:18432
v_mfma_f32_16x16x32_bf16 v[36:39], v[132:135], a[80:83], v[36:39]
buffer_load_dwordx4 v5, s[36:39], s71 offen offset:3072 lds
v_mfma_f32_16x16x32_bf16 v[76:79], v[132:135], a[84:87], v[76:79]
ds_read_b64_tr_b16 v[120:121], v8 offset:16384
v_mfma_f32_16x16x32_bf16 v[80:83], v[132:135], a[88:91], v[80:83]
s_mov_b32 s69, 2
s_add_u32 s69, s69, 4
s_lshl3_add_u32 s69, s56, s69
s_mul_i32 s69, s69, 12
s_add_u32 s72, s62, 0
s_and_b32 s72, s72, 3
s_add_u32 s72, s72, s69
s_lshl_b32 s72, s72, 10
buffer_load_dwordx4 a[0:3], v10, s[32:35], s72 offen offset:0 sc1
v_mfma_f32_16x16x32_bf16 v[84:87], v[132:135], a[92:95], v[84:87]
ds_read_b64_tr_b16 v[122:123], v8 offset:18432
v_mfma_f32_16x16x32_bf16 v[40:43], v[136:139], a[72:75], v[40:43]
s_add_u32 s67, s72, 4096
buffer_load_dwordx4 a[4:7], v10, s[32:35], s67 offen offset:0 sc1
v_mfma_f32_16x16x32_bf16 v[44:47], v[136:139], a[76:79], v[44:47]
ds_read_b64_tr_b16 v[124:125], v9 offset:16384
v_mfma_f32_16x16x32_bf16 v[48:51], v[136:139], a[80:83], v[48:51]
v_mfma_f32_16x16x32_bf16 v[88:91], v[136:139], a[84:87], v[88:91]
ds_read_b64_tr_b16 v[126:127], v9 offset:18432
s_add_u32 s67, s72, 8192
buffer_load_dwordx4 a[8:11], v10, s[32:35], s67 offen offset:0 sc1
v_mfma_f32_16x16x32_bf16 v[92:95], v[136:139], a[88:91], v[92:95]
v_mfma_f32_16x16x32_bf16 v[96:99], v[136:139], a[92:95], v[96:99]
s_add_u32 s67, s72, 786432
buffer_load_dwordx4 a[12:15], v10, s[32:35], s67 offen offset:0 sc1
v_mfma_f32_16x16x32_bf16 v[52:55], v[140:143], a[72:75], v[52:55]
v_mfma_f32_16x16x32_bf16 v[56:59], v[140:143], a[76:79], v[56:59]
v_mfma_f32_16x16x32_bf16 v[60:63], v[140:143], a[80:83], v[60:63]
s_add_u32 s67, s72, 790528
buffer_load_dwordx4 a[16:19], v10, s[32:35], s67 offen offset:0 sc1
v_mfma_f32_16x16x32_bf16 v[100:103], v[140:143], a[84:87], v[100:103]
v_mfma_f32_16x16x32_bf16 v[104:107], v[140:143], a[88:91], v[104:107]
s_add_u32 s67, s72, 794624
buffer_load_dwordx4 a[20:23], v10, s[32:35], s67 offen offset:0 sc1
v_mfma_f32_16x16x32_bf16 v[108:111], v[140:143], a[92:95], v[108:111]
s_waitcnt lgkmcnt(0)
s_waitcnt vmcnt(31)
v_mfma_f32_16x16x32_bf16 v[16:19], v[112:115], a[96:99], v[16:19]
s_add_u32 s71, s62, 1
s_and_b32 s71, s71, 3
s_add_u32 s71, s71, s68
s_lshl_b32 s71, s71, 16
s_add_u32 m0, s57, 4096
s_nop 0
buffer_load_dwordx4 v2, s[36:39], s71 offen offset:0 lds
v_mfma_f32_16x16x32_bf16 v[20:23], v[112:115], a[100:103], v[20:23]
ds_read_b64_tr_b16 v[128:129], v6 offset:20480
v_mfma_f32_16x16x32_bf16 v[24:27], v[112:115], a[104:107], v[24:27]
v_mfma_f32_16x16x32_bf16 v[64:67], v[112:115], a[108:111], v[64:67]
ds_read_b64_tr_b16 v[130:131], v6 offset:22528
buffer_load_dwordx4 v3, s[36:39], s71 offen offset:1024 lds
v_mfma_f32_16x16x32_bf16 v[68:71], v[112:115], a[112:115], v[68:71]
v_mfma_f32_16x16x32_bf16 v[72:75], v[112:115], a[116:119], v[72:75]
ds_read_b64_tr_b16 v[132:133], v7 offset:20480
buffer_load_dwordx4 v4, s[36:39], s71 offen offset:2048 lds
v_mfma_f32_16x16x32_bf16 v[28:31], v[116:119], a[96:99], v[28:31]
v_mfma_f32_16x16x32_bf16 v[32:35], v[116:119], a[100:103], v[32:35]
ds_read_b64_tr_b16 v[134:135], v7 offset:22528
v_mfma_f32_16x16x32_bf16 v[36:39], v[116:119], a[104:107], v[36:39]
buffer_load_dwordx4 v5, s[36:39], s71 offen offset:3072 lds
v_mfma_f32_16x16x32_bf16 v[76:79], v[116:119], a[108:111], v[76:79]
ds_read_b64_tr_b16 v[136:137], v8 offset:20480
v_mfma_f32_16x16x32_bf16 v[80:83], v[116:119], a[112:115], v[80:83]
s_add_u32 s72, s62, 1
s_and_b32 s72, s72, 3
s_add_u32 s72, s72, s69
s_lshl_b32 s72, s72, 10
buffer_load_dwordx4 a[24:27], v10, s[32:35], s72 offen offset:0 sc1
v_mfma_f32_16x16x32_bf16 v[84:87], v[116:119], a[116:119], v[84:87]
ds_read_b64_tr_b16 v[138:139], v8 offset:22528
v_mfma_f32_16x16x32_bf16 v[40:43], v[120:123], a[96:99], v[40:43]
s_add_u32 s67, s72, 4096
buffer_load_dwordx4 a[28:31], v10, s[32:35], s67 offen offset:0 sc1
v_mfma_f32_16x16x32_bf16 v[44:47], v[120:123], a[100:103], v[44:47]
ds_read_b64_tr_b16 v[140:141], v9 offset:20480
v_mfma_f32_16x16x32_bf16 v[48:51], v[120:123], a[104:107], v[48:51]
v_mfma_f32_16x16x32_bf16 v[88:91], v[120:123], a[108:111], v[88:91]
ds_read_b64_tr_b16 v[142:143], v9 offset:22528
s_add_u32 s67, s72, 8192
buffer_load_dwordx4 a[32:35], v10, s[32:35], s67 offen offset:0 sc1
v_mfma_f32_16x16x32_bf16 v[92:95], v[120:123], a[112:115], v[92:95]
v_mfma_f32_16x16x32_bf16 v[96:99], v[120:123], a[116:119], v[96:99]
s_add_u32 s67, s72, 786432
buffer_load_dwordx4 a[36:39], v10, s[32:35], s67 offen offset:0 sc1
v_mfma_f32_16x16x32_bf16 v[52:55], v[124:127], a[96:99], v[52:55]
v_mfma_f32_16x16x32_bf16 v[56:59], v[124:127], a[100:103], v[56:59]
v_mfma_f32_16x16x32_bf16 v[60:63], v[124:127], a[104:107], v[60:63]
s_add_u32 s67, s72, 790528
buffer_load_dwordx4 a[40:43], v10, s[32:35], s67 offen offset:0 sc1
v_mfma_f32_16x16x32_bf16 v[100:103], v[124:127], a[108:111], v[100:103]
v_mfma_f32_16x16x32_bf16 v[104:107], v[124:127], a[112:115], v[104:107]
s_add_u32 s67, s72, 794624
buffer_load_dwordx4 a[44:47], v10, s[32:35], s67 offen offset:0 sc1
v_mfma_f32_16x16x32_bf16 v[108:111], v[124:127], a[116:119], v[108:111]
s_waitcnt lgkmcnt(0)
s_waitcnt vmcnt(30)
s_barrier
v_mfma_f32_16x16x32_bf16 v[16:19], v[128:131], a[120:123], v[16:19]
s_add_u32 s71, s62, 2
s_and_b32 s71, s71, 3
s_add_u32 s71, s71, s68
s_lshl_b32 s71, s71, 16
s_add_u32 m0, s57, 8192
s_nop 0
buffer_load_dwordx4 v2, s[36:39], s71 offen offset:0 lds
v_mfma_f32_16x16x32_bf16 v[20:23], v[128:131], a[124:127], v[20:23]
ds_read_b64_tr_b16 v[112:113], v6 offset:24576
v_mfma_f32_16x16x32_bf16 v[24:27], v[128:131], a[128:131], v[24:27]
v_mfma_f32_16x16x32_bf16 v[64:67], v[128:131], a[132:135], v[64:67]
ds_read_b64_tr_b16 v[114:115], v6 offset:26624
buffer_load_dwordx4 v3, s[36:39], s71 offen offset:1024 lds
v_mfma_f32_16x16x32_bf16 v[68:71], v[128:131], a[136:139], v[68:71]
v_mfma_f32_16x16x32_bf16 v[72:75], v[128:131], a[140:143], v[72:75]
ds_read_b64_tr_b16 v[116:117], v7 offset:24576
buffer_load_dwordx4 v4, s[36:39], s71 offen offset:2048 lds
v_mfma_f32_16x16x32_bf16 v[28:31], v[132:135], a[120:123], v[28:31]
v_mfma_f32_16x16x32_bf16 v[32:35], v[132:135], a[124:127], v[32:35]
ds_read_b64_tr_b16 v[118:119], v7 offset:26624
v_mfma_f32_16x16x32_bf16 v[36:39], v[132:135], a[128:131], v[36:39]
buffer_load_dwordx4 v5, s[36:39], s71 offen offset:3072 lds
v_mfma_f32_16x16x32_bf16 v[76:79], v[132:135], a[132:135], v[76:79]
ds_read_b64_tr_b16 v[120:121], v8 offset:24576
v_mfma_f32_16x16x32_bf16 v[80:83], v[132:135], a[136:139], v[80:83]
s_add_u32 s72, s62, 2
s_and_b32 s72, s72, 3
s_add_u32 s72, s72, s69
s_lshl_b32 s72, s72, 10
buffer_load_dwordx4 a[48:51], v10, s[32:35], s72 offen offset:0 sc1
v_mfma_f32_16x16x32_bf16 v[84:87], v[132:135], a[140:143], v[84:87]
ds_read_b64_tr_b16 v[122:123], v8 offset:26624
v_mfma_f32_16x16x32_bf16 v[40:43], v[136:139], a[120:123], v[40:43]
s_add_u32 s67, s72, 4096
buffer_load_dwordx4 a[52:55], v10, s[32:35], s67 offen offset:0 sc1
v_mfma_f32_16x16x32_bf16 v[44:47], v[136:139], a[124:127], v[44:47]
ds_read_b64_tr_b16 v[124:125], v9 offset:24576
v_mfma_f32_16x16x32_bf16 v[48:51], v[136:139], a[128:131], v[48:51]
v_mfma_f32_16x16x32_bf16 v[88:91], v[136:139], a[132:135], v[88:91]
ds_read_b64_tr_b16 v[126:127], v9 offset:26624
s_add_u32 s67, s72, 8192
buffer_load_dwordx4 a[56:59], v10, s[32:35], s67 offen offset:0 sc1
v_mfma_f32_16x16x32_bf16 v[92:95], v[136:139], a[136:139], v[92:95]
v_mfma_f32_16x16x32_bf16 v[96:99], v[136:139], a[140:143], v[96:99]
s_add_u32 s67, s72, 786432
buffer_load_dwordx4 a[60:63], v10, s[32:35], s67 offen offset:0 sc1
v_mfma_f32_16x16x32_bf16 v[52:55], v[140:143], a[120:123], v[52:55]
v_mfma_f32_16x16x32_bf16 v[56:59], v[140:143], a[124:127], v[56:59]
v_mfma_f32_16x16x32_bf16 v[60:63], v[140:143], a[128:131], v[60:63]
s_add_u32 s67, s72, 790528
buffer_load_dwordx4 a[64:67], v10, s[32:35], s67 offen offset:0 sc1
v_mfma_f32_16x16x32_bf16 v[100:103], v[140:143], a[132:135], v[100:103]
v_mfma_f32_16x16x32_bf16 v[104:107], v[140:143], a[136:139], v[104:107]
s_add_u32 s67, s72, 794624
buffer_load_dwordx4 a[68:71], v10, s[32:35], s67 offen offset:0 sc1
v_mfma_f32_16x16x32_bf16 v[108:111], v[140:143], a[140:143], v[108:111]
s_waitcnt lgkmcnt(0)
s_waitcnt vmcnt(30)
v_mfma_f32_16x16x32_bf16 v[16:19], v[112:115], a[144:147], v[16:19]
s_add_u32 s71, s62, 3
s_and_b32 s71, s71, 3
s_add_u32 s71, s71, s68
s_lshl_b32 s71, s71, 16
s_add_u32 m0, s57, 12288
s_nop 0
buffer_load_dwordx4 v2, s[36:39], s71 offen offset:0 lds
v_mfma_f32_16x16x32_bf16 v[20:23], v[112:115], a[148:151], v[20:23]
ds_read_b64_tr_b16 v[128:129], v6 offset:28672
v_mfma_f32_16x16x32_bf16 v[24:27], v[112:115], a[152:155], v[24:27]
v_mfma_f32_16x16x32_bf16 v[64:67], v[112:115], a[156:159], v[64:67]
ds_read_b64_tr_b16 v[130:131], v6 offset:30720
buffer_load_dwordx4 v3, s[36:39], s71 offen offset:1024 lds
v_mfma_f32_16x16x32_bf16 v[68:71], v[112:115], a[160:163], v[68:71]
v_mfma_f32_16x16x32_bf16 v[72:75], v[112:115], a[164:167], v[72:75]
ds_read_b64_tr_b16 v[132:133], v7 offset:28672
buffer_load_dwordx4 v4, s[36:39], s71 offen offset:2048 lds
v_mfma_f32_16x16x32_bf16 v[28:31], v[116:119], a[144:147], v[28:31]
v_mfma_f32_16x16x32_bf16 v[32:35], v[116:119], a[148:151], v[32:35]
ds_read_b64_tr_b16 v[134:135], v7 offset:30720
v_mfma_f32_16x16x32_bf16 v[36:39], v[116:119], a[152:155], v[36:39]
buffer_load_dwordx4 v5, s[36:39], s71 offen offset:3072 lds
v_mfma_f32_16x16x32_bf16 v[76:79], v[116:119], a[156:159], v[76:79]
ds_read_b64_tr_b16 v[136:137], v8 offset:28672
v_mfma_f32_16x16x32_bf16 v[80:83], v[116:119], a[160:163], v[80:83]
s_add_u32 s72, s62, 3
s_and_b32 s72, s72, 3
s_add_u32 s72, s72, s69
s_lshl_b32 s72, s72, 10
buffer_load_dwordx4 a[72:75], v10, s[32:35], s72 offen offset:0 sc1
v_mfma_f32_16x16x32_bf16 v[84:87], v[116:119], a[164:167], v[84:87]
ds_read_b64_tr_b16 v[138:139], v8 offset:30720
v_mfma_f32_16x16x32_bf16 v[40:43], v[120:123], a[144:147], v[40:43]
s_add_u32 s67, s72, 4096
buffer_load_dwordx4 a[76:79], v10, s[32:35], s67 offen offset:0 sc1
v_mfma_f32_16x16x32_bf16 v[44:47], v[120:123], a[148:151], v[44:47]
ds_read_b64_tr_b16 v[140:141], v9 offset:28672
v_mfma_f32_16x16x32_bf16 v[48:51], v[120:123], a[152:155], v[48:51]
v_mfma_f32_16x16x32_bf16 v[88:91], v[120:123], a[156:159], v[88:91]
ds_read_b64_tr_b16 v[142:143], v9 offset:30720
s_add_u32 s67, s72, 8192
buffer_load_dwordx4 a[80:83], v10, s[32:35], s67 offen offset:0 sc1
v_mfma_f32_16x16x32_bf16 v[92:95], v[120:123], a[160:163], v[92:95]
v_mfma_f32_16x16x32_bf16 v[96:99], v[120:123], a[164:167], v[96:99]
s_add_u32 s67, s72, 786432
buffer_load_dwordx4 a[84:87], v10, s[32:35], s67 offen offset:0 sc1
v_mfma_f32_16x16x32_bf16 v[52:55], v[124:127], a[144:147], v[52:55]
v_mfma_f32_16x16x32_bf16 v[56:59], v[124:127], a[148:151], v[56:59]
v_mfma_f32_16x16x32_bf16 v[60:63], v[124:127], a[152:155], v[60:63]
s_add_u32 s67, s72, 790528
buffer_load_dwordx4 a[88:91], v10, s[32:35], s67 offen offset:0 sc1
v_mfma_f32_16x16x32_bf16 v[100:103], v[124:127], a[156:159], v[100:103]
v_mfma_f32_16x16x32_bf16 v[104:107], v[124:127], a[160:163], v[104:107]
s_add_u32 s67, s72, 794624
buffer_load_dwordx4 a[92:95], v10, s[32:35], s67 offen offset:0 sc1
v_mfma_f32_16x16x32_bf16 v[108:111], v[124:127], a[164:167], v[108:111]
s_waitcnt lgkmcnt(0)
s_waitcnt vmcnt(30)
s_barrier
v_mfma_f32_16x16x32_bf16 v[16:19], v[128:131], a[168:171], v[16:19]
s_mov_b32 s68, 3
s_add_u32 s68, s68, 4
s_lshl3_add_u32 s68, s56, s68
s_lshl_b32 s68, s68, 2
s_add_u32 s71, s62, 0
s_and_b32 s71, s71, 3
s_add_u32 s71, s71, s68
s_lshl_b32 s71, s71, 16
s_add_u32 m0, s57, 16384
s_nop 0
buffer_load_dwordx4 v2, s[36:39], s71 offen offset:0 lds
v_mfma_f32_16x16x32_bf16 v[20:23], v[128:131], a[172:175], v[20:23]
ds_read_b64_tr_b16 v[112:113], v6 offset:0
v_mfma_f32_16x16x32_bf16 v[24:27], v[128:131], a[176:179], v[24:27]
v_mfma_f32_16x16x32_bf16 v[64:67], v[128:131], a[180:183], v[64:67]
ds_read_b64_tr_b16 v[114:115], v6 offset:2048
buffer_load_dwordx4 v3, s[36:39], s71 offen offset:1024 lds
v_mfma_f32_16x16x32_bf16 v[68:71], v[128:131], a[184:187], v[68:71]
v_mfma_f32_16x16x32_bf16 v[72:75], v[128:131], a[188:191], v[72:75]
ds_read_b64_tr_b16 v[116:117], v7 offset:0
buffer_load_dwordx4 v4, s[36:39], s71 offen offset:2048 lds
v_mfma_f32_16x16x32_bf16 v[28:31], v[132:135], a[168:171], v[28:31]
v_mfma_f32_16x16x32_bf16 v[32:35], v[132:135], a[172:175], v[32:35]
ds_read_b64_tr_b16 v[118:119], v7 offset:2048
v_mfma_f32_16x16x32_bf16 v[36:39], v[132:135], a[176:179], v[36:39]
buffer_load_dwordx4 v5, s[36:39], s71 offen offset:3072 lds
v_mfma_f32_16x16x32_bf16 v[76:79], v[132:135], a[180:183], v[76:79]
ds_read_b64_tr_b16 v[120:121], v8 offset:0
v_mfma_f32_16x16x32_bf16 v[80:83], v[132:135], a[184:187], v[80:83]
s_mov_b32 s69, 3
s_add_u32 s69, s69, 4
s_lshl3_add_u32 s69, s56, s69
s_mul_i32 s69, s69, 12
s_add_u32 s72, s62, 0
s_and_b32 s72, s72, 3
s_add_u32 s72, s72, s69
s_lshl_b32 s72, s72, 10
buffer_load_dwordx4 a[96:99], v10, s[32:35], s72 offen offset:0 sc1
v_mfma_f32_16x16x32_bf16 v[84:87], v[132:135], a[188:191], v[84:87]
ds_read_b64_tr_b16 v[122:123], v8 offset:2048
v_mfma_f32_16x16x32_bf16 v[40:43], v[136:139], a[168:171], v[40:43]
s_add_u32 s67, s72, 4096
buffer_load_dwordx4 a[100:103], v10, s[32:35], s67 offen offset:0 sc1
v_mfma_f32_16x16x32_bf16 v[44:47], v[136:139], a[172:175], v[44:47]
ds_read_b64_tr_b16 v[124:125], v9 offset:0
v_mfma_f32_16x16x32_bf16 v[48:51], v[136:139], a[176:179], v[48:51]
v_mfma_f32_16x16x32_bf16 v[88:91], v[136:139], a[180:183], v[88:91]
ds_read_b64_tr_b16 v[126:127], v9 offset:2048
s_add_u32 s67, s72, 8192
buffer_load_dwordx4 a[104:107], v10, s[32:35], s67 offen offset:0 sc1
v_mfma_f32_16x16x32_bf16 v[92:95], v[136:139], a[184:187], v[92:95]
v_mfma_f32_16x16x32_bf16 v[96:99], v[136:139], a[188:191], v[96:99]
s_add_u32 s67, s72, 786432
buffer_load_dwordx4 a[108:111], v10, s[32:35], s67 offen offset:0 sc1
v_mfma_f32_16x16x32_bf16 v[52:55], v[140:143], a[168:171], v[52:55]
v_mfma_f32_16x16x32_bf16 v[56:59], v[140:143], a[172:175], v[56:59]
v_mfma_f32_16x16x32_bf16 v[60:63], v[140:143], a[176:179], v[60:63]
s_add_u32 s67, s72, 790528
buffer_load_dwordx4 a[112:115], v10, s[32:35], s67 offen offset:0 sc1
v_mfma_f32_16x16x32_bf16 v[100:103], v[140:143], a[180:183], v[100:103]
v_mfma_f32_16x16x32_bf16 v[104:107], v[140:143], a[184:187], v[104:107]
s_add_u32 s67, s72, 794624
buffer_load_dwordx4 a[116:119], v10, s[32:35], s67 offen offset:0 sc1
v_mfma_f32_16x16x32_bf16 v[108:111], v[140:143], a[188:191], v[108:111]
s_waitcnt lgkmcnt(0)
s_waitcnt vmcnt(30)
v_mfma_f32_16x16x32_bf16 v[16:19], v[112:115], a[0:3], v[16:19]
s_add_u32 s71, s62, 1
s_and_b32 s71, s71, 3
s_add_u32 s71, s71, s68
s_lshl_b32 s71, s71, 16
s_add_u32 m0, s57, 20480
s_nop 0
buffer_load_dwordx4 v2, s[36:39], s71 offen offset:0 lds
v_mfma_f32_16x16x32_bf16 v[20:23], v[112:115], a[4:7], v[20:23]
ds_read_b64_tr_b16 v[128:129], v6 offset:4096
v_mfma_f32_16x16x32_bf16 v[24:27], v[112:115], a[8:11], v[24:27]
v_mfma_f32_16x16x32_bf16 v[64:67], v[112:115], a[12:15], v[64:67]
ds_read_b64_tr_b16 v[130:131], v6 offset:6144
buffer_load_dwordx4 v3, s[36:39], s71 offen offset:1024 lds
v_mfma_f32_16x16x32_bf16 v[68:71], v[112:115], a[16:19], v[68:71]
v_mfma_f32_16x16x32_bf16 v[72:75], v[112:115], a[20:23], v[72:75]
ds_read_b64_tr_b16 v[132:133], v7 offset:4096
buffer_load_dwordx4 v4, s[36:39], s71 offen offset:2048 lds
v_mfma_f32_16x16x32_bf16 v[28:31], v[116:119], a[0:3], v[28:31]
v_mfma_f32_16x16x32_bf16 v[32:35], v[116:119], a[4:7], v[32:35]
ds_read_b64_tr_b16 v[134:135], v7 offset:6144
v_mfma_f32_16x16x32_bf16 v[36:39], v[116:119], a[8:11], v[36:39]
buffer_load_dwordx4 v5, s[36:39], s71 offen offset:3072 lds
v_mfma_f32_16x16x32_bf16 v[76:79], v[116:119], a[12:15], v[76:79]
ds_read_b64_tr_b16 v[136:137], v8 offset:4096
v_mfma_f32_16x16x32_bf16 v[80:83], v[116:119], a[16:19], v[80:83]
s_add_u32 s72, s62, 1
s_and_b32 s72, s72, 3
s_add_u32 s72, s72, s69
s_lshl_b32 s72, s72, 10
buffer_load_dwordx4 a[120:123], v10, s[32:35], s72 offen offset:0 sc1
v_mfma_f32_16x16x32_bf16 v[84:87], v[116:119], a[20:23], v[84:87]
ds_read_b64_tr_b16 v[138:139], v8 offset:6144
v_mfma_f32_16x16x32_bf16 v[40:43], v[120:123], a[0:3], v[40:43]
s_add_u32 s67, s72, 4096
buffer_load_dwordx4 a[124:127], v10, s[32:35], s67 offen offset:0 sc1
v_mfma_f32_16x16x32_bf16 v[44:47], v[120:123], a[4:7], v[44:47]
ds_read_b64_tr_b16 v[140:141], v9 offset:4096
v_mfma_f32_16x16x32_bf16 v[48:51], v[120:123], a[8:11], v[48:51]
v_mfma_f32_16x16x32_bf16 v[88:91], v[120:123], a[12:15], v[88:91]
ds_read_b64_tr_b16 v[142:143], v9 offset:6144
s_add_u32 s67, s72, 8192
buffer_load_dwordx4 a[128:131], v10, s[32:35], s67 offen offset:0 sc1
v_mfma_f32_16x16x32_bf16 v[92:95], v[120:123], a[16:19], v[92:95]
v_mfma_f32_16x16x32_bf16 v[96:99], v[120:123], a[20:23], v[96:99]
s_add_u32 s67, s72, 786432
buffer_load_dwordx4 a[132:135], v10, s[32:35], s67 offen offset:0 sc1
v_mfma_f32_16x16x32_bf16 v[52:55], v[124:127], a[0:3], v[52:55]
v_mfma_f32_16x16x32_bf16 v[56:59], v[124:127], a[4:7], v[56:59]
v_mfma_f32_16x16x32_bf16 v[60:63], v[124:127], a[8:11], v[60:63]
s_add_u32 s67, s72, 790528
buffer_load_dwordx4 a[136:139], v10, s[32:35], s67 offen offset:0 sc1
v_mfma_f32_16x16x32_bf16 v[100:103], v[124:127], a[12:15], v[100:103]
v_mfma_f32_16x16x32_bf16 v[104:107], v[124:127], a[16:19], v[104:107]
s_add_u32 s67, s72, 794624
buffer_load_dwordx4 a[140:143], v10, s[32:35], s67 offen offset:0 sc1
v_mfma_f32_16x16x32_bf16 v[108:111], v[124:127], a[20:23], v[108:111]
s_waitcnt lgkmcnt(0)
s_waitcnt vmcnt(30)
s_barrier
v_mfma_f32_16x16x32_bf16 v[16:19], v[128:131], a[24:27], v[16:19]
s_add_u32 s71, s62, 2
s_and_b32 s71, s71, 3
s_add_u32 s71, s71, s68
s_lshl_b32 s71, s71, 16
s_add_u32 m0, s57, 24576
s_nop 0
buffer_load_dwordx4 v2, s[36:39], s71 offen offset:0 lds
v_mfma_f32_16x16x32_bf16 v[20:23], v[128:131], a[28:31], v[20:23]
ds_read_b64_tr_b16 v[112:113], v6 offset:8192
v_mfma_f32_16x16x32_bf16 v[24:27], v[128:131], a[32:35], v[24:27]
v_mfma_f32_16x16x32_bf16 v[64:67], v[128:131], a[36:39], v[64:67]
ds_read_b64_tr_b16 v[114:115], v6 offset:10240
buffer_load_dwordx4 v3, s[36:39], s71 offen offset:1024 lds
v_mfma_f32_16x16x32_bf16 v[68:71], v[128:131], a[40:43], v[68:71]
v_mfma_f32_16x16x32_bf16 v[72:75], v[128:131], a[44:47], v[72:75]
ds_read_b64_tr_b16 v[116:117], v7 offset:8192
buffer_load_dwordx4 v4, s[36:39], s71 offen offset:2048 lds
v_mfma_f32_16x16x32_bf16 v[28:31], v[132:135], a[24:27], v[28:31]
v_mfma_f32_16x16x32_bf16 v[32:35], v[132:135], a[28:31], v[32:35]
ds_read_b64_tr_b16 v[118:119], v7 offset:10240
v_mfma_f32_16x16x32_bf16 v[36:39], v[132:135], a[32:35], v[36:39]
buffer_load_dwordx4 v5, s[36:39], s71 offen offset:3072 lds
v_mfma_f32_16x16x32_bf16 v[76:79], v[132:135], a[36:39], v[76:79]
ds_read_b64_tr_b16 v[120:121], v8 offset:8192
v_mfma_f32_16x16x32_bf16 v[80:83], v[132:135], a[40:43], v[80:83]
s_add_u32 s72, s62, 2
s_and_b32 s72, s72, 3
s_add_u32 s72, s72, s69
s_lshl_b32 s72, s72, 10
buffer_load_dwordx4 a[144:147], v10, s[32:35], s72 offen offset:0 sc1
v_mfma_f32_16x16x32_bf16 v[84:87], v[132:135], a[44:47], v[84:87]
ds_read_b64_tr_b16 v[122:123], v8 offset:10240
v_mfma_f32_16x16x32_bf16 v[40:43], v[136:139], a[24:27], v[40:43]
s_add_u32 s67, s72, 4096
buffer_load_dwordx4 a[148:151], v10, s[32:35], s67 offen offset:0 sc1
v_mfma_f32_16x16x32_bf16 v[44:47], v[136:139], a[28:31], v[44:47]
ds_read_b64_tr_b16 v[124:125], v9 offset:8192
v_mfma_f32_16x16x32_bf16 v[48:51], v[136:139], a[32:35], v[48:51]
v_mfma_f32_16x16x32_bf16 v[88:91], v[136:139], a[36:39], v[88:91]
ds_read_b64_tr_b16 v[126:127], v9 offset:10240
s_add_u32 s67, s72, 8192
buffer_load_dwordx4 a[152:155], v10, s[32:35], s67 offen offset:0 sc1
v_mfma_f32_16x16x32_bf16 v[92:95], v[136:139], a[40:43], v[92:95]
v_mfma_f32_16x16x32_bf16 v[96:99], v[136:139], a[44:47], v[96:99]
s_add_u32 s67, s72, 786432
buffer_load_dwordx4 a[156:159], v10, s[32:35], s67 offen offset:0 sc1
v_mfma_f32_16x16x32_bf16 v[52:55], v[140:143], a[24:27], v[52:55]
v_mfma_f32_16x16x32_bf16 v[56:59], v[140:143], a[28:31], v[56:59]
v_mfma_f32_16x16x32_bf16 v[60:63], v[140:143], a[32:35], v[60:63]
s_add_u32 s67, s72, 790528
buffer_load_dwordx4 a[160:163], v10, s[32:35], s67 offen offset:0 sc1
v_mfma_f32_16x16x32_bf16 v[100:103], v[140:143], a[36:39], v[100:103]
v_mfma_f32_16x16x32_bf16 v[104:107], v[140:143], a[40:43], v[104:107]
s_add_u32 s67, s72, 794624
buffer_load_dwordx4 a[164:167], v10, s[32:35], s67 offen offset:0 sc1
v_mfma_f32_16x16x32_bf16 v[108:111], v[140:143], a[44:47], v[108:111]
s_waitcnt lgkmcnt(0)
s_waitcnt vmcnt(30)
v_mfma_f32_16x16x32_bf16 v[16:19], v[112:115], a[48:51], v[16:19]
s_add_u32 s71, s62, 3
s_and_b32 s71, s71, 3
s_add_u32 s71, s71, s68
s_lshl_b32 s71, s71, 16
s_add_u32 m0, s57, 28672
s_nop 0
buffer_load_dwordx4 v2, s[36:39], s71 offen offset:0 lds
v_mfma_f32_16x16x32_bf16 v[20:23], v[112:115], a[52:55], v[20:23]
ds_read_b64_tr_b16 v[128:129], v6 offset:12288
v_mfma_f32_16x16x32_bf16 v[24:27], v[112:115], a[56:59], v[24:27]
v_mfma_f32_16x16x32_bf16 v[64:67], v[112:115], a[60:63], v[64:67]
ds_read_b64_tr_b16 v[130:131], v6 offset:14336
buffer_load_dwordx4 v3, s[36:39], s71 offen offset:1024 lds
v_mfma_f32_16x16x32_bf16 v[68:71], v[112:115], a[64:67], v[68:71]
v_mfma_f32_16x16x32_bf16 v[72:75], v[112:115], a[68:71], v[72:75]
ds_read_b64_tr_b16 v[132:133], v7 offset:12288
buffer_load_dwordx4 v4, s[36:39], s71 offen offset:2048 lds
v_mfma_f32_16x16x32_bf16 v[28:31], v[116:119], a[48:51], v[28:31]
v_mfma_f32_16x16x32_bf16 v[32:35], v[116:119], a[52:55], v[32:35]
ds_read_b64_tr_b16 v[134:135], v7 offset:14336
v_mfma_f32_16x16x32_bf16 v[36:39], v[116:119], a[56:59], v[36:39]
buffer_load_dwordx4 v5, s[36:39], s71 offen offset:3072 lds
v_mfma_f32_16x16x32_bf16 v[76:79], v[116:119], a[60:63], v[76:79]
ds_read_b64_tr_b16 v[136:137], v8 offset:12288
v_mfma_f32_16x16x32_bf16 v[80:83], v[116:119], a[64:67], v[80:83]
s_add_u32 s72, s62, 3
s_and_b32 s72, s72, 3
s_add_u32 s72, s72, s69
s_lshl_b32 s72, s72, 10
buffer_load_dwordx4 a[168:171], v10, s[32:35], s72 offen offset:0 sc1
v_mfma_f32_16x16x32_bf16 v[84:87], v[116:119], a[68:71], v[84:87]
ds_read_b64_tr_b16 v[138:139], v8 offset:14336
v_mfma_f32_16x16x32_bf16 v[40:43], v[120:123], a[48:51], v[40:43]
s_add_u32 s67, s72, 4096
buffer_load_dwordx4 a[172:175], v10, s[32:35], s67 offen offset:0 sc1
v_mfma_f32_16x16x32_bf16 v[44:47], v[120:123], a[52:55], v[44:47]
ds_read_b64_tr_b16 v[140:141], v9 offset:12288
v_mfma_f32_16x16x32_bf16 v[48:51], v[120:123], a[56:59], v[48:51]
v_mfma_f32_16x16x32_bf16 v[88:91], v[120:123], a[60:63], v[88:91]
ds_read_b64_tr_b16 v[142:143], v9 offset:14336
s_add_u32 s67, s72, 8192
buffer_load_dwordx4 a[176:179], v10, s[32:35], s67 offen offset:0 sc1
v_mfma_f32_16x16x32_bf16 v[92:95], v[120:123], a[64:67], v[92:95]
v_mfma_f32_16x16x32_bf16 v[96:99], v[120:123], a[68:71], v[96:99]
s_add_u32 s67, s72, 786432
buffer_load_dwordx4 a[180:183], v10, s[32:35], s67 offen offset:0 sc1
v_mfma_f32_16x16x32_bf16 v[52:55], v[124:127], a[48:51], v[52:55]
v_mfma_f32_16x16x32_bf16 v[56:59], v[124:127], a[52:55], v[56:59]
v_mfma_f32_16x16x32_bf16 v[60:63], v[124:127], a[56:59], v[60:63]
s_add_u32 s67, s72, 790528
buffer_load_dwordx4 a[184:187], v10, s[32:35], s67 offen offset:0 sc1
v_mfma_f32_16x16x32_bf16 v[100:103], v[124:127], a[60:63], v[100:103]
v_mfma_f32_16x16x32_bf16 v[104:107], v[124:127], a[64:67], v[104:107]
s_add_u32 s67, s72, 794624
buffer_load_dwordx4 a[188:191], v10, s[32:35], s67 offen offset:0 sc1
v_mfma_f32_16x16x32_bf16 v[108:111], v[124:127], a[68:71], v[108:111]
s_waitcnt lgkmcnt(0)
s_waitcnt vmcnt(30)
v_mfma_f32_16x16x32_bf16 v[16:19], v[128:131], a[72:75], v[16:19]
v_mfma_f32_16x16x32_bf16 v[20:23], v[128:131], a[76:79], v[20:23]
ds_read_b64_tr_b16 v[112:113], v6 offset:16384
v_mfma_f32_16x16x32_bf16 v[24:27], v[128:131], a[80:83], v[24:27]
v_mfma_f32_16x16x32_bf16 v[64:67], v[128:131], a[84:87], v[64:67]
ds_read_b64_tr_b16 v[114:115], v6 offset:18432
v_mfma_f32_16x16x32_bf16 v[68:71], v[128:131], a[88:91], v[68:71]
v_mfma_f32_16x16x32_bf16 v[72:75], v[128:131], a[92:95], v[72:75]
ds_read_b64_tr_b16 v[116:117], v7 offset:16384
v_mfma_f32_16x16x32_bf16 v[28:31], v[132:135], a[72:75], v[28:31]
v_mfma_f32_16x16x32_bf16 v[32:35], v[132:135], a[76:79], v[32:35]
ds_read_b64_tr_b16 v[118:119], v7 offset:18432
v_mfma_f32_16x16x32_bf16 v[36:39], v[132:135], a[80:83], v[36:39]
v_mfma_f32_16x16x32_bf16 v[76:79], v[132:135], a[84:87], v[76:79]
ds_read_b64_tr_b16 v[120:121], v8 offset:16384
v_mfma_f32_16x16x32_bf16 v[80:83], v[132:135], a[88:91], v[80:83]
v_mfma_f32_16x16x32_bf16 v[84:87], v[132:135], a[92:95], v[84:87]
ds_read_b64_tr_b16 v[122:123], v8 offset:18432
v_mfma_f32_16x16x32_bf16 v[40:43], v[136:139], a[72:75], v[40:43]
v_mfma_f32_16x16x32_bf16 v[44:47], v[136:139], a[76:79], v[44:47]
ds_read_b64_tr_b16 v[124:125], v9 offset:16384
v_mfma_f32_16x16x32_bf16 v[48:51], v[136:139], a[80:83], v[48:51]
v_mfma_f32_16x16x32_bf16 v[88:91], v[136:139], a[84:87], v[88:91]
ds_read_b64_tr_b16 v[126:127], v9 offset:18432
v_mfma_f32_16x16x32_bf16 v[92:95], v[136:139], a[88:91], v[92:95]
v_mfma_f32_16x16x32_bf16 v[96:99], v[136:139], a[92:95], v[96:99]
v_mfma_f32_16x16x32_bf16 v[52:55], v[140:143], a[72:75], v[52:55]
v_mfma_f32_16x16x32_bf16 v[56:59], v[140:143], a[76:79], v[56:59]
v_mfma_f32_16x16x32_bf16 v[60:63], v[140:143], a[80:83], v[60:63]
v_mfma_f32_16x16x32_bf16 v[100:103], v[140:143], a[84:87], v[100:103]
v_mfma_f32_16x16x32_bf16 v[104:107], v[140:143], a[88:91], v[104:107]
v_mfma_f32_16x16x32_bf16 v[108:111], v[140:143], a[92:95], v[108:111]
s_waitcnt lgkmcnt(0)
s_waitcnt vmcnt(20)
v_mfma_f32_16x16x32_bf16 v[16:19], v[112:115], a[96:99], v[16:19]
v_mfma_f32_16x16x32_bf16 v[20:23], v[112:115], a[100:103], v[20:23]
ds_read_b64_tr_b16 v[128:129], v6 offset:20480
v_mfma_f32_16x16x32_bf16 v[24:27], v[112:115], a[104:107], v[24:27]
v_mfma_f32_16x16x32_bf16 v[64:67], v[112:115], a[108:111], v[64:67]
ds_read_b64_tr_b16 v[130:131], v6 offset:22528
v_mfma_f32_16x16x32_bf16 v[68:71], v[112:115], a[112:115], v[68:71]
v_mfma_f32_16x16x32_bf16 v[72:75], v[112:115], a[116:119], v[72:75]
ds_read_b64_tr_b16 v[132:133], v7 offset:20480
v_mfma_f32_16x16x32_bf16 v[28:31], v[116:119], a[96:99], v[28:31]
v_mfma_f32_16x16x32_bf16 v[32:35], v[116:119], a[100:103], v[32:35]
ds_read_b64_tr_b16 v[134:135], v7 offset:22528
v_mfma_f32_16x16x32_bf16 v[36:39], v[116:119], a[104:107], v[36:39]
v_mfma_f32_16x16x32_bf16 v[76:79], v[116:119], a[108:111], v[76:79]
ds_read_b64_tr_b16 v[136:137], v8 offset:20480
v_mfma_f32_16x16x32_bf16 v[80:83], v[116:119], a[112:115], v[80:83]
v_mfma_f32_16x16x32_bf16 v[84:87], v[116:119], a[116:119], v[84:87]
ds_read_b64_tr_b16 v[138:139], v8 offset:22528
v_mfma_f32_16x16x32_bf16 v[40:43], v[120:123], a[96:99], v[40:43]
v_mfma_f32_16x16x32_bf16 v[44:47], v[120:123], a[100:103], v[44:47]
ds_read_b64_tr_b16 v[140:141], v9 offset:20480
v_mfma_f32_16x16x32_bf16 v[48:51], v[120:123], a[104:107], v[48:51]
v_mfma_f32_16x16x32_bf16 v[88:91], v[120:123], a[108:111], v[88:91]
ds_read_b64_tr_b16 v[142:143], v9 offset:22528
v_mfma_f32_16x16x32_bf16 v[92:95], v[120:123], a[112:115], v[92:95]
v_mfma_f32_16x16x32_bf16 v[96:99], v[120:123], a[116:119], v[96:99]
v_mfma_f32_16x16x32_bf16 v[52:55], v[124:127], a[96:99], v[52:55]
v_mfma_f32_16x16x32_bf16 v[56:59], v[124:127], a[100:103], v[56:59]
v_mfma_f32_16x16x32_bf16 v[60:63], v[124:127], a[104:107], v[60:63]
v_mfma_f32_16x16x32_bf16 v[100:103], v[124:127], a[108:111], v[100:103]
v_mfma_f32_16x16x32_bf16 v[104:107], v[124:127], a[112:115], v[104:107]
v_mfma_f32_16x16x32_bf16 v[108:111], v[124:127], a[116:119], v[108:111]
s_waitcnt lgkmcnt(0)
s_waitcnt vmcnt(10)
v_mfma_f32_16x16x32_bf16 v[16:19], v[128:131], a[120:123], v[16:19]
v_mfma_f32_16x16x32_bf16 v[20:23], v[128:131], a[124:127], v[20:23]
ds_read_b64_tr_b16 v[112:113], v6 offset:24576
v_mfma_f32_16x16x32_bf16 v[24:27], v[128:131], a[128:131], v[24:27]
v_mfma_f32_16x16x32_bf16 v[64:67], v[128:131], a[132:135], v[64:67]
ds_read_b64_tr_b16 v[114:115], v6 offset:26624
v_mfma_f32_16x16x32_bf16 v[68:71], v[128:131], a[136:139], v[68:71]
v_mfma_f32_16x16x32_bf16 v[72:75], v[128:131], a[140:143], v[72:75]
ds_read_b64_tr_b16 v[116:117], v7 offset:24576
v_mfma_f32_16x16x32_bf16 v[28:31], v[132:135], a[120:123], v[28:31]
v_mfma_f32_16x16x32_bf16 v[32:35], v[132:135], a[124:127], v[32:35]
ds_read_b64_tr_b16 v[118:119], v7 offset:26624
v_mfma_f32_16x16x32_bf16 v[36:39], v[132:135], a[128:131], v[36:39]
v_mfma_f32_16x16x32_bf16 v[76:79], v[132:135], a[132:135], v[76:79]
ds_read_b64_tr_b16 v[120:121], v8 offset:24576
v_mfma_f32_16x16x32_bf16 v[80:83], v[132:135], a[136:139], v[80:83]
v_mfma_f32_16x16x32_bf16 v[84:87], v[132:135], a[140:143], v[84:87]
ds_read_b64_tr_b16 v[122:123], v8 offset:26624
v_mfma_f32_16x16x32_bf16 v[40:43], v[136:139], a[120:123], v[40:43]
v_mfma_f32_16x16x32_bf16 v[44:47], v[136:139], a[124:127], v[44:47]
ds_read_b64_tr_b16 v[124:125], v9 offset:24576
v_mfma_f32_16x16x32_bf16 v[48:51], v[136:139], a[128:131], v[48:51]
v_mfma_f32_16x16x32_bf16 v[88:91], v[136:139], a[132:135], v[88:91]
ds_read_b64_tr_b16 v[126:127], v9 offset:26624
v_mfma_f32_16x16x32_bf16 v[92:95], v[136:139], a[136:139], v[92:95]
v_mfma_f32_16x16x32_bf16 v[96:99], v[136:139], a[140:143], v[96:99]
v_mfma_f32_16x16x32_bf16 v[52:55], v[140:143], a[120:123], v[52:55]
v_mfma_f32_16x16x32_bf16 v[56:59], v[140:143], a[124:127], v[56:59]
v_mfma_f32_16x16x32_bf16 v[60:63], v[140:143], a[128:131], v[60:63]
v_mfma_f32_16x16x32_bf16 v[100:103], v[140:143], a[132:135], v[100:103]
v_mfma_f32_16x16x32_bf16 v[104:107], v[140:143], a[136:139], v[104:107]
v_mfma_f32_16x16x32_bf16 v[108:111], v[140:143], a[140:143], v[108:111]
s_waitcnt lgkmcnt(0)
s_waitcnt vmcnt(0)
v_mfma_f32_16x16x32_bf16 v[16:19], v[112:115], a[144:147], v[16:19]
v_mfma_f32_16x16x32_bf16 v[20:23], v[112:115], a[148:151], v[20:23]
ds_read_b64_tr_b16 v[128:129], v6 offset:28672
v_mfma_f32_16x16x32_bf16 v[24:27], v[112:115], a[152:155], v[24:27]
v_mfma_f32_16x16x32_bf16 v[64:67], v[112:115], a[156:159], v[64:67]
ds_read_b64_tr_b16 v[130:131], v6 offset:30720
v_mfma_f32_16x16x32_bf16 v[68:71], v[112:115], a[160:163], v[68:71]
v_mfma_f32_16x16x32_bf16 v[72:75], v[112:115], a[164:167], v[72:75]
ds_read_b64_tr_b16 v[132:133], v7 offset:28672
v_mfma_f32_16x16x32_bf16 v[28:31], v[116:119], a[144:147], v[28:31]
v_mfma_f32_16x16x32_bf16 v[32:35], v[116:119], a[148:151], v[32:35]
ds_read_b64_tr_b16 v[134:135], v7 offset:30720
v_mfma_f32_16x16x32_bf16 v[36:39], v[116:119], a[152:155], v[36:39]
v_mfma_f32_16x16x32_bf16 v[76:79], v[116:119], a[156:159], v[76:79]
ds_read_b64_tr_b16 v[136:137], v8 offset:28672
v_mfma_f32_16x16x32_bf16 v[80:83], v[116:119], a[160:163], v[80:83]
v_mfma_f32_16x16x32_bf16 v[84:87], v[116:119], a[164:167], v[84:87]
ds_read_b64_tr_b16 v[138:139], v8 offset:30720
v_mfma_f32_16x16x32_bf16 v[40:43], v[120:123], a[144:147], v[40:43]
v_mfma_f32_16x16x32_bf16 v[44:47], v[120:123], a[148:151], v[44:47]
ds_read_b64_tr_b16 v[140:141], v9 offset:28672
v_mfma_f32_16x16x32_bf16 v[48:51], v[120:123], a[152:155], v[48:51]
v_mfma_f32_16x16x32_bf16 v[88:91], v[120:123], a[156:159], v[88:91]
ds_read_b64_tr_b16 v[142:143], v9 offset:30720
v_mfma_f32_16x16x32_bf16 v[92:95], v[120:123], a[160:163], v[92:95]
v_mfma_f32_16x16x32_bf16 v[96:99], v[120:123], a[164:167], v[96:99]
v_mfma_f32_16x16x32_bf16 v[52:55], v[124:127], a[144:147], v[52:55]
v_mfma_f32_16x16x32_bf16 v[56:59], v[124:127], a[148:151], v[56:59]
v_mfma_f32_16x16x32_bf16 v[60:63], v[124:127], a[152:155], v[60:63]
v_mfma_f32_16x16x32_bf16 v[100:103], v[124:127], a[156:159], v[100:103]
v_mfma_f32_16x16x32_bf16 v[104:107], v[124:127], a[160:163], v[104:107]
v_mfma_f32_16x16x32_bf16 v[108:111], v[124:127], a[164:167], v[108:111]
s_waitcnt lgkmcnt(0)
v_mfma_f32_16x16x32_bf16 v[16:19], v[128:131], a[168:171], v[16:19]
v_mfma_f32_16x16x32_bf16 v[20:23], v[128:131], a[172:175], v[20:23]
v_mfma_f32_16x16x32_bf16 v[24:27], v[128:131], a[176:179], v[24:27]
v_mfma_f32_16x16x32_bf16 v[64:67], v[128:131], a[180:183], v[64:67]
v_mfma_f32_16x16x32_bf16 v[68:71], v[128:131], a[184:187], v[68:71]
v_mfma_f32_16x16x32_bf16 v[72:75], v[128:131], a[188:191], v[72:75]
v_mfma_f32_16x16x32_bf16 v[28:31], v[132:135], a[168:171], v[28:31]
v_mfma_f32_16x16x32_bf16 v[32:35], v[132:135], a[172:175], v[32:35]
v_mfma_f32_16x16x32_bf16 v[36:39], v[132:135], a[176:179], v[36:39]
ds_write_b128 v233, v[16:19] offset:0
v_mfma_f32_16x16x32_bf16 v[76:79], v[132:135], a[180:183], v[76:79]
ds_write_b128 v233, v[20:23] offset:4096
v_mfma_f32_16x16x32_bf16 v[80:83], v[132:135], a[184:187], v[80:83]
ds_write_b128 v233, v[24:27] offset:8192
v_mfma_f32_16x16x32_bf16 v[84:87], v[132:135], a[188:191], v[84:87]
ds_write_b128 v233, v[64:67] offset:12288
v_mfma_f32_16x16x32_bf16 v[40:43], v[136:139], a[168:171], v[40:43]
ds_write_b128 v233, v[68:71] offset:16384
v_mfma_f32_16x16x32_bf16 v[44:47], v[136:139], a[172:175], v[44:47]
ds_write_b128 v233, v[72:75] offset:20480
v_mfma_f32_16x16x32_bf16 v[48:51], v[136:139], a[176:179], v[48:51]
ds_write_b128 v234, v[28:31] offset:0
v_mfma_f32_16x16x32_bf16 v[88:91], v[136:139], a[180:183], v[88:91]
ds_write_b128 v234, v[32:35] offset:4096
v_mfma_f32_16x16x32_bf16 v[92:95], v[136:139], a[184:187], v[92:95]
ds_write_b128 v234, v[36:39] offset:8192
v_mfma_f32_16x16x32_bf16 v[96:99], v[136:139], a[188:191], v[96:99]
ds_write_b128 v234, v[76:79] offset:12288
v_mfma_f32_16x16x32_bf16 v[52:55], v[140:143], a[168:171], v[52:55]
ds_write_b128 v234, v[80:83] offset:16384
v_mfma_f32_16x16x32_bf16 v[56:59], v[140:143], a[172:175], v[56:59]
ds_write_b128 v234, v[84:87] offset:20480
v_mfma_f32_16x16x32_bf16 v[60:63], v[140:143], a[176:179], v[60:63]
ds_write_b128 v235, v[40:43] offset:0
v_mfma_f32_16x16x32_bf16 v[100:103], v[140:143], a[180:183], v[100:103]
ds_write_b128 v235, v[44:47] offset:4096
v_mfma_f32_16x16x32_bf16 v[104:107], v[140:143], a[184:187], v[104:107]
ds_write_b128 v235, v[48:51] offset:8192
v_mfma_f32_16x16x32_bf16 v[108:111], v[140:143], a[188:191], v[108:111]
ds_write_b128 v235, v[88:91] offset:12288
ds_write_b128 v235, v[92:95] offset:16384
ds_write_b128 v235, v[96:99] offset:20480
ds_write_b128 v236, v[52:55] offset:0
ds_write_b128 v236, v[56:59] offset:4096
ds_write_b128 v236, v[60:63] offset:8192
ds_write_b128 v236, v[100:103] offset:12288
ds_write_b128 v236, v[104:107] offset:16384
ds_write_b128 v236, v[108:111] offset:20480
s_branch L_ofin2
L_partB:
s_lshl_b32 s64, s78, 7
s_add_u32 s36, s22, s64
s_addc_u32 s37, s23, 0
s_sub_u32 s38, 8388608, s64
s_mov_b32 s39, 0x20000
s_mul_i32 s64, s30, 393216
s_add_u32 s64, s64, 4194304
s_add_u32 s32, s28, s64
s_addc_u32 s33, s29, 0
s_mov_b32 s34, 1179648
s_mov_b32 s35, 0x20000
s_mul_i32 s64, s30, 196608
s_lshl_b32 s65, s78, 7
s_add_u32 s64, s64, s65
s_add_u32 s64, s64, 2048
s_add_u32 s52, s24, s64
s_addc_u32 s53, s25, 0
s_sub_u32 s54, 1572864, s64
s_mov_b32 s55, 0x20000
v_lshrrev_b32 v11, 1, v1
v_add_u32 v11, s62, v11
v_and_b32 v11, 3, v11
v_add_u32 v12, s56, v11
v_and_b32 v12, 3, v12
v_lshl_add_u32 v11, v11, 2, v12
s_lshl_b32 s64, s30, 2
s_lshl3_add_u32 s64, s64, s76
s_add_u32 s64, s64, 512
v_lshl_add_u32 v11, v11, 1, s64
v_and_b32 v12, 1, v1
v_lshl_add_u32 v11, v12, 6, v11
v_lshlrev_b32 v11, 7, v11
s_mov_b64 exec, 0xff
global_load_dwordx4 v[12:15], v11, s[98:99] sc1
s_mov_b64 exec, -1
s_waitcnt vmcnt(0)
v_mov_b32 v248, 1
v_mov_b32 v249, 1
v_mov_b32 v250, 1
v_mov_b32 v251, 1
s_barrier
s_cmp_lg_u32 s56, 0
s_cbranch_scc1 nosig_17
s_mov_b64 exec, 1
global_store_dwordx4 v216, v[248:251], s[98:99] sc1
s_mov_b64 exec, -1
nosig_17:
v_min3_u32 v12, v12, v13, v14
v_min_u32 v12, v12, v15
v_cmp_ne_u32 vcc, 0, v12
s_nop 0
s_andn2_b32 s64, 0xff, vcc_lo
s_cbranch_scc0 L_b1ok
s_mov_b32 s31, 0x200000
poll_18:
s_mov_b64 exec, 0xff
global_load_dwordx4 v[12:15], v11, s[98:99] sc1
s_mov_b64 exec, -1
pollw_20:
s_waitcnt vmcnt(0)
v_min3_u32 v12, v12, v13, v14
v_min_u32 v12, v12, v15
v_cmp_ne_u32 vcc, 0, v12
s_nop 0
s_andn2_b32 s64, 0xff, vcc_lo
s_cbranch_scc0 polled_19
s_sleep 4
s_sub_u32 s31, s31, 1
s_cbranch_scc0 poll_18
polled_19:
L_b1ok:
s_mov_b32 s68, 0
s_add_u32 s64, s68, s56
s_and_b32 s64, s64, 3
s_lshl2_add_u32 s68, s68, s64
s_lshl1_add_u32 s68, s68, s76
s_lshl_b32 s68, s68, 2
s_add_u32 s71, s62, 0
s_and_b32 s71, s71, 3
s_add_u32 s71, s71, s68
s_lshl_b32 s71, s71, 16
s_add_u32 m0, s57, 0
s_nop 0
buffer_load_dwordx4 v2, s[36:39], s71 offen offset:0 lds
buffer_load_dwordx4 v3, s[36:39], s71 offen offset:1024 lds
buffer_load_dwordx4 v4, s[36:39], s71 offen offset:2048 lds
buffer_load_dwordx4 v5, s[36:39], s71 offen offset:3072 lds
s_mov_b32 s69, 0
s_add_u32 s64, s69, s56
s_and_b32 s64, s64, 3
s_lshl2_add_u32 s69, s69, s64
s_lshl1_add_u32 s69, s69, s76
s_mul_i32 s69, s69, 12
s_add_u32 s72, s62, 0
s_and_b32 s72, s72, 3
s_add_u32 s72, s72, s69
s_lshl_b32 s72, s72, 10
buffer_load_dwordx4 a[0:3], v10, s[32:35], s72 offen offset:0 sc1
s_add_u32 s67, s72, 4096
buffer_load_dwordx4 a[4:7], v10, s[32:35], s67 offen offset:0 sc1
s_add_u32 s67, s72, 8192
buffer_load_dwordx4 a[8:11], v10, s[32:35], s67 offen offset:0 sc1
s_add_u32 s67, s72, 786432
buffer_load_dwordx4 a[12:15], v10, s[32:35], s67 offen offset:0 sc1
s_add_u32 s67, s72, 790528
buffer_load_dwordx4 a[16:19], v10, s[32:35], s67 offen offset:0 sc1
s_add_u32 s67, s72, 794624
buffer_load_dwordx4 a[20:23], v10, s[32:35], s67 offen offset:0 sc1
s_add_u32 s71, s62, 1
s_and_b32 s71, s71, 3
s_add_u32 s71, s71, s68
s_lshl_b32 s71, s71, 16
s_add_u32 m0, s57, 4096
s_nop 0
buffer_load_dwordx4 v2, s[36:39], s71 offen offset:0 lds
buffer_load_dwordx4 v3, s[36:39], s71 offen offset:1024 lds
buffer_load_dwordx4 v4, s[36:39], s71 offen offset:2048 lds
buffer_load_dwordx4 v5, s[36:39], s71 offen offset:3072 lds
s_add_u32 s72, s62, 1
s_and_b32 s72, s72, 3
s_add_u32 s72, s72, s69
s_lshl_b32 s72, s72, 10
buffer_load_dwordx4 a[24:27], v10, s[32:35], s72 offen offset:0 sc1
s_add_u32 s67, s72, 4096
buffer_load_dwordx4 a[28:31], v10, s[32:35], s67 offen offset:0 sc1
s_add_u32 s67, s72, 8192
buffer_load_dwordx4 a[32:35], v10, s[32:35], s67 offen offset:0 sc1
s_add_u32 s67, s72, 786432
buffer_load_dwordx4 a[36:39], v10, s[32:35], s67 offen offset:0 sc1
s_add_u32 s67, s72, 790528
buffer_load_dwordx4 a[40:43], v10, s[32:35], s67 offen offset:0 sc1
s_add_u32 s67, s72, 794624
buffer_load_dwordx4 a[44:47], v10, s[32:35], s67 offen offset:0 sc1
s_add_u32 s71, s62, 2
s_and_b32 s71, s71, 3
s_add_u32 s71, s71, s68
s_lshl_b32 s71, s71, 16
s_add_u32 m0, s57, 8192
s_nop 0
buffer_load_dwordx4 v2, s[36:39], s71 offen offset:0 lds
buffer_load_dwordx4 v3, s[36:39], s71 offen offset:1024 lds
buffer_load_dwordx4 v4, s[36:39], s71 offen offset:2048 lds
buffer_load_dwordx4 v5, s[36:39], s71 offen offset:3072 lds
s_add_u32 s72, s62, 2
s_and_b32 s72, s72, 3
s_add_u32 s72, s72, s69
s_lshl_b32 s72, s72, 10
buffer_load_dwordx4 a[48:51], v10, s[32:35], s72 offen offset:0 sc1
s_add_u32 s67, s72, 4096
buffer_load_dwordx4 a[52:55], v10, s[32:35], s67 offen offset:0 sc1
s_add_u32 s67, s72, 8192
buffer_load_dwordx4 a[56:59], v10, s[32:35], s67 offen offset:0 sc1
s_add_u32 s67, s72, 786432
buffer_load_dwordx4 a[60:63], v10, s[32:35], s67 offen offset:0 sc1
s_add_u32 s67, s72, 790528
buffer_load_dwordx4 a[64:67], v10, s[32:35], s67 offen offset:0 sc1
s_add_u32 s67, s72, 794624
buffer_load_dwordx4 a[68:71], v10, s[32:35], s67 offen offset:0 sc1
s_add_u32 s71, s62, 3
s_and_b32 s71, s71, 3
s_add_u32 s71, s71, s68
s_lshl_b32 s71, s71, 16
s_add_u32 m0, s57, 12288
s_nop 0
buffer_load_dwordx4 v2, s[36:39], s71 offen offset:0 lds
buffer_load_dwordx4 v3, s[36:39], s71 offen offset:1024 lds
buffer_load_dwordx4 v4, s[36:39], s71 offen offset:2048 lds
buffer_load_dwordx4 v5, s[36:39], s71 offen offset:3072 lds
s_add_u32 s72, s62, 3
s_and_b32 s72, s72, 3
s_add_u32 s72, s72, s69
s_lshl_b32 s72, s72, 10
buffer_load_dwordx4 a[72:75], v10, s[32:35], s72 offen offset:0 sc1
s_add_u32 s67, s72, 4096
buffer_load_dwordx4 a[76:79], v10, s[32:35], s67 offen offset:0 sc1
s_add_u32 s67, s72, 8192
buffer_load_dwordx4 a[80:83], v10, s[32:35], s67 offen offset:0 sc1
s_add_u32 s67, s72, 786432
buffer_load_dwordx4 a[84:87], v10, s[32:35], s67 offen offset:0 sc1
s_add_u32 s67, s72, 790528
buffer_load_dwordx4 a[88:91], v10, s[32:35], s67 offen offset:0 sc1
s_add_u32 s67, s72, 794624
buffer_load_dwordx4 a[92:95], v10, s[32:35], s67 offen offset:0 sc1
s_mov_b32 s68, 1
s_add_u32 s64, s68, s56
s_and_b32 s64, s64, 3
s_lshl2_add_u32 s68, s68, s64
s_lshl1_add_u32 s68, s68, s76
s_lshl_b32 s68, s68, 2
s_add_u32 s71, s62, 0
s_and_b32 s71, s71, 3
s_add_u32 s71, s71, s68
s_lshl_b32 s71, s71, 16
s_add_u32 m0, s57, 16384
s_nop 0
buffer_load_dwordx4 v2, s[36:39], s71 offen offset:0 lds
buffer_load_dwordx4 v3, s[36:39], s71 offen offset:1024 lds
buffer_load_dwordx4 v4, s[36:39], s71 offen offset:2048 lds
buffer_load_dwordx4 v5, s[36:39], s71 offen offset:3072 lds
s_mov_b32 s69, 1
s_add_u32 s64, s69, s56
s_and_b32 s64, s64, 3
s_lshl2_add_u32 s69, s69, s64
s_lshl1_add_u32 s69, s69, s76
s_mul_i32 s69, s69, 12
s_add_u32 s72, s62, 0
s_and_b32 s72, s72, 3
s_add_u32 s72, s72, s69
s_lshl_b32 s72, s72, 10
buffer_load_dwordx4 a[96:99], v10, s[32:35], s72 offen offset:0 sc1
s_add_u32 s67, s72, 4096
buffer_load_dwordx4 a[100:103], v10, s[32:35], s67 offen offset:0 sc1
s_add_u32 s67, s72, 8192
buffer_load_dwordx4 a[104:107], v10, s[32:35], s67 offen offset:0 sc1
s_add_u32 s67, s72, 786432
buffer_load_dwordx4 a[108:111], v10, s[32:35], s67 offen offset:0 sc1
s_add_u32 s67, s72, 790528
buffer_load_dwordx4 a[112:115], v10, s[32:35], s67 offen offset:0 sc1
s_add_u32 s67, s72, 794624
buffer_load_dwordx4 a[116:119], v10, s[32:35], s67 offen offset:0 sc1
s_waitcnt vmcnt(40)
ds_read_b64_tr_b16 v[112:113], v6 offset:0
ds_read_b64_tr_b16 v[114:115], v6 offset:2048
ds_read_b64_tr_b16 v[116:117], v7 offset:0
ds_read_b64_tr_b16 v[118:119], v7 offset:2048
ds_read_b64_tr_b16 v[120:121], v8 offset:0
ds_read_b64_tr_b16 v[122:123], v8 offset:2048
ds_read_b64_tr_b16 v[124:125], v9 offset:0
ds_read_b64_tr_b16 v[126:127], v9 offset:2048
s_waitcnt lgkmcnt(0)
s_waitcnt vmcnt(30)
v_mfma_f32_16x16x32_bf16 v[16:19], v[112:115], a[0:3], 0
s_add_u32 s71, s62, 1
s_and_b32 s71, s71, 3
s_add_u32 s71, s71, s68
s_lshl_b32 s71, s71, 16
s_add_u32 m0, s57, 20480
s_nop 0
buffer_load_dwordx4 v2, s[36:39], s71 offen offset:0 lds
v_mfma_f32_16x16x32_bf16 v[20:23], v[112:115], a[4:7], 0
ds_read_b64_tr_b16 v[128:129], v6 offset:4096
v_mfma_f32_16x16x32_bf16 v[24:27], v[112:115], a[8:11], 0
v_mfma_f32_16x16x32_bf16 v[64:67], v[112:115], a[12:15], 0
ds_read_b64_tr_b16 v[130:131], v6 offset:6144
buffer_load_dwordx4 v3, s[36:39], s71 offen offset:1024 lds
v_mfma_f32_16x16x32_bf16 v[68:71], v[112:115], a[16:19], 0
v_mfma_f32_16x16x32_bf16 v[72:75], v[112:115], a[20:23], 0
ds_read_b64_tr_b16 v[132:133], v7 offset:4096
buffer_load_dwordx4 v4, s[36:39], s71 offen offset:2048 lds
v_mfma_f32_16x16x32_bf16 v[28:31], v[116:119], a[0:3], 0
v_mfma_f32_16x16x32_bf16 v[32:35], v[116:119], a[4:7], 0
ds_read_b64_tr_b16 v[134:135], v7 offset:6144
buffer_load_dwordx4 v5, s[36:39], s71 offen offset:3072 lds
v_mfma_f32_16x16x32_bf16 v[36:39], v[116:119], a[8:11], 0
v_mfma_f32_16x16x32_bf16 v[76:79], v[116:119], a[12:15], 0
ds_read_b64_tr_b16 v[136:137], v8 offset:4096
s_add_u32 s72, s62, 1
s_and_b32 s72, s72, 3
s_add_u32 s72, s72, s69
s_lshl_b32 s72, s72, 10
buffer_load_dwordx4 a[120:123], v10, s[32:35], s72 offen offset:0 sc1
v_mfma_f32_16x16x32_bf16 v[80:83], v[116:119], a[16:19], 0
v_mfma_f32_16x16x32_bf16 v[84:87], v[116:119], a[20:23], 0
ds_read_b64_tr_b16 v[138:139], v8 offset:6144
s_add_u32 s67, s72, 4096
buffer_load_dwordx4 a[124:127], v10, s[32:35], s67 offen offset:0 sc1
v_mfma_f32_16x16x32_bf16 v[40:43], v[120:123], a[0:3], 0
v_mfma_f32_16x16x32_bf16 v[44:47], v[120:123], a[4:7], 0
ds_read_b64_tr_b16 v[140:141], v9 offset:4096
v_mfma_f32_16x16x32_bf16 v[48:51], v[120:123], a[8:11], 0
s_add_u32 s67, s72, 8192
buffer_load_dwordx4 a[128:131], v10, s[32:35], s67 offen offset:0 sc1
v_mfma_f32_16x16x32_bf16 v[88:91], v[120:123], a[12:15], 0
ds_read_b64_tr_b16 v[142:143], v9 offset:6144
v_mfma_f32_16x16x32_bf16 v[92:95], v[120:123], a[16:19], 0
s_add_u32 s67, s72, 786432
buffer_load_dwordx4 a[132:135], v10, s[32:35], s67 offen offset:0 sc1
v_mfma_f32_16x16x32_bf16 v[96:99], v[120:123], a[20:23], 0
v_mfma_f32_16x16x32_bf16 v[52:55], v[124:127], a[0:3], 0
s_add_u32 s67, s72, 790528
buffer_load_dwordx4 a[136:139], v10, s[32:35], s67 offen offset:0 sc1
v_mfma_f32_16x16x32_bf16 v[56:59], v[124:127], a[4:7], 0
v_mfma_f32_16x16x32_bf16 v[60:63], v[124:127], a[8:11], 0
s_add_u32 s67, s72, 794624
buffer_load_dwordx4 a[140:143], v10, s[32:35], s67 offen offset:0 sc1
v_mfma_f32_16x16x32_bf16 v[100:103], v[124:127], a[12:15], 0
v_mfma_f32_16x16x32_bf16 v[104:107], v[124:127], a[16:19], 0
v_add_u32 v220, 4194304, v220
global_load_dword v221, v220, s[12:13]
v_mfma_f32_16x16x32_bf16 v[108:111], v[124:127], a[20:23], 0
s_waitcnt lgkmcnt(0)
s_waitcnt vmcnt(31)
v_mfma_f32_16x16x32_bf16 v[16:19], v[128:131], a[24:27], v[16:19]
s_add_u32 s71, s62, 2
s_and_b32 s71, s71, 3
s_add_u32 s71, s71, s68
s_lshl_b32 s71, s71, 16
s_add_u32 m0, s57, 24576
s_nop 0
buffer_load_dwordx4 v2, s[36:39], s71 offen offset:0 lds
v_mfma_f32_16x16x32_bf16 v[20:23], v[128:131], a[28:31], v[20:23]
ds_read_b64_tr_b16 v[112:113], v6 offset:8192
v_mfma_f32_16x16x32_bf16 v[24:27], v[128:131], a[32:35], v[24:27]
v_mfma_f32_16x16x32_bf16 v[64:67], v[128:131], a[36:39], v[64:67]
ds_read_b64_tr_b16 v[114:115], v6 offset:10240
buffer_load_dwordx4 v3, s[36:39], s71 offen offset:1024 lds
v_mfma_f32_16x16x32_bf16 v[68:71], v[128:131], a[40:43], v[68:71]
v_mfma_f32_16x16x32_bf16 v[72:75], v[128:131], a[44:47], v[72:75]
ds_read_b64_tr_b16 v[116:117], v7 offset:8192
buffer_load_dwordx4 v4, s[36:39], s71 offen offset:2048 lds
v_mfma_f32_16x16x32_bf16 v[28:31], v[132:135], a[24:27], v[28:31]
v_mfma_f32_16x16x32_bf16 v[32:35], v[132:135], a[28:31], v[32:35]
ds_read_b64_tr_b16 v[118:119], v7 offset:10240
v_mfma_f32_16x16x32_bf16 v[36:39], v[132:135], a[32:35], v[36:39]
buffer_load_dwordx4 v5, s[36:39], s71 offen offset:3072 lds
v_mfma_f32_16x16x32_bf16 v[76:79], v[132:135], a[36:39], v[76:79]
ds_read_b64_tr_b16 v[120:121], v8 offset:8192
v_mfma_f32_16x16x32_bf16 v[80:83], v[132:135], a[40:43], v[80:83]
s_add_u32 s72, s62, 2
s_and_b32 s72, s72, 3
s_add_u32 s72, s72, s69
s_lshl_b32 s72, s72, 10
buffer_load_dwordx4 a[144:147], v10, s[32:35], s72 offen offset:0 sc1
v_mfma_f32_16x16x32_bf16 v[84:87], v[132:135], a[44:47], v[84:87]
ds_read_b64_tr_b16 v[122:123], v8 offset:10240
v_mfma_f32_16x16x32_bf16 v[40:43], v[136:139], a[24:27], v[40:43]
s_add_u32 s67, s72, 4096
buffer_load_dwordx4 a[148:151], v10, s[32:35], s67 offen offset:0 sc1
v_mfma_f32_16x16x32_bf16 v[44:47], v[136:139], a[28:31], v[44:47]
ds_read_b64_tr_b16 v[124:125], v9 offset:8192
v_mfma_f32_16x16x32_bf16 v[48:51], v[136:139], a[32:35], v[48:51]
v_mfma_f32_16x16x32_bf16 v[88:91], v[136:139], a[36:39], v[88:91]
ds_read_b64_tr_b16 v[126:127], v9 offset:10240
s_add_u32 s67, s72, 8192
buffer_load_dwordx4 a[152:155], v10, s[32:35], s67 offen offset:0 sc1
v_mfma_f32_16x16x32_bf16 v[92:95], v[136:139], a[40:43], v[92:95]
v_mfma_f32_16x16x32_bf16 v[96:99], v[136:139], a[44:47], v[96:99]
s_add_u32 s67, s72, 786432
buffer_load_dwordx4 a[156:159], v10, s[32:35], s67 offen offset:0 sc1
v_mfma_f32_16x16x32_bf16 v[52:55], v[140:143], a[24:27], v[52:55]
v_mfma_f32_16x16x32_bf16 v[56:59], v[140:143], a[28:31], v[56:59]
v_mfma_f32_16x16x32_bf16 v[60:63], v[140:143], a[32:35], v[60:63]
s_add_u32 s67, s72, 790528
buffer_load_dwordx4 a[160:163], v10, s[32:35], s67 offen offset:0 sc1
v_mfma_f32_16x16x32_bf16 v[100:103], v[140:143], a[36:39], v[100:103]
v_mfma_f32_16x16x32_bf16 v[104:107], v[140:143], a[40:43], v[104:107]
s_add_u32 s67, s72, 794624
buffer_load_dwordx4 a[164:167], v10, s[32:35], s67 offen offset:0 sc1
v_mfma_f32_16x16x32_bf16 v[108:111], v[140:143], a[44:47], v[108:111]
s_waitcnt lgkmcnt(0)
s_waitcnt vmcnt(31)
v_mfma_f32_16x16x32_bf16 v[16:19], v[112:115], a[48:51], v[16:19]
s_add_u32 s71, s62, 3
s_and_b32 s71, s71, 3
s_add_u32 s71, s71, s68
s_lshl_b32 s71, s71, 16
s_add_u32 m0, s57, 28672
s_nop 0
buffer_load_dwordx4 v2, s[36:39], s71 offen offset:0 lds
v_mfma_f32_16x16x32_bf16 v[20:23], v[112:115], a[52:55], v[20:23]
ds_read_b64_tr_b16 v[128:129], v6 offset:12288
v_mfma_f32_16x16x32_bf16 v[24:27], v[112:115], a[56:59], v[24:27]
v_mfma_f32_16x16x32_bf16 v[64:67], v[112:115], a[60:63], v[64:67]
ds_read_b64_tr_b16 v[130:131], v6 offset:14336
buffer_load_dwordx4 v3, s[36:39], s71 offen offset:1024 lds
v_mfma_f32_16x16x32_bf16 v[68:71], v[112:115], a[64:67], v[68:71]
v_mfma_f32_16x16x32_bf16 v[72:75], v[112:115], a[68:71], v[72:75]
ds_read_b64_tr_b16 v[132:133], v7 offset:12288
buffer_load_dwordx4 v4, s[36:39], s71 offen offset:2048 lds
v_mfma_f32_16x16x32_bf16 v[28:31], v[116:119], a[48:51], v[28:31]
v_mfma_f32_16x16x32_bf16 v[32:35], v[116:119], a[52:55], v[32:35]
ds_read_b64_tr_b16 v[134:135], v7 offset:14336
v_mfma_f32_16x16x32_bf16 v[36:39], v[116:119], a[56:59], v[36:39]
buffer_load_dwordx4 v5, s[36:39], s71 offen offset:3072 lds
v_mfma_f32_16x16x32_bf16 v[76:79], v[116:119], a[60:63], v[76:79]
ds_read_b64_tr_b16 v[136:137], v8 offset:12288
v_mfma_f32_16x16x32_bf16 v[80:83], v[116:119], a[64:67], v[80:83]
s_add_u32 s72, s62, 3
s_and_b32 s72, s72, 3
s_add_u32 s72, s72, s69
s_lshl_b32 s72, s72, 10
buffer_load_dwordx4 a[168:171], v10, s[32:35], s72 offen offset:0 sc1
v_mfma_f32_16x16x32_bf16 v[84:87], v[116:119], a[68:71], v[84:87]
ds_read_b64_tr_b16 v[138:139], v8 offset:14336
v_mfma_f32_16x16x32_bf16 v[40:43], v[120:123], a[48:51], v[40:43]
s_add_u32 s67, s72, 4096
buffer_load_dwordx4 a[172:175], v10, s[32:35], s67 offen offset:0 sc1
v_mfma_f32_16x16x32_bf16 v[44:47], v[120:123], a[52:55], v[44:47]
ds_read_b64_tr_b16 v[140:141], v9 offset:12288
v_mfma_f32_16x16x32_bf16 v[48:51], v[120:123], a[56:59], v[48:51]
v_mfma_f32_16x16x32_bf16 v[88:91], v[120:123], a[60:63], v[88:91]
ds_read_b64_tr_b16 v[142:143], v9 offset:14336
s_add_u32 s67, s72, 8192
buffer_load_dwordx4 a[176:179], v10, s[32:35], s67 offen offset:0 sc1
v_mfma_f32_16x16x32_bf16 v[92:95], v[120:123], a[64:67], v[92:95]
v_mfma_f32_16x16x32_bf16 v[96:99], v[120:123], a[68:71], v[96:99]
s_add_u32 s67, s72, 786432
buffer_load_dwordx4 a[180:183], v10, s[32:35], s67 offen offset:0 sc1
v_mfma_f32_16x16x32_bf16 v[52:55], v[124:127], a[48:51], v[52:55]
v_mfma_f32_16x16x32_bf16 v[56:59], v[124:127], a[52:55], v[56:59]
v_mfma_f32_16x16x32_bf16 v[60:63], v[124:127], a[56:59], v[60:63]
s_add_u32 s67, s72, 790528
buffer_load_dwordx4 a[184:187], v10, s[32:35], s67 offen offset:0 sc1
v_mfma_f32_16x16x32_bf16 v[100:103], v[124:127], a[60:63], v[100:103]
v_mfma_f32_16x16x32_bf16 v[104:107], v[124:127], a[64:67], v[104:107]
s_add_u32 s67, s72, 794624
buffer_load_dwordx4 a[188:191], v10, s[32:35], s67 offen offset:0 sc1
v_mfma_f32_16x16x32_bf16 v[108:111], v[124:127], a[68:71], v[108:111]
s_waitcnt lgkmcnt(0)
s_waitcnt vmcnt(31)
v_mfma_f32_16x16x32_bf16 v[16:19], v[128:131], a[72:75], v[16:19]
s_mov_b32 s68, 2
s_add_u32 s64, s68, s56
s_and_b32 s64, s64, 3
s_lshl2_add_u32 s68, s68, s64
s_lshl1_add_u32 s68, s68, s76
s_lshl_b32 s68, s68, 2
s_add_u32 s71, s62, 0
s_and_b32 s71, s71, 3
s_add_u32 s71, s71, s68
s_lshl_b32 s71, s71, 16
s_add_u32 m0, s57, 0
s_nop 0
buffer_load_dwordx4 v2, s[36:39], s71 offen offset:0 lds
v_mfma_f32_16x16x32_bf16 v[20:23], v[128:131], a[76:79], v[20:23]
ds_read_b64_tr_b16 v[112:113], v6 offset:16384
v_mfma_f32_16x16x32_bf16 v[24:27], v[128:131], a[80:83], v[24:27]
v_mfma_f32_16x16x32_bf16 v[64:67], v[128:131], a[84:87], v[64:67]
ds_read_b64_tr_b16 v[114:115], v6 offset:18432
buffer_load_dwordx4 v3, s[36:39], s71 offen offset:1024 lds
v_mfma_f32_16x16x32_bf16 v[68:71], v[128:131], a[88:91], v[68:71]
v_mfma_f32_16x16x32_bf16 v[72:75], v[128:131], a[92:95], v[72:75]
ds_read_b64_tr_b16 v[116:117], v7 offset:16384
buffer_load_dwordx4 v4, s[36:39], s71 offen offset:2048 lds
v_mfma_f32_16x16x32_bf16 v[28:31], v[132:135], a[72:75], v[28:31]
v_mfma_f32_16x16x32_bf16 v[32:35], v[132:135], a[76:79], v[32:35]
ds_read_b64_tr_b16 v[118:119], v7 offset:18432
v_mfma_f32_16x16x32_bf16 v[36:39], v[132:135], a[80:83], v[36:39]
buffer_load_dwordx4 v5, s[36:39], s71 offen offset:3072 lds
v_mfma_f32_16x16x32_bf16 v[76:79], v[132:135], a[84:87], v[76:79]
ds_read_b64_tr_b16 v[120:121], v8 offset:16384
v_mfma_f32_16x16x32_bf16 v[80:83], v[132:135], a[88:91], v[80:83]
s_mov_b32 s69, 2
s_add_u32 s64, s69, s56
s_and_b32 s64, s64, 3
s_lshl2_add_u32 s69, s69, s64
s_lshl1_add_u32 s69, s69, s76
s_mul_i32 s69, s69, 12
s_add_u32 s72, s62, 0
s_and_b32 s72, s72, 3
s_add_u32 s72, s72, s69
s_lshl_b32 s72, s72, 10
buffer_load_dwordx4 a[0:3], v10, s[32:35], s72 offen offset:0 sc1
v_mfma_f32_16x16x32_bf16 v[84:87], v[132:135], a[92:95], v[84:87]
ds_read_b64_tr_b16 v[122:123], v8 offset:18432
v_mfma_f32_16x16x32_bf16 v[40:43], v[136:139], a[72:75], v[40:43]
s_add_u32 s67, s72, 4096
buffer_load_dwordx4 a[4:7], v10, s[32:35], s67 offen offset:0 sc1
v_mfma_f32_16x16x32_bf16 v[44:47], v[136:139], a[76:79], v[44:47]
ds_read_b64_tr_b16 v[124:125], v9 offset:16384
v_mfma_f32_16x16x32_bf16 v[48:51], v[136:139], a[80:83], v[48:51]
v_mfma_f32_16x16x32_bf16 v[88:91], v[136:139], a[84:87], v[88:91]
ds_read_b64_tr_b16 v[126:127], v9 offset:18432
s_add_u32 s67, s72, 8192
buffer_load_dwordx4 a[8:11], v10, s[32:35], s67 offen offset:0 sc1
v_mfma_f32_16x16x32_bf16 v[92:95], v[136:139], a[88:91], v[92:95]
v_mfma_f32_16x16x32_bf16 v[96:99], v[136:139], a[92:95], v[96:99]
s_add_u32 s67, s72, 786432
buffer_load_dwordx4 a[12:15], v10, s[32:35], s67 offen offset:0 sc1
v_mfma_f32_16x16x32_bf16 v[52:55], v[140:143], a[72:75], v[52:55]
v_mfma_f32_16x16x32_bf16 v[56:59], v[140:143], a[76:79], v[56:59]
v_mfma_f32_16x16x32_bf16 v[60:63], v[140:143], a[80:83], v[60:63]
s_add_u32 s67, s72, 790528
buffer_load_dwordx4 a[16:19], v10, s[32:35], s67 offen offset:0 sc1
v_mfma_f32_16x16x32_bf16 v[100:103], v[140:143], a[84:87], v[100:103]
v_mfma_f32_16x16x32_bf16 v[104:107], v[140:143], a[88:91], v[104:107]
s_add_u32 s67, s72, 794624
buffer_load_dwordx4 a[20:23], v10, s[32:35], s67 offen offset:0 sc1
v_mfma_f32_16x16x32_bf16 v[108:111], v[140:143], a[92:95], v[108:111]
s_waitcnt lgkmcnt(0)
s_waitcnt vmcnt(31)
v_mfma_f32_16x16x32_bf16 v[16:19], v[112:115], a[96:99], v[16:19]
s_add_u32 s71, s62, 1
s_and_b32 s71, s71, 3
s_add_u32 s71, s71, s68
s_lshl_b32 s71, s71, 16
s_add_u32 m0, s57, 4096
s_nop 0
buffer_load_dwordx4 v2, s[36:39], s71 offen offset:0 lds
v_mfma_f32_16x16x32_bf16 v[20:23], v[112:115], a[100:103], v[20:23]
ds_read_b64_tr_b16 v[128:129], v6 offset:20480
v_mfma_f32_16x16x32_bf16 v[24:27], v[112:115], a[104:107], v[24:27]
v_mfma_f32_16x16x32_bf16 v[64:67], v[112:115], a[108:111], v[64:67]
ds_read_b64_tr_b16 v[130:131], v6 offset:22528
buffer_load_dwordx4 v3, s[36:39], s71 offen offset:1024 lds
v_mfma_f32_16x16x32_bf16 v[68:71], v[112:115], a[112:115], v[68:71]
v_mfma_f32_16x16x32_bf16 v[72:75], v[112:115], a[116:119], v[72:75]
ds_read_b64_tr_b16 v[132:133], v7 offset:20480
buffer_load_dwordx4 v4, s[36:39], s71 offen offset:2048 lds
v_mfma_f32_16x16x32_bf16 v[28:31], v[116:119], a[96:99], v[28:31]
v_mfma_f32_16x16x32_bf16 v[32:35], v[116:119], a[100:103], v[32:35]
ds_read_b64_tr_b16 v[134:135], v7 offset:22528
buffer_load_dwordx4 v5, s[36:39], s71 offen offset:3072 lds
v_mfma_f32_16x16x32_bf16 v[36:39], v[116:119], a[104:107], v[36:39]
v_mfma_f32_16x16x32_bf16 v[76:79], v[116:119], a[108:111], v[76:79]
ds_read_b64_tr_b16 v[136:137], v8 offset:20480
s_add_u32 s72, s62, 1
s_and_b32 s72, s72, 3
s_add_u32 s72, s72, s69
s_lshl_b32 s72, s72, 10
buffer_load_dwordx4 a[24:27], v10, s[32:35], s72 offen offset:0 sc1
v_mfma_f32_16x16x32_bf16 v[80:83], v[116:119], a[112:115], v[80:83]
v_mfma_f32_16x16x32_bf16 v[84:87], v[116:119], a[116:119], v[84:87]
ds_read_b64_tr_b16 v[138:139], v8 offset:22528
s_add_u32 s67, s72, 4096
buffer_load_dwordx4 a[28:31], v10, s[32:35], s67 offen offset:0 sc1
v_mfma_f32_16x16x32_bf16 v[40:43], v[120:123], a[96:99], v[40:43]
v_mfma_f32_16x16x32_bf16 v[44:47], v[120:123], a[100:103], v[44:47]
ds_read_b64_tr_b16 v[140:141], v9 offset:20480
v_mfma_f32_16x16x32_bf16 v[48:51], v[120:123], a[104:107], v[48:51]
s_add_u32 s67, s72, 8192
buffer_load_dwordx4 a[32:35], v10, s[32:35], s67 offen offset:0 sc1
v_mfma_f32_16x16x32_bf16 v[88:91], v[120:123], a[108:111], v[88:91]
ds_read_b64_tr_b16 v[142:143], v9 offset:22528
v_mfma_f32_16x16x32_bf16 v[92:95], v[120:123], a[112:115], v[92:95]
s_add_u32 s67, s72, 786432
buffer_load_dwordx4 a[36:39], v10, s[32:35], s67 offen offset:0 sc1
v_mfma_f32_16x16x32_bf16 v[96:99], v[120:123], a[116:119], v[96:99]
v_mfma_f32_16x16x32_bf16 v[52:55], v[124:127], a[96:99], v[52:55]
s_add_u32 s67, s72, 790528
buffer_load_dwordx4 a[40:43], v10, s[32:35], s67 offen offset:0 sc1
v_mfma_f32_16x16x32_bf16 v[56:59], v[124:127], a[100:103], v[56:59]
v_mfma_f32_16x16x32_bf16 v[60:63], v[124:127], a[104:107], v[60:63]
s_add_u32 s67, s72, 794624
buffer_load_dwordx4 a[44:47], v10, s[32:35], s67 offen offset:0 sc1
v_mfma_f32_16x16x32_bf16 v[100:103], v[124:127], a[108:111], v[100:103]
v_mfma_f32_16x16x32_bf16 v[104:107], v[124:127], a[112:115], v[104:107]
v_add_u32 v220, -3932160, v220
global_load_dword v221, v220, s[12:13]
v_mfma_f32_16x16x32_bf16 v[108:111], v[124:127], a[116:119], v[108:111]
s_waitcnt lgkmcnt(0)
s_waitcnt vmcnt(31)
v_mfma_f32_16x16x32_bf16 v[16:19], v[128:131], a[120:123], v[16:19]
s_add_u32 s71, s62, 2
s_and_b32 s71, s71, 3
s_add_u32 s71, s71, s68
s_lshl_b32 s71, s71, 16
s_add_u32 m0, s57, 8192
s_nop 0
buffer_load_dwordx4 v2, s[36:39], s71 offen offset:0 lds
v_mfma_f32_16x16x32_bf16 v[20:23], v[128:131], a[124:127], v[20:23]
ds_read_b64_tr_b16 v[112:113], v6 offset:24576
v_mfma_f32_16x16x32_bf16 v[24:27], v[128:131], a[128:131], v[24:27]
v_mfma_f32_16x16x32_bf16 v[64:67], v[128:131], a[132:135], v[64:67]
ds_read_b64_tr_b16 v[114:115], v6 offset:26624
buffer_load_dwordx4 v3, s[36:39], s71 offen offset:1024 lds
v_mfma_f32_16x16x32_bf16 v[68:71], v[128:131], a[136:139], v[68:71]
v_mfma_f32_16x16x32_bf16 v[72:75], v[128:131], a[140:143], v[72:75]
ds_read_b64_tr_b16 v[116:117], v7 offset:24576
buffer_load_dwordx4 v4, s[36:39], s71 offen offset:2048 lds
v_mfma_f32_16x16x32_bf16 v[28:31], v[132:135], a[120:123], v[28:31]
v_mfma_f32_16x16x32_bf16 v[32:35], v[132:135], a[124:127], v[32:35]
ds_read_b64_tr_b16 v[118:119], v7 offset:26624
v_mfma_f32_16x16x32_bf16 v[36:39], v[132:135], a[128:131], v[36:39]
buffer_load_dwordx4 v5, s[36:39], s71 offen offset:3072 lds
v_mfma_f32_16x16x32_bf16 v[76:79], v[132:135], a[132:135], v[76:79]
ds_read_b64_tr_b16 v[120:121], v8 offset:24576
v_mfma_f32_16x16x32_bf16 v[80:83], v[132:135], a[136:139], v[80:83]
s_add_u32 s72, s62, 2
s_and_b32 s72, s72, 3
s_add_u32 s72, s72, s69
s_lshl_b32 s72, s72, 10
buffer_load_dwordx4 a[48:51], v10, s[32:35], s72 offen offset:0 sc1
v_mfma_f32_16x16x32_bf16 v[84:87], v[132:135], a[140:143], v[84:87]
ds_read_b64_tr_b16 v[122:123], v8 offset:26624
v_mfma_f32_16x16x32_bf16 v[40:43], v[136:139], a[120:123], v[40:43]
s_add_u32 s67, s72, 4096
buffer_load_dwordx4 a[52:55], v10, s[32:35], s67 offen offset:0 sc1
v_mfma_f32_16x16x32_bf16 v[44:47], v[136:139], a[124:127], v[44:47]
ds_read_b64_tr_b16 v[124:125], v9 offset:24576
v_mfma_f32_16x16x32_bf16 v[48:51], v[136:139], a[128:131], v[48:51]
v_mfma_f32_16x16x32_bf16 v[88:91], v[136:139], a[132:135], v[88:91]
ds_read_b64_tr_b16 v[126:127], v9 offset:26624
s_add_u32 s67, s72, 8192
buffer_load_dwordx4 a[56:59], v10, s[32:35], s67 offen offset:0 sc1
v_mfma_f32_16x16x32_bf16 v[92:95], v[136:139], a[136:139], v[92:95]
v_mfma_f32_16x16x32_bf16 v[96:99], v[136:139], a[140:143], v[96:99]
s_add_u32 s67, s72, 786432
buffer_load_dwordx4 a[60:63], v10, s[32:35], s67 offen offset:0 sc1
v_mfma_f32_16x16x32_bf16 v[52:55], v[140:143], a[120:123], v[52:55]
v_mfma_f32_16x16x32_bf16 v[56:59], v[140:143], a[124:127], v[56:59]
v_mfma_f32_16x16x32_bf16 v[60:63], v[140:143], a[128:131], v[60:63]
s_add_u32 s67, s72, 790528
buffer_load_dwordx4 a[64:67], v10, s[32:35], s67 offen offset:0 sc1
v_mfma_f32_16x16x32_bf16 v[100:103], v[140:143], a[132:135], v[100:103]
v_mfma_f32_16x16x32_bf16 v[104:107], v[140:143], a[136:139], v[104:107]
s_add_u32 s67, s72, 794624
buffer_load_dwordx4 a[68:71], v10, s[32:35], s67 offen offset:0 sc1
v_mfma_f32_16x16x32_bf16 v[108:111], v[140:143], a[140:143], v[108:111]
s_waitcnt lgkmcnt(0)
s_waitcnt vmcnt(31)
v_mfma_f32_16x16x32_bf16 v[16:19], v[112:115], a[144:147], v[16:19]
s_add_u32 s71, s62, 3
s_and_b32 s71, s71, 3
s_add_u32 s71, s71, s68
s_lshl_b32 s71, s71, 16
s_add_u32 m0, s57, 12288
s_nop 0
buffer_load_dwordx4 v2, s[36:39], s71 offen offset:0 lds
v_mfma_f32_16x16x32_bf16 v[20:23], v[112:115], a[148:151], v[20:23]
ds_read_b64_tr_b16 v[128:129], v6 offset:28672
v_mfma_f32_16x16x32_bf16 v[24:27], v[112:115], a[152:155], v[24:27]
v_mfma_f32_16x16x32_bf16 v[64:67], v[112:115], a[156:159], v[64:67]
ds_read_b64_tr_b16 v[130:131], v6 offset:30720
buffer_load_dwordx4 v3, s[36:39], s71 offen offset:1024 lds
v_mfma_f32_16x16x32_bf16 v[68:71], v[112:115], a[160:163], v[68:71]
v_mfma_f32_16x16x32_bf16 v[72:75], v[112:115], a[164:167], v[72:75]
ds_read_b64_tr_b16 v[132:133], v7 offset:28672
buffer_load_dwordx4 v4, s[36:39], s71 offen offset:2048 lds
v_mfma_f32_16x16x32_bf16 v[28:31], v[116:119], a[144:147], v[28:31]
v_mfma_f32_16x16x32_bf16 v[32:35], v[116:119], a[148:151], v[32:35]
ds_read_b64_tr_b16 v[134:135], v7 offset:30720
v_mfma_f32_16x16x32_bf16 v[36:39], v[116:119], a[152:155], v[36:39]
buffer_load_dwordx4 v5, s[36:39], s71 offen offset:3072 lds
v_mfma_f32_16x16x32_bf16 v[76:79], v[116:119], a[156:159], v[76:79]
ds_read_b64_tr_b16 v[136:137], v8 offset:28672
v_mfma_f32_16x16x32_bf16 v[80:83], v[116:119], a[160:163], v[80:83]
s_add_u32 s72, s62, 3
s_and_b32 s72, s72, 3
s_add_u32 s72, s72, s69
s_lshl_b32 s72, s72, 10
buffer_load_dwordx4 a[72:75], v10, s[32:35], s72 offen offset:0 sc1
v_mfma_f32_16x16x32_bf16 v[84:87], v[116:119], a[164:167], v[84:87]
ds_read_b64_tr_b16 v[138:139], v8 offset:30720
v_mfma_f32_16x16x32_bf16 v[40:43], v[120:123], a[144:147], v[40:43]
s_add_u32 s67, s72, 4096
buffer_load_dwordx4 a[76:79], v10, s[32:35], s67 offen offset:0 sc1
v_mfma_f32_16x16x32_bf16 v[44:47], v[120:123], a[148:151], v[44:47]
ds_read_b64_tr_b16 v[140:141], v9 offset:28672
v_mfma_f32_16x16x32_bf16 v[48:51], v[120:123], a[152:155], v[48:51]
v_mfma_f32_16x16x32_bf16 v[88:91], v[120:123], a[156:159], v[88:91]
ds_read_b64_tr_b16 v[142:143], v9 offset:30720
s_add_u32 s67, s72, 8192
buffer_load_dwordx4 a[80:83], v10, s[32:35], s67 offen offset:0 sc1
v_mfma_f32_16x16x32_bf16 v[92:95], v[120:123], a[160:163], v[92:95]
v_mfma_f32_16x16x32_bf16 v[96:99], v[120:123], a[164:167], v[96:99]
s_add_u32 s67, s72, 786432
buffer_load_dwordx4 a[84:87], v10, s[32:35], s67 offen offset:0 sc1
v_mfma_f32_16x16x32_bf16 v[52:55], v[124:127], a[144:147], v[52:55]
v_mfma_f32_16x16x32_bf16 v[56:59], v[124:127], a[148:151], v[56:59]
v_mfma_f32_16x16x32_bf16 v[60:63], v[124:127], a[152:155], v[60:63]
s_add_u32 s67, s72, 790528
buffer_load_dwordx4 a[88:91], v10, s[32:35], s67 offen offset:0 sc1
v_mfma_f32_16x16x32_bf16 v[100:103], v[124:127], a[156:159], v[100:103]
v_mfma_f32_16x16x32_bf16 v[104:107], v[124:127], a[160:163], v[104:107]
s_add_u32 s67, s72, 794624
buffer_load_dwordx4 a[92:95], v10, s[32:35], s67 offen offset:0 sc1
v_mfma_f32_16x16x32_bf16 v[108:111], v[124:127], a[164:167], v[108:111]
s_waitcnt lgkmcnt(0)
s_waitcnt vmcnt(31)
v_mfma_f32_16x16x32_bf16 v[16:19], v[128:131], a[168:171], v[16:19]
s_mov_b32 s68, 3
s_add_u32 s64, s68, s56
s_and_b32 s64, s64, 3
s_lshl2_add_u32 s68, s68, s64
s_lshl1_add_u32 s68, s68, s76
s_lshl_b32 s68, s68, 2
s_add_u32 s71, s62, 0
s_and_b32 s71, s71, 3
s_add_u32 s71, s71, s68
s_lshl_b32 s71, s71, 16
s_add_u32 m0, s57, 16384
s_nop 0
buffer_load_dwordx4 v2, s[36:39], s71 offen offset:0 lds
v_mfma_f32_16x16x32_bf16 v[20:23], v[128:131], a[172:175], v[20:23]
ds_read_b64_tr_b16 v[112:113], v6 offset:0
v_mfma_f32_16x16x32_bf16 v[24:27], v[128:131], a[176:179], v[24:27]
v_mfma_f32_16x16x32_bf16 v[64:67], v[128:131], a[180:183], v[64:67]
ds_read_b64_tr_b16 v[114:115], v6 offset:2048
buffer_load_dwordx4 v3, s[36:39], s71 offen offset:1024 lds
v_mfma_f32_16x16x32_bf16 v[68:71], v[128:131], a[184:187], v[68:71]
v_mfma_f32_16x16x32_bf16 v[72:75], v[128:131], a[188:191], v[72:75]
ds_read_b64_tr_b16 v[116:117], v7 offset:0
buffer_load_dwordx4 v4, s[36:39], s71 offen offset:2048 lds
v_mfma_f32_16x16x32_bf16 v[28:31], v[132:135], a[168:171], v[28:31]
v_mfma_f32_16x16x32_bf16 v[32:35], v[132:135], a[172:175], v[32:35]
ds_read_b64_tr_b16 v[118:119], v7 offset:2048
v_mfma_f32_16x16x32_bf16 v[36:39], v[132:135], a[176:179], v[36:39]
buffer_load_dwordx4 v5, s[36:39], s71 offen offset:3072 lds
v_mfma_f32_16x16x32_bf16 v[76:79], v[132:135], a[180:183], v[76:79]
ds_read_b64_tr_b16 v[120:121], v8 offset:0
v_mfma_f32_16x16x32_bf16 v[80:83], v[132:135], a[184:187], v[80:83]
s_mov_b32 s69, 3
s_add_u32 s64, s69, s56
s_and_b32 s64, s64, 3
s_lshl2_add_u32 s69, s69, s64
s_lshl1_add_u32 s69, s69, s76
s_mul_i32 s69, s69, 12
s_add_u32 s72, s62, 0
s_and_b32 s72, s72, 3
s_add_u32 s72, s72, s69
s_lshl_b32 s72, s72, 10
buffer_load_dwordx4 a[96:99], v10, s[32:35], s72 offen offset:0 sc1
v_mfma_f32_16x16x32_bf16 v[84:87], v[132:135], a[188:191], v[84:87]
ds_read_b64_tr_b16 v[122:123], v8 offset:2048
v_mfma_f32_16x16x32_bf16 v[40:43], v[136:139], a[168:171], v[40:43]
s_add_u32 s67, s72, 4096
buffer_load_dwordx4 a[100:103], v10, s[32:35], s67 offen offset:0 sc1
v_mfma_f32_16x16x32_bf16 v[44:47], v[136:139], a[172:175], v[44:47]
ds_read_b64_tr_b16 v[124:125], v9 offset:0
v_mfma_f32_16x16x32_bf16 v[48:51], v[136:139], a[176:179], v[48:51]
v_mfma_f32_16x16x32_bf16 v[88:91], v[136:139], a[180:183], v[88:91]
ds_read_b64_tr_b16 v[126:127], v9 offset:2048
s_add_u32 s67, s72, 8192
buffer_load_dwordx4 a[104:107], v10, s[32:35], s67 offen offset:0 sc1
v_mfma_f32_16x16x32_bf16 v[92:95], v[136:139], a[184:187], v[92:95]
v_mfma_f32_16x16x32_bf16 v[96:99], v[136:139], a[188:191], v[96:99]
s_add_u32 s67, s72, 786432
buffer_load_dwordx4 a[108:111], v10, s[32:35], s67 offen offset:0 sc1
v_mfma_f32_16x16x32_bf16 v[52:55], v[140:143], a[168:171], v[52:55]
v_mfma_f32_16x16x32_bf16 v[56:59], v[140:143], a[172:175], v[56:59]
v_mfma_f32_16x16x32_bf16 v[60:63], v[140:143], a[176:179], v[60:63]
s_add_u32 s67, s72, 790528
buffer_load_dwordx4 a[112:115], v10, s[32:35], s67 offen offset:0 sc1
v_mfma_f32_16x16x32_bf16 v[100:103], v[140:143], a[180:183], v[100:103]
v_mfma_f32_16x16x32_bf16 v[104:107], v[140:143], a[184:187], v[104:107]
s_add_u32 s67, s72, 794624
buffer_load_dwordx4 a[116:119], v10, s[32:35], s67 offen offset:0 sc1
v_mfma_f32_16x16x32_bf16 v[108:111], v[140:143], a[188:191], v[108:111]
s_waitcnt lgkmcnt(0)
s_waitcnt vmcnt(31)
v_mfma_f32_16x16x32_bf16 v[16:19], v[112:115], a[0:3], v[16:19]
s_add_u32 s71, s62, 1
s_and_b32 s71, s71, 3
s_add_u32 s71, s71, s68
s_lshl_b32 s71, s71, 16
s_add_u32 m0, s57, 20480
s_nop 0
buffer_load_dwordx4 v2, s[36:39], s71 offen offset:0 lds
v_mfma_f32_16x16x32_bf16 v[20:23], v[112:115], a[4:7], v[20:23]
ds_read_b64_tr_b16 v[128:129], v6 offset:4096
v_mfma_f32_16x16x32_bf16 v[24:27], v[112:115], a[8:11], v[24:27]
v_mfma_f32_16x16x32_bf16 v[64:67], v[112:115], a[12:15], v[64:67]
ds_read_b64_tr_b16 v[130:131], v6 offset:6144
buffer_load_dwordx4 v3, s[36:39], s71 offen offset:1024 lds
v_mfma_f32_16x16x32_bf16 v[68:71], v[112:115], a[16:19], v[68:71]
v_mfma_f32_16x16x32_bf16 v[72:75], v[112:115], a[20:23], v[72:75]
ds_read_b64_tr_b16 v[132:133], v7 offset:4096
buffer_load_dwordx4 v4, s[36:39], s71 offen offset:2048 lds
v_mfma_f32_16x16x32_bf16 v[28:31], v[116:119], a[0:3], v[28:31]
v_mfma_f32_16x16x32_bf16 v[32:35], v[116:119], a[4:7], v[32:35]
ds_read_b64_tr_b16 v[134:135], v7 offset:6144
v_mfma_f32_16x16x32_bf16 v[36:39], v[116:119], a[8:11], v[36:39]
buffer_load_dwordx4 v5, s[36:39], s71 offen offset:3072 lds
v_mfma_f32_16x16x32_bf16 v[76:79], v[116:119], a[12:15], v[76:79]
ds_read_b64_tr_b16 v[136:137], v8 offset:4096
v_mfma_f32_16x16x32_bf16 v[80:83], v[116:119], a[16:19], v[80:83]
s_add_u32 s72, s62, 1
s_and_b32 s72, s72, 3
s_add_u32 s72, s72, s69
s_lshl_b32 s72, s72, 10
buffer_load_dwordx4 a[120:123], v10, s[32:35], s72 offen offset:0 sc1
v_mfma_f32_16x16x32_bf16 v[84:87], v[116:119], a[20:23], v[84:87]
ds_read_b64_tr_b16 v[138:139], v8 offset:6144
v_mfma_f32_16x16x32_bf16 v[40:43], v[120:123], a[0:3], v[40:43]
s_add_u32 s67, s72, 4096
buffer_load_dwordx4 a[124:127], v10, s[32:35], s67 offen offset:0 sc1
v_mfma_f32_16x16x32_bf16 v[44:47], v[120:123], a[4:7], v[44:47]
ds_read_b64_tr_b16 v[140:141], v9 offset:4096
v_mfma_f32_16x16x32_bf16 v[48:51], v[120:123], a[8:11], v[48:51]
v_mfma_f32_16x16x32_bf16 v[88:91], v[120:123], a[12:15], v[88:91]
ds_read_b64_tr_b16 v[142:143], v9 offset:6144
s_add_u32 s67, s72, 8192
buffer_load_dwordx4 a[128:131], v10, s[32:35], s67 offen offset:0 sc1
v_mfma_f32_16x16x32_bf16 v[92:95], v[120:123], a[16:19], v[92:95]
v_mfma_f32_16x16x32_bf16 v[96:99], v[120:123], a[20:23], v[96:99]
s_add_u32 s67, s72, 786432
buffer_load_dwordx4 a[132:135], v10, s[32:35], s67 offen offset:0 sc1
v_mfma_f32_16x16x32_bf16 v[52:55], v[124:127], a[0:3], v[52:55]
v_mfma_f32_16x16x32_bf16 v[56:59], v[124:127], a[4:7], v[56:59]
v_mfma_f32_16x16x32_bf16 v[60:63], v[124:127], a[8:11], v[60:63]
s_add_u32 s67, s72, 790528
buffer_load_dwordx4 a[136:139], v10, s[32:35], s67 offen offset:0 sc1
v_mfma_f32_16x16x32_bf16 v[100:103], v[124:127], a[12:15], v[100:103]
v_mfma_f32_16x16x32_bf16 v[104:107], v[124:127], a[16:19], v[104:107]
s_add_u32 s67, s72, 794624
buffer_load_dwordx4 a[140:143], v10, s[32:35], s67 offen offset:0 sc1
v_mfma_f32_16x16x32_bf16 v[108:111], v[124:127], a[20:23], v[108:111]
s_waitcnt lgkmcnt(0)
s_waitcnt vmcnt(30)
v_mfma_f32_16x16x32_bf16 v[16:19], v[128:131], a[24:27], v[16:19]
s_add_u32 s71, s62, 2
s_and_b32 s71, s71, 3
s_add_u32 s71, s71, s68
s_lshl_b32 s71, s71, 16
s_add_u32 m0, s57, 24576
s_nop 0
buffer_load_dwordx4 v2, s[36:39], s71 offen offset:0 lds
v_mfma_f32_16x16x32_bf16 v[20:23], v[128:131], a[28:31], v[20:23]
ds_read_b64_tr_b16 v[112:113], v6 offset:8192
v_mfma_f32_16x16x32_bf16 v[24:27], v[128:131], a[32:35], v[24:27]
v_mfma_f32_16x16x32_bf16 v[64:67], v[128:131], a[36:39], v[64:67]
ds_read_b64_tr_b16 v[114:115], v6 offset:10240
buffer_load_dwordx4 v3, s[36:39], s71 offen offset:1024 lds
v_mfma_f32_16x16x32_bf16 v[68:71], v[128:131], a[40:43], v[68:71]
v_mfma_f32_16x16x32_bf16 v[72:75], v[128:131], a[44:47], v[72:75]
ds_read_b64_tr_b16 v[116:117], v7 offset:8192
buffer_load_dwordx4 v4, s[36:39], s71 offen offset:2048 lds
v_mfma_f32_16x16x32_bf16 v[28:31], v[132:135], a[24:27], v[28:31]
v_mfma_f32_16x16x32_bf16 v[32:35], v[132:135], a[28:31], v[32:35]
ds_read_b64_tr_b16 v[118:119], v7 offset:10240
buffer_load_dwordx4 v5, s[36:39], s71 offen offset:3072 lds
v_mfma_f32_16x16x32_bf16 v[36:39], v[132:135], a[32:35], v[36:39]
v_mfma_f32_16x16x32_bf16 v[76:79], v[132:135], a[36:39], v[76:79]
ds_read_b64_tr_b16 v[120:121], v8 offset:8192
s_add_u32 s72, s62, 2
s_and_b32 s72, s72, 3
s_add_u32 s72, s72, s69
s_lshl_b32 s72, s72, 10
buffer_load_dwordx4 a[144:147], v10, s[32:35], s72 offen offset:0 sc1
v_mfma_f32_16x16x32_bf16 v[80:83], v[132:135], a[40:43], v[80:83]
v_mfma_f32_16x16x32_bf16 v[84:87], v[132:135], a[44:47], v[84:87]
ds_read_b64_tr_b16 v[122:123], v8 offset:10240
s_add_u32 s67, s72, 4096
buffer_load_dwordx4 a[148:151], v10, s[32:35], s67 offen offset:0 sc1
v_mfma_f32_16x16x32_bf16 v[40:43], v[136:139], a[24:27], v[40:43]
v_mfma_f32_16x16x32_bf16 v[44:47], v[136:139], a[28:31], v[44:47]
ds_read_b64_tr_b16 v[124:125], v9 offset:8192
v_mfma_f32_16x16x32_bf16 v[48:51], v[136:139], a[32:35], v[48:51]
s_add_u32 s67, s72, 8192
buffer_load_dwordx4 a[152:155], v10, s[32:35], s67 offen offset:0 sc1
v_mfma_f32_16x16x32_bf16 v[88:91], v[136:139], a[36:39], v[88:91]
ds_read_b64_tr_b16 v[126:127], v9 offset:10240
v_mfma_f32_16x16x32_bf16 v[92:95], v[136:139], a[40:43], v[92:95]
s_add_u32 s67, s72, 786432
buffer_load_dwordx4 a[156:159], v10, s[32:35], s67 offen offset:0 sc1
v_mfma_f32_16x16x32_bf16 v[96:99], v[136:139], a[44:47], v[96:99]
v_mfma_f32_16x16x32_bf16 v[52:55], v[140:143], a[24:27], v[52:55]
s_add_u32 s67, s72, 790528
buffer_load_dwordx4 a[160:163], v10, s[32:35], s67 offen offset:0 sc1
v_mfma_f32_16x16x32_bf16 v[56:59], v[140:143], a[28:31], v[56:59]
v_mfma_f32_16x16x32_bf16 v[60:63], v[140:143], a[32:35], v[60:63]
s_add_u32 s67, s72, 794624
buffer_load_dwordx4 a[164:167], v10, s[32:35], s67 offen offset:0 sc1
v_mfma_f32_16x16x32_bf16 v[100:103], v[140:143], a[36:39], v[100:103]
v_mfma_f32_16x16x32_bf16 v[104:107], v[140:143], a[40:43], v[104:107]
v_add_u32 v220, 4194304, v220
global_load_dword v221, v220, s[12:13]
v_mfma_f32_16x16x32_bf16 v[108:111], v[140:143], a[44:47], v[108:111]
s_waitcnt lgkmcnt(0)
s_waitcnt vmcnt(31)
v_mfma_f32_16x16x32_bf16 v[16:19], v[112:115], a[48:51], v[16:19]
s_add_u32 s71, s62, 3
s_and_b32 s71, s71, 3
s_add_u32 s71, s71, s68
s_lshl_b32 s71, s71, 16
s_add_u32 m0, s57, 28672
s_nop 0
buffer_load_dwordx4 v2, s[36:39], s71 offen offset:0 lds
v_mfma_f32_16x16x32_bf16 v[20:23], v[112:115], a[52:55], v[20:23]
ds_read_b64_tr_b16 v[128:129], v6 offset:12288
v_mfma_f32_16x16x32_bf16 v[24:27], v[112:115], a[56:59], v[24:27]
v_mfma_f32_16x16x32_bf16 v[64:67], v[112:115], a[60:63], v[64:67]
ds_read_b64_tr_b16 v[130:131], v6 offset:14336
buffer_load_dwordx4 v3, s[36:39], s71 offen offset:1024 lds
v_mfma_f32_16x16x32_bf16 v[68:71], v[112:115], a[64:67], v[68:71]
v_mfma_f32_16x16x32_bf16 v[72:75], v[112:115], a[68:71], v[72:75]
ds_read_b64_tr_b16 v[132:133], v7 offset:12288
buffer_load_dwordx4 v4, s[36:39], s71 offen offset:2048 lds
v_mfma_f32_16x16x32_bf16 v[28:31], v[116:119], a[48:51], v[28:31]
v_mfma_f32_16x16x32_bf16 v[32:35], v[116:119], a[52:55], v[32:35]
ds_read_b64_tr_b16 v[134:135], v7 offset:14336
v_mfma_f32_16x16x32_bf16 v[36:39], v[116:119], a[56:59], v[36:39]
buffer_load_dwordx4 v5, s[36:39], s71 offen offset:3072 lds
v_mfma_f32_16x16x32_bf16 v[76:79], v[116:119], a[60:63], v[76:79]
ds_read_b64_tr_b16 v[136:137], v8 offset:12288
v_mfma_f32_16x16x32_bf16 v[80:83], v[116:119], a[64:67], v[80:83]
s_add_u32 s72, s62, 3
s_and_b32 s72, s72, 3
s_add_u32 s72, s72, s69
s_lshl_b32 s72, s72, 10
buffer_load_dwordx4 a[168:171], v10, s[32:35], s72 offen offset:0 sc1
v_mfma_f32_16x16x32_bf16 v[84:87], v[116:119], a[68:71], v[84:87]
ds_read_b64_tr_b16 v[138:139], v8 offset:14336
v_mfma_f32_16x16x32_bf16 v[40:43], v[120:123], a[48:51], v[40:43]
s_add_u32 s67, s72, 4096
buffer_load_dwordx4 a[172:175], v10, s[32:35], s67 offen offset:0 sc1
v_mfma_f32_16x16x32_bf16 v[44:47], v[120:123], a[52:55], v[44:47]
ds_read_b64_tr_b16 v[140:141], v9 offset:12288
v_mfma_f32_16x16x32_bf16 v[48:51], v[120:123], a[56:59], v[48:51]
v_mfma_f32_16x16x32_bf16 v[88:91], v[120:123], a[60:63], v[88:91]
ds_read_b64_tr_b16 v[142:143], v9 offset:14336
s_add_u32 s67, s72, 8192
buffer_load_dwordx4 a[176:179], v10, s[32:35], s67 offen offset:0 sc1
v_mfma_f32_16x16x32_bf16 v[92:95], v[120:123], a[64:67], v[92:95]
v_mfma_f32_16x16x32_bf16 v[96:99], v[120:123], a[68:71], v[96:99]
s_add_u32 s67, s72, 786432
buffer_load_dwordx4 a[180:183], v10, s[32:35], s67 offen offset:0 sc1
v_mfma_f32_16x16x32_bf16 v[52:55], v[124:127], a[48:51], v[52:55]
v_mfma_f32_16x16x32_bf16 v[56:59], v[124:127], a[52:55], v[56:59]
v_mfma_f32_16x16x32_bf16 v[60:63], v[124:127], a[56:59], v[60:63]
s_add_u32 s67, s72, 790528
buffer_load_dwordx4 a[184:187], v10, s[32:35], s67 offen offset:0 sc1
v_mfma_f32_16x16x32_bf16 v[100:103], v[124:127], a[60:63], v[100:103]
v_mfma_f32_16x16x32_bf16 v[104:107], v[124:127], a[64:67], v[104:107]
s_add_u32 s67, s72, 794624
buffer_load_dwordx4 a[188:191], v10, s[32:35], s67 offen offset:0 sc1
v_mfma_f32_16x16x32_bf16 v[108:111], v[124:127], a[68:71], v[108:111]
s_waitcnt lgkmcnt(0)
s_waitcnt vmcnt(31)
v_mfma_f32_16x16x32_bf16 v[16:19], v[128:131], a[72:75], v[16:19]
s_add_u32 s71, s62, 4
s_and_b32 s71, s71, 3
s_add_u32 s64, s71, s56
s_and_b32 s64, s64, 3
s_lshl2_add_u32 s71, s71, s64
s_lshl1_add_u32 s71, s71, s76
s_xor_b32 s71, s71, 1
s_lshl_b32 s71, s71, 18
s_add_u32 m0, s57, 0
s_nop 0
buffer_load_dwordx4 v2, s[36:39], s71 offen offset:0 lds
v_mfma_f32_16x16x32_bf16 v[20:23], v[128:131], a[76:79], v[20:23]
ds_read_b64_tr_b16 v[112:113], v6 offset:16384
v_mfma_f32_16x16x32_bf16 v[24:27], v[128:131], a[80:83], v[24:27]
v_mfma_f32_16x16x32_bf16 v[64:67], v[128:131], a[84:87], v[64:67]
ds_read_b64_tr_b16 v[114:115], v6 offset:18432
buffer_load_dwordx4 v3, s[36:39], s71 offen offset:1024 lds
v_mfma_f32_16x16x32_bf16 v[68:71], v[128:131], a[88:91], v[68:71]
v_mfma_f32_16x16x32_bf16 v[72:75], v[128:131], a[92:95], v[72:75]
ds_read_b64_tr_b16 v[116:117], v7 offset:16384
v_mfma_f32_16x16x32_bf16 v[28:31], v[132:135], a[72:75], v[28:31]
buffer_load_dwordx4 v4, s[36:39], s71 offen offset:2048 lds
v_mfma_f32_16x16x32_bf16 v[32:35], v[132:135], a[76:79], v[32:35]
ds_read_b64_tr_b16 v[118:119], v7 offset:18432
v_mfma_f32_16x16x32_bf16 v[36:39], v[132:135], a[80:83], v[36:39]
v_mfma_f32_16x16x32_bf16 v[76:79], v[132:135], a[84:87], v[76:79]
ds_read_b64_tr_b16 v[120:121], v8 offset:16384
buffer_load_dwordx4 v5, s[36:39], s71 offen offset:3072 lds
v_mfma_f32_16x16x32_bf16 v[80:83], v[132:135], a[88:91], v[80:83]
v_mfma_f32_16x16x32_bf16 v[84:87], v[132:135], a[92:95], v[84:87]
ds_read_b64_tr_b16 v[122:123], v8 offset:18432
v_mfma_f32_16x16x32_bf16 v[40:43], v[136:139], a[72:75], v[40:43]
s_add_u32 s71, s71, 65536
s_add_u32 m0, s57, 4096
s_nop 0
buffer_load_dwordx4 v2, s[36:39], s71 offen offset:0 lds
v_mfma_f32_16x16x32_bf16 v[44:47], v[136:139], a[76:79], v[44:47]
ds_read_b64_tr_b16 v[124:125], v9 offset:16384
v_mfma_f32_16x16x32_bf16 v[48:51], v[136:139], a[80:83], v[48:51]
v_mfma_f32_16x16x32_bf16 v[88:91], v[136:139], a[84:87], v[88:91]
ds_read_b64_tr_b16 v[126:127], v9 offset:18432
buffer_load_dwordx4 v3, s[36:39], s71 offen offset:1024 lds
v_mfma_f32_16x16x32_bf16 v[92:95], v[136:139], a[88:91], v[92:95]
v_mfma_f32_16x16x32_bf16 v[96:99], v[136:139], a[92:95], v[96:99]
v_mfma_f32_16x16x32_bf16 v[52:55], v[140:143], a[72:75], v[52:55]
buffer_load_dwordx4 v4, s[36:39], s71 offen offset:2048 lds
v_mfma_f32_16x16x32_bf16 v[56:59], v[140:143], a[76:79], v[56:59]
v_mfma_f32_16x16x32_bf16 v[60:63], v[140:143], a[80:83], v[60:63]
v_mfma_f32_16x16x32_bf16 v[100:103], v[140:143], a[84:87], v[100:103]
buffer_load_dwordx4 v5, s[36:39], s71 offen offset:3072 lds
v_mfma_f32_16x16x32_bf16 v[104:107], v[140:143], a[88:91], v[104:107]
v_mfma_f32_16x16x32_bf16 v[108:111], v[140:143], a[92:95], v[108:111]
s_waitcnt lgkmcnt(0)
s_waitcnt vmcnt(29)
v_mfma_f32_16x16x32_bf16 v[16:19], v[112:115], a[96:99], v[16:19]
s_add_u32 s71, s71, 65536
s_add_u32 m0, s57, 8192
s_nop 0
buffer_load_dwordx4 v2, s[36:39], s71 offen offset:0 lds
v_mfma_f32_16x16x32_bf16 v[20:23], v[112:115], a[100:103], v[20:23]
ds_read_b64_tr_b16 v[128:129], v6 offset:20480
v_mfma_f32_16x16x32_bf16 v[24:27], v[112:115], a[104:107], v[24:27]
v_mfma_f32_16x16x32_bf16 v[64:67], v[112:115], a[108:111], v[64:67]
ds_read_b64_tr_b16 v[130:131], v6 offset:22528
buffer_load_dwordx4 v3, s[36:39], s71 offen offset:1024 lds
v_mfma_f32_16x16x32_bf16 v[68:71], v[112:115], a[112:115], v[68:71]
v_mfma_f32_16x16x32_bf16 v[72:75], v[112:115], a[116:119], v[72:75]
ds_read_b64_tr_b16 v[132:133], v7 offset:20480
v_mfma_f32_16x16x32_bf16 v[28:31], v[116:119], a[96:99], v[28:31]
buffer_load_dwordx4 v4, s[36:39], s71 offen offset:2048 lds
v_mfma_f32_16x16x32_bf16 v[32:35], v[116:119], a[100:103], v[32:35]
ds_read_b64_tr_b16 v[134:135], v7 offset:22528
v_mfma_f32_16x16x32_bf16 v[36:39], v[116:119], a[104:107], v[36:39]
v_mfma_f32_16x16x32_bf16 v[76:79], v[116:119], a[108:111], v[76:79]
ds_read_b64_tr_b16 v[136:137], v8 offset:20480
buffer_load_dwordx4 v5, s[36:39], s71 offen offset:3072 lds
v_mfma_f32_16x16x32_bf16 v[80:83], v[116:119], a[112:115], v[80:83]
v_mfma_f32_16x16x32_bf16 v[84:87], v[116:119], a[116:119], v[84:87]
ds_read_b64_tr_b16 v[138:139], v8 offset:22528
v_mfma_f32_16x16x32_bf16 v[40:43], v[120:123], a[96:99], v[40:43]
s_add_u32 s71, s71, 65536
s_add_u32 m0, s57, 12288
s_nop 0
buffer_load_dwordx4 v2, s[36:39], s71 offen offset:0 lds
v_mfma_f32_16x16x32_bf16 v[44:47], v[120:123], a[100:103], v[44:47]
ds_read_b64_tr_b16 v[140:141], v9 offset:20480
v_mfma_f32_16x16x32_bf16 v[48:51], v[120:123], a[104:107], v[48:51]
v_mfma_f32_16x16x32_bf16 v[88:91], v[120:123], a[108:111], v[88:91]
ds_read_b64_tr_b16 v[142:143], v9 offset:22528
buffer_load_dwordx4 v3, s[36:39], s71 offen offset:1024 lds
v_mfma_f32_16x16x32_bf16 v[92:95], v[120:123], a[112:115], v[92:95]
v_mfma_f32_16x16x32_bf16 v[96:99], v[120:123], a[116:119], v[96:99]
v_mfma_f32_16x16x32_bf16 v[52:55], v[124:127], a[96:99], v[52:55]
buffer_load_dwordx4 v4, s[36:39], s71 offen offset:2048 lds
v_mfma_f32_16x16x32_bf16 v[56:59], v[124:127], a[100:103], v[56:59]
v_mfma_f32_16x16x32_bf16 v[60:63], v[124:127], a[104:107], v[60:63]
v_mfma_f32_16x16x32_bf16 v[100:103], v[124:127], a[108:111], v[100:103]
buffer_load_dwordx4 v5, s[36:39], s71 offen offset:3072 lds
v_mfma_f32_16x16x32_bf16 v[104:107], v[124:127], a[112:115], v[104:107]
v_mfma_f32_16x16x32_bf16 v[108:111], v[124:127], a[116:119], v[108:111]
s_waitcnt lgkmcnt(0)
s_waitcnt vmcnt(27)
v_mfma_f32_16x16x32_bf16 v[16:19], v[128:131], a[120:123], v[16:19]
s_add_u32 s71, s62, 5
s_and_b32 s71, s71, 3
s_add_u32 s64, s71, s56
s_and_b32 s64, s64, 3
s_lshl2_add_u32 s71, s71, s64
s_lshl1_add_u32 s71, s71, s76
s_xor_b32 s71, s71, 1
s_lshl_b32 s71, s71, 18
s_add_u32 m0, s57, 16384
s_nop 0
buffer_load_dwordx4 v2, s[36:39], s71 offen offset:0 lds
v_mfma_f32_16x16x32_bf16 v[20:23], v[128:131], a[124:127], v[20:23]
ds_read_b64_tr_b16 v[112:113], v6 offset:24576
v_mfma_f32_16x16x32_bf16 v[24:27], v[128:131], a[128:131], v[24:27]
v_mfma_f32_16x16x32_bf16 v[64:67], v[128:131], a[132:135], v[64:67]
ds_read_b64_tr_b16 v[114:115], v6 offset:26624
v_mfma_f32_16x16x32_bf16 v[68:71], v[128:131], a[136:139], v[68:71]
v_mfma_f32_16x16x32_bf16 v[72:75], v[128:131], a[140:143], v[72:75]
ds_read_b64_tr_b16 v[116:117], v7 offset:24576
v_mfma_f32_16x16x32_bf16 v[28:31], v[132:135], a[120:123], v[28:31]
buffer_load_dwordx4 v3, s[36:39], s71 offen offset:1024 lds
v_mfma_f32_16x16x32_bf16 v[32:35], v[132:135], a[124:127], v[32:35]
ds_read_b64_tr_b16 v[118:119], v7 offset:26624
v_mfma_f32_16x16x32_bf16 v[36:39], v[132:135], a[128:131], v[36:39]
v_mfma_f32_16x16x32_bf16 v[76:79], v[132:135], a[132:135], v[76:79]
ds_read_b64_tr_b16 v[120:121], v8 offset:24576
v_mfma_f32_16x16x32_bf16 v[80:83], v[132:135], a[136:139], v[80:83]
v_mfma_f32_16x16x32_bf16 v[84:87], v[132:135], a[140:143], v[84:87]
ds_read_b64_tr_b16 v[122:123], v8 offset:26624
v_mfma_f32_16x16x32_bf16 v[40:43], v[136:139], a[120:123], v[40:43]
buffer_load_dwordx4 v4, s[36:39], s71 offen offset:2048 lds
v_mfma_f32_16x16x32_bf16 v[44:47], v[136:139], a[124:127], v[44:47]
ds_read_b64_tr_b16 v[124:125], v9 offset:24576
v_mfma_f32_16x16x32_bf16 v[48:51], v[136:139], a[128:131], v[48:51]
v_mfma_f32_16x16x32_bf16 v[88:91], v[136:139], a[132:135], v[88:91]
ds_read_b64_tr_b16 v[126:127], v9 offset:26624
v_mfma_f32_16x16x32_bf16 v[92:95], v[136:139], a[136:139], v[92:95]
v_mfma_f32_16x16x32_bf16 v[96:99], v[136:139], a[140:143], v[96:99]
v_mfma_f32_16x16x32_bf16 v[52:55], v[140:143], a[120:123], v[52:55]
buffer_load_dwordx4 v5, s[36:39], s71 offen offset:3072 lds
v_mfma_f32_16x16x32_bf16 v[56:59], v[140:143], a[124:127], v[56:59]
v_mfma_f32_16x16x32_bf16 v[60:63], v[140:143], a[128:131], v[60:63]
v_mfma_f32_16x16x32_bf16 v[100:103], v[140:143], a[132:135], v[100:103]
v_mfma_f32_16x16x32_bf16 v[104:107], v[140:143], a[136:139], v[104:107]
v_mfma_f32_16x16x32_bf16 v[108:111], v[140:143], a[140:143], v[108:111]
s_waitcnt lgkmcnt(0)
s_waitcnt vmcnt(20)
v_mfma_f32_16x16x32_bf16 v[16:19], v[112:115], a[144:147], v[16:19]
s_add_u32 s71, s71, 65536
s_add_u32 m0, s57, 20480
s_nop 0
buffer_load_dwordx4 v2, s[36:39], s71 offen offset:0 lds
v_mfma_f32_16x16x32_bf16 v[20:23], v[112:115], a[148:151], v[20:23]
ds_read_b64_tr_b16 v[128:129], v6 offset:28672
v_mfma_f32_16x16x32_bf16 v[24:27], v[112:115], a[152:155], v[24:27]
v_mfma_f32_16x16x32_bf16 v[64:67], v[112:115], a[156:159], v[64:67]
ds_read_b64_tr_b16 v[130:131], v6 offset:30720
v_mfma_f32_16x16x32_bf16 v[68:71], v[112:115], a[160:163], v[68:71]
v_mfma_f32_16x16x32_bf16 v[72:75], v[112:115], a[164:167], v[72:75]
ds_read_b64_tr_b16 v[132:133], v7 offset:28672
v_mfma_f32_16x16x32_bf16 v[28:31], v[116:119], a[144:147], v[28:31]
buffer_load_dwordx4 v3, s[36:39], s71 offen offset:1024 lds
v_mfma_f32_16x16x32_bf16 v[32:35], v[116:119], a[148:151], v[32:35]
ds_read_b64_tr_b16 v[134:135], v7 offset:30720
v_mfma_f32_16x16x32_bf16 v[36:39], v[116:119], a[152:155], v[36:39]
v_mfma_f32_16x16x32_bf16 v[76:79], v[116:119], a[156:159], v[76:79]
ds_read_b64_tr_b16 v[136:137], v8 offset:28672
v_mfma_f32_16x16x32_bf16 v[80:83], v[116:119], a[160:163], v[80:83]
v_mfma_f32_16x16x32_bf16 v[84:87], v[116:119], a[164:167], v[84:87]
ds_read_b64_tr_b16 v[138:139], v8 offset:30720
v_mfma_f32_16x16x32_bf16 v[40:43], v[120:123], a[144:147], v[40:43]
buffer_load_dwordx4 v4, s[36:39], s71 offen offset:2048 lds
v_mfma_f32_16x16x32_bf16 v[44:47], v[120:123], a[148:151], v[44:47]
ds_read_b64_tr_b16 v[140:141], v9 offset:28672
v_mfma_f32_16x16x32_bf16 v[48:51], v[120:123], a[152:155], v[48:51]
v_mfma_f32_16x16x32_bf16 v[88:91], v[120:123], a[156:159], v[88:91]
ds_read_b64_tr_b16 v[142:143], v9 offset:30720
v_mfma_f32_16x16x32_bf16 v[92:95], v[120:123], a[160:163], v[92:95]
v_mfma_f32_16x16x32_bf16 v[96:99], v[120:123], a[164:167], v[96:99]
v_mfma_f32_16x16x32_bf16 v[52:55], v[124:127], a[144:147], v[52:55]
buffer_load_dwordx4 v5, s[36:39], s71 offen offset:3072 lds
v_mfma_f32_16x16x32_bf16 v[56:59], v[124:127], a[148:151], v[56:59]
v_mfma_f32_16x16x32_bf16 v[60:63], v[124:127], a[152:155], v[60:63]
v_mfma_f32_16x16x32_bf16 v[100:103], v[124:127], a[156:159], v[100:103]
v_mfma_f32_16x16x32_bf16 v[104:107], v[124:127], a[160:163], v[104:107]
v_mfma_f32_16x16x32_bf16 v[108:111], v[124:127], a[164:167], v[108:111]
s_waitcnt lgkmcnt(0)
v_mfma_f32_16x16x32_bf16 v[16:19], v[128:131], a[168:171], v[16:19]
s_add_u32 s71, s71, 65536
s_add_u32 m0, s57, 24576
s_nop 0
buffer_load_dwordx4 v2, s[36:39], s71 offen offset:0 lds
v_mfma_f32_16x16x32_bf16 v[20:23], v[128:131], a[172:175], v[20:23]
v_mfma_f32_16x16x32_bf16 v[24:27], v[128:131], a[176:179], v[24:27]
v_mfma_f32_16x16x32_bf16 v[64:67], v[128:131], a[180:183], v[64:67]
v_mfma_f32_16x16x32_bf16 v[68:71], v[128:131], a[184:187], v[68:71]
v_mfma_f32_16x16x32_bf16 v[72:75], v[128:131], a[188:191], v[72:75]
v_mfma_f32_16x16x32_bf16 v[28:31], v[132:135], a[168:171], v[28:31]
buffer_load_dwordx4 v3, s[36:39], s71 offen offset:1024 lds
v_mfma_f32_16x16x32_bf16 v[32:35], v[132:135], a[172:175], v[32:35]
v_mfma_f32_16x16x32_bf16 v[36:39], v[132:135], a[176:179], v[36:39]
v_mfma_f32_16x16x32_bf16 v[76:79], v[132:135], a[180:183], v[76:79]
v_mfma_f32_16x16x32_bf16 v[80:83], v[132:135], a[184:187], v[80:83]
v_mfma_f32_16x16x32_bf16 v[84:87], v[132:135], a[188:191], v[84:87]
v_mfma_f32_16x16x32_bf16 v[40:43], v[136:139], a[168:171], v[40:43]
buffer_load_dwordx4 v4, s[36:39], s71 offen offset:2048 lds
v_mfma_f32_16x16x32_bf16 v[44:47], v[136:139], a[172:175], v[44:47]
v_mfma_f32_16x16x32_bf16 v[48:51], v[136:139], a[176:179], v[48:51]
v_mfma_f32_16x16x32_bf16 v[88:91], v[136:139], a[180:183], v[88:91]
v_mfma_f32_16x16x32_bf16 v[92:95], v[136:139], a[184:187], v[92:95]
v_mfma_f32_16x16x32_bf16 v[96:99], v[136:139], a[188:191], v[96:99]
v_mfma_f32_16x16x32_bf16 v[52:55], v[140:143], a[168:171], v[52:55]
buffer_load_dwordx4 v5, s[36:39], s71 offen offset:3072 lds
v_mfma_f32_16x16x32_bf16 v[56:59], v[140:143], a[172:175], v[56:59]
v_mfma_f32_16x16x32_bf16 v[60:63], v[140:143], a[176:179], v[60:63]
v_mfma_f32_16x16x32_bf16 v[100:103], v[140:143], a[180:183], v[100:103]
v_mfma_f32_16x16x32_bf16 v[104:107], v[140:143], a[184:187], v[104:107]
v_mfma_f32_16x16x32_bf16 v[108:111], v[140:143], a[188:191], v[108:111]
s_waitcnt vmcnt(24)
ds_read_b64_tr_b16 a[0:1], v6 offset:0
ds_read_b64_tr_b16 a[2:3], v6 offset:2048
ds_read_b64_tr_b16 a[4:5], v7 offset:0
ds_read_b64_tr_b16 a[6:7], v7 offset:2048
ds_read_b64_tr_b16 a[8:9], v8 offset:0
ds_read_b64_tr_b16 a[10:11], v8 offset:2048
ds_read_b64_tr_b16 a[12:13], v9 offset:0
ds_read_b64_tr_b16 a[14:15], v9 offset:2048
s_add_u32 s71, s71, 65536
s_add_u32 m0, s57, 28672
s_nop 0
buffer_load_dwordx4 v2, s[36:39], s71 offen offset:0 lds
buffer_load_dwordx4 v3, s[36:39], s71 offen offset:1024 lds
buffer_load_dwordx4 v4, s[36:39], s71 offen offset:2048 lds
buffer_load_dwordx4 v5, s[36:39], s71 offen offset:3072 lds
s_waitcnt vmcnt(24)
ds_read_b64_tr_b16 a[16:17], v6 offset:4096
ds_read_b64_tr_b16 a[18:19], v6 offset:6144
ds_read_b64_tr_b16 a[20:21], v7 offset:4096
ds_read_b64_tr_b16 a[22:23], v7 offset:6144
ds_read_b64_tr_b16 a[24:25], v8 offset:4096
ds_read_b64_tr_b16 a[26:27], v8 offset:6144
ds_read_b64_tr_b16 a[28:29], v9 offset:4096
ds_read_b64_tr_b16 a[30:31], v9 offset:6144
s_waitcnt lgkmcnt(8)
s_add_u32 s71, s62, 6
s_and_b32 s71, s71, 3
s_add_u32 s64, s71, s56
s_and_b32 s64, s64, 3
s_lshl2_add_u32 s71, s71, s64
s_lshl1_add_u32 s71, s71, s76
s_xor_b32 s71, s71, 1
s_lshl_b32 s71, s71, 18
s_add_u32 m0, s57, 0
s_nop 0
buffer_load_dwordx4 v2, s[36:39], s71 offen offset:0 lds
buffer_load_dwordx4 v3, s[36:39], s71 offen offset:1024 lds
buffer_load_dwordx4 v4, s[36:39], s71 offen offset:2048 lds
buffer_load_dwordx4 v5, s[36:39], s71 offen offset:3072 lds
s_waitcnt vmcnt(24)
ds_read_b64_tr_b16 a[32:33], v6 offset:8192
ds_read_b64_tr_b16 a[34:35], v6 offset:10240
ds_read_b64_tr_b16 a[36:37], v7 offset:8192
ds_read_b64_tr_b16 a[38:39], v7 offset:10240
ds_read_b64_tr_b16 a[40:41], v8 offset:8192
ds_read_b64_tr_b16 a[42:43], v8 offset:10240
ds_read_b64_tr_b16 a[44:45], v9 offset:8192
ds_read_b64_tr_b16 a[46:47], v9 offset:10240
s_waitcnt lgkmcnt(8)
s_add_u32 s71, s71, 65536
s_add_u32 m0, s57, 4096
s_nop 0
buffer_load_dwordx4 v2, s[36:39], s71 offen offset:0 lds
buffer_load_dwordx4 v3, s[36:39], s71 offen offset:1024 lds
buffer_load_dwordx4 v4, s[36:39], s71 offen offset:2048 lds
buffer_load_dwordx4 v5, s[36:39], s71 offen offset:3072 lds
s_waitcnt vmcnt(24)
ds_read_b64_tr_b16 a[48:49], v6 offset:12288
ds_read_b64_tr_b16 a[50:51], v6 offset:14336
ds_read_b64_tr_b16 a[52:53], v7 offset:12288
ds_read_b64_tr_b16 a[54:55], v7 offset:14336
ds_read_b64_tr_b16 a[56:57], v8 offset:12288
ds_read_b64_tr_b16 a[58:59], v8 offset:14336
ds_read_b64_tr_b16 a[60:61], v9 offset:12288
ds_read_b64_tr_b16 a[62:63], v9 offset:14336
s_waitcnt lgkmcnt(8)
s_add_u32 s71, s71, 65536
s_add_u32 m0, s57, 8192
s_nop 0
buffer_load_dwordx4 v2, s[36:39], s71 offen offset:0 lds
buffer_load_dwordx4 v3, s[36:39], s71 offen offset:1024 lds
buffer_load_dwordx4 v4, s[36:39], s71 offen offset:2048 lds
buffer_load_dwordx4 v5, s[36:39], s71 offen offset:3072 lds
s_waitcnt vmcnt(24)
ds_read_b64_tr_b16 a[64:65], v6 offset:16384
ds_read_b64_tr_b16 a[66:67], v6 offset:18432
ds_read_b64_tr_b16 a[68:69], v7 offset:16384
ds_read_b64_tr_b16 a[70:71], v7 offset:18432
ds_read_b64_tr_b16 a[72:73], v8 offset:16384
ds_read_b64_tr_b16 a[74:75], v8 offset:18432
ds_read_b64_tr_b16 a[76:77], v9 offset:16384
ds_read_b64_tr_b16 a[78:79], v9 offset:18432
s_waitcnt lgkmcnt(8)
s_add_u32 s71, s71, 65536
s_add_u32 m0, s57, 12288
s_nop 0
buffer_load_dwordx4 v2, s[36:39], s71 offen offset:0 lds
buffer_load_dwordx4 v3, s[36:39], s71 offen offset:1024 lds
buffer_load_dwordx4 v4, s[36:39], s71 offen offset:2048 lds
buffer_load_dwordx4 v5, s[36:39], s71 offen offset:3072 lds
s_waitcnt vmcnt(24)
ds_read_b64_tr_b16 a[80:81], v6 offset:20480
ds_read_b64_tr_b16 a[82:83], v6 offset:22528
ds_read_b64_tr_b16 a[84:85], v7 offset:20480
ds_read_b64_tr_b16 a[86:87], v7 offset:22528
ds_read_b64_tr_b16 a[88:89], v8 offset:20480
ds_read_b64_tr_b16 a[90:91], v8 offset:22528
ds_read_b64_tr_b16 a[92:93], v9 offset:20480
ds_read_b64_tr_b16 a[94:95], v9 offset:22528
s_waitcnt lgkmcnt(8)
s_add_u32 s71, s62, 7
s_and_b32 s71, s71, 3
s_add_u32 s64, s71, s56
s_and_b32 s64, s64, 3
s_lshl2_add_u32 s71, s71, s64
s_lshl1_add_u32 s71, s71, s76
s_xor_b32 s71, s71, 1
s_lshl_b32 s71, s71, 18
s_add_u32 m0, s57, 16384
s_nop 0
buffer_load_dwordx4 v2, s[36:39], s71 offen offset:0 lds
buffer_load_dwordx4 v3, s[36:39], s71 offen offset:1024 lds
buffer_load_dwordx4 v4, s[36:39], s71 offen offset:2048 lds
buffer_load_dwordx4 v5, s[36:39], s71 offen offset:3072 lds
s_waitcnt vmcnt(24)
ds_read_b64_tr_b16 a[96:97], v6 offset:24576
ds_read_b64_tr_b16 a[98:99], v6 offset:26624
ds_read_b64_tr_b16 a[100:101], v7 offset:24576
ds_read_b64_tr_b16 a[102:103], v7 offset:26624
ds_read_b64_tr_b16 a[104:105], v8 offset:24576
ds_read_b64_tr_b16 a[106:107], v8 offset:26624
ds_read_b64_tr_b16 a[108:109], v9 offset:24576
ds_read_b64_tr_b16 a[110:111], v9 offset:26624
s_waitcnt lgkmcnt(8)
s_add_u32 s71, s71, 65536
s_add_u32 m0, s57, 20480
s_nop 0
buffer_load_dwordx4 v2, s[36:39], s71 offen offset:0 lds
buffer_load_dwordx4 v3, s[36:39], s71 offen offset:1024 lds
buffer_load_dwordx4 v4, s[36:39], s71 offen offset:2048 lds
buffer_load_dwordx4 v5, s[36:39], s71 offen offset:3072 lds
s_waitcnt vmcnt(24)
ds_read_b64_tr_b16 a[112:113], v6 offset:28672
ds_read_b64_tr_b16 a[114:115], v6 offset:30720
ds_read_b64_tr_b16 a[116:117], v7 offset:28672
ds_read_b64_tr_b16 a[118:119], v7 offset:30720
ds_read_b64_tr_b16 a[120:121], v8 offset:28672
ds_read_b64_tr_b16 a[122:123], v8 offset:30720
ds_read_b64_tr_b16 a[124:125], v9 offset:28672
ds_read_b64_tr_b16 a[126:127], v9 offset:30720
s_waitcnt lgkmcnt(8)
s_add_u32 s71, s71, 65536
s_add_u32 m0, s57, 24576
s_nop 0
buffer_load_dwordx4 v2, s[36:39], s71 offen offset:0 lds
buffer_load_dwordx4 v3, s[36:39], s71 offen offset:1024 lds
buffer_load_dwordx4 v4, s[36:39], s71 offen offset:2048 lds
buffer_load_dwordx4 v5, s[36:39], s71 offen offset:3072 lds
s_waitcnt vmcnt(24)
ds_read_b64_tr_b16 a[128:129], v6 offset:0
ds_read_b64_tr_b16 a[130:131], v6 offset:2048
ds_read_b64_tr_b16 a[132:133], v7 offset:0
ds_read_b64_tr_b16 a[134:135], v7 offset:2048
ds_read_b64_tr_b16 a[136:137], v8 offset:0
ds_read_b64_tr_b16 a[138:139], v8 offset:2048
ds_read_b64_tr_b16 a[140:141], v9 offset:0
ds_read_b64_tr_b16 a[142:143], v9 offset:2048
s_waitcnt lgkmcnt(8)
s_add_u32 s71, s71, 65536
s_add_u32 m0, s57, 28672
s_nop 0
buffer_load_dwordx4 v2, s[36:39], s71 offen offset:0 lds
buffer_load_dwordx4 v3, s[36:39], s71 offen offset:1024 lds
buffer_load_dwordx4 v4, s[36:39], s71 offen offset:2048 lds
buffer_load_dwordx4 v5, s[36:39], s71 offen offset:3072 lds
s_waitcnt vmcnt(24)
ds_read_b64_tr_b16 a[144:145], v6 offset:4096
ds_read_b64_tr_b16 a[146:147], v6 offset:6144
ds_read_b64_tr_b16 a[148:149], v7 offset:4096
ds_read_b64_tr_b16 a[150:151], v7 offset:6144
ds_read_b64_tr_b16 a[152:153], v8 offset:4096
ds_read_b64_tr_b16 a[154:155], v8 offset:6144
ds_read_b64_tr_b16 a[156:157], v9 offset:4096
ds_read_b64_tr_b16 a[158:159], v9 offset:6144
s_waitcnt vmcnt(20)
ds_read_b64_tr_b16 a[160:161], v6 offset:8192
ds_read_b64_tr_b16 a[162:163], v6 offset:10240
ds_read_b64_tr_b16 a[164:165], v7 offset:8192
ds_read_b64_tr_b16 a[166:167], v7 offset:10240
ds_read_b64_tr_b16 a[168:169], v8 offset:8192
ds_read_b64_tr_b16 a[170:171], v8 offset:10240
ds_read_b64_tr_b16 a[172:173], v9 offset:8192
ds_read_b64_tr_b16 a[174:175], v9 offset:10240
s_waitcnt vmcnt(16)
ds_read_b64_tr_b16 a[176:177], v6 offset:12288
ds_read_b64_tr_b16 a[178:179], v6 offset:14336
ds_read_b64_tr_b16 a[180:181], v7 offset:12288
ds_read_b64_tr_b16 a[182:183], v7 offset:14336
ds_read_b64_tr_b16 a[184:185], v8 offset:12288
ds_read_b64_tr_b16 a[186:187], v8 offset:14336
ds_read_b64_tr_b16 a[188:189], v9 offset:12288
ds_read_b64_tr_b16 a[190:191], v9 offset:14336
s_waitcnt vmcnt(12)
ds_read_b64_tr_b16 a[192:193], v6 offset:16384
ds_read_b64_tr_b16 a[194:195], v6 offset:18432
ds_read_b64_tr_b16 a[196:197], v7 offset:16384
ds_read_b64_tr_b16 a[198:199], v7 offset:18432
ds_read_b64_tr_b16 a[200:201], v8 offset:16384
ds_read_b64_tr_b16 a[202:203], v8 offset:18432
ds_read_b64_tr_b16 a[204:205], v9 offset:16384
ds_read_b64_tr_b16 a[206:207], v9 offset:18432
s_waitcnt vmcnt(8)
ds_read_b64_tr_b16 a[208:209], v6 offset:20480
ds_read_b64_tr_b16 a[210:211], v6 offset:22528
ds_read_b64_tr_b16 a[212:213], v7 offset:20480
ds_read_b64_tr_b16 a[214:215], v7 offset:22528
ds_read_b64_tr_b16 a[216:217], v8 offset:20480
ds_read_b64_tr_b16 a[218:219], v8 offset:22528
ds_read_b64_tr_b16 a[220:221], v9 offset:20480
ds_read_b64_tr_b16 a[222:223], v9 offset:22528
s_waitcnt vmcnt(4)
ds_read_b64_tr_b16 a[224:225], v6 offset:24576
ds_read_b64_tr_b16 a[226:227], v6 offset:26624
ds_read_b64_tr_b16 a[228:229], v7 offset:24576
ds_read_b64_tr_b16 a[230:231], v7 offset:26624
ds_read_b64_tr_b16 a[232:233], v8 offset:24576
ds_read_b64_tr_b16 a[234:235], v8 offset:26624
ds_read_b64_tr_b16 a[236:237], v9 offset:24576
ds_read_b64_tr_b16 a[238:239], v9 offset:26624
s_waitcnt vmcnt(0)
ds_read_b64_tr_b16 a[240:241], v6 offset:28672
ds_read_b64_tr_b16 a[242:243], v6 offset:30720
ds_read_b64_tr_b16 a[244:245], v7 offset:28672
ds_read_b64_tr_b16 a[246:247], v7 offset:30720
ds_read_b64_tr_b16 a[248:249], v8 offset:28672
ds_read_b64_tr_b16 a[250:251], v8 offset:30720
ds_read_b64_tr_b16 a[252:253], v9 offset:28672
ds_read_b64_tr_b16 a[254:255], v9 offset:30720
s_waitcnt lgkmcnt(0)
v_lshrrev_b32 v240, 5, v1
v_lshlrev_b32 v240, 1, v240
v_xor_b32 v240, v240, v1
s_add_u32 s65, s56, 0
s_and_b32 s65, s65, 3
s_lshl_b32 s64, s65, 2
v_xor_b32 v241, s64, v240
s_lshl_b32 s65, s65, 10
s_add_u32 s65, s65, s57
v_lshl_add_u32 v233, v241, 4, s65
s_add_u32 s65, s56, 1
s_and_b32 s65, s65, 3
s_lshl_b32 s64, s65, 2
v_xor_b32 v241, s64, v240
s_lshl_b32 s65, s65, 10
s_add_u32 s65, s65, s57
v_lshl_add_u32 v234, v241, 4, s65
s_add_u32 s65, s56, 2
s_and_b32 s65, s65, 3
s_lshl_b32 s64, s65, 2
v_xor_b32 v241, s64, v240
s_lshl_b32 s65, s65, 10
s_add_u32 s65, s65, s57
v_lshl_add_u32 v235, v241, 4, s65
s_add_u32 s65, s56, 3
s_and_b32 s65, s65, 3
s_lshl_b32 s64, s65, 2
v_xor_b32 v241, s64, v240
s_lshl_b32 s65, s65, 10
s_add_u32 s65, s65, s57
v_lshl_add_u32 v236, v241, 4, s65
s_mul_i32 s64, s56, 24
v_and_b32 v240, 7, v1
v_lshrrev_b32 v241, 3, v1
v_add3_u32 v241, v241, s64, 0
v_lshlrev_b32 v242, 1, v240
v_xor_b32 v242, v242, v241
v_and_b32 v242, 15, v242
v_lshlrev_b32 v242, 4, v242
v_lshl_add_u32 v242, v240, 9, v242
v_lshrrev_b32 v243, 4, v241
v_lshl_add_u32 v224, v243, 12, v242
v_add_u32 v225, 81920, v224
s_and_b32 s65, s56, 2
s_mul_i32 s65, s65, 24
v_add_u32 v241, s65, v241
v_lshlrev_b32 v241, 12, v241
v_lshl_add_u32 v230, v240, 4, v241
v_lshrrev_b32 v241, 3, v1
v_add3_u32 v241, v241, s64, 8
v_lshlrev_b32 v242, 1, v240
v_xor_b32 v242, v242, v241
v_and_b32 v242, 15, v242
v_lshlrev_b32 v242, 4, v242
v_lshl_add_u32 v242, v240, 9, v242
v_lshrrev_b32 v243, 4, v241
v_lshl_add_u32 v226, v243, 12, v242
v_add_u32 v227, 81920, v226
s_and_b32 s65, s56, 2
s_mul_i32 s65, s65, 24
v_add_u32 v241, s65, v241
v_lshlrev_b32 v241, 12, v241
v_lshl_add_u32 v231, v240, 4, v241
v_lshrrev_b32 v241, 3, v1
v_add3_u32 v241, v241, s64, 16
v_lshlrev_b32 v242, 1, v240
v_xor_b32 v242, v242, v241
v_and_b32 v242, 15, v242
v_lshlrev_b32 v242, 4, v242
v_lshl_add_u32 v242, v240, 9, v242
v_lshrrev_b32 v243, 4, v241
v_lshl_add_u32 v228, v243, 12, v242
v_add_u32 v229, 81920, v228
s_and_b32 s65, s56, 2
s_mul_i32 s65, s65, 24
v_add_u32 v241, s65, v241
v_lshlrev_b32 v241, 12, v241
v_lshl_add_u32 v232, v240, 4, v241
s_lshl2_add_u32 s64, s59, s56
s_sub_u32 s64, s64, 64
s_cmp_ge_u32 s64, 3
s_cbranch_scc1 cp_21
s_getpc_b64 s[66:67]
cppc_22:
s_add_u32 s66, s66, L_tail-cppc_22
s_addc_u32 s67, s67, 0
s_lshl_b32 s64, s64, 13
v_lshl_add_u32 v222, v1, 7, s64
v_min_u32 v222, L_codeend-L_tail-4, v222
global_load_dword v222, v222, s[66:67]
cp_21:
L_tail:
s_add_u32 s68, s62, 4
s_and_b32 s68, s68, 3
s_add_u32 s64, s68, s56
s_and_b32 s64, s64, 3
s_lshl2_add_u32 s68, s68, s64
s_lshl1_add_u32 s68, s68, s76
s_xor_b32 s68, s68, 1
s_mul_i32 s68, s68, 12288
s_add_u32 s69, s62, 5
s_and_b32 s69, s69, 3
s_add_u32 s64, s69, s56
s_and_b32 s64, s64, 3
s_lshl2_add_u32 s69, s69, s64
s_lshl1_add_u32 s69, s69, s76
s_xor_b32 s69, s69, 1
s_mul_i32 s69, s69, 12288
s_add_u32 s74, s62, 6
s_and_b32 s74, s74, 3
s_add_u32 s64, s74, s56
s_and_b32 s64, s64, 3
s_lshl2_add_u32 s74, s74, s64
s_lshl1_add_u32 s74, s74, s76
s_xor_b32 s74, s74, 1
s_mul_i32 s74, s74, 12288
s_add_u32 s75, s62, 7
s_and_b32 s75, s75, 3
s_add_u32 s64, s75, s56
s_and_b32 s64, s64, 3
s_lshl2_add_u32 s75, s75, s64
s_lshl1_add_u32 s75, s75, s76
s_xor_b32 s75, s75, 1
s_mul_i32 s75, s75, 12288
s_xor_b32 s65, s76, 1
v_lshrrev_b32 v11, 1, v1
v_add_u32 v11, s62, v11
v_and_b32 v11, 3, v11
v_add_u32 v12, s56, v11
v_and_b32 v12, 3, v12
v_lshl_add_u32 v11, v11, 2, v12
s_lshl_b32 s64, s30, 2
s_lshl3_add_u32 s64, s64, s65
s_add_u32 s64, s64, 512
v_lshl_add_u32 v11, v11, 1, s64
v_and_b32 v12, 1, v1
v_lshl_add_u32 v11, v12, 6, v11
v_lshlrev_b32 v11, 7, v11
s_mov_b32 s79, 0xffffff00
s_mov_b32 s97, -1
s_mov_b32 s63, -1
s_mov_b32 s65, 0x20000000
s_mov_b32 s66, 0x20000000
s_mov_b32 s67, 0x20000000
s_mov_b32 s31, 0x200000
T_first:
s_mov_b64 exec, 0xff
global_load_dwordx4 v[12:15], v11, s[98:99] sc1
s_mov_b64 exec, -1
s_waitcnt vmcnt(0)
v_min3_u32 v12, v12, v13, v14
v_min_u32 v12, v12, v15
v_cmp_ne_u32 vcc, 0, v12
s_nop 0
s_and_b32 s64, 0xff, vcc_lo
s_cbranch_scc1 T_go
s_sub_u32 s31, s31, 1
s_cbranch_scc0 T_first
T_go:
s_mov_b32 s31, 0x200000
s_branch T_pick1
T_n0:
s_and_b32 s64, s97, s63
s_and_b32 s64, s64, s79
s_cmp_eq_u32 s64, -1
s_cbranch_scc1 T_done
s_sub_u32 s31, s31, 1
s_cbranch_scc1 T_done
s_cmp_lt_i32 s63, 0
s_cbranch_scc1 T_q_23
buffer_load_dwordx4 v[196:199], v10, s[32:35], s71 offen offset:3072 sc1
buffer_load_dwordx4 v[200:203], v10, s[32:35], s72 offen offset:3072 sc1
buffer_load_dwordx4 v[204:207], v10, s[32:35], s70 offen offset:3072 sc1
T_q_23:
s_mov_b64 exec, 0xff
global_load_dwordx4 v[12:15], v11, s[98:99] sc1
s_mov_b64 exec, -1
s_cmp_lt_i32 s97, 0
s_cbranch_scc1 T_z_24
buffer_load_dwordx4 v[112:115], v10, s[32:35], s65 offen offset:0 sc1
buffer_load_dwordx4 v[116:119], v10, s[32:35], s66 offen offset:0 sc1
buffer_load_dwordx4 v[120:123], v10, s[32:35], s67 offen offset:0 sc1
buffer_load_dwordx4 v[124:127], v10, s[32:35], s65 offen offset:1024 sc1
buffer_load_dwordx4 v[128:131], v10, s[32:35], s66 offen offset:1024 sc1
buffer_load_dwordx4 v[132:135], v10, s[32:35], s67 offen offset:1024 sc1
buffer_load_dwordx4 v[136:139], v10, s[32:35], s65 offen offset:2048 sc1
buffer_load_dwordx4 v[140:143], v10, s[32:35], s66 offen offset:2048 sc1
buffer_load_dwordx4 v[144:147], v10, s[32:35], s67 offen offset:2048 sc1
s_waitcnt vmcnt(9)
s_branch T_w_25
T_z_24:
s_waitcnt vmcnt(0)
T_w_25:
v_min3_u32 v12, v12, v13, v14
v_min_u32 v12, v12, v15
v_cmp_ne_u32 vcc, 0, v12
T_pick1:
s_mov_b32 s73, s63
s_andn2_b32 s96, vcc_lo, s79
s_ff1_i32_b32 s63, s96
s_bitset1_b32 s79, s63
s_bitcmp1_b32 s63, 1
s_cselect_b32 s71, s69, s68
s_cselect_b32 s72, s75, s74
s_bitcmp1_b32 s63, 2
s_cselect_b32 s71, s72, s71
s_bitcmp1_b32 s63, 0
s_cselect_b32 s72, 786432, 0
s_add_u32 s71, s71, s72
s_and_b32 s72, s63, 0x20000000
s_or_b32 s71, s71, s72
s_add_u32 s72, s71, 4096
s_add_u32 s70, s71, 8192
s_and_b32 s64, s97, s63
s_and_b32 s64, s64, s79
s_cmp_eq_u32 s64, -1
s_cbranch_scc1 T_last1
s_bitcmp1_b32 s73, 2
s_cbranch_scc1 T_d_26
s_cmp_eq_u32 s73, 0
s_cbranch_scc1 T_b1_0
s_cmp_eq_u32 s73, 1
s_cbranch_scc1 T_b1_1
s_cmp_eq_u32 s73, 2
s_cbranch_scc1 T_b1_2
s_branch T_b1_3
T_d_26:
s_cmp_eq_u32 s73, 4
s_cbranch_scc1 T_b1_4
s_cmp_eq_u32 s73, 5
s_cbranch_scc1 T_b1_5
s_cmp_eq_u32 s73, 6
s_cbranch_scc1 T_b1_6
s_cmp_eq_u32 s73, 7
s_cbranch_scc1 T_b1_7
s_branch T_n1
T_b0_0:
v_mfma_f32_16x16x32_bf16 v[16:19], a[0:3], v[112:115], v[16:19]
buffer_load_dwordx4 v[196:199], v10, s[32:35], s71 offen offset:3072 sc1
v_mfma_f32_16x16x32_bf16 v[20:23], a[0:3], v[116:119], v[20:23]
v_mfma_f32_16x16x32_bf16 v[24:27], a[0:3], v[120:123], v[24:27]
v_mfma_f32_16x16x32_bf16 v[28:31], a[4:7], v[112:115], v[28:31]
v_mfma_f32_16x16x32_bf16 v[32:35], a[4:7], v[116:119], v[32:35]
buffer_load_dwordx4 v[200:203], v10, s[32:35], s72 offen offset:3072 sc1
v_mfma_f32_16x16x32_bf16 v[36:39], a[4:7], v[120:123], v[36:39]
v_mfma_f32_16x16x32_bf16 v[40:43], a[8:11], v[112:115], v[40:43]
v_mfma_f32_16x16x32_bf16 v[44:47], a[8:11], v[116:119], v[44:47]
v_mfma_f32_16x16x32_bf16 v[48:51], a[8:11], v[120:123], v[48:51]
buffer_load_dwordx4 v[204:207], v10, s[32:35], s70 offen offset:3072 sc1
v_mfma_f32_16x16x32_bf16 v[52:55], a[12:15], v[112:115], v[52:55]
v_mfma_f32_16x16x32_bf16 v[56:59], a[12:15], v[116:119], v[56:59]
s_mov_b64 exec, 0xff
global_load_dwordx4 v[12:15], v11, s[98:99] sc1
s_mov_b64 exec, -1
v_mfma_f32_16x16x32_bf16 v[60:63], a[12:15], v[120:123], v[60:63]
v_mfma_f32_16x16x32_bf16 v[16:19], a[16:19], v[124:127], v[16:19]
buffer_load_dwordx4 v[112:115], v10, s[32:35], s65 offen offset:0 sc1
v_mfma_f32_16x16x32_bf16 v[20:23], a[16:19], v[128:131], v[20:23]
v_mfma_f32_16x16x32_bf16 v[24:27], a[16:19], v[132:135], v[24:27]
v_mfma_f32_16x16x32_bf16 v[28:31], a[20:23], v[124:127], v[28:31]
v_mfma_f32_16x16x32_bf16 v[32:35], a[20:23], v[128:131], v[32:35]
buffer_load_dwordx4 v[116:119], v10, s[32:35], s66 offen offset:0 sc1
v_mfma_f32_16x16x32_bf16 v[36:39], a[20:23], v[132:135], v[36:39]
v_mfma_f32_16x16x32_bf16 v[40:43], a[24:27], v[124:127], v[40:43]
v_mfma_f32_16x16x32_bf16 v[44:47], a[24:27], v[128:131], v[44:47]
v_mfma_f32_16x16x32_bf16 v[48:51], a[24:27], v[132:135], v[48:51]
buffer_load_dwordx4 v[120:123], v10, s[32:35], s67 offen offset:0 sc1
v_mfma_f32_16x16x32_bf16 v[52:55], a[28:31], v[124:127], v[52:55]
v_mfma_f32_16x16x32_bf16 v[56:59], a[28:31], v[128:131], v[56:59]
v_mfma_f32_16x16x32_bf16 v[60:63], a[28:31], v[132:135], v[60:63]
v_mfma_f32_16x16x32_bf16 v[16:19], a[32:35], v[136:139], v[16:19]
buffer_load_dwordx4 v[124:127], v10, s[32:35], s65 offen offset:1024 sc1
v_mfma_f32_16x16x32_bf16 v[20:23], a[32:35], v[140:143], v[20:23]
v_mfma_f32_16x16x32_bf16 v[24:27], a[32:35], v[144:147], v[24:27]
v_mfma_f32_16x16x32_bf16 v[28:31], a[36:39], v[136:139], v[28:31]
v_mfma_f32_16x16x32_bf16 v[32:35], a[36:39], v[140:143], v[32:35]
buffer_load_dwordx4 v[128:131], v10, s[32:35], s66 offen offset:1024 sc1
v_mfma_f32_16x16x32_bf16 v[36:39], a[36:39], v[144:147], v[36:39]
v_mfma_f32_16x16x32_bf16 v[40:43], a[40:43], v[136:139], v[40:43]
v_mfma_f32_16x16x32_bf16 v[44:47], a[40:43], v[140:143], v[44:47]
v_mfma_f32_16x16x32_bf16 v[48:51], a[40:43], v[144:147], v[48:51]
buffer_load_dwordx4 v[132:135], v10, s[32:35], s67 offen offset:1024 sc1
v_mfma_f32_16x16x32_bf16 v[52:55], a[44:47], v[136:139], v[52:55]
v_mfma_f32_16x16x32_bf16 v[56:59], a[44:47], v[140:143], v[56:59]
v_mfma_f32_16x16x32_bf16 v[60:63], a[44:47], v[144:147], v[60:63]
s_waitcnt vmcnt(6)
v_min3_u32 v12, v12, v13, v14
v_min_u32 v12, v12, v15
v_mfma_f32_16x16x32_bf16 v[16:19], a[48:51], v[148:151], v[16:19]
buffer_load_dwordx4 v[136:139], v10, s[32:35], s65 offen offset:2048 sc1
v_cmp_ne_u32 vcc, 0, v12
v_mfma_f32_16x16x32_bf16 v[20:23], a[48:51], v[152:155], v[20:23]
s_mov_b32 s73, s63
s_andn2_b32 s96, vcc_lo, s79
v_mfma_f32_16x16x32_bf16 v[24:27], a[48:51], v[156:159], v[24:27]
s_ff1_i32_b32 s63, s96
s_bitset1_b32 s79, s63
v_mfma_f32_16x16x32_bf16 v[28:31], a[52:55], v[148:151], v[28:31]
s_bitcmp1_b32 s63, 1
s_cselect_b32 s71, s69, s68
v_mfma_f32_16x16x32_bf16 v[32:35], a[52:55], v[152:155], v[32:35]
buffer_load_dwordx4 v[140:143], v10, s[32:35], s66 offen offset:2048 sc1
s_cselect_b32 s72, s75, s74
v_mfma_f32_16x16x32_bf16 v[36:39], a[52:55], v[156:159], v[36:39]
s_bitcmp1_b32 s63, 2
s_cselect_b32 s71, s72, s71
v_mfma_f32_16x16x32_bf16 v[40:43], a[56:59], v[148:151], v[40:43]
s_bitcmp1_b32 s63, 0
s_cselect_b32 s72, 786432, 0
v_mfma_f32_16x16x32_bf16 v[44:47], a[56:59], v[152:155], v[44:47]
s_add_u32 s71, s71, s72
s_and_b32 s72, s63, 0x20000000
v_mfma_f32_16x16x32_bf16 v[48:51], a[56:59], v[156:159], v[48:51]
buffer_load_dwordx4 v[144:147], v10, s[32:35], s67 offen offset:2048 sc1
s_or_b32 s71, s71, s72
v_mfma_f32_16x16x32_bf16 v[52:55], a[60:63], v[148:151], v[52:55]
s_add_u32 s72, s71, 4096
s_add_u32 s70, s71, 8192
v_mfma_f32_16x16x32_bf16 v[56:59], a[60:63], v[152:155], v[56:59]
s_and_b32 s64, s97, s63
s_and_b32 s64, s64, s79
v_mfma_f32_16x16x32_bf16 v[60:63], a[60:63], v[156:159], v[60:63]
s_cmp_eq_u32 s64, -1
s_cbranch_scc1 T_last1
s_bitcmp1_b32 s73, 2
s_cbranch_scc1 T_d_27
s_cmp_eq_u32 s73, 0
s_cbranch_scc1 T_b1_0
s_cmp_eq_u32 s73, 1
s_cbranch_scc1 T_b1_1
s_cmp_eq_u32 s73, 2
s_cbranch_scc1 T_b1_2
s_branch T_b1_3
T_d_27:
s_cmp_eq_u32 s73, 4
s_cbranch_scc1 T_b1_4
s_cmp_eq_u32 s73, 5
s_cbranch_scc1 T_b1_5
s_cmp_eq_u32 s73, 6
s_cbranch_scc1 T_b1_6
s_cmp_eq_u32 s73, 7
s_cbranch_scc1 T_b1_7
s_branch T_n1
T_b0_1:
v_mfma_f32_16x16x32_bf16 v[64:67], a[0:3], v[112:115], v[64:67]
buffer_load_dwordx4 v[196:199], v10, s[32:35], s71 offen offset:3072 sc1
v_mfma_f32_16x16x32_bf16 v[68:71], a[0:3], v[116:119], v[68:71]
v_mfma_f32_16x16x32_bf16 v[72:75], a[0:3], v[120:123], v[72:75]
v_mfma_f32_16x16x32_bf16 v[76:79], a[4:7], v[112:115], v[76:79]
v_mfma_f32_16x16x32_bf16 v[80:83], a[4:7], v[116:119], v[80:83]
buffer_load_dwordx4 v[200:203], v10, s[32:35], s72 offen offset:3072 sc1
v_mfma_f32_16x16x32_bf16 v[84:87], a[4:7], v[120:123], v[84:87]
v_mfma_f32_16x16x32_bf16 v[88:91], a[8:11], v[112:115], v[88:91]
v_mfma_f32_16x16x32_bf16 v[92:95], a[8:11], v[116:119], v[92:95]
v_mfma_f32_16x16x32_bf16 v[96:99], a[8:11], v[120:123], v[96:99]
buffer_load_dwordx4 v[204:207], v10, s[32:35], s70 offen offset:3072 sc1
v_mfma_f32_16x16x32_bf16 v[100:103], a[12:15], v[112:115], v[100:103]
v_mfma_f32_16x16x32_bf16 v[104:107], a[12:15], v[116:119], v[104:107]
s_mov_b64 exec, 0xff
global_load_dwordx4 v[12:15], v11, s[98:99] sc1
s_mov_b64 exec, -1
v_mfma_f32_16x16x32_bf16 v[108:111], a[12:15], v[120:123], v[108:111]
v_mfma_f32_16x16x32_bf16 v[64:67], a[16:19], v[124:127], v[64:67]
buffer_load_dwordx4 v[112:115], v10, s[32:35], s65 offen offset:0 sc1
v_mfma_f32_16x16x32_bf16 v[68:71], a[16:19], v[128:131], v[68:71]
v_mfma_f32_16x16x32_bf16 v[72:75], a[16:19], v[132:135], v[72:75]
v_mfma_f32_16x16x32_bf16 v[76:79], a[20:23], v[124:127], v[76:79]
v_mfma_f32_16x16x32_bf16 v[80:83], a[20:23], v[128:131], v[80:83]
buffer_load_dwordx4 v[116:119], v10, s[32:35], s66 offen offset:0 sc1
v_mfma_f32_16x16x32_bf16 v[84:87], a[20:23], v[132:135], v[84:87]
v_mfma_f32_16x16x32_bf16 v[88:91], a[24:27], v[124:127], v[88:91]
v_mfma_f32_16x16x32_bf16 v[92:95], a[24:27], v[128:131], v[92:95]
v_mfma_f32_16x16x32_bf16 v[96:99], a[24:27], v[132:135], v[96:99]
buffer_load_dwordx4 v[120:123], v10, s[32:35], s67 offen offset:0 sc1
v_mfma_f32_16x16x32_bf16 v[100:103], a[28:31], v[124:127], v[100:103]
v_mfma_f32_16x16x32_bf16 v[104:107], a[28:31], v[128:131], v[104:107]
v_mfma_f32_16x16x32_bf16 v[108:111], a[28:31], v[132:135], v[108:111]
v_mfma_f32_16x16x32_bf16 v[64:67], a[32:35], v[136:139], v[64:67]
buffer_load_dwordx4 v[124:127], v10, s[32:35], s65 offen offset:1024 sc1
v_mfma_f32_16x16x32_bf16 v[68:71], a[32:35], v[140:143], v[68:71]
v_mfma_f32_16x16x32_bf16 v[72:75], a[32:35], v[144:147], v[72:75]
v_mfma_f32_16x16x32_bf16 v[76:79], a[36:39], v[136:139], v[76:79]
v_mfma_f32_16x16x32_bf16 v[80:83], a[36:39], v[140:143], v[80:83]
buffer_load_dwordx4 v[128:131], v10, s[32:35], s66 offen offset:1024 sc1
v_mfma_f32_16x16x32_bf16 v[84:87], a[36:39], v[144:147], v[84:87]
v_mfma_f32_16x16x32_bf16 v[88:91], a[40:43], v[136:139], v[88:91]
v_mfma_f32_16x16x32_bf16 v[92:95], a[40:43], v[140:143], v[92:95]
v_mfma_f32_16x16x32_bf16 v[96:99], a[40:43], v[144:147], v[96:99]
buffer_load_dwordx4 v[132:135], v10, s[32:35], s67 offen offset:1024 sc1
v_mfma_f32_16x16x32_bf16 v[100:103], a[44:47], v[136:139], v[100:103]
v_mfma_f32_16x16x32_bf16 v[104:107], a[44:47], v[140:143], v[104:107]
v_mfma_f32_16x16x32_bf16 v[108:111], a[44:47], v[144:147], v[108:111]
s_waitcnt vmcnt(6)
v_min3_u32 v12, v12, v13, v14
v_min_u32 v12, v12, v15
v_mfma_f32_16x16x32_bf16 v[64:67], a[48:51], v[148:151], v[64:67]
buffer_load_dwordx4 v[136:139], v10, s[32:35], s65 offen offset:2048 sc1
v_cmp_ne_u32 vcc, 0, v12
v_mfma_f32_16x16x32_bf16 v[68:71], a[48:51], v[152:155], v[68:71]
s_mov_b32 s73, s63
s_andn2_b32 s96, vcc_lo, s79
v_mfma_f32_16x16x32_bf16 v[72:75], a[48:51], v[156:159], v[72:75]
s_ff1_i32_b32 s63, s96
s_bitset1_b32 s79, s63
v_mfma_f32_16x16x32_bf16 v[76:79], a[52:55], v[148:151], v[76:79]
s_bitcmp1_b32 s63, 1
s_cselect_b32 s71, s69, s68
v_mfma_f32_16x16x32_bf16 v[80:83], a[52:55], v[152:155], v[80:83]
buffer_load_dwordx4 v[140:143], v10, s[32:35], s66 offen offset:2048 sc1
s_cselect_b32 s72, s75, s74
v_mfma_f32_16x16x32_bf16 v[84:87], a[52:55], v[156:159], v[84:87]
s_bitcmp1_b32 s63, 2
s_cselect_b32 s71, s72, s71
v_mfma_f32_16x16x32_bf16 v[88:91], a[56:59], v[148:151], v[88:91]
s_bitcmp1_b32 s63, 0
s_cselect_b32 s72, 786432, 0
v_mfma_f32_16x16x32_bf16 v[92:95], a[56:59], v[152:155], v[92:95]
s_add_u32 s71, s71, s72
s_and_b32 s72, s63, 0x20000000
v_mfma_f32_16x16x32_bf16 v[96:99], a[56:59], v[156:159], v[96:99]
buffer_load_dwordx4 v[144:147], v10, s[32:35], s67 offen offset:2048 sc1
s_or_b32 s71, s71, s72
v_mfma_f32_16x16x32_bf16 v[100:103], a[60:63], v[148:151], v[100:103]
s_add_u32 s72, s71, 4096
s_add_u32 s70, s71, 8192
v_mfma_f32_16x16x32_bf16 v[104:107], a[60:63], v[152:155], v[104:107]
s_and_b32 s64, s97, s63
s_and_b32 s64, s64, s79
v_mfma_f32_16x16x32_bf16 v[108:111], a[60:63], v[156:159], v[108:111]
s_cmp_eq_u32 s64, -1
s_cbranch_scc1 T_last1
s_bitcmp1_b32 s73, 2
s_cbranch_scc1 T_d_28
s_cmp_eq_u32 s73, 0
s_cbranch_scc1 T_b1_0
s_cmp_eq_u32 s73, 1
s_cbranch_scc1 T_b1_1
s_cmp_eq_u32 s73, 2
s_cbranch_scc1 T_b1_2
s_branch T_b1_3
T_d_28:
s_cmp_eq_u32 s73, 4
s_cbranch_scc1 T_b1_4
s_cmp_eq_u32 s73, 5
s_cbranch_scc1 T_b1_5
s_cmp_eq_u32 s73, 6
s_cbranch_scc1 T_b1_6
s_cmp_eq_u32 s73, 7
s_cbranch_scc1 T_b1_7
s_branch T_n1
T_b0_2:
v_mfma_f32_16x16x32_bf16 v[16:19], a[64:67], v[112:115], v[16:19]
buffer_load_dwordx4 v[196:199], v10, s[32:35], s71 offen offset:3072 sc1
v_mfma_f32_16x16x32_bf16 v[20:23], a[64:67], v[116:119], v[20:23]
v_mfma_f32_16x16x32_bf16 v[24:27], a[64:67], v[120:123], v[24:27]
v_mfma_f32_16x16x32_bf16 v[28:31], a[68:71], v[112:115], v[28:31]
v_mfma_f32_16x16x32_bf16 v[32:35], a[68:71], v[116:119], v[32:35]
buffer_load_dwordx4 v[200:203], v10, s[32:35], s72 offen offset:3072 sc1
v_mfma_f32_16x16x32_bf16 v[36:39], a[68:71], v[120:123], v[36:39]
v_mfma_f32_16x16x32_bf16 v[40:43], a[72:75], v[112:115], v[40:43]
v_mfma_f32_16x16x32_bf16 v[44:47], a[72:75], v[116:119], v[44:47]
v_mfma_f32_16x16x32_bf16 v[48:51], a[72:75], v[120:123], v[48:51]
buffer_load_dwordx4 v[204:207], v10, s[32:35], s70 offen offset:3072 sc1
v_mfma_f32_16x16x32_bf16 v[52:55], a[76:79], v[112:115], v[52:55]
v_mfma_f32_16x16x32_bf16 v[56:59], a[76:79], v[116:119], v[56:59]
s_mov_b64 exec, 0xff
global_load_dwordx4 v[12:15], v11, s[98:99] sc1
s_mov_b64 exec, -1
v_mfma_f32_16x16x32_bf16 v[60:63], a[76:79], v[120:123], v[60:63]
v_mfma_f32_16x16x32_bf16 v[16:19], a[80:83], v[124:127], v[16:19]
buffer_load_dwordx4 v[112:115], v10, s[32:35], s65 offen offset:0 sc1
v_mfma_f32_16x16x32_bf16 v[20:23], a[80:83], v[128:131], v[20:23]
v_mfma_f32_16x16x32_bf16 v[24:27], a[80:83], v[132:135], v[24:27]
v_mfma_f32_16x16x32_bf16 v[28:31], a[84:87], v[124:127], v[28:31]
v_mfma_f32_16x16x32_bf16 v[32:35], a[84:87], v[128:131], v[32:35]
buffer_load_dwordx4 v[116:119], v10, s[32:35], s66 offen offset:0 sc1
v_mfma_f32_16x16x32_bf16 v[36:39], a[84:87], v[132:135], v[36:39]
v_mfma_f32_16x16x32_bf16 v[40:43], a[88:91], v[124:127], v[40:43]
v_mfma_f32_16x16x32_bf16 v[44:47], a[88:91], v[128:131], v[44:47]
v_mfma_f32_16x16x32_bf16 v[48:51], a[88:91], v[132:135], v[48:51]
buffer_load_dwordx4 v[120:123], v10, s[32:35], s67 offen offset:0 sc1
v_mfma_f32_16x16x32_bf16 v[52:55], a[92:95], v[124:127], v[52:55]
v_mfma_f32_16x16x32_bf16 v[56:59], a[92:95], v[128:131], v[56:59]
v_mfma_f32_16x16x32_bf16 v[60:63], a[92:95], v[132:135], v[60:63]
v_mfma_f32_16x16x32_bf16 v[16:19], a[96:99], v[136:139], v[16:19]
buffer_load_dwordx4 v[124:127], v10, s[32:35], s65 offen offset:1024 sc1
v_mfma_f32_16x16x32_bf16 v[20:23], a[96:99], v[140:143], v[20:23]
v_mfma_f32_16x16x32_bf16 v[24:27], a[96:99], v[144:147], v[24:27]
v_mfma_f32_16x16x32_bf16 v[28:31], a[100:103], v[136:139], v[28:31]
v_mfma_f32_16x16x32_bf16 v[32:35], a[100:103], v[140:143], v[32:35]
buffer_load_dwordx4 v[128:131], v10, s[32:35], s66 offen offset:1024 sc1
v_mfma_f32_16x16x32_bf16 v[36:39], a[100:103], v[144:147], v[36:39]
v_mfma_f32_16x16x32_bf16 v[40:43], a[104:107], v[136:139], v[40:43]
v_mfma_f32_16x16x32_bf16 v[44:47], a[104:107], v[140:143], v[44:47]
v_mfma_f32_16x16x32_bf16 v[48:51], a[104:107], v[144:147], v[48:51]
buffer_load_dwordx4 v[132:135], v10, s[32:35], s67 offen offset:1024 sc1
v_mfma_f32_16x16x32_bf16 v[52:55], a[108:111], v[136:139], v[52:55]
v_mfma_f32_16x16x32_bf16 v[56:59], a[108:111], v[140:143], v[56:59]
v_mfma_f32_16x16x32_bf16 v[60:63], a[108:111], v[144:147], v[60:63]
s_waitcnt vmcnt(6)
v_min3_u32 v12, v12, v13, v14
v_min_u32 v12, v12, v15
v_mfma_f32_16x16x32_bf16 v[16:19], a[112:115], v[148:151], v[16:19]
buffer_load_dwordx4 v[136:139], v10, s[32:35], s65 offen offset:2048 sc1
v_cmp_ne_u32 vcc, 0, v12
v_mfma_f32_16x16x32_bf16 v[20:23], a[112:115], v[152:155], v[20:23]
s_mov_b32 s73, s63
s_andn2_b32 s96, vcc_lo, s79
v_mfma_f32_16x16x32_bf16 v[24:27], a[112:115], v[156:159], v[24:27]
s_ff1_i32_b32 s63, s96
s_bitset1_b32 s79, s63
v_mfma_f32_16x16x32_bf16 v[28:31], a[116:119], v[148:151], v[28:31]
s_bitcmp1_b32 s63, 1
s_cselect_b32 s71, s69, s68
v_mfma_f32_16x16x32_bf16 v[32:35], a[116:119], v[152:155], v[32:35]
buffer_load_dwordx4 v[140:143], v10, s[32:35], s66 offen offset:2048 sc1
s_cselect_b32 s72, s75, s74
v_mfma_f32_16x16x32_bf16 v[36:39], a[116:119], v[156:159], v[36:39]
s_bitcmp1_b32 s63, 2
s_cselect_b32 s71, s72, s71
v_mfma_f32_16x16x32_bf16 v[40:43], a[120:123], v[148:151], v[40:43]
s_bitcmp1_b32 s63, 0
s_cselect_b32 s72, 786432, 0
v_mfma_f32_16x16x32_bf16 v[44:47], a[120:123], v[152:155], v[44:47]
s_add_u32 s71, s71, s72
s_and_b32 s72, s63, 0x20000000
v_mfma_f32_16x16x32_bf16 v[48:51], a[120:123], v[156:159], v[48:51]
buffer_load_dwordx4 v[144:147], v10, s[32:35], s67 offen offset:2048 sc1
s_or_b32 s71, s71, s72
v_mfma_f32_16x16x32_bf16 v[52:55], a[124:127], v[148:151], v[52:55]
s_add_u32 s72, s71, 4096
s_add_u32 s70, s71, 8192
v_mfma_f32_16x16x32_bf16 v[56:59], a[124:127], v[152:155], v[56:59]
s_and_b32 s64, s97, s63
s_and_b32 s64, s64, s79
v_mfma_f32_16x16x32_bf16 v[60:63], a[124:127], v[156:159], v[60:63]
s_cmp_eq_u32 s64, -1
s_cbranch_scc1 T_last1
s_bitcmp1_b32 s73, 2
s_cbranch_scc1 T_d_29
s_cmp_eq_u32 s73, 0
s_cbranch_scc1 T_b1_0
s_cmp_eq_u32 s73, 1
s_cbranch_scc1 T_b1_1
s_cmp_eq_u32 s73, 2
s_cbranch_scc1 T_b1_2
s_branch T_b1_3
T_d_29:
s_cmp_eq_u32 s73, 4
s_cbranch_scc1 T_b1_4
s_cmp_eq_u32 s73, 5
s_cbranch_scc1 T_b1_5
s_cmp_eq_u32 s73, 6
s_cbranch_scc1 T_b1_6
s_cmp_eq_u32 s73, 7
s_cbranch_scc1 T_b1_7
s_branch T_n1
T_b0_3:
v_mfma_f32_16x16x32_bf16 v[64:67], a[64:67], v[112:115], v[64:67]
buffer_load_dwordx4 v[196:199], v10, s[32:35], s71 offen offset:3072 sc1
v_mfma_f32_16x16x32_bf16 v[68:71], a[64:67], v[116:119], v[68:71]
v_mfma_f32_16x16x32_bf16 v[72:75], a[64:67], v[120:123], v[72:75]
v_mfma_f32_16x16x32_bf16 v[76:79], a[68:71], v[112:115], v[76:79]
v_mfma_f32_16x16x32_bf16 v[80:83], a[68:71], v[116:119], v[80:83]
buffer_load_dwordx4 v[200:203], v10, s[32:35], s72 offen offset:3072 sc1
v_mfma_f32_16x16x32_bf16 v[84:87], a[68:71], v[120:123], v[84:87]
v_mfma_f32_16x16x32_bf16 v[88:91], a[72:75], v[112:115], v[88:91]
v_mfma_f32_16x16x32_bf16 v[92:95], a[72:75], v[116:119], v[92:95]
v_mfma_f32_16x16x32_bf16 v[96:99], a[72:75], v[120:123], v[96:99]
buffer_load_dwordx4 v[204:207], v10, s[32:35], s70 offen offset:3072 sc1
v_mfma_f32_16x16x32_bf16 v[100:103], a[76:79], v[112:115], v[100:103]
v_mfma_f32_16x16x32_bf16 v[104:107], a[76:79], v[116:119], v[104:107]
s_mov_b64 exec, 0xff
global_load_dwordx4 v[12:15], v11, s[98:99] sc1
s_mov_b64 exec, -1
v_mfma_f32_16x16x32_bf16 v[108:111], a[76:79], v[120:123], v[108:111]
v_mfma_f32_16x16x32_bf16 v[64:67], a[80:83], v[124:127], v[64:67]
buffer_load_dwordx4 v[112:115], v10, s[32:35], s65 offen offset:0 sc1
v_mfma_f32_16x16x32_bf16 v[68:71], a[80:83], v[128:131], v[68:71]
v_mfma_f32_16x16x32_bf16 v[72:75], a[80:83], v[132:135], v[72:75]
v_mfma_f32_16x16x32_bf16 v[76:79], a[84:87], v[124:127], v[76:79]
v_mfma_f32_16x16x32_bf16 v[80:83], a[84:87], v[128:131], v[80:83]
buffer_load_dwordx4 v[116:119], v10, s[32:35], s66 offen offset:0 sc1
v_mfma_f32_16x16x32_bf16 v[84:87], a[84:87], v[132:135], v[84:87]
v_mfma_f32_16x16x32_bf16 v[88:91], a[88:91], v[124:127], v[88:91]
v_mfma_f32_16x16x32_bf16 v[92:95], a[88:91], v[128:131], v[92:95]
v_mfma_f32_16x16x32_bf16 v[96:99], a[88:91], v[132:135], v[96:99]
buffer_load_dwordx4 v[120:123], v10, s[32:35], s67 offen offset:0 sc1
v_mfma_f32_16x16x32_bf16 v[100:103], a[92:95], v[124:127], v[100:103]
v_mfma_f32_16x16x32_bf16 v[104:107], a[92:95], v[128:131], v[104:107]
v_mfma_f32_16x16x32_bf16 v[108:111], a[92:95], v[132:135], v[108:111]
v_mfma_f32_16x16x32_bf16 v[64:67], a[96:99], v[136:139], v[64:67]
buffer_load_dwordx4 v[124:127], v10, s[32:35], s65 offen offset:1024 sc1
v_mfma_f32_16x16x32_bf16 v[68:71], a[96:99], v[140:143], v[68:71]
v_mfma_f32_16x16x32_bf16 v[72:75], a[96:99], v[144:147], v[72:75]
v_mfma_f32_16x16x32_bf16 v[76:79], a[100:103], v[136:139], v[76:79]
v_mfma_f32_16x16x32_bf16 v[80:83], a[100:103], v[140:143], v[80:83]
buffer_load_dwordx4 v[128:131], v10, s[32:35], s66 offen offset:1024 sc1
v_mfma_f32_16x16x32_bf16 v[84:87], a[100:103], v[144:147], v[84:87]
v_mfma_f32_16x16x32_bf16 v[88:91], a[104:107], v[136:139], v[88:91]
v_mfma_f32_16x16x32_bf16 v[92:95], a[104:107], v[140:143], v[92:95]
v_mfma_f32_16x16x32_bf16 v[96:99], a[104:107], v[144:147], v[96:99]
buffer_load_dwordx4 v[132:135], v10, s[32:35], s67 offen offset:1024 sc1
v_mfma_f32_16x16x32_bf16 v[100:103], a[108:111], v[136:139], v[100:103]
v_mfma_f32_16x16x32_bf16 v[104:107], a[108:111], v[140:143], v[104:107]
v_mfma_f32_16x16x32_bf16 v[108:111], a[108:111], v[144:147], v[108:111]
s_waitcnt vmcnt(6)
v_min3_u32 v12, v12, v13, v14
v_min_u32 v12, v12, v15
v_mfma_f32_16x16x32_bf16 v[64:67], a[112:115], v[148:151], v[64:67]
buffer_load_dwordx4 v[136:139], v10, s[32:35], s65 offen offset:2048 sc1
v_cmp_ne_u32 vcc, 0, v12
v_mfma_f32_16x16x32_bf16 v[68:71], a[112:115], v[152:155], v[68:71]
s_mov_b32 s73, s63
s_andn2_b32 s96, vcc_lo, s79
v_mfma_f32_16x16x32_bf16 v[72:75], a[112:115], v[156:159], v[72:75]
s_ff1_i32_b32 s63, s96
s_bitset1_b32 s79, s63
v_mfma_f32_16x16x32_bf16 v[76:79], a[116:119], v[148:151], v[76:79]
s_bitcmp1_b32 s63, 1
s_cselect_b32 s71, s69, s68
v_mfma_f32_16x16x32_bf16 v[80:83], a[116:119], v[152:155], v[80:83]
buffer_load_dwordx4 v[140:143], v10, s[32:35], s66 offen offset:2048 sc1
s_cselect_b32 s72, s75, s74
v_mfma_f32_16x16x32_bf16 v[84:87], a[116:119], v[156:159], v[84:87]
s_bitcmp1_b32 s63, 2
s_cselect_b32 s71, s72, s71
v_mfma_f32_16x16x32_bf16 v[88:91], a[120:123], v[148:151], v[88:91]
s_bitcmp1_b32 s63, 0
s_cselect_b32 s72, 786432, 0
v_mfma_f32_16x16x32_bf16 v[92:95], a[120:123], v[152:155], v[92:95]
s_add_u32 s71, s71, s72
s_and_b32 s72, s63, 0x20000000
v_mfma_f32_16x16x32_bf16 v[96:99], a[120:123], v[156:159], v[96:99]
buffer_load_dwordx4 v[144:147], v10, s[32:35], s67 offen offset:2048 sc1
s_or_b32 s71, s71, s72
v_mfma_f32_16x16x32_bf16 v[100:103], a[124:127], v[148:151], v[100:103]
s_add_u32 s72, s71, 4096
s_add_u32 s70, s71, 8192
v_mfma_f32_16x16x32_bf16 v[104:107], a[124:127], v[152:155], v[104:107]
s_and_b32 s64, s97, s63
s_and_b32 s64, s64, s79
v_mfma_f32_16x16x32_bf16 v[108:111], a[124:127], v[156:159], v[108:111]
s_cmp_eq_u32 s64, -1
s_cbranch_scc1 T_last1
s_bitcmp1_b32 s73, 2
s_cbranch_scc1 T_d_30
s_cmp_eq_u32 s73, 0
s_cbranch_scc1 T_b1_0
s_cmp_eq_u32 s73, 1
s_cbranch_scc1 T_b1_1
s_cmp_eq_u32 s73, 2
s_cbranch_scc1 T_b1_2
s_branch T_b1_3
T_d_30:
s_cmp_eq_u32 s73, 4
s_cbranch_scc1 T_b1_4
s_cmp_eq_u32 s73, 5
s_cbranch_scc1 T_b1_5
s_cmp_eq_u32 s73, 6
s_cbranch_scc1 T_b1_6
s_cmp_eq_u32 s73, 7
s_cbranch_scc1 T_b1_7
s_branch T_n1
T_b0_4:
v_mfma_f32_16x16x32_bf16 v[16:19], a[128:131], v[112:115], v[16:19]
buffer_load_dwordx4 v[196:199], v10, s[32:35], s71 offen offset:3072 sc1
v_mfma_f32_16x16x32_bf16 v[20:23], a[128:131], v[116:119], v[20:23]
v_mfma_f32_16x16x32_bf16 v[24:27], a[128:131], v[120:123], v[24:27]
v_mfma_f32_16x16x32_bf16 v[28:31], a[132:135], v[112:115], v[28:31]
v_mfma_f32_16x16x32_bf16 v[32:35], a[132:135], v[116:119], v[32:35]
buffer_load_dwordx4 v[200:203], v10, s[32:35], s72 offen offset:3072 sc1
v_mfma_f32_16x16x32_bf16 v[36:39], a[132:135], v[120:123], v[36:39]
v_mfma_f32_16x16x32_bf16 v[40:43], a[136:139], v[112:115], v[40:43]
v_mfma_f32_16x16x32_bf16 v[44:47], a[136:139], v[116:119], v[44:47]
v_mfma_f32_16x16x32_bf16 v[48:51], a[136:139], v[120:123], v[48:51]
buffer_load_dwordx4 v[204:207], v10, s[32:35], s70 offen offset:3072 sc1
v_mfma_f32_16x16x32_bf16 v[52:55], a[140:143], v[112:115], v[52:55]
v_mfma_f32_16x16x32_bf16 v[56:59], a[140:143], v[116:119], v[56:59]
s_mov_b64 exec, 0xff
global_load_dwordx4 v[12:15], v11, s[98:99] sc1
s_mov_b64 exec, -1
v_mfma_f32_16x16x32_bf16 v[60:63], a[140:143], v[120:123], v[60:63]
v_mfma_f32_16x16x32_bf16 v[16:19], a[144:147], v[124:127], v[16:19]
buffer_load_dwordx4 v[112:115], v10, s[32:35], s65 offen offset:0 sc1
v_mfma_f32_16x16x32_bf16 v[20:23], a[144:147], v[128:131], v[20:23]
v_mfma_f32_16x16x32_bf16 v[24:27], a[144:147], v[132:135], v[24:27]
v_mfma_f32_16x16x32_bf16 v[28:31], a[148:151], v[124:127], v[28:31]
v_mfma_f32_16x16x32_bf16 v[32:35], a[148:151], v[128:131], v[32:35]
buffer_load_dwordx4 v[116:119], v10, s[32:35], s66 offen offset:0 sc1
v_mfma_f32_16x16x32_bf16 v[36:39], a[148:151], v[132:135], v[36:39]
v_mfma_f32_16x16x32_bf16 v[40:43], a[152:155], v[124:127], v[40:43]
v_mfma_f32_16x16x32_bf16 v[44:47], a[152:155], v[128:131], v[44:47]
v_mfma_f32_16x16x32_bf16 v[48:51], a[152:155], v[132:135], v[48:51]
buffer_load_dwordx4 v[120:123], v10, s[32:35], s67 offen offset:0 sc1
v_mfma_f32_16x16x32_bf16 v[52:55], a[156:159], v[124:127], v[52:55]
v_mfma_f32_16x16x32_bf16 v[56:59], a[156:159], v[128:131], v[56:59]
v_mfma_f32_16x16x32_bf16 v[60:63], a[156:159], v[132:135], v[60:63]
v_mfma_f32_16x16x32_bf16 v[16:19], a[160:163], v[136:139], v[16:19]
buffer_load_dwordx4 v[124:127], v10, s[32:35], s65 offen offset:1024 sc1
v_mfma_f32_16x16x32_bf16 v[20:23], a[160:163], v[140:143], v[20:23]
v_mfma_f32_16x16x32_bf16 v[24:27], a[160:163], v[144:147], v[24:27]
v_mfma_f32_16x16x32_bf16 v[28:31], a[164:167], v[136:139], v[28:31]
v_mfma_f32_16x16x32_bf16 v[32:35], a[164:167], v[140:143], v[32:35]
buffer_load_dwordx4 v[128:131], v10, s[32:35], s66 offen offset:1024 sc1
v_mfma_f32_16x16x32_bf16 v[36:39], a[164:167], v[144:147], v[36:39]
v_mfma_f32_16x16x32_bf16 v[40:43], a[168:171], v[136:139], v[40:43]
v_mfma_f32_16x16x32_bf16 v[44:47], a[168:171], v[140:143], v[44:47]
v_mfma_f32_16x16x32_bf16 v[48:51], a[168:171], v[144:147], v[48:51]
buffer_load_dwordx4 v[132:135], v10, s[32:35], s67 offen offset:1024 sc1
v_mfma_f32_16x16x32_bf16 v[52:55], a[172:175], v[136:139], v[52:55]
v_mfma_f32_16x16x32_bf16 v[56:59], a[172:175], v[140:143], v[56:59]
v_mfma_f32_16x16x32_bf16 v[60:63], a[172:175], v[144:147], v[60:63]
s_waitcnt vmcnt(6)
v_min3_u32 v12, v12, v13, v14
v_min_u32 v12, v12, v15
v_mfma_f32_16x16x32_bf16 v[16:19], a[176:179], v[148:151], v[16:19]
buffer_load_dwordx4 v[136:139], v10, s[32:35], s65 offen offset:2048 sc1
v_cmp_ne_u32 vcc, 0, v12
v_mfma_f32_16x16x32_bf16 v[20:23], a[176:179], v[152:155], v[20:23]
s_mov_b32 s73, s63
s_andn2_b32 s96, vcc_lo, s79
v_mfma_f32_16x16x32_bf16 v[24:27], a[176:179], v[156:159], v[24:27]
s_ff1_i32_b32 s63, s96
s_bitset1_b32 s79, s63
v_mfma_f32_16x16x32_bf16 v[28:31], a[180:183], v[148:151], v[28:31]
s_bitcmp1_b32 s63, 1
s_cselect_b32 s71, s69, s68
v_mfma_f32_16x16x32_bf16 v[32:35], a[180:183], v[152:155], v[32:35]
buffer_load_dwordx4 v[140:143], v10, s[32:35], s66 offen offset:2048 sc1
s_cselect_b32 s72, s75, s74
v_mfma_f32_16x16x32_bf16 v[36:39], a[180:183], v[156:159], v[36:39]
s_bitcmp1_b32 s63, 2
s_cselect_b32 s71, s72, s71
v_mfma_f32_16x16x32_bf16 v[40:43], a[184:187], v[148:151], v[40:43]
s_bitcmp1_b32 s63, 0
s_cselect_b32 s72, 786432, 0
v_mfma_f32_16x16x32_bf16 v[44:47], a[184:187], v[152:155], v[44:47]
s_add_u32 s71, s71, s72
s_and_b32 s72, s63, 0x20000000
v_mfma_f32_16x16x32_bf16 v[48:51], a[184:187], v[156:159], v[48:51]
buffer_load_dwordx4 v[144:147], v10, s[32:35], s67 offen offset:2048 sc1
s_or_b32 s71, s71, s72
v_mfma_f32_16x16x32_bf16 v[52:55], a[188:191], v[148:151], v[52:55]
s_add_u32 s72, s71, 4096
s_add_u32 s70, s71, 8192
v_mfma_f32_16x16x32_bf16 v[56:59], a[188:191], v[152:155], v[56:59]
s_and_b32 s64, s97, s63
s_and_b32 s64, s64, s79
v_mfma_f32_16x16x32_bf16 v[60:63], a[188:191], v[156:159], v[60:63]
s_cmp_eq_u32 s64, -1
s_cbranch_scc1 T_last1
s_bitcmp1_b32 s73, 2
s_cbranch_scc1 T_d_31
s_cmp_eq_u32 s73, 0
s_cbranch_scc1 T_b1_0
s_cmp_eq_u32 s73, 1
s_cbranch_scc1 T_b1_1
s_cmp_eq_u32 s73, 2
s_cbranch_scc1 T_b1_2
s_branch T_b1_3
T_d_31:
s_cmp_eq_u32 s73, 4
s_cbranch_scc1 T_b1_4
s_cmp_eq_u32 s73, 5
s_cbranch_scc1 T_b1_5
s_cmp_eq_u32 s73, 6
s_cbranch_scc1 T_b1_6
s_cmp_eq_u32 s73, 7
s_cbranch_scc1 T_b1_7
s_branch T_n1
T_b0_5:
v_mfma_f32_16x16x32_bf16 v[64:67], a[128:131], v[112:115], v[64:67]
buffer_load_dwordx4 v[196:199], v10, s[32:35], s71 offen offset:3072 sc1
v_mfma_f32_16x16x32_bf16 v[68:71], a[128:131], v[116:119], v[68:71]
v_mfma_f32_16x16x32_bf16 v[72:75], a[128:131], v[120:123], v[72:75]
v_mfma_f32_16x16x32_bf16 v[76:79], a[132:135], v[112:115], v[76:79]
v_mfma_f32_16x16x32_bf16 v[80:83], a[132:135], v[116:119], v[80:83]
buffer_load_dwordx4 v[200:203], v10, s[32:35], s72 offen offset:3072 sc1
v_mfma_f32_16x16x32_bf16 v[84:87], a[132:135], v[120:123], v[84:87]
v_mfma_f32_16x16x32_bf16 v[88:91], a[136:139], v[112:115], v[88:91]
v_mfma_f32_16x16x32_bf16 v[92:95], a[136:139], v[116:119], v[92:95]
v_mfma_f32_16x16x32_bf16 v[96:99], a[136:139], v[120:123], v[96:99]
buffer_load_dwordx4 v[204:207], v10, s[32:35], s70 offen offset:3072 sc1
v_mfma_f32_16x16x32_bf16 v[100:103], a[140:143], v[112:115], v[100:103]
v_mfma_f32_16x16x32_bf16 v[104:107], a[140:143], v[116:119], v[104:107]
s_mov_b64 exec, 0xff
global_load_dwordx4 v[12:15], v11, s[98:99] sc1
s_mov_b64 exec, -1
v_mfma_f32_16x16x32_bf16 v[108:111], a[140:143], v[120:123], v[108:111]
v_mfma_f32_16x16x32_bf16 v[64:67], a[144:147], v[124:127], v[64:67]
buffer_load_dwordx4 v[112:115], v10, s[32:35], s65 offen offset:0 sc1
v_mfma_f32_16x16x32_bf16 v[68:71], a[144:147], v[128:131], v[68:71]
v_mfma_f32_16x16x32_bf16 v[72:75], a[144:147], v[132:135], v[72:75]
v_mfma_f32_16x16x32_bf16 v[76:79], a[148:151], v[124:127], v[76:79]
v_mfma_f32_16x16x32_bf16 v[80:83], a[148:151], v[128:131], v[80:83]
buffer_load_dwordx4 v[116:119], v10, s[32:35], s66 offen offset:0 sc1
v_mfma_f32_16x16x32_bf16 v[84:87], a[148:151], v[132:135], v[84:87]
v_mfma_f32_16x16x32_bf16 v[88:91], a[152:155], v[124:127], v[88:91]
v_mfma_f32_16x16x32_bf16 v[92:95], a[152:155], v[128:131], v[92:95]
v_mfma_f32_16x16x32_bf16 v[96:99], a[152:155], v[132:135], v[96:99]
buffer_load_dwordx4 v[120:123], v10, s[32:35], s67 offen offset:0 sc1
v_mfma_f32_16x16x32_bf16 v[100:103], a[156:159], v[124:127], v[100:103]
v_mfma_f32_16x16x32_bf16 v[104:107], a[156:159], v[128:131], v[104:107]
v_mfma_f32_16x16x32_bf16 v[108:111], a[156:159], v[132:135], v[108:111]
v_mfma_f32_16x16x32_bf16 v[64:67], a[160:163], v[136:139], v[64:67]
buffer_load_dwordx4 v[124:127], v10, s[32:35], s65 offen offset:1024 sc1
v_mfma_f32_16x16x32_bf16 v[68:71], a[160:163], v[140:143], v[68:71]
v_mfma_f32_16x16x32_bf16 v[72:75], a[160:163], v[144:147], v[72:75]
v_mfma_f32_16x16x32_bf16 v[76:79], a[164:167], v[136:139], v[76:79]
v_mfma_f32_16x16x32_bf16 v[80:83], a[164:167], v[140:143], v[80:83]
buffer_load_dwordx4 v[128:131], v10, s[32:35], s66 offen offset:1024 sc1
v_mfma_f32_16x16x32_bf16 v[84:87], a[164:167], v[144:147], v[84:87]
v_mfma_f32_16x16x32_bf16 v[88:91], a[168:171], v[136:139], v[88:91]
v_mfma_f32_16x16x32_bf16 v[92:95], a[168:171], v[140:143], v[92:95]
v_mfma_f32_16x16x32_bf16 v[96:99], a[168:171], v[144:147], v[96:99]
buffer_load_dwordx4 v[132:135], v10, s[32:35], s67 offen offset:1024 sc1
v_mfma_f32_16x16x32_bf16 v[100:103], a[172:175], v[136:139], v[100:103]
v_mfma_f32_16x16x32_bf16 v[104:107], a[172:175], v[140:143], v[104:107]
v_mfma_f32_16x16x32_bf16 v[108:111], a[172:175], v[144:147], v[108:111]
s_waitcnt vmcnt(6)
v_min3_u32 v12, v12, v13, v14
v_min_u32 v12, v12, v15
v_mfma_f32_16x16x32_bf16 v[64:67], a[176:179], v[148:151], v[64:67]
buffer_load_dwordx4 v[136:139], v10, s[32:35], s65 offen offset:2048 sc1
v_cmp_ne_u32 vcc, 0, v12
v_mfma_f32_16x16x32_bf16 v[68:71], a[176:179], v[152:155], v[68:71]
s_mov_b32 s73, s63
s_andn2_b32 s96, vcc_lo, s79
v_mfma_f32_16x16x32_bf16 v[72:75], a[176:179], v[156:159], v[72:75]
s_ff1_i32_b32 s63, s96
s_bitset1_b32 s79, s63
v_mfma_f32_16x16x32_bf16 v[76:79], a[180:183], v[148:151], v[76:79]
s_bitcmp1_b32 s63, 1
s_cselect_b32 s71, s69, s68
v_mfma_f32_16x16x32_bf16 v[80:83], a[180:183], v[152:155], v[80:83]
buffer_load_dwordx4 v[140:143], v10, s[32:35], s66 offen offset:2048 sc1
s_cselect_b32 s72, s75, s74
v_mfma_f32_16x16x32_bf16 v[84:87], a[180:183], v[156:159], v[84:87]
s_bitcmp1_b32 s63, 2
s_cselect_b32 s71, s72, s71
v_mfma_f32_16x16x32_bf16 v[88:91], a[184:187], v[148:151], v[88:91]
s_bitcmp1_b32 s63, 0
s_cselect_b32 s72, 786432, 0
v_mfma_f32_16x16x32_bf16 v[92:95], a[184:187], v[152:155], v[92:95]
s_add_u32 s71, s71, s72
s_and_b32 s72, s63, 0x20000000
v_mfma_f32_16x16x32_bf16 v[96:99], a[184:187], v[156:159], v[96:99]
buffer_load_dwordx4 v[144:147], v10, s[32:35], s67 offen offset:2048 sc1
s_or_b32 s71, s71, s72
v_mfma_f32_16x16x32_bf16 v[100:103], a[188:191], v[148:151], v[100:103]
s_add_u32 s72, s71, 4096
s_add_u32 s70, s71, 8192
v_mfma_f32_16x16x32_bf16 v[104:107], a[188:191], v[152:155], v[104:107]
s_and_b32 s64, s97, s63
s_and_b32 s64, s64, s79
v_mfma_f32_16x16x32_bf16 v[108:111], a[188:191], v[156:159], v[108:111]
s_cmp_eq_u32 s64, -1
s_cbranch_scc1 T_last1
s_bitcmp1_b32 s73, 2
s_cbranch_scc1 T_d_32
s_cmp_eq_u32 s73, 0
s_cbranch_scc1 T_b1_0
s_cmp_eq_u32 s73, 1
s_cbranch_scc1 T_b1_1
s_cmp_eq_u32 s73, 2
s_cbranch_scc1 T_b1_2
s_branch T_b1_3
T_d_32:
s_cmp_eq_u32 s73, 4
s_cbranch_scc1 T_b1_4
s_cmp_eq_u32 s73, 5
s_cbranch_scc1 T_b1_5
s_cmp_eq_u32 s73, 6
s_cbranch_scc1 T_b1_6
s_cmp_eq_u32 s73, 7
s_cbranch_scc1 T_b1_7
s_branch T_n1
T_b0_6:
v_mfma_f32_16x16x32_bf16 v[16:19], a[192:195], v[112:115], v[16:19]
buffer_load_dwordx4 v[196:199], v10, s[32:35], s71 offen offset:3072 sc1
v_mfma_f32_16x16x32_bf16 v[20:23], a[192:195], v[116:119], v[20:23]
v_mfma_f32_16x16x32_bf16 v[24:27], a[192:195], v[120:123], v[24:27]
v_mfma_f32_16x16x32_bf16 v[28:31], a[196:199], v[112:115], v[28:31]
v_mfma_f32_16x16x32_bf16 v[32:35], a[196:199], v[116:119], v[32:35]
buffer_load_dwordx4 v[200:203], v10, s[32:35], s72 offen offset:3072 sc1
v_mfma_f32_16x16x32_bf16 v[36:39], a[196:199], v[120:123], v[36:39]
v_mfma_f32_16x16x32_bf16 v[40:43], a[200:203], v[112:115], v[40:43]
v_mfma_f32_16x16x32_bf16 v[44:47], a[200:203], v[116:119], v[44:47]
v_mfma_f32_16x16x32_bf16 v[48:51], a[200:203], v[120:123], v[48:51]
buffer_load_dwordx4 v[204:207], v10, s[32:35], s70 offen offset:3072 sc1
v_mfma_f32_16x16x32_bf16 v[52:55], a[204:207], v[112:115], v[52:55]
v_mfma_f32_16x16x32_bf16 v[56:59], a[204:207], v[116:119], v[56:59]
s_mov_b64 exec, 0xff
global_load_dwordx4 v[12:15], v11, s[98:99] sc1
s_mov_b64 exec, -1
v_mfma_f32_16x16x32_bf16 v[60:63], a[204:207], v[120:123], v[60:63]
v_mfma_f32_16x16x32_bf16 v[16:19], a[208:211], v[124:127], v[16:19]
buffer_load_dwordx4 v[112:115], v10, s[32:35], s65 offen offset:0 sc1
v_mfma_f32_16x16x32_bf16 v[20:23], a[208:211], v[128:131], v[20:23]
v_mfma_f32_16x16x32_bf16 v[24:27], a[208:211], v[132:135], v[24:27]
v_mfma_f32_16x16x32_bf16 v[28:31], a[212:215], v[124:127], v[28:31]
v_mfma_f32_16x16x32_bf16 v[32:35], a[212:215], v[128:131], v[32:35]
buffer_load_dwordx4 v[116:119], v10, s[32:35], s66 offen offset:0 sc1
v_mfma_f32_16x16x32_bf16 v[36:39], a[212:215], v[132:135], v[36:39]
v_mfma_f32_16x16x32_bf16 v[40:43], a[216:219], v[124:127], v[40:43]
v_mfma_f32_16x16x32_bf16 v[44:47], a[216:219], v[128:131], v[44:47]
v_mfma_f32_16x16x32_bf16 v[48:51], a[216:219], v[132:135], v[48:51]
buffer_load_dwordx4 v[120:123], v10, s[32:35], s67 offen offset:0 sc1
v_mfma_f32_16x16x32_bf16 v[52:55], a[220:223], v[124:127], v[52:55]
v_mfma_f32_16x16x32_bf16 v[56:59], a[220:223], v[128:131], v[56:59]
v_mfma_f32_16x16x32_bf16 v[60:63], a[220:223], v[132:135], v[60:63]
v_mfma_f32_16x16x32_bf16 v[16:19], a[224:227], v[136:139], v[16:19]
buffer_load_dwordx4 v[124:127], v10, s[32:35], s65 offen offset:1024 sc1
v_mfma_f32_16x16x32_bf16 v[20:23], a[224:227], v[140:143], v[20:23]
v_mfma_f32_16x16x32_bf16 v[24:27], a[224:227], v[144:147], v[24:27]
v_mfma_f32_16x16x32_bf16 v[28:31], a[228:231], v[136:139], v[28:31]
v_mfma_f32_16x16x32_bf16 v[32:35], a[228:231], v[140:143], v[32:35]
buffer_load_dwordx4 v[128:131], v10, s[32:35], s66 offen offset:1024 sc1
v_mfma_f32_16x16x32_bf16 v[36:39], a[228:231], v[144:147], v[36:39]
v_mfma_f32_16x16x32_bf16 v[40:43], a[232:235], v[136:139], v[40:43]
v_mfma_f32_16x16x32_bf16 v[44:47], a[232:235], v[140:143], v[44:47]
v_mfma_f32_16x16x32_bf16 v[48:51], a[232:235], v[144:147], v[48:51]
buffer_load_dwordx4 v[132:135], v10, s[32:35], s67 offen offset:1024 sc1
v_mfma_f32_16x16x32_bf16 v[52:55], a[236:239], v[136:139], v[52:55]
v_mfma_f32_16x16x32_bf16 v[56:59], a[236:239], v[140:143], v[56:59]
v_mfma_f32_16x16x32_bf16 v[60:63], a[236:239], v[144:147], v[60:63]
s_waitcnt vmcnt(6)
v_min3_u32 v12, v12, v13, v14
v_min_u32 v12, v12, v15
v_mfma_f32_16x16x32_bf16 v[16:19], a[240:243], v[148:151], v[16:19]
buffer_load_dwordx4 v[136:139], v10, s[32:35], s65 offen offset:2048 sc1
v_cmp_ne_u32 vcc, 0, v12
v_mfma_f32_16x16x32_bf16 v[20:23], a[240:243], v[152:155], v[20:23]
s_mov_b32 s73, s63
s_andn2_b32 s96, vcc_lo, s79
v_mfma_f32_16x16x32_bf16 v[24:27], a[240:243], v[156:159], v[24:27]
s_ff1_i32_b32 s63, s96
s_bitset1_b32 s79, s63
v_mfma_f32_16x16x32_bf16 v[28:31], a[244:247], v[148:151], v[28:31]
s_bitcmp1_b32 s63, 1
s_cselect_b32 s71, s69, s68
v_mfma_f32_16x16x32_bf16 v[32:35], a[244:247], v[152:155], v[32:35]
buffer_load_dwordx4 v[140:143], v10, s[32:35], s66 offen offset:2048 sc1
s_cselect_b32 s72, s75, s74
v_mfma_f32_16x16x32_bf16 v[36:39], a[244:247], v[156:159], v[36:39]
s_bitcmp1_b32 s63, 2
s_cselect_b32 s71, s72, s71
v_mfma_f32_16x16x32_bf16 v[40:43], a[248:251], v[148:151], v[40:43]
s_bitcmp1_b32 s63, 0
s_cselect_b32 s72, 786432, 0
v_mfma_f32_16x16x32_bf16 v[44:47], a[248:251], v[152:155], v[44:47]
s_add_u32 s71, s71, s72
s_and_b32 s72, s63, 0x20000000
v_mfma_f32_16x16x32_bf16 v[48:51], a[248:251], v[156:159], v[48:51]
buffer_load_dwordx4 v[144:147], v10, s[32:35], s67 offen offset:2048 sc1
s_or_b32 s71, s71, s72
v_mfma_f32_16x16x32_bf16 v[52:55], a[252:255], v[148:151], v[52:55]
s_add_u32 s72, s71, 4096
s_add_u32 s70, s71, 8192
v_mfma_f32_16x16x32_bf16 v[56:59], a[252:255], v[152:155], v[56:59]
s_and_b32 s64, s97, s63
s_and_b32 s64, s64, s79
v_mfma_f32_16x16x32_bf16 v[60:63], a[252:255], v[156:159], v[60:63]
s_cmp_eq_u32 s64, -1
s_cbranch_scc1 T_last1
s_bitcmp1_b32 s73, 2
s_cbranch_scc1 T_d_33
s_cmp_eq_u32 s73, 0
s_cbranch_scc1 T_b1_0
s_cmp_eq_u32 s73, 1
s_cbranch_scc1 T_b1_1
s_cmp_eq_u32 s73, 2
s_cbranch_scc1 T_b1_2
s_branch T_b1_3
T_d_33:
s_cmp_eq_u32 s73, 4
s_cbranch_scc1 T_b1_4
s_cmp_eq_u32 s73, 5
s_cbranch_scc1 T_b1_5
s_cmp_eq_u32 s73, 6
s_cbranch_scc1 T_b1_6
s_cmp_eq_u32 s73, 7
s_cbranch_scc1 T_b1_7
s_branch T_n1
T_b0_7:
v_mfma_f32_16x16x32_bf16 v[64:67], a[192:195], v[112:115], v[64:67]
buffer_load_dwordx4 v[196:199], v10, s[32:35], s71 offen offset:3072 sc1
v_mfma_f32_16x16x32_bf16 v[68:71], a[192:195], v[116:119], v[68:71]
v_mfma_f32_16x16x32_bf16 v[72:75], a[192:195], v[120:123], v[72:75]
v_mfma_f32_16x16x32_bf16 v[76:79], a[196:199], v[112:115], v[76:79]
v_mfma_f32_16x16x32_bf16 v[80:83], a[196:199], v[116:119], v[80:83]
buffer_load_dwordx4 v[200:203], v10, s[32:35], s72 offen offset:3072 sc1
v_mfma_f32_16x16x32_bf16 v[84:87], a[196:199], v[120:123], v[84:87]
v_mfma_f32_16x16x32_bf16 v[88:91], a[200:203], v[112:115], v[88:91]
v_mfma_f32_16x16x32_bf16 v[92:95], a[200:203], v[116:119], v[92:95]
v_mfma_f32_16x16x32_bf16 v[96:99], a[200:203], v[120:123], v[96:99]
buffer_load_dwordx4 v[204:207], v10, s[32:35], s70 offen offset:3072 sc1
v_mfma_f32_16x16x32_bf16 v[100:103], a[204:207], v[112:115], v[100:103]
v_mfma_f32_16x16x32_bf16 v[104:107], a[204:207], v[116:119], v[104:107]
s_mov_b64 exec, 0xff
global_load_dwordx4 v[12:15], v11, s[98:99] sc1
s_mov_b64 exec, -1
v_mfma_f32_16x16x32_bf16 v[108:111], a[204:207], v[120:123], v[108:111]
v_mfma_f32_16x16x32_bf16 v[64:67], a[208:211], v[124:127], v[64:67]
buffer_load_dwordx4 v[112:115], v10, s[32:35], s65 offen offset:0 sc1
v_mfma_f32_16x16x32_bf16 v[68:71], a[208:211], v[128:131], v[68:71]
v_mfma_f32_16x16x32_bf16 v[72:75], a[208:211], v[132:135], v[72:75]
v_mfma_f32_16x16x32_bf16 v[76:79], a[212:215], v[124:127], v[76:79]
v_mfma_f32_16x16x32_bf16 v[80:83], a[212:215], v[128:131], v[80:83]
buffer_load_dwordx4 v[116:119], v10, s[32:35], s66 offen offset:0 sc1
v_mfma_f32_16x16x32_bf16 v[84:87], a[212:215], v[132:135], v[84:87]
v_mfma_f32_16x16x32_bf16 v[88:91], a[216:219], v[124:127], v[88:91]
v_mfma_f32_16x16x32_bf16 v[92:95], a[216:219], v[128:131], v[92:95]
v_mfma_f32_16x16x32_bf16 v[96:99], a[216:219], v[132:135], v[96:99]
buffer_load_dwordx4 v[120:123], v10, s[32:35], s67 offen offset:0 sc1
v_mfma_f32_16x16x32_bf16 v[100:103], a[220:223], v[124:127], v[100:103]
v_mfma_f32_16x16x32_bf16 v[104:107], a[220:223], v[128:131], v[104:107]
v_mfma_f32_16x16x32_bf16 v[108:111], a[220:223], v[132:135], v[108:111]
v_mfma_f32_16x16x32_bf16 v[64:67], a[224:227], v[136:139], v[64:67]
buffer_load_dwordx4 v[124:127], v10, s[32:35], s65 offen offset:1024 sc1
v_mfma_f32_16x16x32_bf16 v[68:71], a[224:227], v[140:143], v[68:71]
v_mfma_f32_16x16x32_bf16 v[72:75], a[224:227], v[144:147], v[72:75]
v_mfma_f32_16x16x32_bf16 v[76:79], a[228:231], v[136:139], v[76:79]
v_mfma_f32_16x16x32_bf16 v[80:83], a[228:231], v[140:143], v[80:83]
buffer_load_dwordx4 v[128:131], v10, s[32:35], s66 offen offset:1024 sc1
v_mfma_f32_16x16x32_bf16 v[84:87], a[228:231], v[144:147], v[84:87]
v_mfma_f32_16x16x32_bf16 v[88:91], a[232:235], v[136:139], v[88:91]
v_mfma_f32_16x16x32_bf16 v[92:95], a[232:235], v[140:143], v[92:95]
v_mfma_f32_16x16x32_bf16 v[96:99], a[232:235], v[144:147], v[96:99]
buffer_load_dwordx4 v[132:135], v10, s[32:35], s67 offen offset:1024 sc1
v_mfma_f32_16x16x32_bf16 v[100:103], a[236:239], v[136:139], v[100:103]
v_mfma_f32_16x16x32_bf16 v[104:107], a[236:239], v[140:143], v[104:107]
v_mfma_f32_16x16x32_bf16 v[108:111], a[236:239], v[144:147], v[108:111]
s_waitcnt vmcnt(6)
v_min3_u32 v12, v12, v13, v14
v_min_u32 v12, v12, v15
v_mfma_f32_16x16x32_bf16 v[64:67], a[240:243], v[148:151], v[64:67]
buffer_load_dwordx4 v[136:139], v10, s[32:35], s65 offen offset:2048 sc1
v_cmp_ne_u32 vcc, 0, v12
v_mfma_f32_16x16x32_bf16 v[68:71], a[240:243], v[152:155], v[68:71]
s_mov_b32 s73, s63
s_andn2_b32 s96, vcc_lo, s79
v_mfma_f32_16x16x32_bf16 v[72:75], a[240:243], v[156:159], v[72:75]
s_ff1_i32_b32 s63, s96
s_bitset1_b32 s79, s63
v_mfma_f32_16x16x32_bf16 v[76:79], a[244:247], v[148:151], v[76:79]
s_bitcmp1_b32 s63, 1
s_cselect_b32 s71, s69, s68
v_mfma_f32_16x16x32_bf16 v[80:83], a[244:247], v[152:155], v[80:83]
buffer_load_dwordx4 v[140:143], v10, s[32:35], s66 offen offset:2048 sc1
s_cselect_b32 s72, s75, s74
v_mfma_f32_16x16x32_bf16 v[84:87], a[244:247], v[156:159], v[84:87]
s_bitcmp1_b32 s63, 2
s_cselect_b32 s71, s72, s71
v_mfma_f32_16x16x32_bf16 v[88:91], a[248:251], v[148:151], v[88:91]
s_bitcmp1_b32 s63, 0
s_cselect_b32 s72, 786432, 0
v_mfma_f32_16x16x32_bf16 v[92:95], a[248:251], v[152:155], v[92:95]
s_add_u32 s71, s71, s72
s_and_b32 s72, s63, 0x20000000
v_mfma_f32_16x16x32_bf16 v[96:99], a[248:251], v[156:159], v[96:99]
buffer_load_dwordx4 v[144:147], v10, s[32:35], s67 offen offset:2048 sc1
s_or_b32 s71, s71, s72
v_mfma_f32_16x16x32_bf16 v[100:103], a[252:255], v[148:151], v[100:103]
s_add_u32 s72, s71, 4096
s_add_u32 s70, s71, 8192
v_mfma_f32_16x16x32_bf16 v[104:107], a[252:255], v[152:155], v[104:107]
s_and_b32 s64, s97, s63
s_and_b32 s64, s64, s79
v_mfma_f32_16x16x32_bf16 v[108:111], a[252:255], v[156:159], v[108:111]
s_cmp_eq_u32 s64, -1
s_cbranch_scc1 T_last1
s_bitcmp1_b32 s73, 2
s_cbranch_scc1 T_d_34
s_cmp_eq_u32 s73, 0
s_cbranch_scc1 T_b1_0
s_cmp_eq_u32 s73, 1
s_cbranch_scc1 T_b1_1
s_cmp_eq_u32 s73, 2
s_cbranch_scc1 T_b1_2
s_branch T_b1_3
T_d_34:
s_cmp_eq_u32 s73, 4
s_cbranch_scc1 T_b1_4
s_cmp_eq_u32 s73, 5
s_cbranch_scc1 T_b1_5
s_cmp_eq_u32 s73, 6
s_cbranch_scc1 T_b1_6
s_cmp_eq_u32 s73, 7
s_cbranch_scc1 T_b1_7
s_branch T_n1
T_last0:
s_cmp_eq_u32 s73, 0
s_cbranch_scc1 T_l0_0
s_cmp_eq_u32 s73, 1
s_cbranch_scc1 T_l0_1
s_cmp_eq_u32 s73, 2
s_cbranch_scc1 T_l0_2
s_cmp_eq_u32 s73, 3
s_cbranch_scc1 T_l0_3
s_cmp_eq_u32 s73, 4
s_cbranch_scc1 T_l0_4
s_cmp_eq_u32 s73, 5
s_cbranch_scc1 T_l0_5
s_cmp_eq_u32 s73, 6
s_cbranch_scc1 T_l0_6
s_cmp_eq_u32 s73, 7
s_cbranch_scc1 T_l0_7
s_branch T_done
T_l0_0:
v_mfma_f32_16x16x32_bf16 v[16:19], a[0:3], v[112:115], v[16:19]
v_mfma_f32_16x16x32_bf16 v[20:23], a[0:3], v[116:119], v[20:23]
v_mfma_f32_16x16x32_bf16 v[24:27], a[0:3], v[120:123], v[24:27]
v_mfma_f32_16x16x32_bf16 v[28:31], a[4:7], v[112:115], v[28:31]
v_mfma_f32_16x16x32_bf16 v[32:35], a[4:7], v[116:119], v[32:35]
v_mfma_f32_16x16x32_bf16 v[36:39], a[4:7], v[120:123], v[36:39]
v_mfma_f32_16x16x32_bf16 v[40:43], a[8:11], v[112:115], v[40:43]
v_mfma_f32_16x16x32_bf16 v[44:47], a[8:11], v[116:119], v[44:47]
v_mfma_f32_16x16x32_bf16 v[48:51], a[8:11], v[120:123], v[48:51]
ds_write_b128 v233, v[64:67] offset:12288
v_mfma_f32_16x16x32_bf16 v[52:55], a[12:15], v[112:115], v[52:55]
v_mfma_f32_16x16x32_bf16 v[56:59], a[12:15], v[116:119], v[56:59]
v_mfma_f32_16x16x32_bf16 v[60:63], a[12:15], v[120:123], v[60:63]
ds_write_b128 v233, v[68:71] offset:16384
v_mfma_f32_16x16x32_bf16 v[16:19], a[16:19], v[124:127], v[16:19]
v_mfma_f32_16x16x32_bf16 v[20:23], a[16:19], v[128:131], v[20:23]
v_mfma_f32_16x16x32_bf16 v[24:27], a[16:19], v[132:135], v[24:27]
ds_write_b128 v233, v[72:75] offset:20480
v_mfma_f32_16x16x32_bf16 v[28:31], a[20:23], v[124:127], v[28:31]
v_mfma_f32_16x16x32_bf16 v[32:35], a[20:23], v[128:131], v[32:35]
v_mfma_f32_16x16x32_bf16 v[36:39], a[20:23], v[132:135], v[36:39]
ds_write_b128 v234, v[76:79] offset:12288
v_mfma_f32_16x16x32_bf16 v[40:43], a[24:27], v[124:127], v[40:43]
v_mfma_f32_16x16x32_bf16 v[44:47], a[24:27], v[128:131], v[44:47]
v_mfma_f32_16x16x32_bf16 v[48:51], a[24:27], v[132:135], v[48:51]
ds_write_b128 v234, v[80:83] offset:16384
v_mfma_f32_16x16x32_bf16 v[52:55], a[28:31], v[124:127], v[52:55]
v_mfma_f32_16x16x32_bf16 v[56:59], a[28:31], v[128:131], v[56:59]
v_mfma_f32_16x16x32_bf16 v[60:63], a[28:31], v[132:135], v[60:63]
ds_write_b128 v234, v[84:87] offset:20480
v_mfma_f32_16x16x32_bf16 v[16:19], a[32:35], v[136:139], v[16:19]
v_mfma_f32_16x16x32_bf16 v[20:23], a[32:35], v[140:143], v[20:23]
v_mfma_f32_16x16x32_bf16 v[24:27], a[32:35], v[144:147], v[24:27]
ds_write_b128 v235, v[88:91] offset:12288
v_mfma_f32_16x16x32_bf16 v[28:31], a[36:39], v[136:139], v[28:31]
v_mfma_f32_16x16x32_bf16 v[32:35], a[36:39], v[140:143], v[32:35]
v_mfma_f32_16x16x32_bf16 v[36:39], a[36:39], v[144:147], v[36:39]
ds_write_b128 v235, v[92:95] offset:16384
v_mfma_f32_16x16x32_bf16 v[40:43], a[40:43], v[136:139], v[40:43]
v_mfma_f32_16x16x32_bf16 v[44:47], a[40:43], v[140:143], v[44:47]
v_mfma_f32_16x16x32_bf16 v[48:51], a[40:43], v[144:147], v[48:51]
ds_write_b128 v235, v[96:99] offset:20480
v_mfma_f32_16x16x32_bf16 v[52:55], a[44:47], v[136:139], v[52:55]
v_mfma_f32_16x16x32_bf16 v[56:59], a[44:47], v[140:143], v[56:59]
v_mfma_f32_16x16x32_bf16 v[60:63], a[44:47], v[144:147], v[60:63]
ds_write_b128 v236, v[100:103] offset:12288
v_mfma_f32_16x16x32_bf16 v[16:19], a[48:51], v[148:151], v[16:19]
v_mfma_f32_16x16x32_bf16 v[20:23], a[48:51], v[152:155], v[20:23]
v_mfma_f32_16x16x32_bf16 v[24:27], a[48:51], v[156:159], v[24:27]
ds_write_b128 v236, v[104:107] offset:16384
v_mfma_f32_16x16x32_bf16 v[28:31], a[52:55], v[148:151], v[28:31]
v_mfma_f32_16x16x32_bf16 v[32:35], a[52:55], v[152:155], v[32:35]
v_mfma_f32_16x16x32_bf16 v[36:39], a[52:55], v[156:159], v[36:39]
ds_write_b128 v236, v[108:111] offset:20480
v_mfma_f32_16x16x32_bf16 v[40:43], a[56:59], v[148:151], v[40:43]
v_mfma_f32_16x16x32_bf16 v[44:47], a[56:59], v[152:155], v[44:47]
v_mfma_f32_16x16x32_bf16 v[48:51], a[56:59], v[156:159], v[48:51]
ds_write_b128 v233, v[16:19] offset:0
v_mfma_f32_16x16x32_bf16 v[52:55], a[60:63], v[148:151], v[52:55]
ds_write_b128 v233, v[20:23] offset:4096
v_mfma_f32_16x16x32_bf16 v[56:59], a[60:63], v[152:155], v[56:59]
ds_write_b128 v233, v[24:27] offset:8192
v_mfma_f32_16x16x32_bf16 v[60:63], a[60:63], v[156:159], v[60:63]
ds_write_b128 v234, v[28:31] offset:0
ds_write_b128 v234, v[32:35] offset:4096
ds_write_b128 v234, v[36:39] offset:8192
ds_write_b128 v235, v[40:43] offset:0
ds_write_b128 v235, v[44:47] offset:4096
ds_write_b128 v235, v[48:51] offset:8192
ds_write_b128 v236, v[52:55] offset:0
ds_write_b128 v236, v[56:59] offset:4096
ds_write_b128 v236, v[60:63] offset:8192
s_branch L_ofin2
T_l0_1:
v_mfma_f32_16x16x32_bf16 v[64:67], a[0:3], v[112:115], v[64:67]
v_mfma_f32_16x16x32_bf16 v[68:71], a[0:3], v[116:119], v[68:71]
v_mfma_f32_16x16x32_bf16 v[72:75], a[0:3], v[120:123], v[72:75]
v_mfma_f32_16x16x32_bf16 v[76:79], a[4:7], v[112:115], v[76:79]
v_mfma_f32_16x16x32_bf16 v[80:83], a[4:7], v[116:119], v[80:83]
v_mfma_f32_16x16x32_bf16 v[84:87], a[4:7], v[120:123], v[84:87]
v_mfma_f32_16x16x32_bf16 v[88:91], a[8:11], v[112:115], v[88:91]
v_mfma_f32_16x16x32_bf16 v[92:95], a[8:11], v[116:119], v[92:95]
v_mfma_f32_16x16x32_bf16 v[96:99], a[8:11], v[120:123], v[96:99]
ds_write_b128 v233, v[16:19] offset:0
v_mfma_f32_16x16x32_bf16 v[100:103], a[12:15], v[112:115], v[100:103]
v_mfma_f32_16x16x32_bf16 v[104:107], a[12:15], v[116:119], v[104:107]
v_mfma_f32_16x16x32_bf16 v[108:111], a[12:15], v[120:123], v[108:111]
ds_write_b128 v233, v[20:23] offset:4096
v_mfma_f32_16x16x32_bf16 v[64:67], a[16:19], v[124:127], v[64:67]
v_mfma_f32_16x16x32_bf16 v[68:71], a[16:19], v[128:131], v[68:71]
v_mfma_f32_16x16x32_bf16 v[72:75], a[16:19], v[132:135], v[72:75]
ds_write_b128 v233, v[24:27] offset:8192
v_mfma_f32_16x16x32_bf16 v[76:79], a[20:23], v[124:127], v[76:79]
v_mfma_f32_16x16x32_bf16 v[80:83], a[20:23], v[128:131], v[80:83]
v_mfma_f32_16x16x32_bf16 v[84:87], a[20:23], v[132:135], v[84:87]
ds_write_b128 v234, v[28:31] offset:0
v_mfma_f32_16x16x32_bf16 v[88:91], a[24:27], v[124:127], v[88:91]
v_mfma_f32_16x16x32_bf16 v[92:95], a[24:27], v[128:131], v[92:95]
v_mfma_f32_16x16x32_bf16 v[96:99], a[24:27], v[132:135], v[96:99]
ds_write_b128 v234, v[32:35] offset:4096
v_mfma_f32_16x16x32_bf16 v[100:103], a[28:31], v[124:127], v[100:103]
v_mfma_f32_16x16x32_bf16 v[104:107], a[28:31], v[128:131], v[104:107]
v_mfma_f32_16x16x32_bf16 v[108:111], a[28:31], v[132:135], v[108:111]
ds_write_b128 v234, v[36:39] offset:8192
v_mfma_f32_16x16x32_bf16 v[64:67], a[32:35], v[136:139], v[64:67]
v_mfma_f32_16x16x32_bf16 v[68:71], a[32:35], v[140:143], v[68:71]
v_mfma_f32_16x16x32_bf16 v[72:75], a[32:35], v[144:147], v[72:75]
ds_write_b128 v235, v[40:43] offset:0
v_mfma_f32_16x16x32_bf16 v[76:79], a[36:39], v[136:139], v[76:79]
v_mfma_f32_16x16x32_bf16 v[80:83], a[36:39], v[140:143], v[80:83]
v_mfma_f32_16x16x32_bf16 v[84:87], a[36:39], v[144:147], v[84:87]
ds_write_b128 v235, v[44:47] offset:4096
v_mfma_f32_16x16x32_bf16 v[88:91], a[40:43], v[136:139], v[88:91]
v_mfma_f32_16x16x32_bf16 v[92:95], a[40:43], v[140:143], v[92:95]
v_mfma_f32_16x16x32_bf16 v[96:99], a[40:43], v[144:147], v[96:99]
ds_write_b128 v235, v[48:51] offset:8192
v_mfma_f32_16x16x32_bf16 v[100:103], a[44:47], v[136:139], v[100:103]
v_mfma_f32_16x16x32_bf16 v[104:107], a[44:47], v[140:143], v[104:107]
v_mfma_f32_16x16x32_bf16 v[108:111], a[44:47], v[144:147], v[108:111]
ds_write_b128 v236, v[52:55] offset:0
v_mfma_f32_16x16x32_bf16 v[64:67], a[48:51], v[148:151], v[64:67]
v_mfma_f32_16x16x32_bf16 v[68:71], a[48:51], v[152:155], v[68:71]
v_mfma_f32_16x16x32_bf16 v[72:75], a[48:51], v[156:159], v[72:75]
ds_write_b128 v236, v[56:59] offset:4096
v_mfma_f32_16x16x32_bf16 v[76:79], a[52:55], v[148:151], v[76:79]
v_mfma_f32_16x16x32_bf16 v[80:83], a[52:55], v[152:155], v[80:83]
v_mfma_f32_16x16x32_bf16 v[84:87], a[52:55], v[156:159], v[84:87]
ds_write_b128 v236, v[60:63] offset:8192
v_mfma_f32_16x16x32_bf16 v[88:91], a[56:59], v[148:151], v[88:91]
v_mfma_f32_16x16x32_bf16 v[92:95], a[56:59], v[152:155], v[92:95]
v_mfma_f32_16x16x32_bf16 v[96:99], a[56:59], v[156:159], v[96:99]
ds_write_b128 v233, v[64:67] offset:12288
v_mfma_f32_16x16x32_bf16 v[100:103], a[60:63], v[148:151], v[100:103]
ds_write_b128 v233, v[68:71] offset:16384
v_mfma_f32_16x16x32_bf16 v[104:107], a[60:63], v[152:155], v[104:107]
ds_write_b128 v233, v[72:75] offset:20480
v_mfma_f32_16x16x32_bf16 v[108:111], a[60:63], v[156:159], v[108:111]
ds_write_b128 v234, v[76:79] offset:12288
ds_write_b128 v234, v[80:83] offset:16384
ds_write_b128 v234, v[84:87] offset:20480
ds_write_b128 v235, v[88:91] offset:12288
ds_write_b128 v235, v[92:95] offset:16384
ds_write_b128 v235, v[96:99] offset:20480
ds_write_b128 v236, v[100:103] offset:12288
ds_write_b128 v236, v[104:107] offset:16384
ds_write_b128 v236, v[108:111] offset:20480
s_branch L_ofin2
T_l0_2:
v_mfma_f32_16x16x32_bf16 v[16:19], a[64:67], v[112:115], v[16:19]
v_mfma_f32_16x16x32_bf16 v[20:23], a[64:67], v[116:119], v[20:23]
v_mfma_f32_16x16x32_bf16 v[24:27], a[64:67], v[120:123], v[24:27]
v_mfma_f32_16x16x32_bf16 v[28:31], a[68:71], v[112:115], v[28:31]
v_mfma_f32_16x16x32_bf16 v[32:35], a[68:71], v[116:119], v[32:35]
v_mfma_f32_16x16x32_bf16 v[36:39], a[68:71], v[120:123], v[36:39]
v_mfma_f32_16x16x32_bf16 v[40:43], a[72:75], v[112:115], v[40:43]
v_mfma_f32_16x16x32_bf16 v[44:47], a[72:75], v[116:119], v[44:47]
v_mfma_f32_16x16x32_bf16 v[48:51], a[72:75], v[120:123], v[48:51]
ds_write_b128 v233, v[64:67] offset:12288
v_mfma_f32_16x16x32_bf16 v[52:55], a[76:79], v[112:115], v[52:55]
v_mfma_f32_16x16x32_bf16 v[56:59], a[76:79], v[116:119], v[56:59]
v_mfma_f32_16x16x32_bf16 v[60:63], a[76:79], v[120:123], v[60:63]
ds_write_b128 v233, v[68:71] offset:16384
v_mfma_f32_16x16x32_bf16 v[16:19], a[80:83], v[124:127], v[16:19]
v_mfma_f32_16x16x32_bf16 v[20:23], a[80:83], v[128:131], v[20:23]
v_mfma_f32_16x16x32_bf16 v[24:27], a[80:83], v[132:135], v[24:27]
ds_write_b128 v233, v[72:75] offset:20480
v_mfma_f32_16x16x32_bf16 v[28:31], a[84:87], v[124:127], v[28:31]
v_mfma_f32_16x16x32_bf16 v[32:35], a[84:87], v[128:131], v[32:35]
v_mfma_f32_16x16x32_bf16 v[36:39], a[84:87], v[132:135], v[36:39]
ds_write_b128 v234, v[76:79] offset:12288
v_mfma_f32_16x16x32_bf16 v[40:43], a[88:91], v[124:127], v[40:43]
v_mfma_f32_16x16x32_bf16 v[44:47], a[88:91], v[128:131], v[44:47]
v_mfma_f32_16x16x32_bf16 v[48:51], a[88:91], v[132:135], v[48:51]
ds_write_b128 v234, v[80:83] offset:16384
v_mfma_f32_16x16x32_bf16 v[52:55], a[92:95], v[124:127], v[52:55]
v_mfma_f32_16x16x32_bf16 v[56:59], a[92:95], v[128:131], v[56:59]
v_mfma_f32_16x16x32_bf16 v[60:63], a[92:95], v[132:135], v[60:63]
ds_write_b128 v234, v[84:87] offset:20480
v_mfma_f32_16x16x32_bf16 v[16:19], a[96:99], v[136:139], v[16:19]
v_mfma_f32_16x16x32_bf16 v[20:23], a[96:99], v[140:143], v[20:23]
v_mfma_f32_16x16x32_bf16 v[24:27], a[96:99], v[144:147], v[24:27]
ds_write_b128 v235, v[88:91] offset:12288
v_mfma_f32_16x16x32_bf16 v[28:31], a[100:103], v[136:139], v[28:31]
v_mfma_f32_16x16x32_bf16 v[32:35], a[100:103], v[140:143], v[32:35]
v_mfma_f32_16x16x32_bf16 v[36:39], a[100:103], v[144:147], v[36:39]
ds_write_b128 v235, v[92:95] offset:16384
v_mfma_f32_16x16x32_bf16 v[40:43], a[104:107], v[136:139], v[40:43]
v_mfma_f32_16x16x32_bf16 v[44:47], a[104:107], v[140:143], v[44:47]
v_mfma_f32_16x16x32_bf16 v[48:51], a[104:107], v[144:147], v[48:51]
ds_write_b128 v235, v[96:99] offset:20480
v_mfma_f32_16x16x32_bf16 v[52:55], a[108:111], v[136:139], v[52:55]
v_mfma_f32_16x16x32_bf16 v[56:59], a[108:111], v[140:143], v[56:59]
v_mfma_f32_16x16x32_bf16 v[60:63], a[108:111], v[144:147], v[60:63]
ds_write_b128 v236, v[100:103] offset:12288
v_mfma_f32_16x16x32_bf16 v[16:19], a[112:115], v[148:151], v[16:19]
v_mfma_f32_16x16x32_bf16 v[20:23], a[112:115], v[152:155], v[20:23]
v_mfma_f32_16x16x32_bf16 v[24:27], a[112:115], v[156:159], v[24:27]
ds_write_b128 v236, v[104:107] offset:16384
v_mfma_f32_16x16x32_bf16 v[28:31], a[116:119], v[148:151], v[28:31]
v_mfma_f32_16x16x32_bf16 v[32:35], a[116:119], v[152:155], v[32:35]
v_mfma_f32_16x16x32_bf16 v[36:39], a[116:119], v[156:159], v[36:39]
ds_write_b128 v236, v[108:111] offset:20480
v_mfma_f32_16x16x32_bf16 v[40:43], a[120:123], v[148:151], v[40:43]
v_mfma_f32_16x16x32_bf16 v[44:47], a[120:123], v[152:155], v[44:47]
v_mfma_f32_16x16x32_bf16 v[48:51], a[120:123], v[156:159], v[48:51]
ds_write_b128 v233, v[16:19] offset:0
v_mfma_f32_16x16x32_bf16 v[52:55], a[124:127], v[148:151], v[52:55]
ds_write_b128 v233, v[20:23] offset:4096
v_mfma_f32_16x16x32_bf16 v[56:59], a[124:127], v[152:155], v[56:59]
ds_write_b128 v233, v[24:27] offset:8192
v_mfma_f32_16x16x32_bf16 v[60:63], a[124:127], v[156:159], v[60:63]
ds_write_b128 v234, v[28:31] offset:0
ds_write_b128 v234, v[32:35] offset:4096
ds_write_b128 v234, v[36:39] offset:8192
ds_write_b128 v235, v[40:43] offset:0
ds_write_b128 v235, v[44:47] offset:4096
ds_write_b128 v235, v[48:51] offset:8192
ds_write_b128 v236, v[52:55] offset:0
ds_write_b128 v236, v[56:59] offset:4096
ds_write_b128 v236, v[60:63] offset:8192
s_branch L_ofin2
T_l0_3:
v_mfma_f32_16x16x32_bf16 v[64:67], a[64:67], v[112:115], v[64:67]
v_mfma_f32_16x16x32_bf16 v[68:71], a[64:67], v[116:119], v[68:71]
v_mfma_f32_16x16x32_bf16 v[72:75], a[64:67], v[120:123], v[72:75]
v_mfma_f32_16x16x32_bf16 v[76:79], a[68:71], v[112:115], v[76:79]
v_mfma_f32_16x16x32_bf16 v[80:83], a[68:71], v[116:119], v[80:83]
v_mfma_f32_16x16x32_bf16 v[84:87], a[68:71], v[120:123], v[84:87]
v_mfma_f32_16x16x32_bf16 v[88:91], a[72:75], v[112:115], v[88:91]
v_mfma_f32_16x16x32_bf16 v[92:95], a[72:75], v[116:119], v[92:95]
v_mfma_f32_16x16x32_bf16 v[96:99], a[72:75], v[120:123], v[96:99]
ds_write_b128 v233, v[16:19] offset:0
v_mfma_f32_16x16x32_bf16 v[100:103], a[76:79], v[112:115], v[100:103]
v_mfma_f32_16x16x32_bf16 v[104:107], a[76:79], v[116:119], v[104:107]
v_mfma_f32_16x16x32_bf16 v[108:111], a[76:79], v[120:123], v[108:111]
ds_write_b128 v233, v[20:23] offset:4096
v_mfma_f32_16x16x32_bf16 v[64:67], a[80:83], v[124:127], v[64:67]
v_mfma_f32_16x16x32_bf16 v[68:71], a[80:83], v[128:131], v[68:71]
v_mfma_f32_16x16x32_bf16 v[72:75], a[80:83], v[132:135], v[72:75]
ds_write_b128 v233, v[24:27] offset:8192
v_mfma_f32_16x16x32_bf16 v[76:79], a[84:87], v[124:127], v[76:79]
v_mfma_f32_16x16x32_bf16 v[80:83], a[84:87], v[128:131], v[80:83]
v_mfma_f32_16x16x32_bf16 v[84:87], a[84:87], v[132:135], v[84:87]
ds_write_b128 v234, v[28:31] offset:0
v_mfma_f32_16x16x32_bf16 v[88:91], a[88:91], v[124:127], v[88:91]
v_mfma_f32_16x16x32_bf16 v[92:95], a[88:91], v[128:131], v[92:95]
v_mfma_f32_16x16x32_bf16 v[96:99], a[88:91], v[132:135], v[96:99]
ds_write_b128 v234, v[32:35] offset:4096
v_mfma_f32_16x16x32_bf16 v[100:103], a[92:95], v[124:127], v[100:103]
v_mfma_f32_16x16x32_bf16 v[104:107], a[92:95], v[128:131], v[104:107]
v_mfma_f32_16x16x32_bf16 v[108:111], a[92:95], v[132:135], v[108:111]
ds_write_b128 v234, v[36:39] offset:8192
v_mfma_f32_16x16x32_bf16 v[64:67], a[96:99], v[136:139], v[64:67]
v_mfma_f32_16x16x32_bf16 v[68:71], a[96:99], v[140:143], v[68:71]
v_mfma_f32_16x16x32_bf16 v[72:75], a[96:99], v[144:147], v[72:75]
ds_write_b128 v235, v[40:43] offset:0
v_mfma_f32_16x16x32_bf16 v[76:79], a[100:103], v[136:139], v[76:79]
v_mfma_f32_16x16x32_bf16 v[80:83], a[100:103], v[140:143], v[80:83]
v_mfma_f32_16x16x32_bf16 v[84:87], a[100:103], v[144:147], v[84:87]
ds_write_b128 v235, v[44:47] offset:4096
v_mfma_f32_16x16x32_bf16 v[88:91], a[104:107], v[136:139], v[88:91]
v_mfma_f32_16x16x32_bf16 v[92:95], a[104:107], v[140:143], v[92:95]
v_mfma_f32_16x16x32_bf16 v[96:99], a[104:107], v[144:147], v[96:99]
ds_write_b128 v235, v[48:51] offset:8192
v_mfma_f32_16x16x32_bf16 v[100:103], a[108:111], v[136:139], v[100:103]
v_mfma_f32_16x16x32_bf16 v[104:107], a[108:111], v[140:143], v[104:107]
v_mfma_f32_16x16x32_bf16 v[108:111], a[108:111], v[144:147], v[108:111]
ds_write_b128 v236, v[52:55] offset:0
v_mfma_f32_16x16x32_bf16 v[64:67], a[112:115], v[148:151], v[64:67]
v_mfma_f32_16x16x32_bf16 v[68:71], a[112:115], v[152:155], v[68:71]
v_mfma_f32_16x16x32_bf16 v[72:75], a[112:115], v[156:159], v[72:75]
ds_write_b128 v236, v[56:59] offset:4096
v_mfma_f32_16x16x32_bf16 v[76:79], a[116:119], v[148:151], v[76:79]
v_mfma_f32_16x16x32_bf16 v[80:83], a[116:119], v[152:155], v[80:83]
v_mfma_f32_16x16x32_bf16 v[84:87], a[116:119], v[156:159], v[84:87]
ds_write_b128 v236, v[60:63] offset:8192
v_mfma_f32_16x16x32_bf16 v[88:91], a[120:123], v[148:151], v[88:91]
v_mfma_f32_16x16x32_bf16 v[92:95], a[120:123], v[152:155], v[92:95]
v_mfma_f32_16x16x32_bf16 v[96:99], a[120:123], v[156:159], v[96:99]
ds_write_b128 v233, v[64:67] offset:12288
v_mfma_f32_16x16x32_bf16 v[100:103], a[124:127], v[148:151], v[100:103]
ds_write_b128 v233, v[68:71] offset:16384
v_mfma_f32_16x16x32_bf16 v[104:107], a[124:127], v[152:155], v[104:107]
ds_write_b128 v233, v[72:75] offset:20480
v_mfma_f32_16x16x32_bf16 v[108:111], a[124:127], v[156:159], v[108:111]
ds_write_b128 v234, v[76:79] offset:12288
ds_write_b128 v234, v[80:83] offset:16384
ds_write_b128 v234, v[84:87] offset:20480
ds_write_b128 v235, v[88:91] offset:12288
ds_write_b128 v235, v[92:95] offset:16384
ds_write_b128 v235, v[96:99] offset:20480
ds_write_b128 v236, v[100:103] offset:12288
ds_write_b128 v236, v[104:107] offset:16384
ds_write_b128 v236, v[108:111] offset:20480
s_branch L_ofin2
T_l0_4:
v_mfma_f32_16x16x32_bf16 v[16:19], a[128:131], v[112:115], v[16:19]
v_mfma_f32_16x16x32_bf16 v[20:23], a[128:131], v[116:119], v[20:23]
v_mfma_f32_16x16x32_bf16 v[24:27], a[128:131], v[120:123], v[24:27]
v_mfma_f32_16x16x32_bf16 v[28:31], a[132:135], v[112:115], v[28:31]
v_mfma_f32_16x16x32_bf16 v[32:35], a[132:135], v[116:119], v[32:35]
v_mfma_f32_16x16x32_bf16 v[36:39], a[132:135], v[120:123], v[36:39]
v_mfma_f32_16x16x32_bf16 v[40:43], a[136:139], v[112:115], v[40:43]
v_mfma_f32_16x16x32_bf16 v[44:47], a[136:139], v[116:119], v[44:47]
v_mfma_f32_16x16x32_bf16 v[48:51], a[136:139], v[120:123], v[48:51]
ds_write_b128 v233, v[64:67] offset:12288
v_mfma_f32_16x16x32_bf16 v[52:55], a[140:143], v[112:115], v[52:55]
v_mfma_f32_16x16x32_bf16 v[56:59], a[140:143], v[116:119], v[56:59]
v_mfma_f32_16x16x32_bf16 v[60:63], a[140:143], v[120:123], v[60:63]
ds_write_b128 v233, v[68:71] offset:16384
v_mfma_f32_16x16x32_bf16 v[16:19], a[144:147], v[124:127], v[16:19]
v_mfma_f32_16x16x32_bf16 v[20:23], a[144:147], v[128:131], v[20:23]
v_mfma_f32_16x16x32_bf16 v[24:27], a[144:147], v[132:135], v[24:27]
ds_write_b128 v233, v[72:75] offset:20480
v_mfma_f32_16x16x32_bf16 v[28:31], a[148:151], v[124:127], v[28:31]
v_mfma_f32_16x16x32_bf16 v[32:35], a[148:151], v[128:131], v[32:35]
v_mfma_f32_16x16x32_bf16 v[36:39], a[148:151], v[132:135], v[36:39]
ds_write_b128 v234, v[76:79] offset:12288
v_mfma_f32_16x16x32_bf16 v[40:43], a[152:155], v[124:127], v[40:43]
v_mfma_f32_16x16x32_bf16 v[44:47], a[152:155], v[128:131], v[44:47]
v_mfma_f32_16x16x32_bf16 v[48:51], a[152:155], v[132:135], v[48:51]
ds_write_b128 v234, v[80:83] offset:16384
v_mfma_f32_16x16x32_bf16 v[52:55], a[156:159], v[124:127], v[52:55]
v_mfma_f32_16x16x32_bf16 v[56:59], a[156:159], v[128:131], v[56:59]
v_mfma_f32_16x16x32_bf16 v[60:63], a[156:159], v[132:135], v[60:63]
ds_write_b128 v234, v[84:87] offset:20480
v_mfma_f32_16x16x32_bf16 v[16:19], a[160:163], v[136:139], v[16:19]
v_mfma_f32_16x16x32_bf16 v[20:23], a[160:163], v[140:143], v[20:23]
v_mfma_f32_16x16x32_bf16 v[24:27], a[160:163], v[144:147], v[24:27]
ds_write_b128 v235, v[88:91] offset:12288
v_mfma_f32_16x16x32_bf16 v[28:31], a[164:167], v[136:139], v[28:31]
v_mfma_f32_16x16x32_bf16 v[32:35], a[164:167], v[140:143], v[32:35]
v_mfma_f32_16x16x32_bf16 v[36:39], a[164:167], v[144:147], v[36:39]
ds_write_b128 v235, v[92:95] offset:16384
v_mfma_f32_16x16x32_bf16 v[40:43], a[168:171], v[136:139], v[40:43]
v_mfma_f32_16x16x32_bf16 v[44:47], a[168:171], v[140:143], v[44:47]
v_mfma_f32_16x16x32_bf16 v[48:51], a[168:171], v[144:147], v[48:51]
ds_write_b128 v235, v[96:99] offset:20480
v_mfma_f32_16x16x32_bf16 v[52:55], a[172:175], v[136:139], v[52:55]
v_mfma_f32_16x16x32_bf16 v[56:59], a[172:175], v[140:143], v[56:59]
v_mfma_f32_16x16x32_bf16 v[60:63], a[172:175], v[144:147], v[60:63]
ds_write_b128 v236, v[100:103] offset:12288
v_mfma_f32_16x16x32_bf16 v[16:19], a[176:179], v[148:151], v[16:19]
v_mfma_f32_16x16x32_bf16 v[20:23], a[176:179], v[152:155], v[20:23]
v_mfma_f32_16x16x32_bf16 v[24:27], a[176:179], v[156:159], v[24:27]
ds_write_b128 v236, v[104:107] offset:16384
v_mfma_f32_16x16x32_bf16 v[28:31], a[180:183], v[148:151], v[28:31]
v_mfma_f32_16x16x32_bf16 v[32:35], a[180:183], v[152:155], v[32:35]
v_mfma_f32_16x16x32_bf16 v[36:39], a[180:183], v[156:159], v[36:39]
ds_write_b128 v236, v[108:111] offset:20480
v_mfma_f32_16x16x32_bf16 v[40:43], a[184:187], v[148:151], v[40:43]
v_mfma_f32_16x16x32_bf16 v[44:47], a[184:187], v[152:155], v[44:47]
v_mfma_f32_16x16x32_bf16 v[48:51], a[184:187], v[156:159], v[48:51]
ds_write_b128 v233, v[16:19] offset:0
v_mfma_f32_16x16x32_bf16 v[52:55], a[188:191], v[148:151], v[52:55]
ds_write_b128 v233, v[20:23] offset:4096
v_mfma_f32_16x16x32_bf16 v[56:59], a[188:191], v[152:155], v[56:59]
ds_write_b128 v233, v[24:27] offset:8192
v_mfma_f32_16x16x32_bf16 v[60:63], a[188:191], v[156:159], v[60:63]
ds_write_b128 v234, v[28:31] offset:0
ds_write_b128 v234, v[32:35] offset:4096
ds_write_b128 v234, v[36:39] offset:8192
ds_write_b128 v235, v[40:43] offset:0
ds_write_b128 v235, v[44:47] offset:4096
ds_write_b128 v235, v[48:51] offset:8192
ds_write_b128 v236, v[52:55] offset:0
ds_write_b128 v236, v[56:59] offset:4096
ds_write_b128 v236, v[60:63] offset:8192
s_branch L_ofin2
T_l0_5:
v_mfma_f32_16x16x32_bf16 v[64:67], a[128:131], v[112:115], v[64:67]
v_mfma_f32_16x16x32_bf16 v[68:71], a[128:131], v[116:119], v[68:71]
v_mfma_f32_16x16x32_bf16 v[72:75], a[128:131], v[120:123], v[72:75]
v_mfma_f32_16x16x32_bf16 v[76:79], a[132:135], v[112:115], v[76:79]
v_mfma_f32_16x16x32_bf16 v[80:83], a[132:135], v[116:119], v[80:83]
v_mfma_f32_16x16x32_bf16 v[84:87], a[132:135], v[120:123], v[84:87]
v_mfma_f32_16x16x32_bf16 v[88:91], a[136:139], v[112:115], v[88:91]
v_mfma_f32_16x16x32_bf16 v[92:95], a[136:139], v[116:119], v[92:95]
v_mfma_f32_16x16x32_bf16 v[96:99], a[136:139], v[120:123], v[96:99]
ds_write_b128 v233, v[16:19] offset:0
v_mfma_f32_16x16x32_bf16 v[100:103], a[140:143], v[112:115], v[100:103]
v_mfma_f32_16x16x32_bf16 v[104:107], a[140:143], v[116:119], v[104:107]
v_mfma_f32_16x16x32_bf16 v[108:111], a[140:143], v[120:123], v[108:111]
ds_write_b128 v233, v[20:23] offset:4096
v_mfma_f32_16x16x32_bf16 v[64:67], a[144:147], v[124:127], v[64:67]
v_mfma_f32_16x16x32_bf16 v[68:71], a[144:147], v[128:131], v[68:71]
v_mfma_f32_16x16x32_bf16 v[72:75], a[144:147], v[132:135], v[72:75]
ds_write_b128 v233, v[24:27] offset:8192
v_mfma_f32_16x16x32_bf16 v[76:79], a[148:151], v[124:127], v[76:79]
v_mfma_f32_16x16x32_bf16 v[80:83], a[148:151], v[128:131], v[80:83]
v_mfma_f32_16x16x32_bf16 v[84:87], a[148:151], v[132:135], v[84:87]
ds_write_b128 v234, v[28:31] offset:0
v_mfma_f32_16x16x32_bf16 v[88:91], a[152:155], v[124:127], v[88:91]
v_mfma_f32_16x16x32_bf16 v[92:95], a[152:155], v[128:131], v[92:95]
v_mfma_f32_16x16x32_bf16 v[96:99], a[152:155], v[132:135], v[96:99]
ds_write_b128 v234, v[32:35] offset:4096
v_mfma_f32_16x16x32_bf16 v[100:103], a[156:159], v[124:127], v[100:103]
v_mfma_f32_16x16x32_bf16 v[104:107], a[156:159], v[128:131], v[104:107]
v_mfma_f32_16x16x32_bf16 v[108:111], a[156:159], v[132:135], v[108:111]
ds_write_b128 v234, v[36:39] offset:8192
v_mfma_f32_16x16x32_bf16 v[64:67], a[160:163], v[136:139], v[64:67]
v_mfma_f32_16x16x32_bf16 v[68:71], a[160:163], v[140:143], v[68:71]
v_mfma_f32_16x16x32_bf16 v[72:75], a[160:163], v[144:147], v[72:75]
ds_write_b128 v235, v[40:43] offset:0
v_mfma_f32_16x16x32_bf16 v[76:79], a[164:167], v[136:139], v[76:79]
v_mfma_f32_16x16x32_bf16 v[80:83], a[164:167], v[140:143], v[80:83]
v_mfma_f32_16x16x32_bf16 v[84:87], a[164:167], v[144:147], v[84:87]
ds_write_b128 v235, v[44:47] offset:4096
v_mfma_f32_16x16x32_bf16 v[88:91], a[168:171], v[136:139], v[88:91]
v_mfma_f32_16x16x32_bf16 v[92:95], a[168:171], v[140:143], v[92:95]
v_mfma_f32_16x16x32_bf16 v[96:99], a[168:171], v[144:147], v[96:99]
ds_write_b128 v235, v[48:51] offset:8192
v_mfma_f32_16x16x32_bf16 v[100:103], a[172:175], v[136:139], v[100:103]
v_mfma_f32_16x16x32_bf16 v[104:107], a[172:175], v[140:143], v[104:107]
v_mfma_f32_16x16x32_bf16 v[108:111], a[172:175], v[144:147], v[108:111]
ds_write_b128 v236, v[52:55] offset:0
v_mfma_f32_16x16x32_bf16 v[64:67], a[176:179], v[148:151], v[64:67]
v_mfma_f32_16x16x32_bf16 v[68:71], a[176:179], v[152:155], v[68:71]
v_mfma_f32_16x16x32_bf16 v[72:75], a[176:179], v[156:159], v[72:75]
ds_write_b128 v236, v[56:59] offset:4096
v_mfma_f32_16x16x32_bf16 v[76:79], a[180:183], v[148:151], v[76:79]
v_mfma_f32_16x16x32_bf16 v[80:83], a[180:183], v[152:155], v[80:83]
v_mfma_f32_16x16x32_bf16 v[84:87], a[180:183], v[156:159], v[84:87]
ds_write_b128 v236, v[60:63] offset:8192
v_mfma_f32_16x16x32_bf16 v[88:91], a[184:187], v[148:151], v[88:91]
v_mfma_f32_16x16x32_bf16 v[92:95], a[184:187], v[152:155], v[92:95]
v_mfma_f32_16x16x32_bf16 v[96:99], a[184:187], v[156:159], v[96:99]
ds_write_b128 v233, v[64:67] offset:12288
v_mfma_f32_16x16x32_bf16 v[100:103], a[188:191], v[148:151], v[100:103]
ds_write_b128 v233, v[68:71] offset:16384
v_mfma_f32_16x16x32_bf16 v[104:107], a[188:191], v[152:155], v[104:107]
ds_write_b128 v233, v[72:75] offset:20480
v_mfma_f32_16x16x32_bf16 v[108:111], a[188:191], v[156:159], v[108:111]
ds_write_b128 v234, v[76:79] offset:12288
ds_write_b128 v234, v[80:83] offset:16384
ds_write_b128 v234, v[84:87] offset:20480
ds_write_b128 v235, v[88:91] offset:12288
ds_write_b128 v235, v[92:95] offset:16384
ds_write_b128 v235, v[96:99] offset:20480
ds_write_b128 v236, v[100:103] offset:12288
ds_write_b128 v236, v[104:107] offset:16384
ds_write_b128 v236, v[108:111] offset:20480
s_branch L_ofin2
T_l0_6:
v_mfma_f32_16x16x32_bf16 v[16:19], a[192:195], v[112:115], v[16:19]
v_mfma_f32_16x16x32_bf16 v[20:23], a[192:195], v[116:119], v[20:23]
v_mfma_f32_16x16x32_bf16 v[24:27], a[192:195], v[120:123], v[24:27]
v_mfma_f32_16x16x32_bf16 v[28:31], a[196:199], v[112:115], v[28:31]
v_mfma_f32_16x16x32_bf16 v[32:35], a[196:199], v[116:119], v[32:35]
v_mfma_f32_16x16x32_bf16 v[36:39], a[196:199], v[120:123], v[36:39]
v_mfma_f32_16x16x32_bf16 v[40:43], a[200:203], v[112:115], v[40:43]
v_mfma_f32_16x16x32_bf16 v[44:47], a[200:203], v[116:119], v[44:47]
v_mfma_f32_16x16x32_bf16 v[48:51], a[200:203], v[120:123], v[48:51]
ds_write_b128 v233, v[64:67] offset:12288
v_mfma_f32_16x16x32_bf16 v[52:55], a[204:207], v[112:115], v[52:55]
v_mfma_f32_16x16x32_bf16 v[56:59], a[204:207], v[116:119], v[56:59]
v_mfma_f32_16x16x32_bf16 v[60:63], a[204:207], v[120:123], v[60:63]
ds_write_b128 v233, v[68:71] offset:16384
v_mfma_f32_16x16x32_bf16 v[16:19], a[208:211], v[124:127], v[16:19]
v_mfma_f32_16x16x32_bf16 v[20:23], a[208:211], v[128:131], v[20:23]
v_mfma_f32_16x16x32_bf16 v[24:27], a[208:211], v[132:135], v[24:27]
ds_write_b128 v233, v[72:75] offset:20480
v_mfma_f32_16x16x32_bf16 v[28:31], a[212:215], v[124:127], v[28:31]
v_mfma_f32_16x16x32_bf16 v[32:35], a[212:215], v[128:131], v[32:35]
v_mfma_f32_16x16x32_bf16 v[36:39], a[212:215], v[132:135], v[36:39]
ds_write_b128 v234, v[76:79] offset:12288
v_mfma_f32_16x16x32_bf16 v[40:43], a[216:219], v[124:127], v[40:43]
v_mfma_f32_16x16x32_bf16 v[44:47], a[216:219], v[128:131], v[44:47]
v_mfma_f32_16x16x32_bf16 v[48:51], a[216:219], v[132:135], v[48:51]
ds_write_b128 v234, v[80:83] offset:16384
v_mfma_f32_16x16x32_bf16 v[52:55], a[220:223], v[124:127], v[52:55]
v_mfma_f32_16x16x32_bf16 v[56:59], a[220:223], v[128:131], v[56:59]
v_mfma_f32_16x16x32_bf16 v[60:63], a[220:223], v[132:135], v[60:63]
ds_write_b128 v234, v[84:87] offset:20480
v_mfma_f32_16x16x32_bf16 v[16:19], a[224:227], v[136:139], v[16:19]
v_mfma_f32_16x16x32_bf16 v[20:23], a[224:227], v[140:143], v[20:23]
v_mfma_f32_16x16x32_bf16 v[24:27], a[224:227], v[144:147], v[24:27]
ds_write_b128 v235, v[88:91] offset:12288
v_mfma_f32_16x16x32_bf16 v[28:31], a[228:231], v[136:139], v[28:31]
v_mfma_f32_16x16x32_bf16 v[32:35], a[228:231], v[140:143], v[32:35]
v_mfma_f32_16x16x32_bf16 v[36:39], a[228:231], v[144:147], v[36:39]
ds_write_b128 v235, v[92:95] offset:16384
v_mfma_f32_16x16x32_bf16 v[40:43], a[232:235], v[136:139], v[40:43]
v_mfma_f32_16x16x32_bf16 v[44:47], a[232:235], v[140:143], v[44:47]
v_mfma_f32_16x16x32_bf16 v[48:51], a[232:235], v[144:147], v[48:51]
ds_write_b128 v235, v[96:99] offset:20480
v_mfma_f32_16x16x32_bf16 v[52:55], a[236:239], v[136:139], v[52:55]
v_mfma_f32_16x16x32_bf16 v[56:59], a[236:239], v[140:143], v[56:59]
v_mfma_f32_16x16x32_bf16 v[60:63], a[236:239], v[144:147], v[60:63]
ds_write_b128 v236, v[100:103] offset:12288
v_mfma_f32_16x16x32_bf16 v[16:19], a[240:243], v[148:151], v[16:19]
v_mfma_f32_16x16x32_bf16 v[20:23], a[240:243], v[152:155], v[20:23]
v_mfma_f32_16x16x32_bf16 v[24:27], a[240:243], v[156:159], v[24:27]
ds_write_b128 v236, v[104:107] offset:16384
v_mfma_f32_16x16x32_bf16 v[28:31], a[244:247], v[148:151], v[28:31]
v_mfma_f32_16x16x32_bf16 v[32:35], a[244:247], v[152:155], v[32:35]
v_mfma_f32_16x16x32_bf16 v[36:39], a[244:247], v[156:159], v[36:39]
ds_write_b128 v236, v[108:111] offset:20480
v_mfma_f32_16x16x32_bf16 v[40:43], a[248:251], v[148:151], v[40:43]
v_mfma_f32_16x16x32_bf16 v[44:47], a[248:251], v[152:155], v[44:47]
v_mfma_f32_16x16x32_bf16 v[48:51], a[248:251], v[156:159], v[48:51]
ds_write_b128 v233, v[16:19] offset:0
v_mfma_f32_16x16x32_bf16 v[52:55], a[252:255], v[148:151], v[52:55]
ds_write_b128 v233, v[20:23] offset:4096
v_mfma_f32_16x16x32_bf16 v[56:59], a[252:255], v[152:155], v[56:59]
ds_write_b128 v233, v[24:27] offset:8192
v_mfma_f32_16x16x32_bf16 v[60:63], a[252:255], v[156:159], v[60:63]
ds_write_b128 v234, v[28:31] offset:0
ds_write_b128 v234, v[32:35] offset:4096
ds_write_b128 v234, v[36:39] offset:8192
ds_write_b128 v235, v[40:43] offset:0
ds_write_b128 v235, v[44:47] offset:4096
ds_write_b128 v235, v[48:51] offset:8192
ds_write_b128 v236, v[52:55] offset:0
ds_write_b128 v236, v[56:59] offset:4096
ds_write_b128 v236, v[60:63] offset:8192
s_branch L_ofin2
T_l0_7:
v_mfma_f32_16x16x32_bf16 v[64:67], a[192:195], v[112:115], v[64:67]
v_mfma_f32_16x16x32_bf16 v[68:71], a[192:195], v[116:119], v[68:71]
v_mfma_f32_16x16x32_bf16 v[72:75], a[192:195], v[120:123], v[72:75]
v_mfma_f32_16x16x32_bf16 v[76:79], a[196:199], v[112:115], v[76:79]
v_mfma_f32_16x16x32_bf16 v[80:83], a[196:199], v[116:119], v[80:83]
v_mfma_f32_16x16x32_bf16 v[84:87], a[196:199], v[120:123], v[84:87]
v_mfma_f32_16x16x32_bf16 v[88:91], a[200:203], v[112:115], v[88:91]
v_mfma_f32_16x16x32_bf16 v[92:95], a[200:203], v[116:119], v[92:95]
v_mfma_f32_16x16x32_bf16 v[96:99], a[200:203], v[120:123], v[96:99]
ds_write_b128 v233, v[16:19] offset:0
v_mfma_f32_16x16x32_bf16 v[100:103], a[204:207], v[112:115], v[100:103]
v_mfma_f32_16x16x32_bf16 v[104:107], a[204:207], v[116:119], v[104:107]
v_mfma_f32_16x16x32_bf16 v[108:111], a[204:207], v[120:123], v[108:111]
ds_write_b128 v233, v[20:23] offset:4096
v_mfma_f32_16x16x32_bf16 v[64:67], a[208:211], v[124:127], v[64:67]
v_mfma_f32_16x16x32_bf16 v[68:71], a[208:211], v[128:131], v[68:71]
v_mfma_f32_16x16x32_bf16 v[72:75], a[208:211], v[132:135], v[72:75]
ds_write_b128 v233, v[24:27] offset:8192
v_mfma_f32_16x16x32_bf16 v[76:79], a[212:215], v[124:127], v[76:79]
v_mfma_f32_16x16x32_bf16 v[80:83], a[212:215], v[128:131], v[80:83]
v_mfma_f32_16x16x32_bf16 v[84:87], a[212:215], v[132:135], v[84:87]
ds_write_b128 v234, v[28:31] offset:0
v_mfma_f32_16x16x32_bf16 v[88:91], a[216:219], v[124:127], v[88:91]
v_mfma_f32_16x16x32_bf16 v[92:95], a[216:219], v[128:131], v[92:95]
v_mfma_f32_16x16x32_bf16 v[96:99], a[216:219], v[132:135], v[96:99]
ds_write_b128 v234, v[32:35] offset:4096
v_mfma_f32_16x16x32_bf16 v[100:103], a[220:223], v[124:127], v[100:103]
v_mfma_f32_16x16x32_bf16 v[104:107], a[220:223], v[128:131], v[104:107]
v_mfma_f32_16x16x32_bf16 v[108:111], a[220:223], v[132:135], v[108:111]
ds_write_b128 v234, v[36:39] offset:8192
v_mfma_f32_16x16x32_bf16 v[64:67], a[224:227], v[136:139], v[64:67]
v_mfma_f32_16x16x32_bf16 v[68:71], a[224:227], v[140:143], v[68:71]
v_mfma_f32_16x16x32_bf16 v[72:75], a[224:227], v[144:147], v[72:75]
ds_write_b128 v235, v[40:43] offset:0
v_mfma_f32_16x16x32_bf16 v[76:79], a[228:231], v[136:139], v[76:79]
v_mfma_f32_16x16x32_bf16 v[80:83], a[228:231], v[140:143], v[80:83]
v_mfma_f32_16x16x32_bf16 v[84:87], a[228:231], v[144:147], v[84:87]
ds_write_b128 v235, v[44:47] offset:4096
v_mfma_f32_16x16x32_bf16 v[88:91], a[232:235], v[136:139], v[88:91]
v_mfma_f32_16x16x32_bf16 v[92:95], a[232:235], v[140:143], v[92:95]
v_mfma_f32_16x16x32_bf16 v[96:99], a[232:235], v[144:147], v[96:99]
ds_write_b128 v235, v[48:51] offset:8192
v_mfma_f32_16x16x32_bf16 v[100:103], a[236:239], v[136:139], v[100:103]
v_mfma_f32_16x16x32_bf16 v[104:107], a[236:239], v[140:143], v[104:107]
v_mfma_f32_16x16x32_bf16 v[108:111], a[236:239], v[144:147], v[108:111]
ds_write_b128 v236, v[52:55] offset:0
v_mfma_f32_16x16x32_bf16 v[64:67], a[240:243], v[148:151], v[64:67]
v_mfma_f32_16x16x32_bf16 v[68:71], a[240:243], v[152:155], v[68:71]
v_mfma_f32_16x16x32_bf16 v[72:75], a[240:243], v[156:159], v[72:75]
ds_write_b128 v236, v[56:59] offset:4096
v_mfma_f32_16x16x32_bf16 v[76:79], a[244:247], v[148:151], v[76:79]
v_mfma_f32_16x16x32_bf16 v[80:83], a[244:247], v[152:155], v[80:83]
v_mfma_f32_16x16x32_bf16 v[84:87], a[244:247], v[156:159], v[84:87]
ds_write_b128 v236, v[60:63] offset:8192
v_mfma_f32_16x16x32_bf16 v[88:91], a[248:251], v[148:151], v[88:91]
v_mfma_f32_16x16x32_bf16 v[92:95], a[248:251], v[152:155], v[92:95]
v_mfma_f32_16x16x32_bf16 v[96:99], a[248:251], v[156:159], v[96:99]
ds_write_b128 v233, v[64:67] offset:12288
v_mfma_f32_16x16x32_bf16 v[100:103], a[252:255], v[148:151], v[100:103]
ds_write_b128 v233, v[68:71] offset:16384
v_mfma_f32_16x16x32_bf16 v[104:107], a[252:255], v[152:155], v[104:107]
ds_write_b128 v233, v[72:75] offset:20480
v_mfma_f32_16x16x32_bf16 v[108:111], a[252:255], v[156:159], v[108:111]
ds_write_b128 v234, v[76:79] offset:12288
ds_write_b128 v234, v[80:83] offset:16384
ds_write_b128 v234, v[84:87] offset:20480
ds_write_b128 v235, v[88:91] offset:12288
ds_write_b128 v235, v[92:95] offset:16384
ds_write_b128 v235, v[96:99] offset:20480
ds_write_b128 v236, v[100:103] offset:12288
ds_write_b128 v236, v[104:107] offset:16384
ds_write_b128 v236, v[108:111] offset:20480
s_branch L_ofin2
T_n1:
s_and_b32 s64, s97, s63
s_and_b32 s64, s64, s79
s_cmp_eq_u32 s64, -1
s_cbranch_scc1 T_done
s_sub_u32 s31, s31, 1
s_cbranch_scc1 T_done
s_cmp_lt_i32 s97, 0
s_cbranch_scc1 T_q_35
buffer_load_dwordx4 v[148:151], v10, s[32:35], s65 offen offset:3072 sc1
buffer_load_dwordx4 v[152:155], v10, s[32:35], s66 offen offset:3072 sc1
buffer_load_dwordx4 v[156:159], v10, s[32:35], s67 offen offset:3072 sc1
T_q_35:
s_mov_b64 exec, 0xff
global_load_dwordx4 v[12:15], v11, s[98:99] sc1
s_mov_b64 exec, -1
s_cmp_lt_i32 s63, 0
s_cbranch_scc1 T_z_36
buffer_load_dwordx4 v[160:163], v10, s[32:35], s71 offen offset:0 sc1
buffer_load_dwordx4 v[164:167], v10, s[32:35], s72 offen offset:0 sc1
buffer_load_dwordx4 v[168:171], v10, s[32:35], s70 offen offset:0 sc1
buffer_load_dwordx4 v[172:175], v10, s[32:35], s71 offen offset:1024 sc1
buffer_load_dwordx4 v[176:179], v10, s[32:35], s72 offen offset:1024 sc1
buffer_load_dwordx4 v[180:183], v10, s[32:35], s70 offen offset:1024 sc1
buffer_load_dwordx4 v[184:187], v10, s[32:35], s71 offen offset:2048 sc1
buffer_load_dwordx4 v[188:191], v10, s[32:35], s72 offen offset:2048 sc1
buffer_load_dwordx4 v[192:195], v10, s[32:35], s70 offen offset:2048 sc1
s_waitcnt vmcnt(9)
s_branch T_w_37
T_z_36:
s_waitcnt vmcnt(0)
T_w_37:
v_min3_u32 v12, v12, v13, v14
v_min_u32 v12, v12, v15
v_cmp_ne_u32 vcc, 0, v12
s_mov_b32 s73, s97
s_andn2_b32 s96, vcc_lo, s79
s_ff1_i32_b32 s97, s96
s_bitset1_b32 s79, s97
s_bitcmp1_b32 s97, 1
s_cselect_b32 s65, s69, s68
s_cselect_b32 s66, s75, s74
s_bitcmp1_b32 s97, 2
s_cselect_b32 s65, s66, s65
s_bitcmp1_b32 s97, 0
s_cselect_b32 s66, 786432, 0
s_add_u32 s65, s65, s66
s_and_b32 s66, s97, 0x20000000
s_or_b32 s65, s65, s66
s_add_u32 s66, s65, 4096
s_add_u32 s67, s65, 8192
s_and_b32 s64, s97, s63
s_and_b32 s64, s64, s79
s_cmp_eq_u32 s64, -1
s_cbranch_scc1 T_last0
s_bitcmp1_b32 s73, 2
s_cbranch_scc1 T_d_38
s_cmp_eq_u32 s73, 0
s_cbranch_scc1 T_b0_0
s_cmp_eq_u32 s73, 1
s_cbranch_scc1 T_b0_1
s_cmp_eq_u32 s73, 2
s_cbranch_scc1 T_b0_2
s_branch T_b0_3
T_d_38:
s_cmp_eq_u32 s73, 4
s_cbranch_scc1 T_b0_4
s_cmp_eq_u32 s73, 5
s_cbranch_scc1 T_b0_5
s_cmp_eq_u32 s73, 6
s_cbranch_scc1 T_b0_6
s_cmp_eq_u32 s73, 7
s_cbranch_scc1 T_b0_7
s_branch T_n0
T_b1_0:
v_mfma_f32_16x16x32_bf16 v[16:19], a[0:3], v[160:163], v[16:19]
buffer_load_dwordx4 v[148:151], v10, s[32:35], s65 offen offset:3072 sc1
v_mfma_f32_16x16x32_bf16 v[20:23], a[0:3], v[164:167], v[20:23]
v_mfma_f32_16x16x32_bf16 v[24:27], a[0:3], v[168:171], v[24:27]
v_mfma_f32_16x16x32_bf16 v[28:31], a[4:7], v[160:163], v[28:31]
v_mfma_f32_16x16x32_bf16 v[32:35], a[4:7], v[164:167], v[32:35]
buffer_load_dwordx4 v[152:155], v10, s[32:35], s66 offen offset:3072 sc1
v_mfma_f32_16x16x32_bf16 v[36:39], a[4:7], v[168:171], v[36:39]
v_mfma_f32_16x16x32_bf16 v[40:43], a[8:11], v[160:163], v[40:43]
v_mfma_f32_16x16x32_bf16 v[44:47], a[8:11], v[164:167], v[44:47]
v_mfma_f32_16x16x32_bf16 v[48:51], a[8:11], v[168:171], v[48:51]
buffer_load_dwordx4 v[156:159], v10, s[32:35], s67 offen offset:3072 sc1
v_mfma_f32_16x16x32_bf16 v[52:55], a[12:15], v[160:163], v[52:55]
v_mfma_f32_16x16x32_bf16 v[56:59], a[12:15], v[164:167], v[56:59]
s_mov_b64 exec, 0xff
global_load_dwordx4 v[12:15], v11, s[98:99] sc1
s_mov_b64 exec, -1
v_mfma_f32_16x16x32_bf16 v[60:63], a[12:15], v[168:171], v[60:63]
v_mfma_f32_16x16x32_bf16 v[16:19], a[16:19], v[172:175], v[16:19]
buffer_load_dwordx4 v[160:163], v10, s[32:35], s71 offen offset:0 sc1
v_mfma_f32_16x16x32_bf16 v[20:23], a[16:19], v[176:179], v[20:23]
v_mfma_f32_16x16x32_bf16 v[24:27], a[16:19], v[180:183], v[24:27]
v_mfma_f32_16x16x32_bf16 v[28:31], a[20:23], v[172:175], v[28:31]
v_mfma_f32_16x16x32_bf16 v[32:35], a[20:23], v[176:179], v[32:35]
buffer_load_dwordx4 v[164:167], v10, s[32:35], s72 offen offset:0 sc1
v_mfma_f32_16x16x32_bf16 v[36:39], a[20:23], v[180:183], v[36:39]
v_mfma_f32_16x16x32_bf16 v[40:43], a[24:27], v[172:175], v[40:43]
v_mfma_f32_16x16x32_bf16 v[44:47], a[24:27], v[176:179], v[44:47]
v_mfma_f32_16x16x32_bf16 v[48:51], a[24:27], v[180:183], v[48:51]
buffer_load_dwordx4 v[168:171], v10, s[32:35], s70 offen offset:0 sc1
v_mfma_f32_16x16x32_bf16 v[52:55], a[28:31], v[172:175], v[52:55]
v_mfma_f32_16x16x32_bf16 v[56:59], a[28:31], v[176:179], v[56:59]
v_mfma_f32_16x16x32_bf16 v[60:63], a[28:31], v[180:183], v[60:63]
v_mfma_f32_16x16x32_bf16 v[16:19], a[32:35], v[184:187], v[16:19]
buffer_load_dwordx4 v[172:175], v10, s[32:35], s71 offen offset:1024 sc1
v_mfma_f32_16x16x32_bf16 v[20:23], a[32:35], v[188:191], v[20:23]
v_mfma_f32_16x16x32_bf16 v[24:27], a[32:35], v[192:195], v[24:27]
v_mfma_f32_16x16x32_bf16 v[28:31], a[36:39], v[184:187], v[28:31]
v_mfma_f32_16x16x32_bf16 v[32:35], a[36:39], v[188:191], v[32:35]
buffer_load_dwordx4 v[176:179], v10, s[32:35], s72 offen offset:1024 sc1
v_mfma_f32_16x16x32_bf16 v[36:39], a[36:39], v[192:195], v[36:39]
v_mfma_f32_16x16x32_bf16 v[40:43], a[40:43], v[184:187], v[40:43]
v_mfma_f32_16x16x32_bf16 v[44:47], a[40:43], v[188:191], v[44:47]
v_mfma_f32_16x16x32_bf16 v[48:51], a[40:43], v[192:195], v[48:51]
buffer_load_dwordx4 v[180:183], v10, s[32:35], s70 offen offset:1024 sc1
v_mfma_f32_16x16x32_bf16 v[52:55], a[44:47], v[184:187], v[52:55]
v_mfma_f32_16x16x32_bf16 v[56:59], a[44:47], v[188:191], v[56:59]
v_mfma_f32_16x16x32_bf16 v[60:63], a[44:47], v[192:195], v[60:63]
s_waitcnt vmcnt(6)
v_min3_u32 v12, v12, v13, v14
v_min_u32 v12, v12, v15
v_mfma_f32_16x16x32_bf16 v[16:19], a[48:51], v[196:199], v[16:19]
buffer_load_dwordx4 v[184:187], v10, s[32:35], s71 offen offset:2048 sc1
v_cmp_ne_u32 vcc, 0, v12
v_mfma_f32_16x16x32_bf16 v[20:23], a[48:51], v[200:203], v[20:23]
s_mov_b32 s73, s97
s_andn2_b32 s96, vcc_lo, s79
v_mfma_f32_16x16x32_bf16 v[24:27], a[48:51], v[204:207], v[24:27]
s_ff1_i32_b32 s97, s96
s_bitset1_b32 s79, s97
v_mfma_f32_16x16x32_bf16 v[28:31], a[52:55], v[196:199], v[28:31]
s_bitcmp1_b32 s97, 1
s_cselect_b32 s65, s69, s68
v_mfma_f32_16x16x32_bf16 v[32:35], a[52:55], v[200:203], v[32:35]
buffer_load_dwordx4 v[188:191], v10, s[32:35], s72 offen offset:2048 sc1
s_cselect_b32 s66, s75, s74
v_mfma_f32_16x16x32_bf16 v[36:39], a[52:55], v[204:207], v[36:39]
s_bitcmp1_b32 s97, 2
s_cselect_b32 s65, s66, s65
v_mfma_f32_16x16x32_bf16 v[40:43], a[56:59], v[196:199], v[40:43]
s_bitcmp1_b32 s97, 0
s_cselect_b32 s66, 786432, 0
v_mfma_f32_16x16x32_bf16 v[44:47], a[56:59], v[200:203], v[44:47]
s_add_u32 s65, s65, s66
s_and_b32 s66, s97, 0x20000000
v_mfma_f32_16x16x32_bf16 v[48:51], a[56:59], v[204:207], v[48:51]
buffer_load_dwordx4 v[192:195], v10, s[32:35], s70 offen offset:2048 sc1
s_or_b32 s65, s65, s66
v_mfma_f32_16x16x32_bf16 v[52:55], a[60:63], v[196:199], v[52:55]
s_add_u32 s66, s65, 4096
s_add_u32 s67, s65, 8192
v_mfma_f32_16x16x32_bf16 v[56:59], a[60:63], v[200:203], v[56:59]
s_and_b32 s64, s97, s63
s_and_b32 s64, s64, s79
v_mfma_f32_16x16x32_bf16 v[60:63], a[60:63], v[204:207], v[60:63]
s_cmp_eq_u32 s64, -1
s_cbranch_scc1 T_last0
s_bitcmp1_b32 s73, 2
s_cbranch_scc1 T_d_39
s_cmp_eq_u32 s73, 0
s_cbranch_scc1 T_b0_0
s_cmp_eq_u32 s73, 1
s_cbranch_scc1 T_b0_1
s_cmp_eq_u32 s73, 2
s_cbranch_scc1 T_b0_2
s_branch T_b0_3
T_d_39:
s_cmp_eq_u32 s73, 4
s_cbranch_scc1 T_b0_4
s_cmp_eq_u32 s73, 5
s_cbranch_scc1 T_b0_5
s_cmp_eq_u32 s73, 6
s_cbranch_scc1 T_b0_6
s_cmp_eq_u32 s73, 7
s_cbranch_scc1 T_b0_7
s_branch T_n0
T_b1_1:
v_mfma_f32_16x16x32_bf16 v[64:67], a[0:3], v[160:163], v[64:67]
buffer_load_dwordx4 v[148:151], v10, s[32:35], s65 offen offset:3072 sc1
v_mfma_f32_16x16x32_bf16 v[68:71], a[0:3], v[164:167], v[68:71]
v_mfma_f32_16x16x32_bf16 v[72:75], a[0:3], v[168:171], v[72:75]
v_mfma_f32_16x16x32_bf16 v[76:79], a[4:7], v[160:163], v[76:79]
v_mfma_f32_16x16x32_bf16 v[80:83], a[4:7], v[164:167], v[80:83]
buffer_load_dwordx4 v[152:155], v10, s[32:35], s66 offen offset:3072 sc1
v_mfma_f32_16x16x32_bf16 v[84:87], a[4:7], v[168:171], v[84:87]
v_mfma_f32_16x16x32_bf16 v[88:91], a[8:11], v[160:163], v[88:91]
v_mfma_f32_16x16x32_bf16 v[92:95], a[8:11], v[164:167], v[92:95]
v_mfma_f32_16x16x32_bf16 v[96:99], a[8:11], v[168:171], v[96:99]
buffer_load_dwordx4 v[156:159], v10, s[32:35], s67 offen offset:3072 sc1
v_mfma_f32_16x16x32_bf16 v[100:103], a[12:15], v[160:163], v[100:103]
v_mfma_f32_16x16x32_bf16 v[104:107], a[12:15], v[164:167], v[104:107]
s_mov_b64 exec, 0xff
global_load_dwordx4 v[12:15], v11, s[98:99] sc1
s_mov_b64 exec, -1
v_mfma_f32_16x16x32_bf16 v[108:111], a[12:15], v[168:171], v[108:111]
v_mfma_f32_16x16x32_bf16 v[64:67], a[16:19], v[172:175], v[64:67]
buffer_load_dwordx4 v[160:163], v10, s[32:35], s71 offen offset:0 sc1
v_mfma_f32_16x16x32_bf16 v[68:71], a[16:19], v[176:179], v[68:71]
v_mfma_f32_16x16x32_bf16 v[72:75], a[16:19], v[180:183], v[72:75]
v_mfma_f32_16x16x32_bf16 v[76:79], a[20:23], v[172:175], v[76:79]
v_mfma_f32_16x16x32_bf16 v[80:83], a[20:23], v[176:179], v[80:83]
buffer_load_dwordx4 v[164:167], v10, s[32:35], s72 offen offset:0 sc1
v_mfma_f32_16x16x32_bf16 v[84:87], a[20:23], v[180:183], v[84:87]
v_mfma_f32_16x16x32_bf16 v[88:91], a[24:27], v[172:175], v[88:91]
v_mfma_f32_16x16x32_bf16 v[92:95], a[24:27], v[176:179], v[92:95]
v_mfma_f32_16x16x32_bf16 v[96:99], a[24:27], v[180:183], v[96:99]
buffer_load_dwordx4 v[168:171], v10, s[32:35], s70 offen offset:0 sc1
v_mfma_f32_16x16x32_bf16 v[100:103], a[28:31], v[172:175], v[100:103]
v_mfma_f32_16x16x32_bf16 v[104:107], a[28:31], v[176:179], v[104:107]
v_mfma_f32_16x16x32_bf16 v[108:111], a[28:31], v[180:183], v[108:111]
v_mfma_f32_16x16x32_bf16 v[64:67], a[32:35], v[184:187], v[64:67]
buffer_load_dwordx4 v[172:175], v10, s[32:35], s71 offen offset:1024 sc1
v_mfma_f32_16x16x32_bf16 v[68:71], a[32:35], v[188:191], v[68:71]
v_mfma_f32_16x16x32_bf16 v[72:75], a[32:35], v[192:195], v[72:75]
v_mfma_f32_16x16x32_bf16 v[76:79], a[36:39], v[184:187], v[76:79]
v_mfma_f32_16x16x32_bf16 v[80:83], a[36:39], v[188:191], v[80:83]
buffer_load_dwordx4 v[176:179], v10, s[32:35], s72 offen offset:1024 sc1
v_mfma_f32_16x16x32_bf16 v[84:87], a[36:39], v[192:195], v[84:87]
v_mfma_f32_16x16x32_bf16 v[88:91], a[40:43], v[184:187], v[88:91]
v_mfma_f32_16x16x32_bf16 v[92:95], a[40:43], v[188:191], v[92:95]
v_mfma_f32_16x16x32_bf16 v[96:99], a[40:43], v[192:195], v[96:99]
buffer_load_dwordx4 v[180:183], v10, s[32:35], s70 offen offset:1024 sc1
v_mfma_f32_16x16x32_bf16 v[100:103], a[44:47], v[184:187], v[100:103]
v_mfma_f32_16x16x32_bf16 v[104:107], a[44:47], v[188:191], v[104:107]
v_mfma_f32_16x16x32_bf16 v[108:111], a[44:47], v[192:195], v[108:111]
s_waitcnt vmcnt(6)
v_min3_u32 v12, v12, v13, v14
v_min_u32 v12, v12, v15
v_mfma_f32_16x16x32_bf16 v[64:67], a[48:51], v[196:199], v[64:67]
buffer_load_dwordx4 v[184:187], v10, s[32:35], s71 offen offset:2048 sc1
v_cmp_ne_u32 vcc, 0, v12
v_mfma_f32_16x16x32_bf16 v[68:71], a[48:51], v[200:203], v[68:71]
s_mov_b32 s73, s97
s_andn2_b32 s96, vcc_lo, s79
v_mfma_f32_16x16x32_bf16 v[72:75], a[48:51], v[204:207], v[72:75]
s_ff1_i32_b32 s97, s96
s_bitset1_b32 s79, s97
v_mfma_f32_16x16x32_bf16 v[76:79], a[52:55], v[196:199], v[76:79]
s_bitcmp1_b32 s97, 1
s_cselect_b32 s65, s69, s68
v_mfma_f32_16x16x32_bf16 v[80:83], a[52:55], v[200:203], v[80:83]
buffer_load_dwordx4 v[188:191], v10, s[32:35], s72 offen offset:2048 sc1
s_cselect_b32 s66, s75, s74
v_mfma_f32_16x16x32_bf16 v[84:87], a[52:55], v[204:207], v[84:87]
s_bitcmp1_b32 s97, 2
s_cselect_b32 s65, s66, s65
v_mfma_f32_16x16x32_bf16 v[88:91], a[56:59], v[196:199], v[88:91]
s_bitcmp1_b32 s97, 0
s_cselect_b32 s66, 786432, 0
v_mfma_f32_16x16x32_bf16 v[92:95], a[56:59], v[200:203], v[92:95]
s_add_u32 s65, s65, s66
s_and_b32 s66, s97, 0x20000000
v_mfma_f32_16x16x32_bf16 v[96:99], a[56:59], v[204:207], v[96:99]
buffer_load_dwordx4 v[192:195], v10, s[32:35], s70 offen offset:2048 sc1
s_or_b32 s65, s65, s66
v_mfma_f32_16x16x32_bf16 v[100:103], a[60:63], v[196:199], v[100:103]
s_add_u32 s66, s65, 4096
s_add_u32 s67, s65, 8192
v_mfma_f32_16x16x32_bf16 v[104:107], a[60:63], v[200:203], v[104:107]
s_and_b32 s64, s97, s63
s_and_b32 s64, s64, s79
v_mfma_f32_16x16x32_bf16 v[108:111], a[60:63], v[204:207], v[108:111]
s_cmp_eq_u32 s64, -1
s_cbranch_scc1 T_last0
s_bitcmp1_b32 s73, 2
s_cbranch_scc1 T_d_40
s_cmp_eq_u32 s73, 0
s_cbranch_scc1 T_b0_0
s_cmp_eq_u32 s73, 1
s_cbranch_scc1 T_b0_1
s_cmp_eq_u32 s73, 2
s_cbranch_scc1 T_b0_2
s_branch T_b0_3
T_d_40:
s_cmp_eq_u32 s73, 4
s_cbranch_scc1 T_b0_4
s_cmp_eq_u32 s73, 5
s_cbranch_scc1 T_b0_5
s_cmp_eq_u32 s73, 6
s_cbranch_scc1 T_b0_6
s_cmp_eq_u32 s73, 7
s_cbranch_scc1 T_b0_7
s_branch T_n0
T_b1_2:
v_mfma_f32_16x16x32_bf16 v[16:19], a[64:67], v[160:163], v[16:19]
buffer_load_dwordx4 v[148:151], v10, s[32:35], s65 offen offset:3072 sc1
v_mfma_f32_16x16x32_bf16 v[20:23], a[64:67], v[164:167], v[20:23]
v_mfma_f32_16x16x32_bf16 v[24:27], a[64:67], v[168:171], v[24:27]
v_mfma_f32_16x16x32_bf16 v[28:31], a[68:71], v[160:163], v[28:31]
v_mfma_f32_16x16x32_bf16 v[32:35], a[68:71], v[164:167], v[32:35]
buffer_load_dwordx4 v[152:155], v10, s[32:35], s66 offen offset:3072 sc1
v_mfma_f32_16x16x32_bf16 v[36:39], a[68:71], v[168:171], v[36:39]
v_mfma_f32_16x16x32_bf16 v[40:43], a[72:75], v[160:163], v[40:43]
v_mfma_f32_16x16x32_bf16 v[44:47], a[72:75], v[164:167], v[44:47]
v_mfma_f32_16x16x32_bf16 v[48:51], a[72:75], v[168:171], v[48:51]
buffer_load_dwordx4 v[156:159], v10, s[32:35], s67 offen offset:3072 sc1
v_mfma_f32_16x16x32_bf16 v[52:55], a[76:79], v[160:163], v[52:55]
v_mfma_f32_16x16x32_bf16 v[56:59], a[76:79], v[164:167], v[56:59]
s_mov_b64 exec, 0xff
global_load_dwordx4 v[12:15], v11, s[98:99] sc1
s_mov_b64 exec, -1
v_mfma_f32_16x16x32_bf16 v[60:63], a[76:79], v[168:171], v[60:63]
v_mfma_f32_16x16x32_bf16 v[16:19], a[80:83], v[172:175], v[16:19]
buffer_load_dwordx4 v[160:163], v10, s[32:35], s71 offen offset:0 sc1
v_mfma_f32_16x16x32_bf16 v[20:23], a[80:83], v[176:179], v[20:23]
v_mfma_f32_16x16x32_bf16 v[24:27], a[80:83], v[180:183], v[24:27]
v_mfma_f32_16x16x32_bf16 v[28:31], a[84:87], v[172:175], v[28:31]
v_mfma_f32_16x16x32_bf16 v[32:35], a[84:87], v[176:179], v[32:35]
buffer_load_dwordx4 v[164:167], v10, s[32:35], s72 offen offset:0 sc1
v_mfma_f32_16x16x32_bf16 v[36:39], a[84:87], v[180:183], v[36:39]
v_mfma_f32_16x16x32_bf16 v[40:43], a[88:91], v[172:175], v[40:43]
v_mfma_f32_16x16x32_bf16 v[44:47], a[88:91], v[176:179], v[44:47]
v_mfma_f32_16x16x32_bf16 v[48:51], a[88:91], v[180:183], v[48:51]
buffer_load_dwordx4 v[168:171], v10, s[32:35], s70 offen offset:0 sc1
v_mfma_f32_16x16x32_bf16 v[52:55], a[92:95], v[172:175], v[52:55]
v_mfma_f32_16x16x32_bf16 v[56:59], a[92:95], v[176:179], v[56:59]
v_mfma_f32_16x16x32_bf16 v[60:63], a[92:95], v[180:183], v[60:63]
v_mfma_f32_16x16x32_bf16 v[16:19], a[96:99], v[184:187], v[16:19]
buffer_load_dwordx4 v[172:175], v10, s[32:35], s71 offen offset:1024 sc1
v_mfma_f32_16x16x32_bf16 v[20:23], a[96:99], v[188:191], v[20:23]
v_mfma_f32_16x16x32_bf16 v[24:27], a[96:99], v[192:195], v[24:27]
v_mfma_f32_16x16x32_bf16 v[28:31], a[100:103], v[184:187], v[28:31]
v_mfma_f32_16x16x32_bf16 v[32:35], a[100:103], v[188:191], v[32:35]
buffer_load_dwordx4 v[176:179], v10, s[32:35], s72 offen offset:1024 sc1
v_mfma_f32_16x16x32_bf16 v[36:39], a[100:103], v[192:195], v[36:39]
v_mfma_f32_16x16x32_bf16 v[40:43], a[104:107], v[184:187], v[40:43]
v_mfma_f32_16x16x32_bf16 v[44:47], a[104:107], v[188:191], v[44:47]
v_mfma_f32_16x16x32_bf16 v[48:51], a[104:107], v[192:195], v[48:51]
buffer_load_dwordx4 v[180:183], v10, s[32:35], s70 offen offset:1024 sc1
v_mfma_f32_16x16x32_bf16 v[52:55], a[108:111], v[184:187], v[52:55]
v_mfma_f32_16x16x32_bf16 v[56:59], a[108:111], v[188:191], v[56:59]
v_mfma_f32_16x16x32_bf16 v[60:63], a[108:111], v[192:195], v[60:63]
s_waitcnt vmcnt(6)
v_min3_u32 v12, v12, v13, v14
v_min_u32 v12, v12, v15
v_mfma_f32_16x16x32_bf16 v[16:19], a[112:115], v[196:199], v[16:19]
buffer_load_dwordx4 v[184:187], v10, s[32:35], s71 offen offset:2048 sc1
v_cmp_ne_u32 vcc, 0, v12
v_mfma_f32_16x16x32_bf16 v[20:23], a[112:115], v[200:203], v[20:23]
s_mov_b32 s73, s97
s_andn2_b32 s96, vcc_lo, s79
v_mfma_f32_16x16x32_bf16 v[24:27], a[112:115], v[204:207], v[24:27]
s_ff1_i32_b32 s97, s96
s_bitset1_b32 s79, s97
v_mfma_f32_16x16x32_bf16 v[28:31], a[116:119], v[196:199], v[28:31]
s_bitcmp1_b32 s97, 1
s_cselect_b32 s65, s69, s68
v_mfma_f32_16x16x32_bf16 v[32:35], a[116:119], v[200:203], v[32:35]
buffer_load_dwordx4 v[188:191], v10, s[32:35], s72 offen offset:2048 sc1
s_cselect_b32 s66, s75, s74
v_mfma_f32_16x16x32_bf16 v[36:39], a[116:119], v[204:207], v[36:39]
s_bitcmp1_b32 s97, 2
s_cselect_b32 s65, s66, s65
v_mfma_f32_16x16x32_bf16 v[40:43], a[120:123], v[196:199], v[40:43]
s_bitcmp1_b32 s97, 0
s_cselect_b32 s66, 786432, 0
v_mfma_f32_16x16x32_bf16 v[44:47], a[120:123], v[200:203], v[44:47]
s_add_u32 s65, s65, s66
s_and_b32 s66, s97, 0x20000000
v_mfma_f32_16x16x32_bf16 v[48:51], a[120:123], v[204:207], v[48:51]
buffer_load_dwordx4 v[192:195], v10, s[32:35], s70 offen offset:2048 sc1
s_or_b32 s65, s65, s66
v_mfma_f32_16x16x32_bf16 v[52:55], a[124:127], v[196:199], v[52:55]
s_add_u32 s66, s65, 4096
s_add_u32 s67, s65, 8192
v_mfma_f32_16x16x32_bf16 v[56:59], a[124:127], v[200:203], v[56:59]
s_and_b32 s64, s97, s63
s_and_b32 s64, s64, s79
v_mfma_f32_16x16x32_bf16 v[60:63], a[124:127], v[204:207], v[60:63]
s_cmp_eq_u32 s64, -1
s_cbranch_scc1 T_last0
s_bitcmp1_b32 s73, 2
s_cbranch_scc1 T_d_41
s_cmp_eq_u32 s73, 0
s_cbranch_scc1 T_b0_0
s_cmp_eq_u32 s73, 1
s_cbranch_scc1 T_b0_1
s_cmp_eq_u32 s73, 2
s_cbranch_scc1 T_b0_2
s_branch T_b0_3
T_d_41:
s_cmp_eq_u32 s73, 4
s_cbranch_scc1 T_b0_4
s_cmp_eq_u32 s73, 5
s_cbranch_scc1 T_b0_5
s_cmp_eq_u32 s73, 6
s_cbranch_scc1 T_b0_6
s_cmp_eq_u32 s73, 7
s_cbranch_scc1 T_b0_7
s_branch T_n0
T_b1_3:
v_mfma_f32_16x16x32_bf16 v[64:67], a[64:67], v[160:163], v[64:67]
buffer_load_dwordx4 v[148:151], v10, s[32:35], s65 offen offset:3072 sc1
v_mfma_f32_16x16x32_bf16 v[68:71], a[64:67], v[164:167], v[68:71]
v_mfma_f32_16x16x32_bf16 v[72:75], a[64:67], v[168:171], v[72:75]
v_mfma_f32_16x16x32_bf16 v[76:79], a[68:71], v[160:163], v[76:79]
v_mfma_f32_16x16x32_bf16 v[80:83], a[68:71], v[164:167], v[80:83]
buffer_load_dwordx4 v[152:155], v10, s[32:35], s66 offen offset:3072 sc1
v_mfma_f32_16x16x32_bf16 v[84:87], a[68:71], v[168:171], v[84:87]
v_mfma_f32_16x16x32_bf16 v[88:91], a[72:75], v[160:163], v[88:91]
v_mfma_f32_16x16x32_bf16 v[92:95], a[72:75], v[164:167], v[92:95]
v_mfma_f32_16x16x32_bf16 v[96:99], a[72:75], v[168:171], v[96:99]
buffer_load_dwordx4 v[156:159], v10, s[32:35], s67 offen offset:3072 sc1
v_mfma_f32_16x16x32_bf16 v[100:103], a[76:79], v[160:163], v[100:103]
v_mfma_f32_16x16x32_bf16 v[104:107], a[76:79], v[164:167], v[104:107]
s_mov_b64 exec, 0xff
global_load_dwordx4 v[12:15], v11, s[98:99] sc1
s_mov_b64 exec, -1
v_mfma_f32_16x16x32_bf16 v[108:111], a[76:79], v[168:171], v[108:111]
v_mfma_f32_16x16x32_bf16 v[64:67], a[80:83], v[172:175], v[64:67]
buffer_load_dwordx4 v[160:163], v10, s[32:35], s71 offen offset:0 sc1
v_mfma_f32_16x16x32_bf16 v[68:71], a[80:83], v[176:179], v[68:71]
v_mfma_f32_16x16x32_bf16 v[72:75], a[80:83], v[180:183], v[72:75]
v_mfma_f32_16x16x32_bf16 v[76:79], a[84:87], v[172:175], v[76:79]
v_mfma_f32_16x16x32_bf16 v[80:83], a[84:87], v[176:179], v[80:83]
buffer_load_dwordx4 v[164:167], v10, s[32:35], s72 offen offset:0 sc1
v_mfma_f32_16x16x32_bf16 v[84:87], a[84:87], v[180:183], v[84:87]
v_mfma_f32_16x16x32_bf16 v[88:91], a[88:91], v[172:175], v[88:91]
v_mfma_f32_16x16x32_bf16 v[92:95], a[88:91], v[176:179], v[92:95]
v_mfma_f32_16x16x32_bf16 v[96:99], a[88:91], v[180:183], v[96:99]
buffer_load_dwordx4 v[168:171], v10, s[32:35], s70 offen offset:0 sc1
v_mfma_f32_16x16x32_bf16 v[100:103], a[92:95], v[172:175], v[100:103]
v_mfma_f32_16x16x32_bf16 v[104:107], a[92:95], v[176:179], v[104:107]
v_mfma_f32_16x16x32_bf16 v[108:111], a[92:95], v[180:183], v[108:111]
v_mfma_f32_16x16x32_bf16 v[64:67], a[96:99], v[184:187], v[64:67]
buffer_load_dwordx4 v[172:175], v10, s[32:35], s71 offen offset:1024 sc1
v_mfma_f32_16x16x32_bf16 v[68:71], a[96:99], v[188:191], v[68:71]
v_mfma_f32_16x16x32_bf16 v[72:75], a[96:99], v[192:195], v[72:75]
v_mfma_f32_16x16x32_bf16 v[76:79], a[100:103], v[184:187], v[76:79]
v_mfma_f32_16x16x32_bf16 v[80:83], a[100:103], v[188:191], v[80:83]
buffer_load_dwordx4 v[176:179], v10, s[32:35], s72 offen offset:1024 sc1
v_mfma_f32_16x16x32_bf16 v[84:87], a[100:103], v[192:195], v[84:87]
v_mfma_f32_16x16x32_bf16 v[88:91], a[104:107], v[184:187], v[88:91]
v_mfma_f32_16x16x32_bf16 v[92:95], a[104:107], v[188:191], v[92:95]
v_mfma_f32_16x16x32_bf16 v[96:99], a[104:107], v[192:195], v[96:99]
buffer_load_dwordx4 v[180:183], v10, s[32:35], s70 offen offset:1024 sc1
v_mfma_f32_16x16x32_bf16 v[100:103], a[108:111], v[184:187], v[100:103]
v_mfma_f32_16x16x32_bf16 v[104:107], a[108:111], v[188:191], v[104:107]
v_mfma_f32_16x16x32_bf16 v[108:111], a[108:111], v[192:195], v[108:111]
s_waitcnt vmcnt(6)
v_min3_u32 v12, v12, v13, v14
v_min_u32 v12, v12, v15
v_mfma_f32_16x16x32_bf16 v[64:67], a[112:115], v[196:199], v[64:67]
buffer_load_dwordx4 v[184:187], v10, s[32:35], s71 offen offset:2048 sc1
v_cmp_ne_u32 vcc, 0, v12
v_mfma_f32_16x16x32_bf16 v[68:71], a[112:115], v[200:203], v[68:71]
s_mov_b32 s73, s97
s_andn2_b32 s96, vcc_lo, s79
v_mfma_f32_16x16x32_bf16 v[72:75], a[112:115], v[204:207], v[72:75]
s_ff1_i32_b32 s97, s96
s_bitset1_b32 s79, s97
v_mfma_f32_16x16x32_bf16 v[76:79], a[116:119], v[196:199], v[76:79]
s_bitcmp1_b32 s97, 1
s_cselect_b32 s65, s69, s68
v_mfma_f32_16x16x32_bf16 v[80:83], a[116:119], v[200:203], v[80:83]
buffer_load_dwordx4 v[188:191], v10, s[32:35], s72 offen offset:2048 sc1
s_cselect_b32 s66, s75, s74
v_mfma_f32_16x16x32_bf16 v[84:87], a[116:119], v[204:207], v[84:87]
s_bitcmp1_b32 s97, 2
s_cselect_b32 s65, s66, s65
v_mfma_f32_16x16x32_bf16 v[88:91], a[120:123], v[196:199], v[88:91]
s_bitcmp1_b32 s97, 0
s_cselect_b32 s66, 786432, 0
v_mfma_f32_16x16x32_bf16 v[92:95], a[120:123], v[200:203], v[92:95]
s_add_u32 s65, s65, s66
s_and_b32 s66, s97, 0x20000000
v_mfma_f32_16x16x32_bf16 v[96:99], a[120:123], v[204:207], v[96:99]
buffer_load_dwordx4 v[192:195], v10, s[32:35], s70 offen offset:2048 sc1
s_or_b32 s65, s65, s66
v_mfma_f32_16x16x32_bf16 v[100:103], a[124:127], v[196:199], v[100:103]
s_add_u32 s66, s65, 4096
s_add_u32 s67, s65, 8192
v_mfma_f32_16x16x32_bf16 v[104:107], a[124:127], v[200:203], v[104:107]
s_and_b32 s64, s97, s63
s_and_b32 s64, s64, s79
v_mfma_f32_16x16x32_bf16 v[108:111], a[124:127], v[204:207], v[108:111]
s_cmp_eq_u32 s64, -1
s_cbranch_scc1 T_last0
s_bitcmp1_b32 s73, 2
s_cbranch_scc1 T_d_42
s_cmp_eq_u32 s73, 0
s_cbranch_scc1 T_b0_0
s_cmp_eq_u32 s73, 1
s_cbranch_scc1 T_b0_1
s_cmp_eq_u32 s73, 2
s_cbranch_scc1 T_b0_2
s_branch T_b0_3
T_d_42:
s_cmp_eq_u32 s73, 4
s_cbranch_scc1 T_b0_4
s_cmp_eq_u32 s73, 5
s_cbranch_scc1 T_b0_5
s_cmp_eq_u32 s73, 6
s_cbranch_scc1 T_b0_6
s_cmp_eq_u32 s73, 7
s_cbranch_scc1 T_b0_7
s_branch T_n0
T_b1_4:
v_mfma_f32_16x16x32_bf16 v[16:19], a[128:131], v[160:163], v[16:19]
buffer_load_dwordx4 v[148:151], v10, s[32:35], s65 offen offset:3072 sc1
v_mfma_f32_16x16x32_bf16 v[20:23], a[128:131], v[164:167], v[20:23]
v_mfma_f32_16x16x32_bf16 v[24:27], a[128:131], v[168:171], v[24:27]
v_mfma_f32_16x16x32_bf16 v[28:31], a[132:135], v[160:163], v[28:31]
v_mfma_f32_16x16x32_bf16 v[32:35], a[132:135], v[164:167], v[32:35]
buffer_load_dwordx4 v[152:155], v10, s[32:35], s66 offen offset:3072 sc1
v_mfma_f32_16x16x32_bf16 v[36:39], a[132:135], v[168:171], v[36:39]
v_mfma_f32_16x16x32_bf16 v[40:43], a[136:139], v[160:163], v[40:43]
v_mfma_f32_16x16x32_bf16 v[44:47], a[136:139], v[164:167], v[44:47]
v_mfma_f32_16x16x32_bf16 v[48:51], a[136:139], v[168:171], v[48:51]
buffer_load_dwordx4 v[156:159], v10, s[32:35], s67 offen offset:3072 sc1
v_mfma_f32_16x16x32_bf16 v[52:55], a[140:143], v[160:163], v[52:55]
v_mfma_f32_16x16x32_bf16 v[56:59], a[140:143], v[164:167], v[56:59]
s_mov_b64 exec, 0xff
global_load_dwordx4 v[12:15], v11, s[98:99] sc1
s_mov_b64 exec, -1
v_mfma_f32_16x16x32_bf16 v[60:63], a[140:143], v[168:171], v[60:63]
v_mfma_f32_16x16x32_bf16 v[16:19], a[144:147], v[172:175], v[16:19]
buffer_load_dwordx4 v[160:163], v10, s[32:35], s71 offen offset:0 sc1
v_mfma_f32_16x16x32_bf16 v[20:23], a[144:147], v[176:179], v[20:23]
v_mfma_f32_16x16x32_bf16 v[24:27], a[144:147], v[180:183], v[24:27]
v_mfma_f32_16x16x32_bf16 v[28:31], a[148:151], v[172:175], v[28:31]
v_mfma_f32_16x16x32_bf16 v[32:35], a[148:151], v[176:179], v[32:35]
buffer_load_dwordx4 v[164:167], v10, s[32:35], s72 offen offset:0 sc1
v_mfma_f32_16x16x32_bf16 v[36:39], a[148:151], v[180:183], v[36:39]
v_mfma_f32_16x16x32_bf16 v[40:43], a[152:155], v[172:175], v[40:43]
v_mfma_f32_16x16x32_bf16 v[44:47], a[152:155], v[176:179], v[44:47]
v_mfma_f32_16x16x32_bf16 v[48:51], a[152:155], v[180:183], v[48:51]
buffer_load_dwordx4 v[168:171], v10, s[32:35], s70 offen offset:0 sc1
v_mfma_f32_16x16x32_bf16 v[52:55], a[156:159], v[172:175], v[52:55]
v_mfma_f32_16x16x32_bf16 v[56:59], a[156:159], v[176:179], v[56:59]
v_mfma_f32_16x16x32_bf16 v[60:63], a[156:159], v[180:183], v[60:63]
v_mfma_f32_16x16x32_bf16 v[16:19], a[160:163], v[184:187], v[16:19]
buffer_load_dwordx4 v[172:175], v10, s[32:35], s71 offen offset:1024 sc1
v_mfma_f32_16x16x32_bf16 v[20:23], a[160:163], v[188:191], v[20:23]
v_mfma_f32_16x16x32_bf16 v[24:27], a[160:163], v[192:195], v[24:27]
v_mfma_f32_16x16x32_bf16 v[28:31], a[164:167], v[184:187], v[28:31]
v_mfma_f32_16x16x32_bf16 v[32:35], a[164:167], v[188:191], v[32:35]
buffer_load_dwordx4 v[176:179], v10, s[32:35], s72 offen offset:1024 sc1
v_mfma_f32_16x16x32_bf16 v[36:39], a[164:167], v[192:195], v[36:39]
v_mfma_f32_16x16x32_bf16 v[40:43], a[168:171], v[184:187], v[40:43]
v_mfma_f32_16x16x32_bf16 v[44:47], a[168:171], v[188:191], v[44:47]
v_mfma_f32_16x16x32_bf16 v[48:51], a[168:171], v[192:195], v[48:51]
buffer_load_dwordx4 v[180:183], v10, s[32:35], s70 offen offset:1024 sc1
v_mfma_f32_16x16x32_bf16 v[52:55], a[172:175], v[184:187], v[52:55]
v_mfma_f32_16x16x32_bf16 v[56:59], a[172:175], v[188:191], v[56:59]
v_mfma_f32_16x16x32_bf16 v[60:63], a[172:175], v[192:195], v[60:63]
s_waitcnt vmcnt(6)
v_min3_u32 v12, v12, v13, v14
v_min_u32 v12, v12, v15
v_mfma_f32_16x16x32_bf16 v[16:19], a[176:179], v[196:199], v[16:19]
buffer_load_dwordx4 v[184:187], v10, s[32:35], s71 offen offset:2048 sc1
v_cmp_ne_u32 vcc, 0, v12
v_mfma_f32_16x16x32_bf16 v[20:23], a[176:179], v[200:203], v[20:23]
s_mov_b32 s73, s97
s_andn2_b32 s96, vcc_lo, s79
v_mfma_f32_16x16x32_bf16 v[24:27], a[176:179], v[204:207], v[24:27]
s_ff1_i32_b32 s97, s96
s_bitset1_b32 s79, s97
v_mfma_f32_16x16x32_bf16 v[28:31], a[180:183], v[196:199], v[28:31]
s_bitcmp1_b32 s97, 1
s_cselect_b32 s65, s69, s68
v_mfma_f32_16x16x32_bf16 v[32:35], a[180:183], v[200:203], v[32:35]
buffer_load_dwordx4 v[188:191], v10, s[32:35], s72 offen offset:2048 sc1
s_cselect_b32 s66, s75, s74
v_mfma_f32_16x16x32_bf16 v[36:39], a[180:183], v[204:207], v[36:39]
s_bitcmp1_b32 s97, 2
s_cselect_b32 s65, s66, s65
v_mfma_f32_16x16x32_bf16 v[40:43], a[184:187], v[196:199], v[40:43]
s_bitcmp1_b32 s97, 0
s_cselect_b32 s66, 786432, 0
v_mfma_f32_16x16x32_bf16 v[44:47], a[184:187], v[200:203], v[44:47]
s_add_u32 s65, s65, s66
s_and_b32 s66, s97, 0x20000000
v_mfma_f32_16x16x32_bf16 v[48:51], a[184:187], v[204:207], v[48:51]
buffer_load_dwordx4 v[192:195], v10, s[32:35], s70 offen offset:2048 sc1
s_or_b32 s65, s65, s66
v_mfma_f32_16x16x32_bf16 v[52:55], a[188:191], v[196:199], v[52:55]
s_add_u32 s66, s65, 4096
s_add_u32 s67, s65, 8192
v_mfma_f32_16x16x32_bf16 v[56:59], a[188:191], v[200:203], v[56:59]
s_and_b32 s64, s97, s63
s_and_b32 s64, s64, s79
v_mfma_f32_16x16x32_bf16 v[60:63], a[188:191], v[204:207], v[60:63]
s_cmp_eq_u32 s64, -1
s_cbranch_scc1 T_last0
s_bitcmp1_b32 s73, 2
s_cbranch_scc1 T_d_43
s_cmp_eq_u32 s73, 0
s_cbranch_scc1 T_b0_0
s_cmp_eq_u32 s73, 1
s_cbranch_scc1 T_b0_1
s_cmp_eq_u32 s73, 2
s_cbranch_scc1 T_b0_2
s_branch T_b0_3
T_d_43:
s_cmp_eq_u32 s73, 4
s_cbranch_scc1 T_b0_4
s_cmp_eq_u32 s73, 5
s_cbranch_scc1 T_b0_5
s_cmp_eq_u32 s73, 6
s_cbranch_scc1 T_b0_6
s_cmp_eq_u32 s73, 7
s_cbranch_scc1 T_b0_7
s_branch T_n0
T_b1_5:
v_mfma_f32_16x16x32_bf16 v[64:67], a[128:131], v[160:163], v[64:67]
buffer_load_dwordx4 v[148:151], v10, s[32:35], s65 offen offset:3072 sc1
v_mfma_f32_16x16x32_bf16 v[68:71], a[128:131], v[164:167], v[68:71]
v_mfma_f32_16x16x32_bf16 v[72:75], a[128:131], v[168:171], v[72:75]
v_mfma_f32_16x16x32_bf16 v[76:79], a[132:135], v[160:163], v[76:79]
v_mfma_f32_16x16x32_bf16 v[80:83], a[132:135], v[164:167], v[80:83]
buffer_load_dwordx4 v[152:155], v10, s[32:35], s66 offen offset:3072 sc1
v_mfma_f32_16x16x32_bf16 v[84:87], a[132:135], v[168:171], v[84:87]
v_mfma_f32_16x16x32_bf16 v[88:91], a[136:139], v[160:163], v[88:91]
v_mfma_f32_16x16x32_bf16 v[92:95], a[136:139], v[164:167], v[92:95]
v_mfma_f32_16x16x32_bf16 v[96:99], a[136:139], v[168:171], v[96:99]
buffer_load_dwordx4 v[156:159], v10, s[32:35], s67 offen offset:3072 sc1
v_mfma_f32_16x16x32_bf16 v[100:103], a[140:143], v[160:163], v[100:103]
v_mfma_f32_16x16x32_bf16 v[104:107], a[140:143], v[164:167], v[104:107]
s_mov_b64 exec, 0xff
global_load_dwordx4 v[12:15], v11, s[98:99] sc1
s_mov_b64 exec, -1
v_mfma_f32_16x16x32_bf16 v[108:111], a[140:143], v[168:171], v[108:111]
v_mfma_f32_16x16x32_bf16 v[64:67], a[144:147], v[172:175], v[64:67]
buffer_load_dwordx4 v[160:163], v10, s[32:35], s71 offen offset:0 sc1
v_mfma_f32_16x16x32_bf16 v[68:71], a[144:147], v[176:179], v[68:71]
v_mfma_f32_16x16x32_bf16 v[72:75], a[144:147], v[180:183], v[72:75]
v_mfma_f32_16x16x32_bf16 v[76:79], a[148:151], v[172:175], v[76:79]
v_mfma_f32_16x16x32_bf16 v[80:83], a[148:151], v[176:179], v[80:83]
buffer_load_dwordx4 v[164:167], v10, s[32:35], s72 offen offset:0 sc1
v_mfma_f32_16x16x32_bf16 v[84:87], a[148:151], v[180:183], v[84:87]
v_mfma_f32_16x16x32_bf16 v[88:91], a[152:155], v[172:175], v[88:91]
v_mfma_f32_16x16x32_bf16 v[92:95], a[152:155], v[176:179], v[92:95]
v_mfma_f32_16x16x32_bf16 v[96:99], a[152:155], v[180:183], v[96:99]
buffer_load_dwordx4 v[168:171], v10, s[32:35], s70 offen offset:0 sc1
v_mfma_f32_16x16x32_bf16 v[100:103], a[156:159], v[172:175], v[100:103]
v_mfma_f32_16x16x32_bf16 v[104:107], a[156:159], v[176:179], v[104:107]
v_mfma_f32_16x16x32_bf16 v[108:111], a[156:159], v[180:183], v[108:111]
v_mfma_f32_16x16x32_bf16 v[64:67], a[160:163], v[184:187], v[64:67]
buffer_load_dwordx4 v[172:175], v10, s[32:35], s71 offen offset:1024 sc1
v_mfma_f32_16x16x32_bf16 v[68:71], a[160:163], v[188:191], v[68:71]
v_mfma_f32_16x16x32_bf16 v[72:75], a[160:163], v[192:195], v[72:75]
v_mfma_f32_16x16x32_bf16 v[76:79], a[164:167], v[184:187], v[76:79]
v_mfma_f32_16x16x32_bf16 v[80:83], a[164:167], v[188:191], v[80:83]
buffer_load_dwordx4 v[176:179], v10, s[32:35], s72 offen offset:1024 sc1
v_mfma_f32_16x16x32_bf16 v[84:87], a[164:167], v[192:195], v[84:87]
v_mfma_f32_16x16x32_bf16 v[88:91], a[168:171], v[184:187], v[88:91]
v_mfma_f32_16x16x32_bf16 v[92:95], a[168:171], v[188:191], v[92:95]
v_mfma_f32_16x16x32_bf16 v[96:99], a[168:171], v[192:195], v[96:99]
buffer_load_dwordx4 v[180:183], v10, s[32:35], s70 offen offset:1024 sc1
v_mfma_f32_16x16x32_bf16 v[100:103], a[172:175], v[184:187], v[100:103]
v_mfma_f32_16x16x32_bf16 v[104:107], a[172:175], v[188:191], v[104:107]
v_mfma_f32_16x16x32_bf16 v[108:111], a[172:175], v[192:195], v[108:111]
s_waitcnt vmcnt(6)
v_min3_u32 v12, v12, v13, v14
v_min_u32 v12, v12, v15
v_mfma_f32_16x16x32_bf16 v[64:67], a[176:179], v[196:199], v[64:67]
buffer_load_dwordx4 v[184:187], v10, s[32:35], s71 offen offset:2048 sc1
v_cmp_ne_u32 vcc, 0, v12
v_mfma_f32_16x16x32_bf16 v[68:71], a[176:179], v[200:203], v[68:71]
s_mov_b32 s73, s97
s_andn2_b32 s96, vcc_lo, s79
v_mfma_f32_16x16x32_bf16 v[72:75], a[176:179], v[204:207], v[72:75]
s_ff1_i32_b32 s97, s96
s_bitset1_b32 s79, s97
v_mfma_f32_16x16x32_bf16 v[76:79], a[180:183], v[196:199], v[76:79]
s_bitcmp1_b32 s97, 1
s_cselect_b32 s65, s69, s68
v_mfma_f32_16x16x32_bf16 v[80:83], a[180:183], v[200:203], v[80:83]
buffer_load_dwordx4 v[188:191], v10, s[32:35], s72 offen offset:2048 sc1
s_cselect_b32 s66, s75, s74
v_mfma_f32_16x16x32_bf16 v[84:87], a[180:183], v[204:207], v[84:87]
s_bitcmp1_b32 s97, 2
s_cselect_b32 s65, s66, s65
v_mfma_f32_16x16x32_bf16 v[88:91], a[184:187], v[196:199], v[88:91]
s_bitcmp1_b32 s97, 0
s_cselect_b32 s66, 786432, 0
v_mfma_f32_16x16x32_bf16 v[92:95], a[184:187], v[200:203], v[92:95]
s_add_u32 s65, s65, s66
s_and_b32 s66, s97, 0x20000000
v_mfma_f32_16x16x32_bf16 v[96:99], a[184:187], v[204:207], v[96:99]
buffer_load_dwordx4 v[192:195], v10, s[32:35], s70 offen offset:2048 sc1
s_or_b32 s65, s65, s66
v_mfma_f32_16x16x32_bf16 v[100:103], a[188:191], v[196:199], v[100:103]
s_add_u32 s66, s65, 4096
s_add_u32 s67, s65, 8192
v_mfma_f32_16x16x32_bf16 v[104:107], a[188:191], v[200:203], v[104:107]
s_and_b32 s64, s97, s63
s_and_b32 s64, s64, s79
v_mfma_f32_16x16x32_bf16 v[108:111], a[188:191], v[204:207], v[108:111]
s_cmp_eq_u32 s64, -1
s_cbranch_scc1 T_last0
s_bitcmp1_b32 s73, 2
s_cbranch_scc1 T_d_44
s_cmp_eq_u32 s73, 0
s_cbranch_scc1 T_b0_0
s_cmp_eq_u32 s73, 1
s_cbranch_scc1 T_b0_1
s_cmp_eq_u32 s73, 2
s_cbranch_scc1 T_b0_2
s_branch T_b0_3
T_d_44:
s_cmp_eq_u32 s73, 4
s_cbranch_scc1 T_b0_4
s_cmp_eq_u32 s73, 5
s_cbranch_scc1 T_b0_5
s_cmp_eq_u32 s73, 6
s_cbranch_scc1 T_b0_6
s_cmp_eq_u32 s73, 7
s_cbranch_scc1 T_b0_7
s_branch T_n0
T_b1_6:
v_mfma_f32_16x16x32_bf16 v[16:19], a[192:195], v[160:163], v[16:19]
buffer_load_dwordx4 v[148:151], v10, s[32:35], s65 offen offset:3072 sc1
v_mfma_f32_16x16x32_bf16 v[20:23], a[192:195], v[164:167], v[20:23]
v_mfma_f32_16x16x32_bf16 v[24:27], a[192:195], v[168:171], v[24:27]
v_mfma_f32_16x16x32_bf16 v[28:31], a[196:199], v[160:163], v[28:31]
v_mfma_f32_16x16x32_bf16 v[32:35], a[196:199], v[164:167], v[32:35]
buffer_load_dwordx4 v[152:155], v10, s[32:35], s66 offen offset:3072 sc1
v_mfma_f32_16x16x32_bf16 v[36:39], a[196:199], v[168:171], v[36:39]
v_mfma_f32_16x16x32_bf16 v[40:43], a[200:203], v[160:163], v[40:43]
v_mfma_f32_16x16x32_bf16 v[44:47], a[200:203], v[164:167], v[44:47]
v_mfma_f32_16x16x32_bf16 v[48:51], a[200:203], v[168:171], v[48:51]
buffer_load_dwordx4 v[156:159], v10, s[32:35], s67 offen offset:3072 sc1
v_mfma_f32_16x16x32_bf16 v[52:55], a[204:207], v[160:163], v[52:55]
v_mfma_f32_16x16x32_bf16 v[56:59], a[204:207], v[164:167], v[56:59]
s_mov_b64 exec, 0xff
global_load_dwordx4 v[12:15], v11, s[98:99] sc1
s_mov_b64 exec, -1
v_mfma_f32_16x16x32_bf16 v[60:63], a[204:207], v[168:171], v[60:63]
v_mfma_f32_16x16x32_bf16 v[16:19], a[208:211], v[172:175], v[16:19]
buffer_load_dwordx4 v[160:163], v10, s[32:35], s71 offen offset:0 sc1
v_mfma_f32_16x16x32_bf16 v[20:23], a[208:211], v[176:179], v[20:23]
v_mfma_f32_16x16x32_bf16 v[24:27], a[208:211], v[180:183], v[24:27]
v_mfma_f32_16x16x32_bf16 v[28:31], a[212:215], v[172:175], v[28:31]
v_mfma_f32_16x16x32_bf16 v[32:35], a[212:215], v[176:179], v[32:35]
buffer_load_dwordx4 v[164:167], v10, s[32:35], s72 offen offset:0 sc1
v_mfma_f32_16x16x32_bf16 v[36:39], a[212:215], v[180:183], v[36:39]
v_mfma_f32_16x16x32_bf16 v[40:43], a[216:219], v[172:175], v[40:43]
v_mfma_f32_16x16x32_bf16 v[44:47], a[216:219], v[176:179], v[44:47]
v_mfma_f32_16x16x32_bf16 v[48:51], a[216:219], v[180:183], v[48:51]
buffer_load_dwordx4 v[168:171], v10, s[32:35], s70 offen offset:0 sc1
v_mfma_f32_16x16x32_bf16 v[52:55], a[220:223], v[172:175], v[52:55]
v_mfma_f32_16x16x32_bf16 v[56:59], a[220:223], v[176:179], v[56:59]
v_mfma_f32_16x16x32_bf16 v[60:63], a[220:223], v[180:183], v[60:63]
v_mfma_f32_16x16x32_bf16 v[16:19], a[224:227], v[184:187], v[16:19]
buffer_load_dwordx4 v[172:175], v10, s[32:35], s71 offen offset:1024 sc1
v_mfma_f32_16x16x32_bf16 v[20:23], a[224:227], v[188:191], v[20:23]
v_mfma_f32_16x16x32_bf16 v[24:27], a[224:227], v[192:195], v[24:27]
v_mfma_f32_16x16x32_bf16 v[28:31], a[228:231], v[184:187], v[28:31]
v_mfma_f32_16x16x32_bf16 v[32:35], a[228:231], v[188:191], v[32:35]
buffer_load_dwordx4 v[176:179], v10, s[32:35], s72 offen offset:1024 sc1
v_mfma_f32_16x16x32_bf16 v[36:39], a[228:231], v[192:195], v[36:39]
v_mfma_f32_16x16x32_bf16 v[40:43], a[232:235], v[184:187], v[40:43]
v_mfma_f32_16x16x32_bf16 v[44:47], a[232:235], v[188:191], v[44:47]
v_mfma_f32_16x16x32_bf16 v[48:51], a[232:235], v[192:195], v[48:51]
buffer_load_dwordx4 v[180:183], v10, s[32:35], s70 offen offset:1024 sc1
v_mfma_f32_16x16x32_bf16 v[52:55], a[236:239], v[184:187], v[52:55]
v_mfma_f32_16x16x32_bf16 v[56:59], a[236:239], v[188:191], v[56:59]
v_mfma_f32_16x16x32_bf16 v[60:63], a[236:239], v[192:195], v[60:63]
s_waitcnt vmcnt(6)
v_min3_u32 v12, v12, v13, v14
v_min_u32 v12, v12, v15
v_mfma_f32_16x16x32_bf16 v[16:19], a[240:243], v[196:199], v[16:19]
buffer_load_dwordx4 v[184:187], v10, s[32:35], s71 offen offset:2048 sc1
v_cmp_ne_u32 vcc, 0, v12
v_mfma_f32_16x16x32_bf16 v[20:23], a[240:243], v[200:203], v[20:23]
s_mov_b32 s73, s97
s_andn2_b32 s96, vcc_lo, s79
v_mfma_f32_16x16x32_bf16 v[24:27], a[240:243], v[204:207], v[24:27]
s_ff1_i32_b32 s97, s96
s_bitset1_b32 s79, s97
v_mfma_f32_16x16x32_bf16 v[28:31], a[244:247], v[196:199], v[28:31]
s_bitcmp1_b32 s97, 1
s_cselect_b32 s65, s69, s68
v_mfma_f32_16x16x32_bf16 v[32:35], a[244:247], v[200:203], v[32:35]
buffer_load_dwordx4 v[188:191], v10, s[32:35], s72 offen offset:2048 sc1
s_cselect_b32 s66, s75, s74
v_mfma_f32_16x16x32_bf16 v[36:39], a[244:247], v[204:207], v[36:39]
s_bitcmp1_b32 s97, 2
s_cselect_b32 s65, s66, s65
v_mfma_f32_16x16x32_bf16 v[40:43], a[248:251], v[196:199], v[40:43]
s_bitcmp1_b32 s97, 0
s_cselect_b32 s66, 786432, 0
v_mfma_f32_16x16x32_bf16 v[44:47], a[248:251], v[200:203], v[44:47]
s_add_u32 s65, s65, s66
s_and_b32 s66, s97, 0x20000000
v_mfma_f32_16x16x32_bf16 v[48:51], a[248:251], v[204:207], v[48:51]
buffer_load_dwordx4 v[192:195], v10, s[32:35], s70 offen offset:2048 sc1
s_or_b32 s65, s65, s66
v_mfma_f32_16x16x32_bf16 v[52:55], a[252:255], v[196:199], v[52:55]
s_add_u32 s66, s65, 4096
s_add_u32 s67, s65, 8192
v_mfma_f32_16x16x32_bf16 v[56:59], a[252:255], v[200:203], v[56:59]
s_and_b32 s64, s97, s63
s_and_b32 s64, s64, s79
v_mfma_f32_16x16x32_bf16 v[60:63], a[252:255], v[204:207], v[60:63]
s_cmp_eq_u32 s64, -1
s_cbranch_scc1 T_last0
s_bitcmp1_b32 s73, 2
s_cbranch_scc1 T_d_45
s_cmp_eq_u32 s73, 0
s_cbranch_scc1 T_b0_0
s_cmp_eq_u32 s73, 1
s_cbranch_scc1 T_b0_1
s_cmp_eq_u32 s73, 2
s_cbranch_scc1 T_b0_2
s_branch T_b0_3
T_d_45:
s_cmp_eq_u32 s73, 4
s_cbranch_scc1 T_b0_4
s_cmp_eq_u32 s73, 5
s_cbranch_scc1 T_b0_5
s_cmp_eq_u32 s73, 6
s_cbranch_scc1 T_b0_6
s_cmp_eq_u32 s73, 7
s_cbranch_scc1 T_b0_7
s_branch T_n0
T_b1_7:
v_mfma_f32_16x16x32_bf16 v[64:67], a[192:195], v[160:163], v[64:67]
buffer_load_dwordx4 v[148:151], v10, s[32:35], s65 offen offset:3072 sc1
v_mfma_f32_16x16x32_bf16 v[68:71], a[192:195], v[164:167], v[68:71]
v_mfma_f32_16x16x32_bf16 v[72:75], a[192:195], v[168:171], v[72:75]
v_mfma_f32_16x16x32_bf16 v[76:79], a[196:199], v[160:163], v[76:79]
v_mfma_f32_16x16x32_bf16 v[80:83], a[196:199], v[164:167], v[80:83]
buffer_load_dwordx4 v[152:155], v10, s[32:35], s66 offen offset:3072 sc1
v_mfma_f32_16x16x32_bf16 v[84:87], a[196:199], v[168:171], v[84:87]
v_mfma_f32_16x16x32_bf16 v[88:91], a[200:203], v[160:163], v[88:91]
v_mfma_f32_16x16x32_bf16 v[92:95], a[200:203], v[164:167], v[92:95]
v_mfma_f32_16x16x32_bf16 v[96:99], a[200:203], v[168:171], v[96:99]
buffer_load_dwordx4 v[156:159], v10, s[32:35], s67 offen offset:3072 sc1
v_mfma_f32_16x16x32_bf16 v[100:103], a[204:207], v[160:163], v[100:103]
v_mfma_f32_16x16x32_bf16 v[104:107], a[204:207], v[164:167], v[104:107]
s_mov_b64 exec, 0xff
global_load_dwordx4 v[12:15], v11, s[98:99] sc1
s_mov_b64 exec, -1
v_mfma_f32_16x16x32_bf16 v[108:111], a[204:207], v[168:171], v[108:111]
v_mfma_f32_16x16x32_bf16 v[64:67], a[208:211], v[172:175], v[64:67]
buffer_load_dwordx4 v[160:163], v10, s[32:35], s71 offen offset:0 sc1
v_mfma_f32_16x16x32_bf16 v[68:71], a[208:211], v[176:179], v[68:71]
v_mfma_f32_16x16x32_bf16 v[72:75], a[208:211], v[180:183], v[72:75]
v_mfma_f32_16x16x32_bf16 v[76:79], a[212:215], v[172:175], v[76:79]
v_mfma_f32_16x16x32_bf16 v[80:83], a[212:215], v[176:179], v[80:83]
buffer_load_dwordx4 v[164:167], v10, s[32:35], s72 offen offset:0 sc1
v_mfma_f32_16x16x32_bf16 v[84:87], a[212:215], v[180:183], v[84:87]
v_mfma_f32_16x16x32_bf16 v[88:91], a[216:219], v[172:175], v[88:91]
v_mfma_f32_16x16x32_bf16 v[92:95], a[216:219], v[176:179], v[92:95]
v_mfma_f32_16x16x32_bf16 v[96:99], a[216:219], v[180:183], v[96:99]
buffer_load_dwordx4 v[168:171], v10, s[32:35], s70 offen offset:0 sc1
v_mfma_f32_16x16x32_bf16 v[100:103], a[220:223], v[172:175], v[100:103]
v_mfma_f32_16x16x32_bf16 v[104:107], a[220:223], v[176:179], v[104:107]
v_mfma_f32_16x16x32_bf16 v[108:111], a[220:223], v[180:183], v[108:111]
v_mfma_f32_16x16x32_bf16 v[64:67], a[224:227], v[184:187], v[64:67]
buffer_load_dwordx4 v[172:175], v10, s[32:35], s71 offen offset:1024 sc1
v_mfma_f32_16x16x32_bf16 v[68:71], a[224:227], v[188:191], v[68:71]
v_mfma_f32_16x16x32_bf16 v[72:75], a[224:227], v[192:195], v[72:75]
v_mfma_f32_16x16x32_bf16 v[76:79], a[228:231], v[184:187], v[76:79]
v_mfma_f32_16x16x32_bf16 v[80:83], a[228:231], v[188:191], v[80:83]
buffer_load_dwordx4 v[176:179], v10, s[32:35], s72 offen offset:1024 sc1
v_mfma_f32_16x16x32_bf16 v[84:87], a[228:231], v[192:195], v[84:87]
v_mfma_f32_16x16x32_bf16 v[88:91], a[232:235], v[184:187], v[88:91]
v_mfma_f32_16x16x32_bf16 v[92:95], a[232:235], v[188:191], v[92:95]
v_mfma_f32_16x16x32_bf16 v[96:99], a[232:235], v[192:195], v[96:99]
buffer_load_dwordx4 v[180:183], v10, s[32:35], s70 offen offset:1024 sc1
v_mfma_f32_16x16x32_bf16 v[100:103], a[236:239], v[184:187], v[100:103]
v_mfma_f32_16x16x32_bf16 v[104:107], a[236:239], v[188:191], v[104:107]
v_mfma_f32_16x16x32_bf16 v[108:111], a[236:239], v[192:195], v[108:111]
s_waitcnt vmcnt(6)
v_min3_u32 v12, v12, v13, v14
v_min_u32 v12, v12, v15
v_mfma_f32_16x16x32_bf16 v[64:67], a[240:243], v[196:199], v[64:67]
buffer_load_dwordx4 v[184:187], v10, s[32:35], s71 offen offset:2048 sc1
v_cmp_ne_u32 vcc, 0, v12
v_mfma_f32_16x16x32_bf16 v[68:71], a[240:243], v[200:203], v[68:71]
s_mov_b32 s73, s97
s_andn2_b32 s96, vcc_lo, s79
v_mfma_f32_16x16x32_bf16 v[72:75], a[240:243], v[204:207], v[72:75]
s_ff1_i32_b32 s97, s96
s_bitset1_b32 s79, s97
v_mfma_f32_16x16x32_bf16 v[76:79], a[244:247], v[196:199], v[76:79]
s_bitcmp1_b32 s97, 1
s_cselect_b32 s65, s69, s68
v_mfma_f32_16x16x32_bf16 v[80:83], a[244:247], v[200:203], v[80:83]
buffer_load_dwordx4 v[188:191], v10, s[32:35], s72 offen offset:2048 sc1
s_cselect_b32 s66, s75, s74
v_mfma_f32_16x16x32_bf16 v[84:87], a[244:247], v[204:207], v[84:87]
s_bitcmp1_b32 s97, 2
s_cselect_b32 s65, s66, s65
v_mfma_f32_16x16x32_bf16 v[88:91], a[248:251], v[196:199], v[88:91]
s_bitcmp1_b32 s97, 0
s_cselect_b32 s66, 786432, 0
v_mfma_f32_16x16x32_bf16 v[92:95], a[248:251], v[200:203], v[92:95]
s_add_u32 s65, s65, s66
s_and_b32 s66, s97, 0x20000000
v_mfma_f32_16x16x32_bf16 v[96:99], a[248:251], v[204:207], v[96:99]
buffer_load_dwordx4 v[192:195], v10, s[32:35], s70 offen offset:2048 sc1
s_or_b32 s65, s65, s66
v_mfma_f32_16x16x32_bf16 v[100:103], a[252:255], v[196:199], v[100:103]
s_add_u32 s66, s65, 4096
s_add_u32 s67, s65, 8192
v_mfma_f32_16x16x32_bf16 v[104:107], a[252:255], v[200:203], v[104:107]
s_and_b32 s64, s97, s63
s_and_b32 s64, s64, s79
v_mfma_f32_16x16x32_bf16 v[108:111], a[252:255], v[204:207], v[108:111]
s_cmp_eq_u32 s64, -1
s_cbranch_scc1 T_last0
s_bitcmp1_b32 s73, 2
s_cbranch_scc1 T_d_46
s_cmp_eq_u32 s73, 0
s_cbranch_scc1 T_b0_0
s_cmp_eq_u32 s73, 1
s_cbranch_scc1 T_b0_1
s_cmp_eq_u32 s73, 2
s_cbranch_scc1 T_b0_2
s_branch T_b0_3
T_d_46:
s_cmp_eq_u32 s73, 4
s_cbranch_scc1 T_b0_4
s_cmp_eq_u32 s73, 5
s_cbranch_scc1 T_b0_5
s_cmp_eq_u32 s73, 6
s_cbranch_scc1 T_b0_6
s_cmp_eq_u32 s73, 7
s_cbranch_scc1 T_b0_7
s_branch T_n0
T_last1:
s_cmp_eq_u32 s73, 0
s_cbranch_scc1 T_l1_0
s_cmp_eq_u32 s73, 1
s_cbranch_scc1 T_l1_1
s_cmp_eq_u32 s73, 2
s_cbranch_scc1 T_l1_2
s_cmp_eq_u32 s73, 3
s_cbranch_scc1 T_l1_3
s_cmp_eq_u32 s73, 4
s_cbranch_scc1 T_l1_4
s_cmp_eq_u32 s73, 5
s_cbranch_scc1 T_l1_5
s_cmp_eq_u32 s73, 6
s_cbranch_scc1 T_l1_6
s_cmp_eq_u32 s73, 7
s_cbranch_scc1 T_l1_7
s_branch T_done
T_l1_0:
v_mfma_f32_16x16x32_bf16 v[16:19], a[0:3], v[160:163], v[16:19]
v_mfma_f32_16x16x32_bf16 v[20:23], a[0:3], v[164:167], v[20:23]
v_mfma_f32_16x16x32_bf16 v[24:27], a[0:3], v[168:171], v[24:27]
v_mfma_f32_16x16x32_bf16 v[28:31], a[4:7], v[160:163], v[28:31]
v_mfma_f32_16x16x32_bf16 v[32:35], a[4:7], v[164:167], v[32:35]
v_mfma_f32_16x16x32_bf16 v[36:39], a[4:7], v[168:171], v[36:39]
v_mfma_f32_16x16x32_bf16 v[40:43], a[8:11], v[160:163], v[40:43]
v_mfma_f32_16x16x32_bf16 v[44:47], a[8:11], v[164:167], v[44:47]
v_mfma_f32_16x16x32_bf16 v[48:51], a[8:11], v[168:171], v[48:51]
ds_write_b128 v233, v[64:67] offset:12288
v_mfma_f32_16x16x32_bf16 v[52:55], a[12:15], v[160:163], v[52:55]
v_mfma_f32_16x16x32_bf16 v[56:59], a[12:15], v[164:167], v[56:59]
v_mfma_f32_16x16x32_bf16 v[60:63], a[12:15], v[168:171], v[60:63]
ds_write_b128 v233, v[68:71] offset:16384
v_mfma_f32_16x16x32_bf16 v[16:19], a[16:19], v[172:175], v[16:19]
v_mfma_f32_16x16x32_bf16 v[20:23], a[16:19], v[176:179], v[20:23]
v_mfma_f32_16x16x32_bf16 v[24:27], a[16:19], v[180:183], v[24:27]
ds_write_b128 v233, v[72:75] offset:20480
v_mfma_f32_16x16x32_bf16 v[28:31], a[20:23], v[172:175], v[28:31]
v_mfma_f32_16x16x32_bf16 v[32:35], a[20:23], v[176:179], v[32:35]
v_mfma_f32_16x16x32_bf16 v[36:39], a[20:23], v[180:183], v[36:39]
ds_write_b128 v234, v[76:79] offset:12288
v_mfma_f32_16x16x32_bf16 v[40:43], a[24:27], v[172:175], v[40:43]
v_mfma_f32_16x16x32_bf16 v[44:47], a[24:27], v[176:179], v[44:47]
v_mfma_f32_16x16x32_bf16 v[48:51], a[24:27], v[180:183], v[48:51]
ds_write_b128 v234, v[80:83] offset:16384
v_mfma_f32_16x16x32_bf16 v[52:55], a[28:31], v[172:175], v[52:55]
v_mfma_f32_16x16x32_bf16 v[56:59], a[28:31], v[176:179], v[56:59]
v_mfma_f32_16x16x32_bf16 v[60:63], a[28:31], v[180:183], v[60:63]
ds_write_b128 v234, v[84:87] offset:20480
v_mfma_f32_16x16x32_bf16 v[16:19], a[32:35], v[184:187], v[16:19]
v_mfma_f32_16x16x32_bf16 v[20:23], a[32:35], v[188:191], v[20:23]
v_mfma_f32_16x16x32_bf16 v[24:27], a[32:35], v[192:195], v[24:27]
ds_write_b128 v235, v[88:91] offset:12288
v_mfma_f32_16x16x32_bf16 v[28:31], a[36:39], v[184:187], v[28:31]
v_mfma_f32_16x16x32_bf16 v[32:35], a[36:39], v[188:191], v[32:35]
v_mfma_f32_16x16x32_bf16 v[36:39], a[36:39], v[192:195], v[36:39]
ds_write_b128 v235, v[92:95] offset:16384
v_mfma_f32_16x16x32_bf16 v[40:43], a[40:43], v[184:187], v[40:43]
v_mfma_f32_16x16x32_bf16 v[44:47], a[40:43], v[188:191], v[44:47]
v_mfma_f32_16x16x32_bf16 v[48:51], a[40:43], v[192:195], v[48:51]
ds_write_b128 v235, v[96:99] offset:20480
v_mfma_f32_16x16x32_bf16 v[52:55], a[44:47], v[184:187], v[52:55]
v_mfma_f32_16x16x32_bf16 v[56:59], a[44:47], v[188:191], v[56:59]
v_mfma_f32_16x16x32_bf16 v[60:63], a[44:47], v[192:195], v[60:63]
ds_write_b128 v236, v[100:103] offset:12288
v_mfma_f32_16x16x32_bf16 v[16:19], a[48:51], v[196:199], v[16:19]
v_mfma_f32_16x16x32_bf16 v[20:23], a[48:51], v[200:203], v[20:23]
v_mfma_f32_16x16x32_bf16 v[24:27], a[48:51], v[204:207], v[24:27]
ds_write_b128 v236, v[104:107] offset:16384
v_mfma_f32_16x16x32_bf16 v[28:31], a[52:55], v[196:199], v[28:31]
v_mfma_f32_16x16x32_bf16 v[32:35], a[52:55], v[200:203], v[32:35]
v_mfma_f32_16x16x32_bf16 v[36:39], a[52:55], v[204:207], v[36:39]
ds_write_b128 v236, v[108:111] offset:20480
v_mfma_f32_16x16x32_bf16 v[40:43], a[56:59], v[196:199], v[40:43]
v_mfma_f32_16x16x32_bf16 v[44:47], a[56:59], v[200:203], v[44:47]
v_mfma_f32_16x16x32_bf16 v[48:51], a[56:59], v[204:207], v[48:51]
ds_write_b128 v233, v[16:19] offset:0
v_mfma_f32_16x16x32_bf16 v[52:55], a[60:63], v[196:199], v[52:55]
ds_write_b128 v233, v[20:23] offset:4096
v_mfma_f32_16x16x32_bf16 v[56:59], a[60:63], v[200:203], v[56:59]
ds_write_b128 v233, v[24:27] offset:8192
v_mfma_f32_16x16x32_bf16 v[60:63], a[60:63], v[204:207], v[60:63]
ds_write_b128 v234, v[28:31] offset:0
ds_write_b128 v234, v[32:35] offset:4096
ds_write_b128 v234, v[36:39] offset:8192
ds_write_b128 v235, v[40:43] offset:0
ds_write_b128 v235, v[44:47] offset:4096
ds_write_b128 v235, v[48:51] offset:8192
ds_write_b128 v236, v[52:55] offset:0
ds_write_b128 v236, v[56:59] offset:4096
ds_write_b128 v236, v[60:63] offset:8192
s_branch L_ofin2
T_l1_1:
v_mfma_f32_16x16x32_bf16 v[64:67], a[0:3], v[160:163], v[64:67]
v_mfma_f32_16x16x32_bf16 v[68:71], a[0:3], v[164:167], v[68:71]
v_mfma_f32_16x16x32_bf16 v[72:75], a[0:3], v[168:171], v[72:75]
v_mfma_f32_16x16x32_bf16 v[76:79], a[4:7], v[160:163], v[76:79]
v_mfma_f32_16x16x32_bf16 v[80:83], a[4:7], v[164:167], v[80:83]
v_mfma_f32_16x16x32_bf16 v[84:87], a[4:7], v[168:171], v[84:87]
v_mfma_f32_16x16x32_bf16 v[88:91], a[8:11], v[160:163], v[88:91]
v_mfma_f32_16x16x32_bf16 v[92:95], a[8:11], v[164:167], v[92:95]
v_mfma_f32_16x16x32_bf16 v[96:99], a[8:11], v[168:171], v[96:99]
ds_write_b128 v233, v[16:19] offset:0
v_mfma_f32_16x16x32_bf16 v[100:103], a[12:15], v[160:163], v[100:103]
v_mfma_f32_16x16x32_bf16 v[104:107], a[12:15], v[164:167], v[104:107]
v_mfma_f32_16x16x32_bf16 v[108:111], a[12:15], v[168:171], v[108:111]
ds_write_b128 v233, v[20:23] offset:4096
v_mfma_f32_16x16x32_bf16 v[64:67], a[16:19], v[172:175], v[64:67]
v_mfma_f32_16x16x32_bf16 v[68:71], a[16:19], v[176:179], v[68:71]
v_mfma_f32_16x16x32_bf16 v[72:75], a[16:19], v[180:183], v[72:75]
ds_write_b128 v233, v[24:27] offset:8192
v_mfma_f32_16x16x32_bf16 v[76:79], a[20:23], v[172:175], v[76:79]
v_mfma_f32_16x16x32_bf16 v[80:83], a[20:23], v[176:179], v[80:83]
v_mfma_f32_16x16x32_bf16 v[84:87], a[20:23], v[180:183], v[84:87]
ds_write_b128 v234, v[28:31] offset:0
v_mfma_f32_16x16x32_bf16 v[88:91], a[24:27], v[172:175], v[88:91]
v_mfma_f32_16x16x32_bf16 v[92:95], a[24:27], v[176:179], v[92:95]
v_mfma_f32_16x16x32_bf16 v[96:99], a[24:27], v[180:183], v[96:99]
ds_write_b128 v234, v[32:35] offset:4096
v_mfma_f32_16x16x32_bf16 v[100:103], a[28:31], v[172:175], v[100:103]
v_mfma_f32_16x16x32_bf16 v[104:107], a[28:31], v[176:179], v[104:107]
v_mfma_f32_16x16x32_bf16 v[108:111], a[28:31], v[180:183], v[108:111]
ds_write_b128 v234, v[36:39] offset:8192
v_mfma_f32_16x16x32_bf16 v[64:67], a[32:35], v[184:187], v[64:67]
v_mfma_f32_16x16x32_bf16 v[68:71], a[32:35], v[188:191], v[68:71]
v_mfma_f32_16x16x32_bf16 v[72:75], a[32:35], v[192:195], v[72:75]
ds_write_b128 v235, v[40:43] offset:0
v_mfma_f32_16x16x32_bf16 v[76:79], a[36:39], v[184:187], v[76:79]
v_mfma_f32_16x16x32_bf16 v[80:83], a[36:39], v[188:191], v[80:83]
v_mfma_f32_16x16x32_bf16 v[84:87], a[36:39], v[192:195], v[84:87]
ds_write_b128 v235, v[44:47] offset:4096
v_mfma_f32_16x16x32_bf16 v[88:91], a[40:43], v[184:187], v[88:91]
v_mfma_f32_16x16x32_bf16 v[92:95], a[40:43], v[188:191], v[92:95]
v_mfma_f32_16x16x32_bf16 v[96:99], a[40:43], v[192:195], v[96:99]
ds_write_b128 v235, v[48:51] offset:8192
v_mfma_f32_16x16x32_bf16 v[100:103], a[44:47], v[184:187], v[100:103]
v_mfma_f32_16x16x32_bf16 v[104:107], a[44:47], v[188:191], v[104:107]
v_mfma_f32_16x16x32_bf16 v[108:111], a[44:47], v[192:195], v[108:111]
ds_write_b128 v236, v[52:55] offset:0
v_mfma_f32_16x16x32_bf16 v[64:67], a[48:51], v[196:199], v[64:67]
v_mfma_f32_16x16x32_bf16 v[68:71], a[48:51], v[200:203], v[68:71]
v_mfma_f32_16x16x32_bf16 v[72:75], a[48:51], v[204:207], v[72:75]
ds_write_b128 v236, v[56:59] offset:4096
v_mfma_f32_16x16x32_bf16 v[76:79], a[52:55], v[196:199], v[76:79]
v_mfma_f32_16x16x32_bf16 v[80:83], a[52:55], v[200:203], v[80:83]
v_mfma_f32_16x16x32_bf16 v[84:87], a[52:55], v[204:207], v[84:87]
ds_write_b128 v236, v[60:63] offset:8192
v_mfma_f32_16x16x32_bf16 v[88:91], a[56:59], v[196:199], v[88:91]
v_mfma_f32_16x16x32_bf16 v[92:95], a[56:59], v[200:203], v[92:95]
v_mfma_f32_16x16x32_bf16 v[96:99], a[56:59], v[204:207], v[96:99]
ds_write_b128 v233, v[64:67] offset:12288
v_mfma_f32_16x16x32_bf16 v[100:103], a[60:63], v[196:199], v[100:103]
ds_write_b128 v233, v[68:71] offset:16384
v_mfma_f32_16x16x32_bf16 v[104:107], a[60:63], v[200:203], v[104:107]
ds_write_b128 v233, v[72:75] offset:20480
v_mfma_f32_16x16x32_bf16 v[108:111], a[60:63], v[204:207], v[108:111]
ds_write_b128 v234, v[76:79] offset:12288
ds_write_b128 v234, v[80:83] offset:16384
ds_write_b128 v234, v[84:87] offset:20480
ds_write_b128 v235, v[88:91] offset:12288
ds_write_b128 v235, v[92:95] offset:16384
ds_write_b128 v235, v[96:99] offset:20480
ds_write_b128 v236, v[100:103] offset:12288
ds_write_b128 v236, v[104:107] offset:16384
ds_write_b128 v236, v[108:111] offset:20480
s_branch L_ofin2
T_l1_2:
v_mfma_f32_16x16x32_bf16 v[16:19], a[64:67], v[160:163], v[16:19]
v_mfma_f32_16x16x32_bf16 v[20:23], a[64:67], v[164:167], v[20:23]
v_mfma_f32_16x16x32_bf16 v[24:27], a[64:67], v[168:171], v[24:27]
v_mfma_f32_16x16x32_bf16 v[28:31], a[68:71], v[160:163], v[28:31]
v_mfma_f32_16x16x32_bf16 v[32:35], a[68:71], v[164:167], v[32:35]
v_mfma_f32_16x16x32_bf16 v[36:39], a[68:71], v[168:171], v[36:39]
v_mfma_f32_16x16x32_bf16 v[40:43], a[72:75], v[160:163], v[40:43]
v_mfma_f32_16x16x32_bf16 v[44:47], a[72:75], v[164:167], v[44:47]
v_mfma_f32_16x16x32_bf16 v[48:51], a[72:75], v[168:171], v[48:51]
ds_write_b128 v233, v[64:67] offset:12288
v_mfma_f32_16x16x32_bf16 v[52:55], a[76:79], v[160:163], v[52:55]
v_mfma_f32_16x16x32_bf16 v[56:59], a[76:79], v[164:167], v[56:59]
v_mfma_f32_16x16x32_bf16 v[60:63], a[76:79], v[168:171], v[60:63]
ds_write_b128 v233, v[68:71] offset:16384
v_mfma_f32_16x16x32_bf16 v[16:19], a[80:83], v[172:175], v[16:19]
v_mfma_f32_16x16x32_bf16 v[20:23], a[80:83], v[176:179], v[20:23]
v_mfma_f32_16x16x32_bf16 v[24:27], a[80:83], v[180:183], v[24:27]
ds_write_b128 v233, v[72:75] offset:20480
v_mfma_f32_16x16x32_bf16 v[28:31], a[84:87], v[172:175], v[28:31]
v_mfma_f32_16x16x32_bf16 v[32:35], a[84:87], v[176:179], v[32:35]
v_mfma_f32_16x16x32_bf16 v[36:39], a[84:87], v[180:183], v[36:39]
ds_write_b128 v234, v[76:79] offset:12288
v_mfma_f32_16x16x32_bf16 v[40:43], a[88:91], v[172:175], v[40:43]
v_mfma_f32_16x16x32_bf16 v[44:47], a[88:91], v[176:179], v[44:47]
v_mfma_f32_16x16x32_bf16 v[48:51], a[88:91], v[180:183], v[48:51]
ds_write_b128 v234, v[80:83] offset:16384
v_mfma_f32_16x16x32_bf16 v[52:55], a[92:95], v[172:175], v[52:55]
v_mfma_f32_16x16x32_bf16 v[56:59], a[92:95], v[176:179], v[56:59]
v_mfma_f32_16x16x32_bf16 v[60:63], a[92:95], v[180:183], v[60:63]
ds_write_b128 v234, v[84:87] offset:20480
v_mfma_f32_16x16x32_bf16 v[16:19], a[96:99], v[184:187], v[16:19]
v_mfma_f32_16x16x32_bf16 v[20:23], a[96:99], v[188:191], v[20:23]
v_mfma_f32_16x16x32_bf16 v[24:27], a[96:99], v[192:195], v[24:27]
ds_write_b128 v235, v[88:91] offset:12288
v_mfma_f32_16x16x32_bf16 v[28:31], a[100:103], v[184:187], v[28:31]
v_mfma_f32_16x16x32_bf16 v[32:35], a[100:103], v[188:191], v[32:35]
v_mfma_f32_16x16x32_bf16 v[36:39], a[100:103], v[192:195], v[36:39]
ds_write_b128 v235, v[92:95] offset:16384
v_mfma_f32_16x16x32_bf16 v[40:43], a[104:107], v[184:187], v[40:43]
v_mfma_f32_16x16x32_bf16 v[44:47], a[104:107], v[188:191], v[44:47]
v_mfma_f32_16x16x32_bf16 v[48:51], a[104:107], v[192:195], v[48:51]
ds_write_b128 v235, v[96:99] offset:20480
v_mfma_f32_16x16x32_bf16 v[52:55], a[108:111], v[184:187], v[52:55]
v_mfma_f32_16x16x32_bf16 v[56:59], a[108:111], v[188:191], v[56:59]
v_mfma_f32_16x16x32_bf16 v[60:63], a[108:111], v[192:195], v[60:63]
ds_write_b128 v236, v[100:103] offset:12288
v_mfma_f32_16x16x32_bf16 v[16:19], a[112:115], v[196:199], v[16:19]
v_mfma_f32_16x16x32_bf16 v[20:23], a[112:115], v[200:203], v[20:23]
v_mfma_f32_16x16x32_bf16 v[24:27], a[112:115], v[204:207], v[24:27]
ds_write_b128 v236, v[104:107] offset:16384
v_mfma_f32_16x16x32_bf16 v[28:31], a[116:119], v[196:199], v[28:31]
v_mfma_f32_16x16x32_bf16 v[32:35], a[116:119], v[200:203], v[32:35]
v_mfma_f32_16x16x32_bf16 v[36:39], a[116:119], v[204:207], v[36:39]
ds_write_b128 v236, v[108:111] offset:20480
v_mfma_f32_16x16x32_bf16 v[40:43], a[120:123], v[196:199], v[40:43]
v_mfma_f32_16x16x32_bf16 v[44:47], a[120:123], v[200:203], v[44:47]
v_mfma_f32_16x16x32_bf16 v[48:51], a[120:123], v[204:207], v[48:51]
ds_write_b128 v233, v[16:19] offset:0
v_mfma_f32_16x16x32_bf16 v[52:55], a[124:127], v[196:199], v[52:55]
ds_write_b128 v233, v[20:23] offset:4096
v_mfma_f32_16x16x32_bf16 v[56:59], a[124:127], v[200:203], v[56:59]
ds_write_b128 v233, v[24:27] offset:8192
v_mfma_f32_16x16x32_bf16 v[60:63], a[124:127], v[204:207], v[60:63]
ds_write_b128 v234, v[28:31] offset:0
ds_write_b128 v234, v[32:35] offset:4096
ds_write_b128 v234, v[36:39] offset:8192
ds_write_b128 v235, v[40:43] offset:0
ds_write_b128 v235, v[44:47] offset:4096
ds_write_b128 v235, v[48:51] offset:8192
ds_write_b128 v236, v[52:55] offset:0
ds_write_b128 v236, v[56:59] offset:4096
ds_write_b128 v236, v[60:63] offset:8192
s_branch L_ofin2
T_l1_3:
v_mfma_f32_16x16x32_bf16 v[64:67], a[64:67], v[160:163], v[64:67]
v_mfma_f32_16x16x32_bf16 v[68:71], a[64:67], v[164:167], v[68:71]
v_mfma_f32_16x16x32_bf16 v[72:75], a[64:67], v[168:171], v[72:75]
v_mfma_f32_16x16x32_bf16 v[76:79], a[68:71], v[160:163], v[76:79]
v_mfma_f32_16x16x32_bf16 v[80:83], a[68:71], v[164:167], v[80:83]
v_mfma_f32_16x16x32_bf16 v[84:87], a[68:71], v[168:171], v[84:87]
v_mfma_f32_16x16x32_bf16 v[88:91], a[72:75], v[160:163], v[88:91]
v_mfma_f32_16x16x32_bf16 v[92:95], a[72:75], v[164:167], v[92:95]
v_mfma_f32_16x16x32_bf16 v[96:99], a[72:75], v[168:171], v[96:99]
ds_write_b128 v233, v[16:19] offset:0
v_mfma_f32_16x16x32_bf16 v[100:103], a[76:79], v[160:163], v[100:103]
v_mfma_f32_16x16x32_bf16 v[104:107], a[76:79], v[164:167], v[104:107]
v_mfma_f32_16x16x32_bf16 v[108:111], a[76:79], v[168:171], v[108:111]
ds_write_b128 v233, v[20:23] offset:4096
v_mfma_f32_16x16x32_bf16 v[64:67], a[80:83], v[172:175], v[64:67]
v_mfma_f32_16x16x32_bf16 v[68:71], a[80:83], v[176:179], v[68:71]
v_mfma_f32_16x16x32_bf16 v[72:75], a[80:83], v[180:183], v[72:75]
ds_write_b128 v233, v[24:27] offset:8192
v_mfma_f32_16x16x32_bf16 v[76:79], a[84:87], v[172:175], v[76:79]
v_mfma_f32_16x16x32_bf16 v[80:83], a[84:87], v[176:179], v[80:83]
v_mfma_f32_16x16x32_bf16 v[84:87], a[84:87], v[180:183], v[84:87]
ds_write_b128 v234, v[28:31] offset:0
v_mfma_f32_16x16x32_bf16 v[88:91], a[88:91], v[172:175], v[88:91]
v_mfma_f32_16x16x32_bf16 v[92:95], a[88:91], v[176:179], v[92:95]
v_mfma_f32_16x16x32_bf16 v[96:99], a[88:91], v[180:183], v[96:99]
ds_write_b128 v234, v[32:35] offset:4096
v_mfma_f32_16x16x32_bf16 v[100:103], a[92:95], v[172:175], v[100:103]
v_mfma_f32_16x16x32_bf16 v[104:107], a[92:95], v[176:179], v[104:107]
v_mfma_f32_16x16x32_bf16 v[108:111], a[92:95], v[180:183], v[108:111]
ds_write_b128 v234, v[36:39] offset:8192
v_mfma_f32_16x16x32_bf16 v[64:67], a[96:99], v[184:187], v[64:67]
v_mfma_f32_16x16x32_bf16 v[68:71], a[96:99], v[188:191], v[68:71]
v_mfma_f32_16x16x32_bf16 v[72:75], a[96:99], v[192:195], v[72:75]
ds_write_b128 v235, v[40:43] offset:0
v_mfma_f32_16x16x32_bf16 v[76:79], a[100:103], v[184:187], v[76:79]
v_mfma_f32_16x16x32_bf16 v[80:83], a[100:103], v[188:191], v[80:83]
v_mfma_f32_16x16x32_bf16 v[84:87], a[100:103], v[192:195], v[84:87]
ds_write_b128 v235, v[44:47] offset:4096
v_mfma_f32_16x16x32_bf16 v[88:91], a[104:107], v[184:187], v[88:91]
v_mfma_f32_16x16x32_bf16 v[92:95], a[104:107], v[188:191], v[92:95]
v_mfma_f32_16x16x32_bf16 v[96:99], a[104:107], v[192:195], v[96:99]
ds_write_b128 v235, v[48:51] offset:8192
v_mfma_f32_16x16x32_bf16 v[100:103], a[108:111], v[184:187], v[100:103]
v_mfma_f32_16x16x32_bf16 v[104:107], a[108:111], v[188:191], v[104:107]
v_mfma_f32_16x16x32_bf16 v[108:111], a[108:111], v[192:195], v[108:111]
ds_write_b128 v236, v[52:55] offset:0
v_mfma_f32_16x16x32_bf16 v[64:67], a[112:115], v[196:199], v[64:67]
v_mfma_f32_16x16x32_bf16 v[68:71], a[112:115], v[200:203], v[68:71]
v_mfma_f32_16x16x32_bf16 v[72:75], a[112:115], v[204:207], v[72:75]
ds_write_b128 v236, v[56:59] offset:4096
v_mfma_f32_16x16x32_bf16 v[76:79], a[116:119], v[196:199], v[76:79]
v_mfma_f32_16x16x32_bf16 v[80:83], a[116:119], v[200:203], v[80:83]
v_mfma_f32_16x16x32_bf16 v[84:87], a[116:119], v[204:207], v[84:87]
ds_write_b128 v236, v[60:63] offset:8192
v_mfma_f32_16x16x32_bf16 v[88:91], a[120:123], v[196:199], v[88:91]
v_mfma_f32_16x16x32_bf16 v[92:95], a[120:123], v[200:203], v[92:95]
v_mfma_f32_16x16x32_bf16 v[96:99], a[120:123], v[204:207], v[96:99]
ds_write_b128 v233, v[64:67] offset:12288
v_mfma_f32_16x16x32_bf16 v[100:103], a[124:127], v[196:199], v[100:103]
ds_write_b128 v233, v[68:71] offset:16384
v_mfma_f32_16x16x32_bf16 v[104:107], a[124:127], v[200:203], v[104:107]
ds_write_b128 v233, v[72:75] offset:20480
v_mfma_f32_16x16x32_bf16 v[108:111], a[124:127], v[204:207], v[108:111]
ds_write_b128 v234, v[76:79] offset:12288
ds_write_b128 v234, v[80:83] offset:16384
ds_write_b128 v234, v[84:87] offset:20480
ds_write_b128 v235, v[88:91] offset:12288
ds_write_b128 v235, v[92:95] offset:16384
ds_write_b128 v235, v[96:99] offset:20480
ds_write_b128 v236, v[100:103] offset:12288
ds_write_b128 v236, v[104:107] offset:16384
ds_write_b128 v236, v[108:111] offset:20480
s_branch L_ofin2
T_l1_4:
v_mfma_f32_16x16x32_bf16 v[16:19], a[128:131], v[160:163], v[16:19]
v_mfma_f32_16x16x32_bf16 v[20:23], a[128:131], v[164:167], v[20:23]
v_mfma_f32_16x16x32_bf16 v[24:27], a[128:131], v[168:171], v[24:27]
v_mfma_f32_16x16x32_bf16 v[28:31], a[132:135], v[160:163], v[28:31]
v_mfma_f32_16x16x32_bf16 v[32:35], a[132:135], v[164:167], v[32:35]
v_mfma_f32_16x16x32_bf16 v[36:39], a[132:135], v[168:171], v[36:39]
v_mfma_f32_16x16x32_bf16 v[40:43], a[136:139], v[160:163], v[40:43]
v_mfma_f32_16x16x32_bf16 v[44:47], a[136:139], v[164:167], v[44:47]
v_mfma_f32_16x16x32_bf16 v[48:51], a[136:139], v[168:171], v[48:51]
ds_write_b128 v233, v[64:67] offset:12288
v_mfma_f32_16x16x32_bf16 v[52:55], a[140:143], v[160:163], v[52:55]
v_mfma_f32_16x16x32_bf16 v[56:59], a[140:143], v[164:167], v[56:59]
v_mfma_f32_16x16x32_bf16 v[60:63], a[140:143], v[168:171], v[60:63]
ds_write_b128 v233, v[68:71] offset:16384
v_mfma_f32_16x16x32_bf16 v[16:19], a[144:147], v[172:175], v[16:19]
v_mfma_f32_16x16x32_bf16 v[20:23], a[144:147], v[176:179], v[20:23]
v_mfma_f32_16x16x32_bf16 v[24:27], a[144:147], v[180:183], v[24:27]
ds_write_b128 v233, v[72:75] offset:20480
v_mfma_f32_16x16x32_bf16 v[28:31], a[148:151], v[172:175], v[28:31]
v_mfma_f32_16x16x32_bf16 v[32:35], a[148:151], v[176:179], v[32:35]
v_mfma_f32_16x16x32_bf16 v[36:39], a[148:151], v[180:183], v[36:39]
ds_write_b128 v234, v[76:79] offset:12288
v_mfma_f32_16x16x32_bf16 v[40:43], a[152:155], v[172:175], v[40:43]
v_mfma_f32_16x16x32_bf16 v[44:47], a[152:155], v[176:179], v[44:47]
v_mfma_f32_16x16x32_bf16 v[48:51], a[152:155], v[180:183], v[48:51]
ds_write_b128 v234, v[80:83] offset:16384
v_mfma_f32_16x16x32_bf16 v[52:55], a[156:159], v[172:175], v[52:55]
v_mfma_f32_16x16x32_bf16 v[56:59], a[156:159], v[176:179], v[56:59]
v_mfma_f32_16x16x32_bf16 v[60:63], a[156:159], v[180:183], v[60:63]
ds_write_b128 v234, v[84:87] offset:20480
v_mfma_f32_16x16x32_bf16 v[16:19], a[160:163], v[184:187], v[16:19]
v_mfma_f32_16x16x32_bf16 v[20:23], a[160:163], v[188:191], v[20:23]
v_mfma_f32_16x16x32_bf16 v[24:27], a[160:163], v[192:195], v[24:27]
ds_write_b128 v235, v[88:91] offset:12288
v_mfma_f32_16x16x32_bf16 v[28:31], a[164:167], v[184:187], v[28:31]
v_mfma_f32_16x16x32_bf16 v[32:35], a[164:167], v[188:191], v[32:35]
v_mfma_f32_16x16x32_bf16 v[36:39], a[164:167], v[192:195], v[36:39]
ds_write_b128 v235, v[92:95] offset:16384
v_mfma_f32_16x16x32_bf16 v[40:43], a[168:171], v[184:187], v[40:43]
v_mfma_f32_16x16x32_bf16 v[44:47], a[168:171], v[188:191], v[44:47]
v_mfma_f32_16x16x32_bf16 v[48:51], a[168:171], v[192:195], v[48:51]
ds_write_b128 v235, v[96:99] offset:20480
v_mfma_f32_16x16x32_bf16 v[52:55], a[172:175], v[184:187], v[52:55]
v_mfma_f32_16x16x32_bf16 v[56:59], a[172:175], v[188:191], v[56:59]
v_mfma_f32_16x16x32_bf16 v[60:63], a[172:175], v[192:195], v[60:63]
ds_write_b128 v236, v[100:103] offset:12288
v_mfma_f32_16x16x32_bf16 v[16:19], a[176:179], v[196:199], v[16:19]
v_mfma_f32_16x16x32_bf16 v[20:23], a[176:179], v[200:203], v[20:23]
v_mfma_f32_16x16x32_bf16 v[24:27], a[176:179], v[204:207], v[24:27]
ds_write_b128 v236, v[104:107] offset:16384
v_mfma_f32_16x16x32_bf16 v[28:31], a[180:183], v[196:199], v[28:31]
v_mfma_f32_16x16x32_bf16 v[32:35], a[180:183], v[200:203], v[32:35]
v_mfma_f32_16x16x32_bf16 v[36:39], a[180:183], v[204:207], v[36:39]
ds_write_b128 v236, v[108:111] offset:20480
v_mfma_f32_16x16x32_bf16 v[40:43], a[184:187], v[196:199], v[40:43]
v_mfma_f32_16x16x32_bf16 v[44:47], a[184:187], v[200:203], v[44:47]
v_mfma_f32_16x16x32_bf16 v[48:51], a[184:187], v[204:207], v[48:51]
ds_write_b128 v233, v[16:19] offset:0
v_mfma_f32_16x16x32_bf16 v[52:55], a[188:191], v[196:199], v[52:55]
ds_write_b128 v233, v[20:23] offset:4096
v_mfma_f32_16x16x32_bf16 v[56:59], a[188:191], v[200:203], v[56:59]
ds_write_b128 v233, v[24:27] offset:8192
v_mfma_f32_16x16x32_bf16 v[60:63], a[188:191], v[204:207], v[60:63]
ds_write_b128 v234, v[28:31] offset:0
ds_write_b128 v234, v[32:35] offset:4096
ds_write_b128 v234, v[36:39] offset:8192
ds_write_b128 v235, v[40:43] offset:0
ds_write_b128 v235, v[44:47] offset:4096
ds_write_b128 v235, v[48:51] offset:8192
ds_write_b128 v236, v[52:55] offset:0
ds_write_b128 v236, v[56:59] offset:4096
ds_write_b128 v236, v[60:63] offset:8192
s_branch L_ofin2
T_l1_5:
v_mfma_f32_16x16x32_bf16 v[64:67], a[128:131], v[160:163], v[64:67]
v_mfma_f32_16x16x32_bf16 v[68:71], a[128:131], v[164:167], v[68:71]
v_mfma_f32_16x16x32_bf16 v[72:75], a[128:131], v[168:171], v[72:75]
v_mfma_f32_16x16x32_bf16 v[76:79], a[132:135], v[160:163], v[76:79]
v_mfma_f32_16x16x32_bf16 v[80:83], a[132:135], v[164:167], v[80:83]
v_mfma_f32_16x16x32_bf16 v[84:87], a[132:135], v[168:171], v[84:87]
v_mfma_f32_16x16x32_bf16 v[88:91], a[136:139], v[160:163], v[88:91]
v_mfma_f32_16x16x32_bf16 v[92:95], a[136:139], v[164:167], v[92:95]
v_mfma_f32_16x16x32_bf16 v[96:99], a[136:139], v[168:171], v[96:99]
ds_write_b128 v233, v[16:19] offset:0
v_mfma_f32_16x16x32_bf16 v[100:103], a[140:143], v[160:163], v[100:103]
v_mfma_f32_16x16x32_bf16 v[104:107], a[140:143], v[164:167], v[104:107]
v_mfma_f32_16x16x32_bf16 v[108:111], a[140:143], v[168:171], v[108:111]
ds_write_b128 v233, v[20:23] offset:4096
v_mfma_f32_16x16x32_bf16 v[64:67], a[144:147], v[172:175], v[64:67]
v_mfma_f32_16x16x32_bf16 v[68:71], a[144:147], v[176:179], v[68:71]
v_mfma_f32_16x16x32_bf16 v[72:75], a[144:147], v[180:183], v[72:75]
ds_write_b128 v233, v[24:27] offset:8192
v_mfma_f32_16x16x32_bf16 v[76:79], a[148:151], v[172:175], v[76:79]
v_mfma_f32_16x16x32_bf16 v[80:83], a[148:151], v[176:179], v[80:83]
v_mfma_f32_16x16x32_bf16 v[84:87], a[148:151], v[180:183], v[84:87]
ds_write_b128 v234, v[28:31] offset:0
v_mfma_f32_16x16x32_bf16 v[88:91], a[152:155], v[172:175], v[88:91]
v_mfma_f32_16x16x32_bf16 v[92:95], a[152:155], v[176:179], v[92:95]
v_mfma_f32_16x16x32_bf16 v[96:99], a[152:155], v[180:183], v[96:99]
ds_write_b128 v234, v[32:35] offset:4096
v_mfma_f32_16x16x32_bf16 v[100:103], a[156:159], v[172:175], v[100:103]
v_mfma_f32_16x16x32_bf16 v[104:107], a[156:159], v[176:179], v[104:107]
v_mfma_f32_16x16x32_bf16 v[108:111], a[156:159], v[180:183], v[108:111]
ds_write_b128 v234, v[36:39] offset:8192
v_mfma_f32_16x16x32_bf16 v[64:67], a[160:163], v[184:187], v[64:67]
v_mfma_f32_16x16x32_bf16 v[68:71], a[160:163], v[188:191], v[68:71]
v_mfma_f32_16x16x32_bf16 v[72:75], a[160:163], v[192:195], v[72:75]
ds_write_b128 v235, v[40:43] offset:0
v_mfma_f32_16x16x32_bf16 v[76:79], a[164:167], v[184:187], v[76:79]
v_mfma_f32_16x16x32_bf16 v[80:83], a[164:167], v[188:191], v[80:83]
v_mfma_f32_16x16x32_bf16 v[84:87], a[164:167], v[192:195], v[84:87]
ds_write_b128 v235, v[44:47] offset:4096
v_mfma_f32_16x16x32_bf16 v[88:91], a[168:171], v[184:187], v[88:91]
v_mfma_f32_16x16x32_bf16 v[92:95], a[168:171], v[188:191], v[92:95]
v_mfma_f32_16x16x32_bf16 v[96:99], a[168:171], v[192:195], v[96:99]
ds_write_b128 v235, v[48:51] offset:8192
v_mfma_f32_16x16x32_bf16 v[100:103], a[172:175], v[184:187], v[100:103]
v_mfma_f32_16x16x32_bf16 v[104:107], a[172:175], v[188:191], v[104:107]
v_mfma_f32_16x16x32_bf16 v[108:111], a[172:175], v[192:195], v[108:111]
ds_write_b128 v236, v[52:55] offset:0
v_mfma_f32_16x16x32_bf16 v[64:67], a[176:179], v[196:199], v[64:67]
v_mfma_f32_16x16x32_bf16 v[68:71], a[176:179], v[200:203], v[68:71]
v_mfma_f32_16x16x32_bf16 v[72:75], a[176:179], v[204:207], v[72:75]
ds_write_b128 v236, v[56:59] offset:4096
v_mfma_f32_16x16x32_bf16 v[76:79], a[180:183], v[196:199], v[76:79]
v_mfma_f32_16x16x32_bf16 v[80:83], a[180:183], v[200:203], v[80:83]
v_mfma_f32_16x16x32_bf16 v[84:87], a[180:183], v[204:207], v[84:87]
ds_write_b128 v236, v[60:63] offset:8192
v_mfma_f32_16x16x32_bf16 v[88:91], a[184:187], v[196:199], v[88:91]
v_mfma_f32_16x16x32_bf16 v[92:95], a[184:187], v[200:203], v[92:95]
v_mfma_f32_16x16x32_bf16 v[96:99], a[184:187], v[204:207], v[96:99]
ds_write_b128 v233, v[64:67] offset:12288
v_mfma_f32_16x16x32_bf16 v[100:103], a[188:191], v[196:199], v[100:103]
ds_write_b128 v233, v[68:71] offset:16384
v_mfma_f32_16x16x32_bf16 v[104:107], a[188:191], v[200:203], v[104:107]
ds_write_b128 v233, v[72:75] offset:20480
v_mfma_f32_16x16x32_bf16 v[108:111], a[188:191], v[204:207], v[108:111]
ds_write_b128 v234, v[76:79] offset:12288
ds_write_b128 v234, v[80:83] offset:16384
ds_write_b128 v234, v[84:87] offset:20480
ds_write_b128 v235, v[88:91] offset:12288
ds_write_b128 v235, v[92:95] offset:16384
ds_write_b128 v235, v[96:99] offset:20480
ds_write_b128 v236, v[100:103] offset:12288
ds_write_b128 v236, v[104:107] offset:16384
ds_write_b128 v236, v[108:111] offset:20480
s_branch L_ofin2
T_l1_6:
v_mfma_f32_16x16x32_bf16 v[16:19], a[192:195], v[160:163], v[16:19]
v_mfma_f32_16x16x32_bf16 v[20:23], a[192:195], v[164:167], v[20:23]
v_mfma_f32_16x16x32_bf16 v[24:27], a[192:195], v[168:171], v[24:27]
v_mfma_f32_16x16x32_bf16 v[28:31], a[196:199], v[160:163], v[28:31]
v_mfma_f32_16x16x32_bf16 v[32:35], a[196:199], v[164:167], v[32:35]
v_mfma_f32_16x16x32_bf16 v[36:39], a[196:199], v[168:171], v[36:39]
v_mfma_f32_16x16x32_bf16 v[40:43], a[200:203], v[160:163], v[40:43]
v_mfma_f32_16x16x32_bf16 v[44:47], a[200:203], v[164:167], v[44:47]
v_mfma_f32_16x16x32_bf16 v[48:51], a[200:203], v[168:171], v[48:51]
ds_write_b128 v233, v[64:67] offset:12288
v_mfma_f32_16x16x32_bf16 v[52:55], a[204:207], v[160:163], v[52:55]
v_mfma_f32_16x16x32_bf16 v[56:59], a[204:207], v[164:167], v[56:59]
v_mfma_f32_16x16x32_bf16 v[60:63], a[204:207], v[168:171], v[60:63]
ds_write_b128 v233, v[68:71] offset:16384
v_mfma_f32_16x16x32_bf16 v[16:19], a[208:211], v[172:175], v[16:19]
v_mfma_f32_16x16x32_bf16 v[20:23], a[208:211], v[176:179], v[20:23]
v_mfma_f32_16x16x32_bf16 v[24:27], a[208:211], v[180:183], v[24:27]
ds_write_b128 v233, v[72:75] offset:20480
v_mfma_f32_16x16x32_bf16 v[28:31], a[212:215], v[172:175], v[28:31]
v_mfma_f32_16x16x32_bf16 v[32:35], a[212:215], v[176:179], v[32:35]
v_mfma_f32_16x16x32_bf16 v[36:39], a[212:215], v[180:183], v[36:39]
ds_write_b128 v234, v[76:79] offset:12288
v_mfma_f32_16x16x32_bf16 v[40:43], a[216:219], v[172:175], v[40:43]
v_mfma_f32_16x16x32_bf16 v[44:47], a[216:219], v[176:179], v[44:47]
v_mfma_f32_16x16x32_bf16 v[48:51], a[216:219], v[180:183], v[48:51]
ds_write_b128 v234, v[80:83] offset:16384
v_mfma_f32_16x16x32_bf16 v[52:55], a[220:223], v[172:175], v[52:55]
v_mfma_f32_16x16x32_bf16 v[56:59], a[220:223], v[176:179], v[56:59]
v_mfma_f32_16x16x32_bf16 v[60:63], a[220:223], v[180:183], v[60:63]
ds_write_b128 v234, v[84:87] offset:20480
v_mfma_f32_16x16x32_bf16 v[16:19], a[224:227], v[184:187], v[16:19]
v_mfma_f32_16x16x32_bf16 v[20:23], a[224:227], v[188:191], v[20:23]
v_mfma_f32_16x16x32_bf16 v[24:27], a[224:227], v[192:195], v[24:27]
ds_write_b128 v235, v[88:91] offset:12288
v_mfma_f32_16x16x32_bf16 v[28:31], a[228:231], v[184:187], v[28:31]
v_mfma_f32_16x16x32_bf16 v[32:35], a[228:231], v[188:191], v[32:35]
v_mfma_f32_16x16x32_bf16 v[36:39], a[228:231], v[192:195], v[36:39]
ds_write_b128 v235, v[92:95] offset:16384
v_mfma_f32_16x16x32_bf16 v[40:43], a[232:235], v[184:187], v[40:43]
v_mfma_f32_16x16x32_bf16 v[44:47], a[232:235], v[188:191], v[44:47]
v_mfma_f32_16x16x32_bf16 v[48:51], a[232:235], v[192:195], v[48:51]
ds_write_b128 v235, v[96:99] offset:20480
v_mfma_f32_16x16x32_bf16 v[52:55], a[236:239], v[184:187], v[52:55]
v_mfma_f32_16x16x32_bf16 v[56:59], a[236:239], v[188:191], v[56:59]
v_mfma_f32_16x16x32_bf16 v[60:63], a[236:239], v[192:195], v[60:63]
ds_write_b128 v236, v[100:103] offset:12288
v_mfma_f32_16x16x32_bf16 v[16:19], a[240:243], v[196:199], v[16:19]
v_mfma_f32_16x16x32_bf16 v[20:23], a[240:243], v[200:203], v[20:23]
v_mfma_f32_16x16x32_bf16 v[24:27], a[240:243], v[204:207], v[24:27]
ds_write_b128 v236, v[104:107] offset:16384
v_mfma_f32_16x16x32_bf16 v[28:31], a[244:247], v[196:199], v[28:31]
v_mfma_f32_16x16x32_bf16 v[32:35], a[244:247], v[200:203], v[32:35]
v_mfma_f32_16x16x32_bf16 v[36:39], a[244:247], v[204:207], v[36:39]
ds_write_b128 v236, v[108:111] offset:20480
v_mfma_f32_16x16x32_bf16 v[40:43], a[248:251], v[196:199], v[40:43]
v_mfma_f32_16x16x32_bf16 v[44:47], a[248:251], v[200:203], v[44:47]
v_mfma_f32_16x16x32_bf16 v[48:51], a[248:251], v[204:207], v[48:51]
ds_write_b128 v233, v[16:19] offset:0
v_mfma_f32_16x16x32_bf16 v[52:55], a[252:255], v[196:199], v[52:55]
ds_write_b128 v233, v[20:23] offset:4096
v_mfma_f32_16x16x32_bf16 v[56:59], a[252:255], v[200:203], v[56:59]
ds_write_b128 v233, v[24:27] offset:8192
v_mfma_f32_16x16x32_bf16 v[60:63], a[252:255], v[204:207], v[60:63]
ds_write_b128 v234, v[28:31] offset:0
ds_write_b128 v234, v[32:35] offset:4096
ds_write_b128 v234, v[36:39] offset:8192
ds_write_b128 v235, v[40:43] offset:0
ds_write_b128 v235, v[44:47] offset:4096
ds_write_b128 v235, v[48:51] offset:8192
ds_write_b128 v236, v[52:55] offset:0
ds_write_b128 v236, v[56:59] offset:4096
ds_write_b128 v236, v[60:63] offset:8192
s_branch L_ofin2
T_l1_7:
v_mfma_f32_16x16x32_bf16 v[64:67], a[192:195], v[160:163], v[64:67]
v_mfma_f32_16x16x32_bf16 v[68:71], a[192:195], v[164:167], v[68:71]
v_mfma_f32_16x16x32_bf16 v[72:75], a[192:195], v[168:171], v[72:75]
v_mfma_f32_16x16x32_bf16 v[76:79], a[196:199], v[160:163], v[76:79]
v_mfma_f32_16x16x32_bf16 v[80:83], a[196:199], v[164:167], v[80:83]
v_mfma_f32_16x16x32_bf16 v[84:87], a[196:199], v[168:171], v[84:87]
v_mfma_f32_16x16x32_bf16 v[88:91], a[200:203], v[160:163], v[88:91]
v_mfma_f32_16x16x32_bf16 v[92:95], a[200:203], v[164:167], v[92:95]
v_mfma_f32_16x16x32_bf16 v[96:99], a[200:203], v[168:171], v[96:99]
ds_write_b128 v233, v[16:19] offset:0
v_mfma_f32_16x16x32_bf16 v[100:103], a[204:207], v[160:163], v[100:103]
v_mfma_f32_16x16x32_bf16 v[104:107], a[204:207], v[164:167], v[104:107]
v_mfma_f32_16x16x32_bf16 v[108:111], a[204:207], v[168:171], v[108:111]
ds_write_b128 v233, v[20:23] offset:4096
v_mfma_f32_16x16x32_bf16 v[64:67], a[208:211], v[172:175], v[64:67]
v_mfma_f32_16x16x32_bf16 v[68:71], a[208:211], v[176:179], v[68:71]
v_mfma_f32_16x16x32_bf16 v[72:75], a[208:211], v[180:183], v[72:75]
ds_write_b128 v233, v[24:27] offset:8192
v_mfma_f32_16x16x32_bf16 v[76:79], a[212:215], v[172:175], v[76:79]
v_mfma_f32_16x16x32_bf16 v[80:83], a[212:215], v[176:179], v[80:83]
v_mfma_f32_16x16x32_bf16 v[84:87], a[212:215], v[180:183], v[84:87]
ds_write_b128 v234, v[28:31] offset:0
v_mfma_f32_16x16x32_bf16 v[88:91], a[216:219], v[172:175], v[88:91]
v_mfma_f32_16x16x32_bf16 v[92:95], a[216:219], v[176:179], v[92:95]
v_mfma_f32_16x16x32_bf16 v[96:99], a[216:219], v[180:183], v[96:99]
ds_write_b128 v234, v[32:35] offset:4096
v_mfma_f32_16x16x32_bf16 v[100:103], a[220:223], v[172:175], v[100:103]
v_mfma_f32_16x16x32_bf16 v[104:107], a[220:223], v[176:179], v[104:107]
v_mfma_f32_16x16x32_bf16 v[108:111], a[220:223], v[180:183], v[108:111]
ds_write_b128 v234, v[36:39] offset:8192
v_mfma_f32_16x16x32_bf16 v[64:67], a[224:227], v[184:187], v[64:67]
v_mfma_f32_16x16x32_bf16 v[68:71], a[224:227], v[188:191], v[68:71]
v_mfma_f32_16x16x32_bf16 v[72:75], a[224:227], v[192:195], v[72:75]
ds_write_b128 v235, v[40:43] offset:0
v_mfma_f32_16x16x32_bf16 v[76:79], a[228:231], v[184:187], v[76:79]
v_mfma_f32_16x16x32_bf16 v[80:83], a[228:231], v[188:191], v[80:83]
v_mfma_f32_16x16x32_bf16 v[84:87], a[228:231], v[192:195], v[84:87]
ds_write_b128 v235, v[44:47] offset:4096
v_mfma_f32_16x16x32_bf16 v[88:91], a[232:235], v[184:187], v[88:91]
v_mfma_f32_16x16x32_bf16 v[92:95], a[232:235], v[188:191], v[92:95]
v_mfma_f32_16x16x32_bf16 v[96:99], a[232:235], v[192:195], v[96:99]
ds_write_b128 v235, v[48:51] offset:8192
v_mfma_f32_16x16x32_bf16 v[100:103], a[236:239], v[184:187], v[100:103]
v_mfma_f32_16x16x32_bf16 v[104:107], a[236:239], v[188:191], v[104:107]
v_mfma_f32_16x16x32_bf16 v[108:111], a[236:239], v[192:195], v[108:111]
ds_write_b128 v236, v[52:55] offset:0
v_mfma_f32_16x16x32_bf16 v[64:67], a[240:243], v[196:199], v[64:67]
v_mfma_f32_16x16x32_bf16 v[68:71], a[240:243], v[200:203], v[68:71]
v_mfma_f32_16x16x32_bf16 v[72:75], a[240:243], v[204:207], v[72:75]
ds_write_b128 v236, v[56:59] offset:4096
v_mfma_f32_16x16x32_bf16 v[76:79], a[244:247], v[196:199], v[76:79]
v_mfma_f32_16x16x32_bf16 v[80:83], a[244:247], v[200:203], v[80:83]
v_mfma_f32_16x16x32_bf16 v[84:87], a[244:247], v[204:207], v[84:87]
ds_write_b128 v236, v[60:63] offset:8192
v_mfma_f32_16x16x32_bf16 v[88:91], a[248:251], v[196:199], v[88:91]
v_mfma_f32_16x16x32_bf16 v[92:95], a[248:251], v[200:203], v[92:95]
v_mfma_f32_16x16x32_bf16 v[96:99], a[248:251], v[204:207], v[96:99]
ds_write_b128 v233, v[64:67] offset:12288
v_mfma_f32_16x16x32_bf16 v[100:103], a[252:255], v[196:199], v[100:103]
ds_write_b128 v233, v[68:71] offset:16384
v_mfma_f32_16x16x32_bf16 v[104:107], a[252:255], v[200:203], v[104:107]
ds_write_b128 v233, v[72:75] offset:20480
v_mfma_f32_16x16x32_bf16 v[108:111], a[252:255], v[204:207], v[108:111]
ds_write_b128 v234, v[76:79] offset:12288
ds_write_b128 v234, v[80:83] offset:16384
ds_write_b128 v234, v[84:87] offset:20480
ds_write_b128 v235, v[88:91] offset:12288
ds_write_b128 v235, v[92:95] offset:16384
ds_write_b128 v235, v[96:99] offset:20480
ds_write_b128 v236, v[100:103] offset:12288
ds_write_b128 v236, v[104:107] offset:16384
ds_write_b128 v236, v[108:111] offset:20480
s_branch L_ofin2
T_done:
L_ofin:
ds_write_b128 v233, v[16:19] offset:0
ds_write_b128 v234, v[28:31] offset:0
ds_write_b128 v235, v[40:43] offset:0
ds_write_b128 v236, v[52:55] offset:0
ds_write_b128 v233, v[20:23] offset:4096
ds_write_b128 v234, v[32:35] offset:4096
ds_write_b128 v235, v[44:47] offset:4096
ds_write_b128 v236, v[56:59] offset:4096
ds_write_b128 v233, v[24:27] offset:8192
ds_write_b128 v234, v[36:39] offset:8192
ds_write_b128 v235, v[48:51] offset:8192
ds_write_b128 v236, v[60:63] offset:8192
ds_write_b128 v233, v[64:67] offset:12288
ds_write_b128 v234, v[76:79] offset:12288
ds_write_b128 v235, v[88:91] offset:12288
ds_write_b128 v236, v[100:103] offset:12288
ds_write_b128 v233, v[68:71] offset:16384
ds_write_b128 v234, v[80:83] offset:16384
ds_write_b128 v235, v[92:95] offset:16384
ds_write_b128 v236, v[104:107] offset:16384
ds_write_b128 v233, v[72:75] offset:20480
ds_write_b128 v234, v[84:87] offset:20480
ds_write_b128 v235, v[96:99] offset:20480
ds_write_b128 v236, v[108:111] offset:20480
L_ofin2:
s_waitcnt lgkmcnt(0)
s_barrier
ds_read_b128 v[16:19], v224 offset:0
ds_read_b128 v[20:23], v224 offset:256
ds_read_b128 v[24:27], v224 offset:40960
ds_read_b128 v[28:31], v224 offset:41216
ds_read_b128 v[32:35], v225 offset:0
ds_read_b128 v[36:39], v225 offset:256
ds_read_b128 v[40:43], v225 offset:40960
ds_read_b128 v[44:47], v225 offset:41216
ds_read_b128 v[48:51], v226 offset:0
ds_read_b128 v[52:55], v226 offset:256
ds_read_b128 v[56:59], v226 offset:40960
ds_read_b128 v[60:63], v226 offset:41216
ds_read_b128 v[64:67], v227 offset:0
ds_read_b128 v[68:71], v227 offset:256
ds_read_b128 v[72:75], v227 offset:40960
ds_read_b128 v[76:79], v227 offset:41216
ds_read_b128 v[80:83], v228 offset:0
ds_read_b128 v[84:87], v228 offset:256
ds_read_b128 v[88:91], v228 offset:40960
ds_read_b128 v[92:95], v228 offset:41216
ds_read_b128 v[96:99], v229 offset:0
ds_read_b128 v[100:103], v229 offset:256
ds_read_b128 v[104:107], v229 offset:40960
ds_read_b128 v[108:111], v229 offset:41216
s_waitcnt lgkmcnt(15)
v_pk_add_f32 v[16:17], v[16:17], v[24:25]
v_pk_add_f32 v[18:19], v[18:19], v[26:27]
v_pk_add_f32 v[20:21], v[20:21], v[28:29]
v_pk_add_f32 v[22:23], v[22:23], v[30:31]
v_pk_add_f32 v[16:17], v[16:17], v[32:33]
v_pk_add_f32 v[18:19], v[18:19], v[34:35]
v_pk_add_f32 v[20:21], v[20:21], v[36:37]
v_pk_add_f32 v[22:23], v[22:23], v[38:39]
v_pk_add_f32 v[16:17], v[16:17], v[40:41]
v_pk_add_f32 v[18:19], v[18:19], v[42:43]
v_pk_add_f32 v[20:21], v[20:21], v[44:45]
v_pk_add_f32 v[22:23], v[22:23], v[46:47]
v_cvt_pk_bf16_f32 v16, v16, v17
v_cvt_pk_bf16_f32 v17, v18, v19
v_cvt_pk_bf16_f32 v18, v20, v21
v_cvt_pk_bf16_f32 v19, v22, v23
buffer_store_dwordx4 v[16:19], v230, s[52:55], 0 offen
s_waitcnt lgkmcnt(12)
v_pk_add_f32 v[48:49], v[48:49], v[56:57]
v_pk_add_f32 v[50:51], v[50:51], v[58:59]
v_pk_add_f32 v[52:53], v[52:53], v[60:61]
v_pk_add_f32 v[54:55], v[54:55], v[62:63]
s_waitcnt lgkmcnt(10)
v_pk_add_f32 v[48:49], v[48:49], v[64:65]
v_pk_add_f32 v[50:51], v[50:51], v[66:67]
v_pk_add_f32 v[52:53], v[52:53], v[68:69]
v_pk_add_f32 v[54:55], v[54:55], v[70:71]
s_waitcnt lgkmcnt(8)
v_pk_add_f32 v[48:49], v[48:49], v[72:73]
v_pk_add_f32 v[50:51], v[50:51], v[74:75]
v_pk_add_f32 v[52:53], v[52:53], v[76:77]
v_pk_add_f32 v[54:55], v[54:55], v[78:79]
v_cvt_pk_bf16_f32 v48, v48, v49
v_cvt_pk_bf16_f32 v49, v50, v51
v_cvt_pk_bf16_f32 v50, v52, v53
v_cvt_pk_bf16_f32 v51, v54, v55
buffer_store_dwordx4 v[48:51], v231, s[52:55], 0 offen
s_waitcnt lgkmcnt(4)
v_pk_add_f32 v[80:81], v[80:81], v[88:89]
v_pk_add_f32 v[82:83], v[82:83], v[90:91]
v_pk_add_f32 v[84:85], v[84:85], v[92:93]
v_pk_add_f32 v[86:87], v[86:87], v[94:95]
s_waitcnt lgkmcnt(2)
v_pk_add_f32 v[80:81], v[80:81], v[96:97]
v_pk_add_f32 v[82:83], v[82:83], v[98:99]
v_pk_add_f32 v[84:85], v[84:85], v[100:101]
v_pk_add_f32 v[86:87], v[86:87], v[102:103]
s_waitcnt lgkmcnt(0)
v_pk_add_f32 v[80:81], v[80:81], v[104:105]
v_pk_add_f32 v[82:83], v[82:83], v[106:107]
v_pk_add_f32 v[84:85], v[84:85], v[108:109]
v_pk_add_f32 v[86:87], v[86:87], v[110:111]
v_cvt_pk_bf16_f32 v80, v80, v81
v_cvt_pk_bf16_f32 v81, v82, v83
v_cvt_pk_bf16_f32 v82, v84, v85
v_cvt_pk_bf16_f32 v83, v86, v87
buffer_store_dwordx4 v[80:83], v232, s[52:55], 0 offen
L_fin:
L_end:
s_endpgm
A_rare0:
v_max3_f32 v240, v96, v97, v98
v_max3_f32 v240, v240, v99, v100
v_max3_f32 v240, v240, v101, v102
v_max_f32 v240, v240, v103
v_mov_b32 v242, v240
s_nop 1
v_permlane32_swap_b32 v242, v240
v_max_f32 v240, v242, v240
v_mov_b32 v242, v240
s_nop 1
v_permlane16_swap_b32 v242, v240
v_max_f32 v240, v242, v240
v_max_f32 v240, s69, v240
v_sub_f32 v96, v96, v240
v_sub_f32 v97, v97, v240
v_sub_f32 v98, v98, v240
v_sub_f32 v99, v99, v240
v_sub_f32 v100, v100, v240
v_sub_f32 v101, v101, v240
v_sub_f32 v102, v102, v240
v_sub_f32 v103, v103, v240
v_sub_f32 v144, v144, v240
v_sub_f32 v145, v145, v240
v_sub_f32 v146, v146, v240
v_sub_f32 v147, v147, v240
v_max3_f32 v241, v104, v105, v106
v_max3_f32 v241, v241, v107, v108
v_max3_f32 v241, v241, v109, v110
v_max_f32 v241, v241, v111
v_mov_b32 v242, v241
s_nop 1
v_permlane32_swap_b32 v242, v241
v_max_f32 v241, v242, v241
v_mov_b32 v242, v241
s_nop 1
v_permlane16_swap_b32 v242, v241
v_max_f32 v241, v242, v241
v_max_f32 v241, s69, v241
v_sub_f32 v104, v104, v241
v_sub_f32 v105, v105, v241
v_sub_f32 v106, v106, v241
v_sub_f32 v107, v107, v241
v_sub_f32 v108, v108, v241
v_sub_f32 v109, v109, v241
v_sub_f32 v110, v110, v241
v_sub_f32 v111, v111, v241
v_sub_f32 v148, v148, v241
v_sub_f32 v149, v149, v241
v_sub_f32 v150, v150, v241
v_sub_f32 v151, v151, v241
s_cmp_lg_u32 s69, 0
s_cbranch_scc1 A_ret0
s_branch A_rare0_b
A_rare1:
v_max3_f32 v240, v112, v113, v114
v_max3_f32 v240, v240, v115, v116
v_max3_f32 v240, v240, v117, v118
v_max_f32 v240, v240, v119
v_mov_b32 v242, v240
s_nop 1
v_permlane32_swap_b32 v242, v240
v_max_f32 v240, v242, v240
v_mov_b32 v242, v240
s_nop 1
v_permlane16_swap_b32 v242, v240
v_max_f32 v240, v242, v240
v_max_f32 v240, s69, v240
v_sub_f32 v112, v112, v240
v_sub_f32 v113, v113, v240
v_sub_f32 v114, v114, v240
v_sub_f32 v115, v115, v240
v_sub_f32 v116, v116, v240
v_sub_f32 v117, v117, v240
v_sub_f32 v118, v118, v240
v_sub_f32 v119, v119, v240
v_sub_f32 v152, v152, v240
v_sub_f32 v153, v153, v240
v_sub_f32 v154, v154, v240
v_sub_f32 v155, v155, v240
v_max3_f32 v241, v120, v121, v122
v_max3_f32 v241, v241, v123, v124
v_max3_f32 v241, v241, v125, v126
v_max_f32 v241, v241, v127
v_mov_b32 v242, v241
s_nop 1
v_permlane32_swap_b32 v242, v241
v_max_f32 v241, v242, v241
v_mov_b32 v242, v241
s_nop 1
v_permlane16_swap_b32 v242, v241
v_max_f32 v241, v242, v241
v_max_f32 v241, s69, v241
v_sub_f32 v120, v120, v241
v_sub_f32 v121, v121, v241
v_sub_f32 v122, v122, v241
v_sub_f32 v123, v123, v241
v_sub_f32 v124, v124, v241
v_sub_f32 v125, v125, v241
v_sub_f32 v126, v126, v241
v_sub_f32 v127, v127, v241
v_sub_f32 v156, v156, v241
v_sub_f32 v157, v157, v241
v_sub_f32 v158, v158, v241
v_sub_f32 v159, v159, v241
s_cmp_lg_u32 s69, 0
s_cbranch_scc1 A_ret1
s_branch A_rare1_b
A_rare2:
v_max3_f32 v240, v96, v97, v98
v_max3_f32 v240, v240, v99, v100
v_max3_f32 v240, v240, v101, v102
v_max_f32 v240, v240, v103
v_mov_b32 v242, v240
s_nop 1
v_permlane32_swap_b32 v242, v240
v_max_f32 v240, v242, v240
v_mov_b32 v242, v240
s_nop 1
v_permlane16_swap_b32 v242, v240
v_max_f32 v240, v242, v240
v_max_f32 v240, s69, v240
v_sub_f32 v96, v96, v240
v_sub_f32 v97, v97, v240
v_sub_f32 v98, v98, v240
v_sub_f32 v99, v99, v240
v_sub_f32 v100, v100, v240
v_sub_f32 v101, v101, v240
v_sub_f32 v102, v102, v240
v_sub_f32 v103, v103, v240
v_sub_f32 v160, v160, v240
v_sub_f32 v161, v161, v240
v_sub_f32 v162, v162, v240
v_sub_f32 v163, v163, v240
v_max3_f32 v241, v104, v105, v106
v_max3_f32 v241, v241, v107, v108
v_max3_f32 v241, v241, v109, v110
v_max_f32 v241, v241, v111
v_mov_b32 v242, v241
s_nop 1
v_permlane32_swap_b32 v242, v241
v_max_f32 v241, v242, v241
v_mov_b32 v242, v241
s_nop 1
v_permlane16_swap_b32 v242, v241
v_max_f32 v241, v242, v241
v_max_f32 v241, s69, v241
v_sub_f32 v104, v104, v241
v_sub_f32 v105, v105, v241
v_sub_f32 v106, v106, v241
v_sub_f32 v107, v107, v241
v_sub_f32 v108, v108, v241
v_sub_f32 v109, v109, v241
v_sub_f32 v110, v110, v241
v_sub_f32 v111, v111, v241
v_sub_f32 v164, v164, v241
v_sub_f32 v165, v165, v241
v_sub_f32 v166, v166, v241
v_sub_f32 v167, v167, v241
s_cmp_lg_u32 s69, 0
s_cbranch_scc1 A_ret2
s_branch A_rare2_b
A_rare3:
v_max3_f32 v240, v112, v113, v114
v_max3_f32 v240, v240, v115, v116
v_max3_f32 v240, v240, v117, v118
v_max_f32 v240, v240, v119
v_mov_b32 v242, v240
s_nop 1
v_permlane32_swap_b32 v242, v240
v_max_f32 v240, v242, v240
v_mov_b32 v242, v240
s_nop 1
v_permlane16_swap_b32 v242, v240
v_max_f32 v240, v242, v240
v_max_f32 v240, s69, v240
v_sub_f32 v112, v112, v240
v_sub_f32 v113, v113, v240
v_sub_f32 v114, v114, v240
v_sub_f32 v115, v115, v240
v_sub_f32 v116, v116, v240
v_sub_f32 v117, v117, v240
v_sub_f32 v118, v118, v240
v_sub_f32 v119, v119, v240
v_sub_f32 v144, v144, v240
v_sub_f32 v145, v145, v240
v_sub_f32 v146, v146, v240
v_sub_f32 v147, v147, v240
v_max3_f32 v241, v120, v121, v122
v_max3_f32 v241, v241, v123, v124
v_max3_f32 v241, v241, v125, v126
v_max_f32 v241, v241, v127
v_mov_b32 v242, v241
s_nop 1
v_permlane32_swap_b32 v242, v241
v_max_f32 v241, v242, v241
v_mov_b32 v242, v241
s_nop 1
v_permlane16_swap_b32 v242, v241
v_max_f32 v241, v242, v241
v_max_f32 v241, s69, v241
v_sub_f32 v120, v120, v241
v_sub_f32 v121, v121, v241
v_sub_f32 v122, v122, v241
v_sub_f32 v123, v123, v241
v_sub_f32 v124, v124, v241
v_sub_f32 v125, v125, v241
v_sub_f32 v126, v126, v241
v_sub_f32 v127, v127, v241
v_sub_f32 v148, v148, v241
v_sub_f32 v149, v149, v241
v_sub_f32 v150, v150, v241
v_sub_f32 v151, v151, v241
s_cmp_lg_u32 s69, 0
s_cbranch_scc1 A_ret3
s_branch A_rare3_b
A_rare4:
v_max3_f32 v240, v96, v97, v98
v_max3_f32 v240, v240, v99, v100
v_max3_f32 v240, v240, v101, v102
v_max_f32 v240, v240, v103
v_mov_b32 v242, v240
s_nop 1
v_permlane32_swap_b32 v242, v240
v_max_f32 v240, v242, v240
v_mov_b32 v242, v240
s_nop 1
v_permlane16_swap_b32 v242, v240
v_max_f32 v240, v242, v240
v_max_f32 v240, s69, v240
v_sub_f32 v96, v96, v240
v_sub_f32 v97, v97, v240
v_sub_f32 v98, v98, v240
v_sub_f32 v99, v99, v240
v_sub_f32 v100, v100, v240
v_sub_f32 v101, v101, v240
v_sub_f32 v102, v102, v240
v_sub_f32 v103, v103, v240
v_sub_f32 v152, v152, v240
v_sub_f32 v153, v153, v240
v_sub_f32 v154, v154, v240
v_sub_f32 v155, v155, v240
v_max3_f32 v241, v104, v105, v106
v_max3_f32 v241, v241, v107, v108
v_max3_f32 v241, v241, v109, v110
v_max_f32 v241, v241, v111
v_mov_b32 v242, v241
s_nop 1
v_permlane32_swap_b32 v242, v241
v_max_f32 v241, v242, v241
v_mov_b32 v242, v241
s_nop 1
v_permlane16_swap_b32 v242, v241
v_max_f32 v241, v242, v241
v_max_f32 v241, s69, v241
v_sub_f32 v104, v104, v241
v_sub_f32 v105, v105, v241
v_sub_f32 v106, v106, v241
v_sub_f32 v107, v107, v241
v_sub_f32 v108, v108, v241
v_sub_f32 v109, v109, v241
v_sub_f32 v110, v110, v241
v_sub_f32 v111, v111, v241
v_sub_f32 v156, v156, v241
v_sub_f32 v157, v157, v241
v_sub_f32 v158, v158, v241
v_sub_f32 v159, v159, v241
s_cmp_lg_u32 s69, 0
s_cbranch_scc1 A_ret4
s_branch A_rare4_b
A_rare5:
v_max3_f32 v240, v112, v113, v114
v_max3_f32 v240, v240, v115, v116
v_max3_f32 v240, v240, v117, v118
v_max_f32 v240, v240, v119
v_mov_b32 v242, v240
s_nop 1
v_permlane32_swap_b32 v242, v240
v_max_f32 v240, v242, v240
v_mov_b32 v242, v240
s_nop 1
v_permlane16_swap_b32 v242, v240
v_max_f32 v240, v242, v240
v_max_f32 v240, s69, v240
v_sub_f32 v112, v112, v240
v_sub_f32 v113, v113, v240
v_sub_f32 v114, v114, v240
v_sub_f32 v115, v115, v240
v_sub_f32 v116, v116, v240
v_sub_f32 v117, v117, v240
v_sub_f32 v118, v118, v240
v_sub_f32 v119, v119, v240
v_sub_f32 v160, v160, v240
v_sub_f32 v161, v161, v240
v_sub_f32 v162, v162, v240
v_sub_f32 v163, v163, v240
v_max3_f32 v241, v120, v121, v122
v_max3_f32 v241, v241, v123, v124
v_max3_f32 v241, v241, v125, v126
v_max_f32 v241, v241, v127
v_mov_b32 v242, v241
s_nop 1
v_permlane32_swap_b32 v242, v241
v_max_f32 v241, v242, v241
v_mov_b32 v242, v241
s_nop 1
v_permlane16_swap_b32 v242, v241
v_max_f32 v241, v242, v241
v_max_f32 v241, s69, v241
v_sub_f32 v120, v120, v241
v_sub_f32 v121, v121, v241
v_sub_f32 v122, v122, v241
v_sub_f32 v123, v123, v241
v_sub_f32 v124, v124, v241
v_sub_f32 v125, v125, v241
v_sub_f32 v126, v126, v241
v_sub_f32 v127, v127, v241
v_sub_f32 v164, v164, v241
v_sub_f32 v165, v165, v241
v_sub_f32 v166, v166, v241
v_sub_f32 v167, v167, v241
s_cmp_lg_u32 s69, 0
s_cbranch_scc1 A_ret5
s_branch A_rare5_b
A_rare0z:
v_max3_f32 v240, v96, v97, v98
v_max3_f32 v240, v240, v99, v100
v_max3_f32 v240, v240, v101, v102
v_max_f32 v240, v240, v103
v_mov_b32 v242, v240
s_nop 1
v_permlane32_swap_b32 v242, v240
v_max_f32 v240, v242, v240
v_mov_b32 v242, v240
s_nop 1
v_permlane16_swap_b32 v242, v240
v_max_f32 v240, v242, v240
v_max_f32 v240, s69, v240
v_sub_f32 v96, v96, v240
v_sub_f32 v97, v97, v240
v_sub_f32 v98, v98, v240
v_sub_f32 v99, v99, v240
v_sub_f32 v100, v100, v240
v_sub_f32 v101, v101, v240
v_sub_f32 v102, v102, v240
v_sub_f32 v103, v103, v240
v_sub_f32 v144, v144, v240
v_sub_f32 v145, v145, v240
v_sub_f32 v146, v146, v240
v_sub_f32 v147, v147, v240
v_max3_f32 v241, v104, v105, v106
v_max3_f32 v241, v241, v107, v108
v_max3_f32 v241, v241, v109, v110
v_max_f32 v241, v241, v111
v_mov_b32 v242, v241
s_nop 1
v_permlane32_swap_b32 v242, v241
v_max_f32 v241, v242, v241
v_mov_b32 v242, v241
s_nop 1
v_permlane16_swap_b32 v242, v241
v_max_f32 v241, v242, v241
v_max_f32 v241, s69, v241
v_sub_f32 v104, v104, v241
v_sub_f32 v105, v105, v241
v_sub_f32 v106, v106, v241
v_sub_f32 v107, v107, v241
v_sub_f32 v108, v108, v241
v_sub_f32 v109, v109, v241
v_sub_f32 v110, v110, v241
v_sub_f32 v111, v111, v241
v_sub_f32 v148, v148, v241
v_sub_f32 v149, v149, v241
v_sub_f32 v150, v150, v241
v_sub_f32 v151, v151, v241
s_cmp_lg_u32 s69, 0
s_cbranch_scc1 A_ret0z
s_branch A_rare0z_b
A_rare1z:
v_max3_f32 v240, v112, v113, v114
v_max3_f32 v240, v240, v115, v116
v_max3_f32 v240, v240, v117, v118
v_max_f32 v240, v240, v119
v_mov_b32 v242, v240
s_nop 1
v_permlane32_swap_b32 v242, v240
v_max_f32 v240, v242, v240
v_mov_b32 v242, v240
s_nop 1
v_permlane16_swap_b32 v242, v240
v_max_f32 v240, v242, v240
v_max_f32 v240, s69, v240
v_sub_f32 v112, v112, v240
v_sub_f32 v113, v113, v240
v_sub_f32 v114, v114, v240
v_sub_f32 v115, v115, v240
v_sub_f32 v116, v116, v240
v_sub_f32 v117, v117, v240
v_sub_f32 v118, v118, v240
v_sub_f32 v119, v119, v240
v_sub_f32 v152, v152, v240
v_sub_f32 v153, v153, v240
v_sub_f32 v154, v154, v240
v_sub_f32 v155, v155, v240
v_max3_f32 v241, v120, v121, v122
v_max3_f32 v241, v241, v123, v124
v_max3_f32 v241, v241, v125, v126
v_max_f32 v241, v241, v127
v_mov_b32 v242, v241
s_nop 1
v_permlane32_swap_b32 v242, v241
v_max_f32 v241, v242, v241
v_mov_b32 v242, v241
s_nop 1
v_permlane16_swap_b32 v242, v241
v_max_f32 v241, v242, v241
v_max_f32 v241, s69, v241
v_sub_f32 v120, v120, v241
v_sub_f32 v121, v121, v241
v_sub_f32 v122, v122, v241
v_sub_f32 v123, v123, v241
v_sub_f32 v124, v124, v241
v_sub_f32 v125, v125, v241
v_sub_f32 v126, v126, v241
v_sub_f32 v127, v127, v241
v_sub_f32 v156, v156, v241
v_sub_f32 v157, v157, v241
v_sub_f32 v158, v158, v241
v_sub_f32 v159, v159, v241
s_cmp_lg_u32 s69, 0
s_cbranch_scc1 A_ret1z
s_branch A_rare1z_b
A_rare2z:
v_max3_f32 v240, v96, v97, v98
v_max3_f32 v240, v240, v99, v100
v_max3_f32 v240, v240, v101, v102
v_max_f32 v240, v240, v103
v_mov_b32 v242, v240
s_nop 1
v_permlane32_swap_b32 v242, v240
v_max_f32 v240, v242, v240
v_mov_b32 v242, v240
s_nop 1
v_permlane16_swap_b32 v242, v240
v_max_f32 v240, v242, v240
v_max_f32 v240, s69, v240
v_sub_f32 v96, v96, v240
v_sub_f32 v97, v97, v240
v_sub_f32 v98, v98, v240
v_sub_f32 v99, v99, v240
v_sub_f32 v100, v100, v240
v_sub_f32 v101, v101, v240
v_sub_f32 v102, v102, v240
v_sub_f32 v103, v103, v240
v_sub_f32 v160, v160, v240
v_sub_f32 v161, v161, v240
v_sub_f32 v162, v162, v240
v_sub_f32 v163, v163, v240
v_max3_f32 v241, v104, v105, v106
v_max3_f32 v241, v241, v107, v108
v_max3_f32 v241, v241, v109, v110
v_max_f32 v241, v241, v111
v_mov_b32 v242, v241
s_nop 1
v_permlane32_swap_b32 v242, v241
v_max_f32 v241, v242, v241
v_mov_b32 v242, v241
s_nop 1
v_permlane16_swap_b32 v242, v241
v_max_f32 v241, v242, v241
v_max_f32 v241, s69, v241
v_sub_f32 v104, v104, v241
v_sub_f32 v105, v105, v241
v_sub_f32 v106, v106, v241
v_sub_f32 v107, v107, v241
v_sub_f32 v108, v108, v241
v_sub_f32 v109, v109, v241
v_sub_f32 v110, v110, v241
v_sub_f32 v111, v111, v241
v_sub_f32 v164, v164, v241
v_sub_f32 v165, v165, v241
v_sub_f32 v166, v166, v241
v_sub_f32 v167, v167, v241
s_cmp_lg_u32 s69, 0
s_cbranch_scc1 A_ret2z
s_branch A_rare2z_b
A_rare3z:
v_max3_f32 v240, v112, v113, v114
v_max3_f32 v240, v240, v115, v116
v_max3_f32 v240, v240, v117, v118
v_max_f32 v240, v240, v119
v_mov_b32 v242, v240
s_nop 1
v_permlane32_swap_b32 v242, v240
v_max_f32 v240, v242, v240
v_mov_b32 v242, v240
s_nop 1
v_permlane16_swap_b32 v242, v240
v_max_f32 v240, v242, v240
v_max_f32 v240, s69, v240
v_sub_f32 v112, v112, v240
v_sub_f32 v113, v113, v240
v_sub_f32 v114, v114, v240
v_sub_f32 v115, v115, v240
v_sub_f32 v116, v116, v240
v_sub_f32 v117, v117, v240
v_sub_f32 v118, v118, v240
v_sub_f32 v119, v119, v240
v_sub_f32 v144, v144, v240
v_sub_f32 v145, v145, v240
v_sub_f32 v146, v146, v240
v_sub_f32 v147, v147, v240
v_max3_f32 v241, v120, v121, v122
v_max3_f32 v241, v241, v123, v124
v_max3_f32 v241, v241, v125, v126
v_max_f32 v241, v241, v127
v_mov_b32 v242, v241
s_nop 1
v_permlane32_swap_b32 v242, v241
v_max_f32 v241, v242, v241
v_mov_b32 v242, v241
s_nop 1
v_permlane16_swap_b32 v242, v241
v_max_f32 v241, v242, v241
v_max_f32 v241, s69, v241
v_sub_f32 v120, v120, v241
v_sub_f32 v121, v121, v241
v_sub_f32 v122, v122, v241
v_sub_f32 v123, v123, v241
v_sub_f32 v124, v124, v241
v_sub_f32 v125, v125, v241
v_sub_f32 v126, v126, v241
v_sub_f32 v127, v127, v241
v_sub_f32 v148, v148, v241
v_sub_f32 v149, v149, v241
v_sub_f32 v150, v150, v241
v_sub_f32 v151, v151, v241
s_cmp_lg_u32 s69, 0
s_cbranch_scc1 A_ret3z
s_branch A_rare3z_b
A_rare4z:
v_max3_f32 v240, v96, v97, v98
v_max3_f32 v240, v240, v99, v100
v_max3_f32 v240, v240, v101, v102
v_max_f32 v240, v240, v103
v_mov_b32 v242, v240
s_nop 1
v_permlane32_swap_b32 v242, v240
v_max_f32 v240, v242, v240
v_mov_b32 v242, v240
s_nop 1
v_permlane16_swap_b32 v242, v240
v_max_f32 v240, v242, v240
v_max_f32 v240, s69, v240
v_sub_f32 v96, v96, v240
v_sub_f32 v97, v97, v240
v_sub_f32 v98, v98, v240
v_sub_f32 v99, v99, v240
v_sub_f32 v100, v100, v240
v_sub_f32 v101, v101, v240
v_sub_f32 v102, v102, v240
v_sub_f32 v103, v103, v240
v_sub_f32 v152, v152, v240
v_sub_f32 v153, v153, v240
v_sub_f32 v154, v154, v240
v_sub_f32 v155, v155, v240
v_max3_f32 v241, v104, v105, v106
v_max3_f32 v241, v241, v107, v108
v_max3_f32 v241, v241, v109, v110
v_max_f32 v241, v241, v111
v_mov_b32 v242, v241
s_nop 1
v_permlane32_swap_b32 v242, v241
v_max_f32 v241, v242, v241
v_mov_b32 v242, v241
s_nop 1
v_permlane16_swap_b32 v242, v241
v_max_f32 v241, v242, v241
v_max_f32 v241, s69, v241
v_sub_f32 v104, v104, v241
v_sub_f32 v105, v105, v241
v_sub_f32 v106, v106, v241
v_sub_f32 v107, v107, v241
v_sub_f32 v108, v108, v241
v_sub_f32 v109, v109, v241
v_sub_f32 v110, v110, v241
v_sub_f32 v111, v111, v241
v_sub_f32 v156, v156, v241
v_sub_f32 v157, v157, v241
v_sub_f32 v158, v158, v241
v_sub_f32 v159, v159, v241
s_cmp_lg_u32 s69, 0
s_cbranch_scc1 A_ret4z
s_branch A_rare4z_b
A_rare5z:
v_max3_f32 v240, v112, v113, v114
v_max3_f32 v240, v240, v115, v116
v_max3_f32 v240, v240, v117, v118
v_max_f32 v240, v240, v119
v_mov_b32 v242, v240
s_nop 1
v_permlane32_swap_b32 v242, v240
v_max_f32 v240, v242, v240
v_mov_b32 v242, v240
s_nop 1
v_permlane16_swap_b32 v242, v240
v_max_f32 v240, v242, v240
v_max_f32 v240, s69, v240
v_sub_f32 v112, v112, v240
v_sub_f32 v113, v113, v240
v_sub_f32 v114, v114, v240
v_sub_f32 v115, v115, v240
v_sub_f32 v116, v116, v240
v_sub_f32 v117, v117, v240
v_sub_f32 v118, v118, v240
v_sub_f32 v119, v119, v240
v_sub_f32 v160, v160, v240
v_sub_f32 v161, v161, v240
v_sub_f32 v162, v162, v240
v_sub_f32 v163, v163, v240
v_max3_f32 v241, v120, v121, v122
v_max3_f32 v241, v241, v123, v124
v_max3_f32 v241, v241, v125, v126
v_max_f32 v241, v241, v127
v_mov_b32 v242, v241
s_nop 1
v_permlane32_swap_b32 v242, v241
v_max_f32 v241, v242, v241
v_mov_b32 v242, v241
s_nop 1
v_permlane16_swap_b32 v242, v241
v_max_f32 v241, v242, v241
v_max_f32 v241, s69, v241
v_sub_f32 v120, v120, v241
v_sub_f32 v121, v121, v241
v_sub_f32 v122, v122, v241
v_sub_f32 v123, v123, v241
v_sub_f32 v124, v124, v241
v_sub_f32 v125, v125, v241
v_sub_f32 v126, v126, v241
v_sub_f32 v127, v127, v241
v_sub_f32 v164, v164, v241
v_sub_f32 v165, v165, v241
v_sub_f32 v166, v166, v241
v_sub_f32 v167, v167, v241
s_cmp_lg_u32 s69, 0
s_cbranch_scc1 A_ret5z
s_branch A_rare5z_b
A_rare0_b:
s_nop 15
v_sub_f32 v240, 0, v240
v_exp_f32 v240, v240
s_nop 0
v_mul_f32 v22, v22, v240
v_accvgpr_read_b32 v242, a0
v_mul_f32 v242, v242, v240
v_accvgpr_write_b32 a0, v242
v_accvgpr_read_b32 v243, a1
v_mul_f32 v243, v243, v240
v_accvgpr_write_b32 a1, v243
v_accvgpr_read_b32 v244, a2
v_mul_f32 v244, v244, v240
v_accvgpr_write_b32 a2, v244
v_accvgpr_read_b32 v245, a3
v_mul_f32 v245, v245, v240
v_accvgpr_write_b32 a3, v245
v_accvgpr_read_b32 v242, a4
v_mul_f32 v242, v242, v240
v_accvgpr_write_b32 a4, v242
v_accvgpr_read_b32 v243, a5
v_mul_f32 v243, v243, v240
v_accvgpr_write_b32 a5, v243
v_accvgpr_read_b32 v244, a6
v_mul_f32 v244, v244, v240
v_accvgpr_write_b32 a6, v244
v_accvgpr_read_b32 v245, a7
v_mul_f32 v245, v245, v240
v_accvgpr_write_b32 a7, v245
v_accvgpr_read_b32 v242, a8
v_mul_f32 v242, v242, v240
v_accvgpr_write_b32 a8, v242
v_accvgpr_read_b32 v243, a9
v_mul_f32 v243, v243, v240
v_accvgpr_write_b32 a9, v243
v_accvgpr_read_b32 v244, a10
v_mul_f32 v244, v244, v240
v_accvgpr_write_b32 a10, v244
v_accvgpr_read_b32 v245, a11
v_mul_f32 v245, v245, v240
v_accvgpr_write_b32 a11, v245
v_accvgpr_read_b32 v242, a12
v_mul_f32 v242, v242, v240
v_accvgpr_write_b32 a12, v242
v_accvgpr_read_b32 v243, a13
v_mul_f32 v243, v243, v240
v_accvgpr_write_b32 a13, v243
v_accvgpr_read_b32 v244, a14
v_mul_f32 v244, v244, v240
v_accvgpr_write_b32 a14, v244
v_accvgpr_read_b32 v245, a15
v_mul_f32 v245, v245, v240
v_accvgpr_write_b32 a15, v245
v_accvgpr_read_b32 v242, a16
v_mul_f32 v242, v242, v240
v_accvgpr_write_b32 a16, v242
v_accvgpr_read_b32 v243, a17
v_mul_f32 v243, v243, v240
v_accvgpr_write_b32 a17, v243
v_accvgpr_read_b32 v244, a18
v_mul_f32 v244, v244, v240
v_accvgpr_write_b32 a18, v244
v_accvgpr_read_b32 v245, a19
v_mul_f32 v245, v245, v240
v_accvgpr_write_b32 a19, v245
v_accvgpr_read_b32 v242, a20
v_mul_f32 v242, v242, v240
v_accvgpr_write_b32 a20, v242
v_accvgpr_read_b32 v243, a21
v_mul_f32 v243, v243, v240
v_accvgpr_write_b32 a21, v243
v_accvgpr_read_b32 v244, a22
v_mul_f32 v244, v244, v240
v_accvgpr_write_b32 a22, v244
v_accvgpr_read_b32 v245, a23
v_mul_f32 v245, v245, v240
v_accvgpr_write_b32 a23, v245
v_accvgpr_read_b32 v242, a24
v_mul_f32 v242, v242, v240
v_accvgpr_write_b32 a24, v242
v_accvgpr_read_b32 v243, a25
v_mul_f32 v243, v243, v240
v_accvgpr_write_b32 a25, v243
v_accvgpr_read_b32 v244, a26
v_mul_f32 v244, v244, v240
v_accvgpr_write_b32 a26, v244
v_accvgpr_read_b32 v245, a27
v_mul_f32 v245, v245, v240
v_accvgpr_write_b32 a27, v245
v_accvgpr_read_b32 v242, a28
v_mul_f32 v242, v242, v240
v_accvgpr_write_b32 a28, v242
v_accvgpr_read_b32 v243, a29
v_mul_f32 v243, v243, v240
v_accvgpr_write_b32 a29, v243
v_accvgpr_read_b32 v244, a30
v_mul_f32 v244, v244, v240
v_accvgpr_write_b32 a30, v244
v_accvgpr_read_b32 v245, a31
v_mul_f32 v245, v245, v240
v_accvgpr_write_b32 a31, v245
v_sub_f32 v241, 0, v241
v_exp_f32 v241, v241
s_nop 0
v_mul_f32 v26, v26, v241
v_accvgpr_read_b32 v242, a32
v_mul_f32 v242, v242, v241
v_accvgpr_write_b32 a32, v242
v_accvgpr_read_b32 v243, a33
v_mul_f32 v243, v243, v241
v_accvgpr_write_b32 a33, v243
v_accvgpr_read_b32 v244, a34
v_mul_f32 v244, v244, v241
v_accvgpr_write_b32 a34, v244
v_accvgpr_read_b32 v245, a35
v_mul_f32 v245, v245, v241
v_accvgpr_write_b32 a35, v245
v_accvgpr_read_b32 v242, a36
v_mul_f32 v242, v242, v241
v_accvgpr_write_b32 a36, v242
v_accvgpr_read_b32 v243, a37
v_mul_f32 v243, v243, v241
v_accvgpr_write_b32 a37, v243
v_accvgpr_read_b32 v244, a38
v_mul_f32 v244, v244, v241
v_accvgpr_write_b32 a38, v244
v_accvgpr_read_b32 v245, a39
v_mul_f32 v245, v245, v241
v_accvgpr_write_b32 a39, v245
v_accvgpr_read_b32 v242, a40
v_mul_f32 v242, v242, v241
v_accvgpr_write_b32 a40, v242
v_accvgpr_read_b32 v243, a41
v_mul_f32 v243, v243, v241
v_accvgpr_write_b32 a41, v243
v_accvgpr_read_b32 v244, a42
v_mul_f32 v244, v244, v241
v_accvgpr_write_b32 a42, v244
v_accvgpr_read_b32 v245, a43
v_mul_f32 v245, v245, v241
v_accvgpr_write_b32 a43, v245
v_accvgpr_read_b32 v242, a44
v_mul_f32 v242, v242, v241
v_accvgpr_write_b32 a44, v242
v_accvgpr_read_b32 v243, a45
v_mul_f32 v243, v243, v241
v_accvgpr_write_b32 a45, v243
v_accvgpr_read_b32 v244, a46
v_mul_f32 v244, v244, v241
v_accvgpr_write_b32 a46, v244
v_accvgpr_read_b32 v245, a47
v_mul_f32 v245, v245, v241
v_accvgpr_write_b32 a47, v245
v_accvgpr_read_b32 v242, a48
v_mul_f32 v242, v242, v241
v_accvgpr_write_b32 a48, v242
v_accvgpr_read_b32 v243, a49
v_mul_f32 v243, v243, v241
v_accvgpr_write_b32 a49, v243
v_accvgpr_read_b32 v244, a50
v_mul_f32 v244, v244, v241
v_accvgpr_write_b32 a50, v244
v_accvgpr_read_b32 v245, a51
v_mul_f32 v245, v245, v241
v_accvgpr_write_b32 a51, v245
v_accvgpr_read_b32 v242, a52
v_mul_f32 v242, v242, v241
v_accvgpr_write_b32 a52, v242
v_accvgpr_read_b32 v243, a53
v_mul_f32 v243, v243, v241
v_accvgpr_write_b32 a53, v243
v_accvgpr_read_b32 v244, a54
v_mul_f32 v244, v244, v241
v_accvgpr_write_b32 a54, v244
v_accvgpr_read_b32 v245, a55
v_mul_f32 v245, v245, v241
v_accvgpr_write_b32 a55, v245
v_accvgpr_read_b32 v242, a56
v_mul_f32 v242, v242, v241
v_accvgpr_write_b32 a56, v242
v_accvgpr_read_b32 v243, a57
v_mul_f32 v243, v243, v241
v_accvgpr_write_b32 a57, v243
v_accvgpr_read_b32 v244, a58
v_mul_f32 v244, v244, v241
v_accvgpr_write_b32 a58, v244
v_accvgpr_read_b32 v245, a59
v_mul_f32 v245, v245, v241
v_accvgpr_write_b32 a59, v245
v_accvgpr_read_b32 v242, a60
v_mul_f32 v242, v242, v241
v_accvgpr_write_b32 a60, v242
v_accvgpr_read_b32 v243, a61
v_mul_f32 v243, v243, v241
v_accvgpr_write_b32 a61, v243
v_accvgpr_read_b32 v244, a62
v_mul_f32 v244, v244, v241
v_accvgpr_write_b32 a62, v244
v_accvgpr_read_b32 v245, a63
v_mul_f32 v245, v245, v241
v_accvgpr_write_b32 a63, v245
s_branch A_ret0
A_rare1_b:
s_nop 15
v_sub_f32 v240, 0, v240
v_exp_f32 v240, v240
s_nop 0
v_mul_f32 v224, v224, v240
v_accvgpr_read_b32 v242, a64
v_mul_f32 v242, v242, v240
v_accvgpr_write_b32 a64, v242
v_accvgpr_read_b32 v243, a65
v_mul_f32 v243, v243, v240
v_accvgpr_write_b32 a65, v243
v_accvgpr_read_b32 v244, a66
v_mul_f32 v244, v244, v240
v_accvgpr_write_b32 a66, v244
v_accvgpr_read_b32 v245, a67
v_mul_f32 v245, v245, v240
v_accvgpr_write_b32 a67, v245
v_accvgpr_read_b32 v242, a68
v_mul_f32 v242, v242, v240
v_accvgpr_write_b32 a68, v242
v_accvgpr_read_b32 v243, a69
v_mul_f32 v243, v243, v240
v_accvgpr_write_b32 a69, v243
v_accvgpr_read_b32 v244, a70
v_mul_f32 v244, v244, v240
v_accvgpr_write_b32 a70, v244
v_accvgpr_read_b32 v245, a71
v_mul_f32 v245, v245, v240
v_accvgpr_write_b32 a71, v245
v_accvgpr_read_b32 v242, a72
v_mul_f32 v242, v242, v240
v_accvgpr_write_b32 a72, v242
v_accvgpr_read_b32 v243, a73
v_mul_f32 v243, v243, v240
v_accvgpr_write_b32 a73, v243
v_accvgpr_read_b32 v244, a74
v_mul_f32 v244, v244, v240
v_accvgpr_write_b32 a74, v244
v_accvgpr_read_b32 v245, a75
v_mul_f32 v245, v245, v240
v_accvgpr_write_b32 a75, v245
v_accvgpr_read_b32 v242, a76
v_mul_f32 v242, v242, v240
v_accvgpr_write_b32 a76, v242
v_accvgpr_read_b32 v243, a77
v_mul_f32 v243, v243, v240
v_accvgpr_write_b32 a77, v243
v_accvgpr_read_b32 v244, a78
v_mul_f32 v244, v244, v240
v_accvgpr_write_b32 a78, v244
v_accvgpr_read_b32 v245, a79
v_mul_f32 v245, v245, v240
v_accvgpr_write_b32 a79, v245
v_accvgpr_read_b32 v242, a80
v_mul_f32 v242, v242, v240
v_accvgpr_write_b32 a80, v242
v_accvgpr_read_b32 v243, a81
v_mul_f32 v243, v243, v240
v_accvgpr_write_b32 a81, v243
v_accvgpr_read_b32 v244, a82
v_mul_f32 v244, v244, v240
v_accvgpr_write_b32 a82, v244
v_accvgpr_read_b32 v245, a83
v_mul_f32 v245, v245, v240
v_accvgpr_write_b32 a83, v245
v_accvgpr_read_b32 v242, a84
v_mul_f32 v242, v242, v240
v_accvgpr_write_b32 a84, v242
v_accvgpr_read_b32 v243, a85
v_mul_f32 v243, v243, v240
v_accvgpr_write_b32 a85, v243
v_accvgpr_read_b32 v244, a86
v_mul_f32 v244, v244, v240
v_accvgpr_write_b32 a86, v244
v_accvgpr_read_b32 v245, a87
v_mul_f32 v245, v245, v240
v_accvgpr_write_b32 a87, v245
v_accvgpr_read_b32 v242, a88
v_mul_f32 v242, v242, v240
v_accvgpr_write_b32 a88, v242
v_accvgpr_read_b32 v243, a89
v_mul_f32 v243, v243, v240
v_accvgpr_write_b32 a89, v243
v_accvgpr_read_b32 v244, a90
v_mul_f32 v244, v244, v240
v_accvgpr_write_b32 a90, v244
v_accvgpr_read_b32 v245, a91
v_mul_f32 v245, v245, v240
v_accvgpr_write_b32 a91, v245
v_accvgpr_read_b32 v242, a92
v_mul_f32 v242, v242, v240
v_accvgpr_write_b32 a92, v242
v_accvgpr_read_b32 v243, a93
v_mul_f32 v243, v243, v240
v_accvgpr_write_b32 a93, v243
v_accvgpr_read_b32 v244, a94
v_mul_f32 v244, v244, v240
v_accvgpr_write_b32 a94, v244
v_accvgpr_read_b32 v245, a95
v_mul_f32 v245, v245, v240
v_accvgpr_write_b32 a95, v245
v_sub_f32 v241, 0, v241
v_exp_f32 v241, v241
s_nop 0
v_mul_f32 v228, v228, v241
v_accvgpr_read_b32 v242, a96
v_mul_f32 v242, v242, v241
v_accvgpr_write_b32 a96, v242
v_accvgpr_read_b32 v243, a97
v_mul_f32 v243, v243, v241
v_accvgpr_write_b32 a97, v243
v_accvgpr_read_b32 v244, a98
v_mul_f32 v244, v244, v241
v_accvgpr_write_b32 a98, v244
v_accvgpr_read_b32 v245, a99
v_mul_f32 v245, v245, v241
v_accvgpr_write_b32 a99, v245
v_accvgpr_read_b32 v242, a100
v_mul_f32 v242, v242, v241
v_accvgpr_write_b32 a100, v242
v_accvgpr_read_b32 v243, a101
v_mul_f32 v243, v243, v241
v_accvgpr_write_b32 a101, v243
v_accvgpr_read_b32 v244, a102
v_mul_f32 v244, v244, v241
v_accvgpr_write_b32 a102, v244
v_accvgpr_read_b32 v245, a103
v_mul_f32 v245, v245, v241
v_accvgpr_write_b32 a103, v245
v_accvgpr_read_b32 v242, a104
v_mul_f32 v242, v242, v241
v_accvgpr_write_b32 a104, v242
v_accvgpr_read_b32 v243, a105
v_mul_f32 v243, v243, v241
v_accvgpr_write_b32 a105, v243
v_accvgpr_read_b32 v244, a106
v_mul_f32 v244, v244, v241
v_accvgpr_write_b32 a106, v244
v_accvgpr_read_b32 v245, a107
v_mul_f32 v245, v245, v241
v_accvgpr_write_b32 a107, v245
v_accvgpr_read_b32 v242, a108
v_mul_f32 v242, v242, v241
v_accvgpr_write_b32 a108, v242
v_accvgpr_read_b32 v243, a109
v_mul_f32 v243, v243, v241
v_accvgpr_write_b32 a109, v243
v_accvgpr_read_b32 v244, a110
v_mul_f32 v244, v244, v241
v_accvgpr_write_b32 a110, v244
v_accvgpr_read_b32 v245, a111
v_mul_f32 v245, v245, v241
v_accvgpr_write_b32 a111, v245
v_accvgpr_read_b32 v242, a112
v_mul_f32 v242, v242, v241
v_accvgpr_write_b32 a112, v242
v_accvgpr_read_b32 v243, a113
v_mul_f32 v243, v243, v241
v_accvgpr_write_b32 a113, v243
v_accvgpr_read_b32 v244, a114
v_mul_f32 v244, v244, v241
v_accvgpr_write_b32 a114, v244
v_accvgpr_read_b32 v245, a115
v_mul_f32 v245, v245, v241
v_accvgpr_write_b32 a115, v245
v_accvgpr_read_b32 v242, a116
v_mul_f32 v242, v242, v241
v_accvgpr_write_b32 a116, v242
v_accvgpr_read_b32 v243, a117
v_mul_f32 v243, v243, v241
v_accvgpr_write_b32 a117, v243
v_accvgpr_read_b32 v244, a118
v_mul_f32 v244, v244, v241
v_accvgpr_write_b32 a118, v244
v_accvgpr_read_b32 v245, a119
v_mul_f32 v245, v245, v241
v_accvgpr_write_b32 a119, v245
v_accvgpr_read_b32 v242, a120
v_mul_f32 v242, v242, v241
v_accvgpr_write_b32 a120, v242
v_accvgpr_read_b32 v243, a121
v_mul_f32 v243, v243, v241
v_accvgpr_write_b32 a121, v243
v_accvgpr_read_b32 v244, a122
v_mul_f32 v244, v244, v241
v_accvgpr_write_b32 a122, v244
v_accvgpr_read_b32 v245, a123
v_mul_f32 v245, v245, v241
v_accvgpr_write_b32 a123, v245
v_accvgpr_read_b32 v242, a124
v_mul_f32 v242, v242, v241
v_accvgpr_write_b32 a124, v242
v_accvgpr_read_b32 v243, a125
v_mul_f32 v243, v243, v241
v_accvgpr_write_b32 a125, v243
v_accvgpr_read_b32 v244, a126
v_mul_f32 v244, v244, v241
v_accvgpr_write_b32 a126, v244
v_accvgpr_read_b32 v245, a127
v_mul_f32 v245, v245, v241
v_accvgpr_write_b32 a127, v245
s_branch A_ret1
A_rare2_b:
s_nop 15
v_sub_f32 v240, 0, v240
v_exp_f32 v240, v240
s_nop 0
v_mul_f32 v232, v232, v240
v_accvgpr_read_b32 v242, a128
v_mul_f32 v242, v242, v240
v_accvgpr_write_b32 a128, v242
v_accvgpr_read_b32 v243, a129
v_mul_f32 v243, v243, v240
v_accvgpr_write_b32 a129, v243
v_accvgpr_read_b32 v244, a130
v_mul_f32 v244, v244, v240
v_accvgpr_write_b32 a130, v244
v_accvgpr_read_b32 v245, a131
v_mul_f32 v245, v245, v240
v_accvgpr_write_b32 a131, v245
v_accvgpr_read_b32 v242, a132
v_mul_f32 v242, v242, v240
v_accvgpr_write_b32 a132, v242
v_accvgpr_read_b32 v243, a133
v_mul_f32 v243, v243, v240
v_accvgpr_write_b32 a133, v243
v_accvgpr_read_b32 v244, a134
v_mul_f32 v244, v244, v240
v_accvgpr_write_b32 a134, v244
v_accvgpr_read_b32 v245, a135
v_mul_f32 v245, v245, v240
v_accvgpr_write_b32 a135, v245
v_accvgpr_read_b32 v242, a136
v_mul_f32 v242, v242, v240
v_accvgpr_write_b32 a136, v242
v_accvgpr_read_b32 v243, a137
v_mul_f32 v243, v243, v240
v_accvgpr_write_b32 a137, v243
v_accvgpr_read_b32 v244, a138
v_mul_f32 v244, v244, v240
v_accvgpr_write_b32 a138, v244
v_accvgpr_read_b32 v245, a139
v_mul_f32 v245, v245, v240
v_accvgpr_write_b32 a139, v245
v_accvgpr_read_b32 v242, a140
v_mul_f32 v242, v242, v240
v_accvgpr_write_b32 a140, v242
v_accvgpr_read_b32 v243, a141
v_mul_f32 v243, v243, v240
v_accvgpr_write_b32 a141, v243
v_accvgpr_read_b32 v244, a142
v_mul_f32 v244, v244, v240
v_accvgpr_write_b32 a142, v244
v_accvgpr_read_b32 v245, a143
v_mul_f32 v245, v245, v240
v_accvgpr_write_b32 a143, v245
v_accvgpr_read_b32 v242, a144
v_mul_f32 v242, v242, v240
v_accvgpr_write_b32 a144, v242
v_accvgpr_read_b32 v243, a145
v_mul_f32 v243, v243, v240
v_accvgpr_write_b32 a145, v243
v_accvgpr_read_b32 v244, a146
v_mul_f32 v244, v244, v240
v_accvgpr_write_b32 a146, v244
v_accvgpr_read_b32 v245, a147
v_mul_f32 v245, v245, v240
v_accvgpr_write_b32 a147, v245
v_accvgpr_read_b32 v242, a148
v_mul_f32 v242, v242, v240
v_accvgpr_write_b32 a148, v242
v_accvgpr_read_b32 v243, a149
v_mul_f32 v243, v243, v240
v_accvgpr_write_b32 a149, v243
v_accvgpr_read_b32 v244, a150
v_mul_f32 v244, v244, v240
v_accvgpr_write_b32 a150, v244
v_accvgpr_read_b32 v245, a151
v_mul_f32 v245, v245, v240
v_accvgpr_write_b32 a151, v245
v_accvgpr_read_b32 v242, a152
v_mul_f32 v242, v242, v240
v_accvgpr_write_b32 a152, v242
v_accvgpr_read_b32 v243, a153
v_mul_f32 v243, v243, v240
v_accvgpr_write_b32 a153, v243
v_accvgpr_read_b32 v244, a154
v_mul_f32 v244, v244, v240
v_accvgpr_write_b32 a154, v244
v_accvgpr_read_b32 v245, a155
v_mul_f32 v245, v245, v240
v_accvgpr_write_b32 a155, v245
v_accvgpr_read_b32 v242, a156
v_mul_f32 v242, v242, v240
v_accvgpr_write_b32 a156, v242
v_accvgpr_read_b32 v243, a157
v_mul_f32 v243, v243, v240
v_accvgpr_write_b32 a157, v243
v_accvgpr_read_b32 v244, a158
v_mul_f32 v244, v244, v240
v_accvgpr_write_b32 a158, v244
v_accvgpr_read_b32 v245, a159
v_mul_f32 v245, v245, v240
v_accvgpr_write_b32 a159, v245
v_sub_f32 v241, 0, v241
v_exp_f32 v241, v241
s_nop 0
v_mul_f32 v236, v236, v241
v_accvgpr_read_b32 v242, a160
v_mul_f32 v242, v242, v241
v_accvgpr_write_b32 a160, v242
v_accvgpr_read_b32 v243, a161
v_mul_f32 v243, v243, v241
v_accvgpr_write_b32 a161, v243
v_accvgpr_read_b32 v244, a162
v_mul_f32 v244, v244, v241
v_accvgpr_write_b32 a162, v244
v_accvgpr_read_b32 v245, a163
v_mul_f32 v245, v245, v241
v_accvgpr_write_b32 a163, v245
v_accvgpr_read_b32 v242, a164
v_mul_f32 v242, v242, v241
v_accvgpr_write_b32 a164, v242
v_accvgpr_read_b32 v243, a165
v_mul_f32 v243, v243, v241
v_accvgpr_write_b32 a165, v243
v_accvgpr_read_b32 v244, a166
v_mul_f32 v244, v244, v241
v_accvgpr_write_b32 a166, v244
v_accvgpr_read_b32 v245, a167
v_mul_f32 v245, v245, v241
v_accvgpr_write_b32 a167, v245
v_accvgpr_read_b32 v242, a168
v_mul_f32 v242, v242, v241
v_accvgpr_write_b32 a168, v242
v_accvgpr_read_b32 v243, a169
v_mul_f32 v243, v243, v241
v_accvgpr_write_b32 a169, v243
v_accvgpr_read_b32 v244, a170
v_mul_f32 v244, v244, v241
v_accvgpr_write_b32 a170, v244
v_accvgpr_read_b32 v245, a171
v_mul_f32 v245, v245, v241
v_accvgpr_write_b32 a171, v245
v_accvgpr_read_b32 v242, a172
v_mul_f32 v242, v242, v241
v_accvgpr_write_b32 a172, v242
v_accvgpr_read_b32 v243, a173
v_mul_f32 v243, v243, v241
v_accvgpr_write_b32 a173, v243
v_accvgpr_read_b32 v244, a174
v_mul_f32 v244, v244, v241
v_accvgpr_write_b32 a174, v244
v_accvgpr_read_b32 v245, a175
v_mul_f32 v245, v245, v241
v_accvgpr_write_b32 a175, v245
v_accvgpr_read_b32 v242, a176
v_mul_f32 v242, v242, v241
v_accvgpr_write_b32 a176, v242
v_accvgpr_read_b32 v243, a177
v_mul_f32 v243, v243, v241
v_accvgpr_write_b32 a177, v243
v_accvgpr_read_b32 v244, a178
v_mul_f32 v244, v244, v241
v_accvgpr_write_b32 a178, v244
v_accvgpr_read_b32 v245, a179
v_mul_f32 v245, v245, v241
v_accvgpr_write_b32 a179, v245
v_accvgpr_read_b32 v242, a180
v_mul_f32 v242, v242, v241
v_accvgpr_write_b32 a180, v242
v_accvgpr_read_b32 v243, a181
v_mul_f32 v243, v243, v241
v_accvgpr_write_b32 a181, v243
v_accvgpr_read_b32 v244, a182
v_mul_f32 v244, v244, v241
v_accvgpr_write_b32 a182, v244
v_accvgpr_read_b32 v245, a183
v_mul_f32 v245, v245, v241
v_accvgpr_write_b32 a183, v245
v_accvgpr_read_b32 v242, a184
v_mul_f32 v242, v242, v241
v_accvgpr_write_b32 a184, v242
v_accvgpr_read_b32 v243, a185
v_mul_f32 v243, v243, v241
v_accvgpr_write_b32 a185, v243
v_accvgpr_read_b32 v244, a186
v_mul_f32 v244, v244, v241
v_accvgpr_write_b32 a186, v244
v_accvgpr_read_b32 v245, a187
v_mul_f32 v245, v245, v241
v_accvgpr_write_b32 a187, v245
v_accvgpr_read_b32 v242, a188
v_mul_f32 v242, v242, v241
v_accvgpr_write_b32 a188, v242
v_accvgpr_read_b32 v243, a189
v_mul_f32 v243, v243, v241
v_accvgpr_write_b32 a189, v243
v_accvgpr_read_b32 v244, a190
v_mul_f32 v244, v244, v241
v_accvgpr_write_b32 a190, v244
v_accvgpr_read_b32 v245, a191
v_mul_f32 v245, v245, v241
v_accvgpr_write_b32 a191, v245
s_branch A_ret2
A_rare3_b:
s_nop 15
v_sub_f32 v240, 0, v240
v_exp_f32 v240, v240
s_nop 0
v_mul_f32 v22, v22, v240
v_accvgpr_read_b32 v242, a0
v_mul_f32 v242, v242, v240
v_accvgpr_write_b32 a0, v242
v_accvgpr_read_b32 v243, a1
v_mul_f32 v243, v243, v240
v_accvgpr_write_b32 a1, v243
v_accvgpr_read_b32 v244, a2
v_mul_f32 v244, v244, v240
v_accvgpr_write_b32 a2, v244
v_accvgpr_read_b32 v245, a3
v_mul_f32 v245, v245, v240
v_accvgpr_write_b32 a3, v245
v_accvgpr_read_b32 v242, a4
v_mul_f32 v242, v242, v240
v_accvgpr_write_b32 a4, v242
v_accvgpr_read_b32 v243, a5
v_mul_f32 v243, v243, v240
v_accvgpr_write_b32 a5, v243
v_accvgpr_read_b32 v244, a6
v_mul_f32 v244, v244, v240
v_accvgpr_write_b32 a6, v244
v_accvgpr_read_b32 v245, a7
v_mul_f32 v245, v245, v240
v_accvgpr_write_b32 a7, v245
v_accvgpr_read_b32 v242, a8
v_mul_f32 v242, v242, v240
v_accvgpr_write_b32 a8, v242
v_accvgpr_read_b32 v243, a9
v_mul_f32 v243, v243, v240
v_accvgpr_write_b32 a9, v243
v_accvgpr_read_b32 v244, a10
v_mul_f32 v244, v244, v240
v_accvgpr_write_b32 a10, v244
v_accvgpr_read_b32 v245, a11
v_mul_f32 v245, v245, v240
v_accvgpr_write_b32 a11, v245
v_accvgpr_read_b32 v242, a12
v_mul_f32 v242, v242, v240
v_accvgpr_write_b32 a12, v242
v_accvgpr_read_b32 v243, a13
v_mul_f32 v243, v243, v240
v_accvgpr_write_b32 a13, v243
v_accvgpr_read_b32 v244, a14
v_mul_f32 v244, v244, v240
v_accvgpr_write_b32 a14, v244
v_accvgpr_read_b32 v245, a15
v_mul_f32 v245, v245, v240
v_accvgpr_write_b32 a15, v245
v_accvgpr_read_b32 v242, a16
v_mul_f32 v242, v242, v240
v_accvgpr_write_b32 a16, v242
v_accvgpr_read_b32 v243, a17
v_mul_f32 v243, v243, v240
v_accvgpr_write_b32 a17, v243
v_accvgpr_read_b32 v244, a18
v_mul_f32 v244, v244, v240
v_accvgpr_write_b32 a18, v244
v_accvgpr_read_b32 v245, a19
v_mul_f32 v245, v245, v240
v_accvgpr_write_b32 a19, v245
v_accvgpr_read_b32 v242, a20
v_mul_f32 v242, v242, v240
v_accvgpr_write_b32 a20, v242
v_accvgpr_read_b32 v243, a21
v_mul_f32 v243, v243, v240
v_accvgpr_write_b32 a21, v243
v_accvgpr_read_b32 v244, a22
v_mul_f32 v244, v244, v240
v_accvgpr_write_b32 a22, v244
v_accvgpr_read_b32 v245, a23
v_mul_f32 v245, v245, v240
v_accvgpr_write_b32 a23, v245
v_accvgpr_read_b32 v242, a24
v_mul_f32 v242, v242, v240
v_accvgpr_write_b32 a24, v242
v_accvgpr_read_b32 v243, a25
v_mul_f32 v243, v243, v240
v_accvgpr_write_b32 a25, v243
v_accvgpr_read_b32 v244, a26
v_mul_f32 v244, v244, v240
v_accvgpr_write_b32 a26, v244
v_accvgpr_read_b32 v245, a27
v_mul_f32 v245, v245, v240
v_accvgpr_write_b32 a27, v245
v_accvgpr_read_b32 v242, a28
v_mul_f32 v242, v242, v240
v_accvgpr_write_b32 a28, v242
v_accvgpr_read_b32 v243, a29
v_mul_f32 v243, v243, v240
v_accvgpr_write_b32 a29, v243
v_accvgpr_read_b32 v244, a30
v_mul_f32 v244, v244, v240
v_accvgpr_write_b32 a30, v244
v_accvgpr_read_b32 v245, a31
v_mul_f32 v245, v245, v240
v_accvgpr_write_b32 a31, v245
v_sub_f32 v241, 0, v241
v_exp_f32 v241, v241
s_nop 0
v_mul_f32 v26, v26, v241
v_accvgpr_read_b32 v242, a32
v_mul_f32 v242, v242, v241
v_accvgpr_write_b32 a32, v242
v_accvgpr_read_b32 v243, a33
v_mul_f32 v243, v243, v241
v_accvgpr_write_b32 a33, v243
v_accvgpr_read_b32 v244, a34
v_mul_f32 v244, v244, v241
v_accvgpr_write_b32 a34, v244
v_accvgpr_read_b32 v245, a35
v_mul_f32 v245, v245, v241
v_accvgpr_write_b32 a35, v245
v_accvgpr_read_b32 v242, a36
v_mul_f32 v242, v242, v241
v_accvgpr_write_b32 a36, v242
v_accvgpr_read_b32 v243, a37
v_mul_f32 v243, v243, v241
v_accvgpr_write_b32 a37, v243
v_accvgpr_read_b32 v244, a38
v_mul_f32 v244, v244, v241
v_accvgpr_write_b32 a38, v244
v_accvgpr_read_b32 v245, a39
v_mul_f32 v245, v245, v241
v_accvgpr_write_b32 a39, v245
v_accvgpr_read_b32 v242, a40
v_mul_f32 v242, v242, v241
v_accvgpr_write_b32 a40, v242
v_accvgpr_read_b32 v243, a41
v_mul_f32 v243, v243, v241
v_accvgpr_write_b32 a41, v243
v_accvgpr_read_b32 v244, a42
v_mul_f32 v244, v244, v241
v_accvgpr_write_b32 a42, v244
v_accvgpr_read_b32 v245, a43
v_mul_f32 v245, v245, v241
v_accvgpr_write_b32 a43, v245
v_accvgpr_read_b32 v242, a44
v_mul_f32 v242, v242, v241
v_accvgpr_write_b32 a44, v242
v_accvgpr_read_b32 v243, a45
v_mul_f32 v243, v243, v241
v_accvgpr_write_b32 a45, v243
v_accvgpr_read_b32 v244, a46
v_mul_f32 v244, v244, v241
v_accvgpr_write_b32 a46, v244
v_accvgpr_read_b32 v245, a47
v_mul_f32 v245, v245, v241
v_accvgpr_write_b32 a47, v245
v_accvgpr_read_b32 v242, a48
v_mul_f32 v242, v242, v241
v_accvgpr_write_b32 a48, v242
v_accvgpr_read_b32 v243, a49
v_mul_f32 v243, v243, v241
v_accvgpr_write_b32 a49, v243
v_accvgpr_read_b32 v244, a50
v_mul_f32 v244, v244, v241
v_accvgpr_write_b32 a50, v244
v_accvgpr_read_b32 v245, a51
v_mul_f32 v245, v245, v241
v_accvgpr_write_b32 a51, v245
v_accvgpr_read_b32 v242, a52
v_mul_f32 v242, v242, v241
v_accvgpr_write_b32 a52, v242
v_accvgpr_read_b32 v243, a53
v_mul_f32 v243, v243, v241
v_accvgpr_write_b32 a53, v243
v_accvgpr_read_b32 v244, a54
v_mul_f32 v244, v244, v241
v_accvgpr_write_b32 a54, v244
v_accvgpr_read_b32 v245, a55
v_mul_f32 v245, v245, v241
v_accvgpr_write_b32 a55, v245
v_accvgpr_read_b32 v242, a56
v_mul_f32 v242, v242, v241
v_accvgpr_write_b32 a56, v242
v_accvgpr_read_b32 v243, a57
v_mul_f32 v243, v243, v241
v_accvgpr_write_b32 a57, v243
v_accvgpr_read_b32 v244, a58
v_mul_f32 v244, v244, v241
v_accvgpr_write_b32 a58, v244
v_accvgpr_read_b32 v245, a59
v_mul_f32 v245, v245, v241
v_accvgpr_write_b32 a59, v245
v_accvgpr_read_b32 v242, a60
v_mul_f32 v242, v242, v241
v_accvgpr_write_b32 a60, v242
v_accvgpr_read_b32 v243, a61
v_mul_f32 v243, v243, v241
v_accvgpr_write_b32 a61, v243
v_accvgpr_read_b32 v244, a62
v_mul_f32 v244, v244, v241
v_accvgpr_write_b32 a62, v244
v_accvgpr_read_b32 v245, a63
v_mul_f32 v245, v245, v241
v_accvgpr_write_b32 a63, v245
s_branch A_ret3
A_rare4_b:
s_nop 15
v_sub_f32 v240, 0, v240
v_exp_f32 v240, v240
s_nop 0
v_mul_f32 v224, v224, v240
v_accvgpr_read_b32 v242, a64
v_mul_f32 v242, v242, v240
v_accvgpr_write_b32 a64, v242
v_accvgpr_read_b32 v243, a65
v_mul_f32 v243, v243, v240
v_accvgpr_write_b32 a65, v243
v_accvgpr_read_b32 v244, a66
v_mul_f32 v244, v244, v240
v_accvgpr_write_b32 a66, v244
v_accvgpr_read_b32 v245, a67
v_mul_f32 v245, v245, v240
v_accvgpr_write_b32 a67, v245
v_accvgpr_read_b32 v242, a68
v_mul_f32 v242, v242, v240
v_accvgpr_write_b32 a68, v242
v_accvgpr_read_b32 v243, a69
v_mul_f32 v243, v243, v240
v_accvgpr_write_b32 a69, v243
v_accvgpr_read_b32 v244, a70
v_mul_f32 v244, v244, v240
v_accvgpr_write_b32 a70, v244
v_accvgpr_read_b32 v245, a71
v_mul_f32 v245, v245, v240
v_accvgpr_write_b32 a71, v245
v_accvgpr_read_b32 v242, a72
v_mul_f32 v242, v242, v240
v_accvgpr_write_b32 a72, v242
v_accvgpr_read_b32 v243, a73
v_mul_f32 v243, v243, v240
v_accvgpr_write_b32 a73, v243
v_accvgpr_read_b32 v244, a74
v_mul_f32 v244, v244, v240
v_accvgpr_write_b32 a74, v244
v_accvgpr_read_b32 v245, a75
v_mul_f32 v245, v245, v240
v_accvgpr_write_b32 a75, v245
v_accvgpr_read_b32 v242, a76
v_mul_f32 v242, v242, v240
v_accvgpr_write_b32 a76, v242
v_accvgpr_read_b32 v243, a77
v_mul_f32 v243, v243, v240
v_accvgpr_write_b32 a77, v243
v_accvgpr_read_b32 v244, a78
v_mul_f32 v244, v244, v240
v_accvgpr_write_b32 a78, v244
v_accvgpr_read_b32 v245, a79
v_mul_f32 v245, v245, v240
v_accvgpr_write_b32 a79, v245
v_accvgpr_read_b32 v242, a80
v_mul_f32 v242, v242, v240
v_accvgpr_write_b32 a80, v242
v_accvgpr_read_b32 v243, a81
v_mul_f32 v243, v243, v240
v_accvgpr_write_b32 a81, v243
v_accvgpr_read_b32 v244, a82
v_mul_f32 v244, v244, v240
v_accvgpr_write_b32 a82, v244
v_accvgpr_read_b32 v245, a83
v_mul_f32 v245, v245, v240
v_accvgpr_write_b32 a83, v245
v_accvgpr_read_b32 v242, a84
v_mul_f32 v242, v242, v240
v_accvgpr_write_b32 a84, v242
v_accvgpr_read_b32 v243, a85
v_mul_f32 v243, v243, v240
v_accvgpr_write_b32 a85, v243
v_accvgpr_read_b32 v244, a86
v_mul_f32 v244, v244, v240
v_accvgpr_write_b32 a86, v244
v_accvgpr_read_b32 v245, a87
v_mul_f32 v245, v245, v240
v_accvgpr_write_b32 a87, v245
v_accvgpr_read_b32 v242, a88
v_mul_f32 v242, v242, v240
v_accvgpr_write_b32 a88, v242
v_accvgpr_read_b32 v243, a89
v_mul_f32 v243, v243, v240
v_accvgpr_write_b32 a89, v243
v_accvgpr_read_b32 v244, a90
v_mul_f32 v244, v244, v240
v_accvgpr_write_b32 a90, v244
v_accvgpr_read_b32 v245, a91
v_mul_f32 v245, v245, v240
v_accvgpr_write_b32 a91, v245
v_accvgpr_read_b32 v242, a92
v_mul_f32 v242, v242, v240
v_accvgpr_write_b32 a92, v242
v_accvgpr_read_b32 v243, a93
v_mul_f32 v243, v243, v240
v_accvgpr_write_b32 a93, v243
v_accvgpr_read_b32 v244, a94
v_mul_f32 v244, v244, v240
v_accvgpr_write_b32 a94, v244
v_accvgpr_read_b32 v245, a95
v_mul_f32 v245, v245, v240
v_accvgpr_write_b32 a95, v245
v_sub_f32 v241, 0, v241
v_exp_f32 v241, v241
s_nop 0
v_mul_f32 v228, v228, v241
v_accvgpr_read_b32 v242, a96
v_mul_f32 v242, v242, v241
v_accvgpr_write_b32 a96, v242
v_accvgpr_read_b32 v243, a97
v_mul_f32 v243, v243, v241
v_accvgpr_write_b32 a97, v243
v_accvgpr_read_b32 v244, a98
v_mul_f32 v244, v244, v241
v_accvgpr_write_b32 a98, v244
v_accvgpr_read_b32 v245, a99
v_mul_f32 v245, v245, v241
v_accvgpr_write_b32 a99, v245
v_accvgpr_read_b32 v242, a100
v_mul_f32 v242, v242, v241
v_accvgpr_write_b32 a100, v242
v_accvgpr_read_b32 v243, a101
v_mul_f32 v243, v243, v241
v_accvgpr_write_b32 a101, v243
v_accvgpr_read_b32 v244, a102
v_mul_f32 v244, v244, v241
v_accvgpr_write_b32 a102, v244
v_accvgpr_read_b32 v245, a103
v_mul_f32 v245, v245, v241
v_accvgpr_write_b32 a103, v245
v_accvgpr_read_b32 v242, a104
v_mul_f32 v242, v242, v241
v_accvgpr_write_b32 a104, v242
v_accvgpr_read_b32 v243, a105
v_mul_f32 v243, v243, v241
v_accvgpr_write_b32 a105, v243
v_accvgpr_read_b32 v244, a106
v_mul_f32 v244, v244, v241
v_accvgpr_write_b32 a106, v244
v_accvgpr_read_b32 v245, a107
v_mul_f32 v245, v245, v241
v_accvgpr_write_b32 a107, v245
v_accvgpr_read_b32 v242, a108
v_mul_f32 v242, v242, v241
v_accvgpr_write_b32 a108, v242
v_accvgpr_read_b32 v243, a109
v_mul_f32 v243, v243, v241
v_accvgpr_write_b32 a109, v243
v_accvgpr_read_b32 v244, a110
v_mul_f32 v244, v244, v241
v_accvgpr_write_b32 a110, v244
v_accvgpr_read_b32 v245, a111
v_mul_f32 v245, v245, v241
v_accvgpr_write_b32 a111, v245
v_accvgpr_read_b32 v242, a112
v_mul_f32 v242, v242, v241
v_accvgpr_write_b32 a112, v242
v_accvgpr_read_b32 v243, a113
v_mul_f32 v243, v243, v241
v_accvgpr_write_b32 a113, v243
v_accvgpr_read_b32 v244, a114
v_mul_f32 v244, v244, v241
v_accvgpr_write_b32 a114, v244
v_accvgpr_read_b32 v245, a115
v_mul_f32 v245, v245, v241
v_accvgpr_write_b32 a115, v245
v_accvgpr_read_b32 v242, a116
v_mul_f32 v242, v242, v241
v_accvgpr_write_b32 a116, v242
v_accvgpr_read_b32 v243, a117
v_mul_f32 v243, v243, v241
v_accvgpr_write_b32 a117, v243
v_accvgpr_read_b32 v244, a118
v_mul_f32 v244, v244, v241
v_accvgpr_write_b32 a118, v244
v_accvgpr_read_b32 v245, a119
v_mul_f32 v245, v245, v241
v_accvgpr_write_b32 a119, v245
v_accvgpr_read_b32 v242, a120
v_mul_f32 v242, v242, v241
v_accvgpr_write_b32 a120, v242
v_accvgpr_read_b32 v243, a121
v_mul_f32 v243, v243, v241
v_accvgpr_write_b32 a121, v243
v_accvgpr_read_b32 v244, a122
v_mul_f32 v244, v244, v241
v_accvgpr_write_b32 a122, v244
v_accvgpr_read_b32 v245, a123
v_mul_f32 v245, v245, v241
v_accvgpr_write_b32 a123, v245
v_accvgpr_read_b32 v242, a124
v_mul_f32 v242, v242, v241
v_accvgpr_write_b32 a124, v242
v_accvgpr_read_b32 v243, a125
v_mul_f32 v243, v243, v241
v_accvgpr_write_b32 a125, v243
v_accvgpr_read_b32 v244, a126
v_mul_f32 v244, v244, v241
v_accvgpr_write_b32 a126, v244
v_accvgpr_read_b32 v245, a127
v_mul_f32 v245, v245, v241
v_accvgpr_write_b32 a127, v245
s_branch A_ret4
A_rare5_b:
s_nop 15
v_sub_f32 v240, 0, v240
v_exp_f32 v240, v240
s_nop 0
v_mul_f32 v232, v232, v240
v_accvgpr_read_b32 v242, a128
v_mul_f32 v242, v242, v240
v_accvgpr_write_b32 a128, v242
v_accvgpr_read_b32 v243, a129
v_mul_f32 v243, v243, v240
v_accvgpr_write_b32 a129, v243
v_accvgpr_read_b32 v244, a130
v_mul_f32 v244, v244, v240
v_accvgpr_write_b32 a130, v244
v_accvgpr_read_b32 v245, a131
v_mul_f32 v245, v245, v240
v_accvgpr_write_b32 a131, v245
v_accvgpr_read_b32 v242, a132
v_mul_f32 v242, v242, v240
v_accvgpr_write_b32 a132, v242
v_accvgpr_read_b32 v243, a133
v_mul_f32 v243, v243, v240
v_accvgpr_write_b32 a133, v243
v_accvgpr_read_b32 v244, a134
v_mul_f32 v244, v244, v240
v_accvgpr_write_b32 a134, v244
v_accvgpr_read_b32 v245, a135
v_mul_f32 v245, v245, v240
v_accvgpr_write_b32 a135, v245
v_accvgpr_read_b32 v242, a136
v_mul_f32 v242, v242, v240
v_accvgpr_write_b32 a136, v242
v_accvgpr_read_b32 v243, a137
v_mul_f32 v243, v243, v240
v_accvgpr_write_b32 a137, v243
v_accvgpr_read_b32 v244, a138
v_mul_f32 v244, v244, v240
v_accvgpr_write_b32 a138, v244
v_accvgpr_read_b32 v245, a139
v_mul_f32 v245, v245, v240
v_accvgpr_write_b32 a139, v245
v_accvgpr_read_b32 v242, a140
v_mul_f32 v242, v242, v240
v_accvgpr_write_b32 a140, v242
v_accvgpr_read_b32 v243, a141
v_mul_f32 v243, v243, v240
v_accvgpr_write_b32 a141, v243
v_accvgpr_read_b32 v244, a142
v_mul_f32 v244, v244, v240
v_accvgpr_write_b32 a142, v244
v_accvgpr_read_b32 v245, a143
v_mul_f32 v245, v245, v240
v_accvgpr_write_b32 a143, v245
v_accvgpr_read_b32 v242, a144
v_mul_f32 v242, v242, v240
v_accvgpr_write_b32 a144, v242
v_accvgpr_read_b32 v243, a145
v_mul_f32 v243, v243, v240
v_accvgpr_write_b32 a145, v243
v_accvgpr_read_b32 v244, a146
v_mul_f32 v244, v244, v240
v_accvgpr_write_b32 a146, v244
v_accvgpr_read_b32 v245, a147
v_mul_f32 v245, v245, v240
v_accvgpr_write_b32 a147, v245
v_accvgpr_read_b32 v242, a148
v_mul_f32 v242, v242, v240
v_accvgpr_write_b32 a148, v242
v_accvgpr_read_b32 v243, a149
v_mul_f32 v243, v243, v240
v_accvgpr_write_b32 a149, v243
v_accvgpr_read_b32 v244, a150
v_mul_f32 v244, v244, v240
v_accvgpr_write_b32 a150, v244
v_accvgpr_read_b32 v245, a151
v_mul_f32 v245, v245, v240
v_accvgpr_write_b32 a151, v245
v_accvgpr_read_b32 v242, a152
v_mul_f32 v242, v242, v240
v_accvgpr_write_b32 a152, v242
v_accvgpr_read_b32 v243, a153
v_mul_f32 v243, v243, v240
v_accvgpr_write_b32 a153, v243
v_accvgpr_read_b32 v244, a154
v_mul_f32 v244, v244, v240
v_accvgpr_write_b32 a154, v244
v_accvgpr_read_b32 v245, a155
v_mul_f32 v245, v245, v240
v_accvgpr_write_b32 a155, v245
v_accvgpr_read_b32 v242, a156
v_mul_f32 v242, v242, v240
v_accvgpr_write_b32 a156, v242
v_accvgpr_read_b32 v243, a157
v_mul_f32 v243, v243, v240
v_accvgpr_write_b32 a157, v243
v_accvgpr_read_b32 v244, a158
v_mul_f32 v244, v244, v240
v_accvgpr_write_b32 a158, v244
v_accvgpr_read_b32 v245, a159
v_mul_f32 v245, v245, v240
v_accvgpr_write_b32 a159, v245
v_sub_f32 v241, 0, v241
v_exp_f32 v241, v241
s_nop 0
v_mul_f32 v236, v236, v241
v_accvgpr_read_b32 v242, a160
v_mul_f32 v242, v242, v241
v_accvgpr_write_b32 a160, v242
v_accvgpr_read_b32 v243, a161
v_mul_f32 v243, v243, v241
v_accvgpr_write_b32 a161, v243
v_accvgpr_read_b32 v244, a162
v_mul_f32 v244, v244, v241
v_accvgpr_write_b32 a162, v244
v_accvgpr_read_b32 v245, a163
v_mul_f32 v245, v245, v241
v_accvgpr_write_b32 a163, v245
v_accvgpr_read_b32 v242, a164
v_mul_f32 v242, v242, v241
v_accvgpr_write_b32 a164, v242
v_accvgpr_read_b32 v243, a165
v_mul_f32 v243, v243, v241
v_accvgpr_write_b32 a165, v243
v_accvgpr_read_b32 v244, a166
v_mul_f32 v244, v244, v241
v_accvgpr_write_b32 a166, v244
v_accvgpr_read_b32 v245, a167
v_mul_f32 v245, v245, v241
v_accvgpr_write_b32 a167, v245
v_accvgpr_read_b32 v242, a168
v_mul_f32 v242, v242, v241
v_accvgpr_write_b32 a168, v242
v_accvgpr_read_b32 v243, a169
v_mul_f32 v243, v243, v241
v_accvgpr_write_b32 a169, v243
v_accvgpr_read_b32 v244, a170
v_mul_f32 v244, v244, v241
v_accvgpr_write_b32 a170, v244
v_accvgpr_read_b32 v245, a171
v_mul_f32 v245, v245, v241
v_accvgpr_write_b32 a171, v245
v_accvgpr_read_b32 v242, a172
v_mul_f32 v242, v242, v241
v_accvgpr_write_b32 a172, v242
v_accvgpr_read_b32 v243, a173
v_mul_f32 v243, v243, v241
v_accvgpr_write_b32 a173, v243
v_accvgpr_read_b32 v244, a174
v_mul_f32 v244, v244, v241
v_accvgpr_write_b32 a174, v244
v_accvgpr_read_b32 v245, a175
v_mul_f32 v245, v245, v241
v_accvgpr_write_b32 a175, v245
v_accvgpr_read_b32 v242, a176
v_mul_f32 v242, v242, v241
v_accvgpr_write_b32 a176, v242
v_accvgpr_read_b32 v243, a177
v_mul_f32 v243, v243, v241
v_accvgpr_write_b32 a177, v243
v_accvgpr_read_b32 v244, a178
v_mul_f32 v244, v244, v241
v_accvgpr_write_b32 a178, v244
v_accvgpr_read_b32 v245, a179
v_mul_f32 v245, v245, v241
v_accvgpr_write_b32 a179, v245
v_accvgpr_read_b32 v242, a180
v_mul_f32 v242, v242, v241
v_accvgpr_write_b32 a180, v242
v_accvgpr_read_b32 v243, a181
v_mul_f32 v243, v243, v241
v_accvgpr_write_b32 a181, v243
v_accvgpr_read_b32 v244, a182
v_mul_f32 v244, v244, v241
v_accvgpr_write_b32 a182, v244
v_accvgpr_read_b32 v245, a183
v_mul_f32 v245, v245, v241
v_accvgpr_write_b32 a183, v245
v_accvgpr_read_b32 v242, a184
v_mul_f32 v242, v242, v241
v_accvgpr_write_b32 a184, v242
v_accvgpr_read_b32 v243, a185
v_mul_f32 v243, v243, v241
v_accvgpr_write_b32 a185, v243
v_accvgpr_read_b32 v244, a186
v_mul_f32 v244, v244, v241
v_accvgpr_write_b32 a186, v244
v_accvgpr_read_b32 v245, a187
v_mul_f32 v245, v245, v241
v_accvgpr_write_b32 a187, v245
v_accvgpr_read_b32 v242, a188
v_mul_f32 v242, v242, v241
v_accvgpr_write_b32 a188, v242
v_accvgpr_read_b32 v243, a189
v_mul_f32 v243, v243, v241
v_accvgpr_write_b32 a189, v243
v_accvgpr_read_b32 v244, a190
v_mul_f32 v244, v244, v241
v_accvgpr_write_b32 a190, v244
v_accvgpr_read_b32 v245, a191
v_mul_f32 v245, v245, v241
v_accvgpr_write_b32 a191, v245
s_branch A_ret5
A_rare0z_b:
s_nop 15
v_sub_f32 v240, 0, v240
v_exp_f32 v240, v240
s_nop 0
v_mul_f32 v22, v22, v240
v_accvgpr_read_b32 v242, a0
v_mul_f32 v242, v242, v240
v_accvgpr_write_b32 a0, v242
v_accvgpr_read_b32 v243, a1
v_mul_f32 v243, v243, v240
v_accvgpr_write_b32 a1, v243
v_accvgpr_read_b32 v244, a2
v_mul_f32 v244, v244, v240
v_accvgpr_write_b32 a2, v244
v_accvgpr_read_b32 v245, a3
v_mul_f32 v245, v245, v240
v_accvgpr_write_b32 a3, v245
v_accvgpr_read_b32 v242, a4
v_mul_f32 v242, v242, v240
v_accvgpr_write_b32 a4, v242
v_accvgpr_read_b32 v243, a5
v_mul_f32 v243, v243, v240
v_accvgpr_write_b32 a5, v243
v_accvgpr_read_b32 v244, a6
v_mul_f32 v244, v244, v240
v_accvgpr_write_b32 a6, v244
v_accvgpr_read_b32 v245, a7
v_mul_f32 v245, v245, v240
v_accvgpr_write_b32 a7, v245
v_accvgpr_read_b32 v242, a8
v_mul_f32 v242, v242, v240
v_accvgpr_write_b32 a8, v242
v_accvgpr_read_b32 v243, a9
v_mul_f32 v243, v243, v240
v_accvgpr_write_b32 a9, v243
v_accvgpr_read_b32 v244, a10
v_mul_f32 v244, v244, v240
v_accvgpr_write_b32 a10, v244
v_accvgpr_read_b32 v245, a11
v_mul_f32 v245, v245, v240
v_accvgpr_write_b32 a11, v245
v_accvgpr_read_b32 v242, a12
v_mul_f32 v242, v242, v240
v_accvgpr_write_b32 a12, v242
v_accvgpr_read_b32 v243, a13
v_mul_f32 v243, v243, v240
v_accvgpr_write_b32 a13, v243
v_accvgpr_read_b32 v244, a14
v_mul_f32 v244, v244, v240
v_accvgpr_write_b32 a14, v244
v_accvgpr_read_b32 v245, a15
v_mul_f32 v245, v245, v240
v_accvgpr_write_b32 a15, v245
v_accvgpr_read_b32 v242, a16
v_mul_f32 v242, v242, v240
v_accvgpr_write_b32 a16, v242
v_accvgpr_read_b32 v243, a17
v_mul_f32 v243, v243, v240
v_accvgpr_write_b32 a17, v243
v_accvgpr_read_b32 v244, a18
v_mul_f32 v244, v244, v240
v_accvgpr_write_b32 a18, v244
v_accvgpr_read_b32 v245, a19
v_mul_f32 v245, v245, v240
v_accvgpr_write_b32 a19, v245
v_accvgpr_read_b32 v242, a20
v_mul_f32 v242, v242, v240
v_accvgpr_write_b32 a20, v242
v_accvgpr_read_b32 v243, a21
v_mul_f32 v243, v243, v240
v_accvgpr_write_b32 a21, v243
v_accvgpr_read_b32 v244, a22
v_mul_f32 v244, v244, v240
v_accvgpr_write_b32 a22, v244
v_accvgpr_read_b32 v245, a23
v_mul_f32 v245, v245, v240
v_accvgpr_write_b32 a23, v245
v_accvgpr_read_b32 v242, a24
v_mul_f32 v242, v242, v240
v_accvgpr_write_b32 a24, v242
v_accvgpr_read_b32 v243, a25
v_mul_f32 v243, v243, v240
v_accvgpr_write_b32 a25, v243
v_accvgpr_read_b32 v244, a26
v_mul_f32 v244, v244, v240
v_accvgpr_write_b32 a26, v244
v_accvgpr_read_b32 v245, a27
v_mul_f32 v245, v245, v240
v_accvgpr_write_b32 a27, v245
v_accvgpr_read_b32 v242, a28
v_mul_f32 v242, v242, v240
v_accvgpr_write_b32 a28, v242
v_accvgpr_read_b32 v243, a29
v_mul_f32 v243, v243, v240
v_accvgpr_write_b32 a29, v243
v_accvgpr_read_b32 v244, a30
v_mul_f32 v244, v244, v240
v_accvgpr_write_b32 a30, v244
v_accvgpr_read_b32 v245, a31
v_mul_f32 v245, v245, v240
v_accvgpr_write_b32 a31, v245
v_sub_f32 v241, 0, v241
v_exp_f32 v241, v241
s_nop 0
v_mul_f32 v26, v26, v241
v_accvgpr_read_b32 v242, a32
v_mul_f32 v242, v242, v241
v_accvgpr_write_b32 a32, v242
v_accvgpr_read_b32 v243, a33
v_mul_f32 v243, v243, v241
v_accvgpr_write_b32 a33, v243
v_accvgpr_read_b32 v244, a34
v_mul_f32 v244, v244, v241
v_accvgpr_write_b32 a34, v244
v_accvgpr_read_b32 v245, a35
v_mul_f32 v245, v245, v241
v_accvgpr_write_b32 a35, v245
v_accvgpr_read_b32 v242, a36
v_mul_f32 v242, v242, v241
v_accvgpr_write_b32 a36, v242
v_accvgpr_read_b32 v243, a37
v_mul_f32 v243, v243, v241
v_accvgpr_write_b32 a37, v243
v_accvgpr_read_b32 v244, a38
v_mul_f32 v244, v244, v241
v_accvgpr_write_b32 a38, v244
v_accvgpr_read_b32 v245, a39
v_mul_f32 v245, v245, v241
v_accvgpr_write_b32 a39, v245
v_accvgpr_read_b32 v242, a40
v_mul_f32 v242, v242, v241
v_accvgpr_write_b32 a40, v242
v_accvgpr_read_b32 v243, a41
v_mul_f32 v243, v243, v241
v_accvgpr_write_b32 a41, v243
v_accvgpr_read_b32 v244, a42
v_mul_f32 v244, v244, v241
v_accvgpr_write_b32 a42, v244
v_accvgpr_read_b32 v245, a43
v_mul_f32 v245, v245, v241
v_accvgpr_write_b32 a43, v245
v_accvgpr_read_b32 v242, a44
v_mul_f32 v242, v242, v241
v_accvgpr_write_b32 a44, v242
v_accvgpr_read_b32 v243, a45
v_mul_f32 v243, v243, v241
v_accvgpr_write_b32 a45, v243
v_accvgpr_read_b32 v244, a46
v_mul_f32 v244, v244, v241
v_accvgpr_write_b32 a46, v244
v_accvgpr_read_b32 v245, a47
v_mul_f32 v245, v245, v241
v_accvgpr_write_b32 a47, v245
v_accvgpr_read_b32 v242, a48
v_mul_f32 v242, v242, v241
v_accvgpr_write_b32 a48, v242
v_accvgpr_read_b32 v243, a49
v_mul_f32 v243, v243, v241
v_accvgpr_write_b32 a49, v243
v_accvgpr_read_b32 v244, a50
v_mul_f32 v244, v244, v241
v_accvgpr_write_b32 a50, v244
v_accvgpr_read_b32 v245, a51
v_mul_f32 v245, v245, v241
v_accvgpr_write_b32 a51, v245
v_accvgpr_read_b32 v242, a52
v_mul_f32 v242, v242, v241
v_accvgpr_write_b32 a52, v242
v_accvgpr_read_b32 v243, a53
v_mul_f32 v243, v243, v241
v_accvgpr_write_b32 a53, v243
v_accvgpr_read_b32 v244, a54
v_mul_f32 v244, v244, v241
v_accvgpr_write_b32 a54, v244
v_accvgpr_read_b32 v245, a55
v_mul_f32 v245, v245, v241
v_accvgpr_write_b32 a55, v245
v_accvgpr_read_b32 v242, a56
v_mul_f32 v242, v242, v241
v_accvgpr_write_b32 a56, v242
v_accvgpr_read_b32 v243, a57
v_mul_f32 v243, v243, v241
v_accvgpr_write_b32 a57, v243
v_accvgpr_read_b32 v244, a58
v_mul_f32 v244, v244, v241
v_accvgpr_write_b32 a58, v244
v_accvgpr_read_b32 v245, a59
v_mul_f32 v245, v245, v241
v_accvgpr_write_b32 a59, v245
v_accvgpr_read_b32 v242, a60
v_mul_f32 v242, v242, v241
v_accvgpr_write_b32 a60, v242
v_accvgpr_read_b32 v243, a61
v_mul_f32 v243, v243, v241
v_accvgpr_write_b32 a61, v243
v_accvgpr_read_b32 v244, a62
v_mul_f32 v244, v244, v241
v_accvgpr_write_b32 a62, v244
v_accvgpr_read_b32 v245, a63
v_mul_f32 v245, v245, v241
v_accvgpr_write_b32 a63, v245
s_branch A_ret0z
A_rare1z_b:
s_nop 15
v_sub_f32 v240, 0, v240
v_exp_f32 v240, v240
s_nop 0
v_mul_f32 v224, v224, v240
v_accvgpr_read_b32 v242, a64
v_mul_f32 v242, v242, v240
v_accvgpr_write_b32 a64, v242
v_accvgpr_read_b32 v243, a65
v_mul_f32 v243, v243, v240
v_accvgpr_write_b32 a65, v243
v_accvgpr_read_b32 v244, a66
v_mul_f32 v244, v244, v240
v_accvgpr_write_b32 a66, v244
v_accvgpr_read_b32 v245, a67
v_mul_f32 v245, v245, v240
v_accvgpr_write_b32 a67, v245
v_accvgpr_read_b32 v242, a68
v_mul_f32 v242, v242, v240
v_accvgpr_write_b32 a68, v242
v_accvgpr_read_b32 v243, a69
v_mul_f32 v243, v243, v240
v_accvgpr_write_b32 a69, v243
v_accvgpr_read_b32 v244, a70
v_mul_f32 v244, v244, v240
v_accvgpr_write_b32 a70, v244
v_accvgpr_read_b32 v245, a71
v_mul_f32 v245, v245, v240
v_accvgpr_write_b32 a71, v245
v_accvgpr_read_b32 v242, a72
v_mul_f32 v242, v242, v240
v_accvgpr_write_b32 a72, v242
v_accvgpr_read_b32 v243, a73
v_mul_f32 v243, v243, v240
v_accvgpr_write_b32 a73, v243
v_accvgpr_read_b32 v244, a74
v_mul_f32 v244, v244, v240
v_accvgpr_write_b32 a74, v244
v_accvgpr_read_b32 v245, a75
v_mul_f32 v245, v245, v240
v_accvgpr_write_b32 a75, v245
v_accvgpr_read_b32 v242, a76
v_mul_f32 v242, v242, v240
v_accvgpr_write_b32 a76, v242
v_accvgpr_read_b32 v243, a77
v_mul_f32 v243, v243, v240
v_accvgpr_write_b32 a77, v243
v_accvgpr_read_b32 v244, a78
v_mul_f32 v244, v244, v240
v_accvgpr_write_b32 a78, v244
v_accvgpr_read_b32 v245, a79
v_mul_f32 v245, v245, v240
v_accvgpr_write_b32 a79, v245
v_accvgpr_read_b32 v242, a80
v_mul_f32 v242, v242, v240
v_accvgpr_write_b32 a80, v242
v_accvgpr_read_b32 v243, a81
v_mul_f32 v243, v243, v240
v_accvgpr_write_b32 a81, v243
v_accvgpr_read_b32 v244, a82
v_mul_f32 v244, v244, v240
v_accvgpr_write_b32 a82, v244
v_accvgpr_read_b32 v245, a83
v_mul_f32 v245, v245, v240
v_accvgpr_write_b32 a83, v245
v_accvgpr_read_b32 v242, a84
v_mul_f32 v242, v242, v240
v_accvgpr_write_b32 a84, v242
v_accvgpr_read_b32 v243, a85
v_mul_f32 v243, v243, v240
v_accvgpr_write_b32 a85, v243
v_accvgpr_read_b32 v244, a86
v_mul_f32 v244, v244, v240
v_accvgpr_write_b32 a86, v244
v_accvgpr_read_b32 v245, a87
v_mul_f32 v245, v245, v240
v_accvgpr_write_b32 a87, v245
v_accvgpr_read_b32 v242, a88
v_mul_f32 v242, v242, v240
v_accvgpr_write_b32 a88, v242
v_accvgpr_read_b32 v243, a89
v_mul_f32 v243, v243, v240
v_accvgpr_write_b32 a89, v243
v_accvgpr_read_b32 v244, a90
v_mul_f32 v244, v244, v240
v_accvgpr_write_b32 a90, v244
v_accvgpr_read_b32 v245, a91
v_mul_f32 v245, v245, v240
v_accvgpr_write_b32 a91, v245
v_accvgpr_read_b32 v242, a92
v_mul_f32 v242, v242, v240
v_accvgpr_write_b32 a92, v242
v_accvgpr_read_b32 v243, a93
v_mul_f32 v243, v243, v240
v_accvgpr_write_b32 a93, v243
v_accvgpr_read_b32 v244, a94
v_mul_f32 v244, v244, v240
v_accvgpr_write_b32 a94, v244
v_accvgpr_read_b32 v245, a95
v_mul_f32 v245, v245, v240
v_accvgpr_write_b32 a95, v245
v_sub_f32 v241, 0, v241
v_exp_f32 v241, v241
s_nop 0
v_mul_f32 v228, v228, v241
v_accvgpr_read_b32 v242, a96
v_mul_f32 v242, v242, v241
v_accvgpr_write_b32 a96, v242
v_accvgpr_read_b32 v243, a97
v_mul_f32 v243, v243, v241
v_accvgpr_write_b32 a97, v243
v_accvgpr_read_b32 v244, a98
v_mul_f32 v244, v244, v241
v_accvgpr_write_b32 a98, v244
v_accvgpr_read_b32 v245, a99
v_mul_f32 v245, v245, v241
v_accvgpr_write_b32 a99, v245
v_accvgpr_read_b32 v242, a100
v_mul_f32 v242, v242, v241
v_accvgpr_write_b32 a100, v242
v_accvgpr_read_b32 v243, a101
v_mul_f32 v243, v243, v241
v_accvgpr_write_b32 a101, v243
v_accvgpr_read_b32 v244, a102
v_mul_f32 v244, v244, v241
v_accvgpr_write_b32 a102, v244
v_accvgpr_read_b32 v245, a103
v_mul_f32 v245, v245, v241
v_accvgpr_write_b32 a103, v245
v_accvgpr_read_b32 v242, a104
v_mul_f32 v242, v242, v241
v_accvgpr_write_b32 a104, v242
v_accvgpr_read_b32 v243, a105
v_mul_f32 v243, v243, v241
v_accvgpr_write_b32 a105, v243
v_accvgpr_read_b32 v244, a106
v_mul_f32 v244, v244, v241
v_accvgpr_write_b32 a106, v244
v_accvgpr_read_b32 v245, a107
v_mul_f32 v245, v245, v241
v_accvgpr_write_b32 a107, v245
v_accvgpr_read_b32 v242, a108
v_mul_f32 v242, v242, v241
v_accvgpr_write_b32 a108, v242
v_accvgpr_read_b32 v243, a109
v_mul_f32 v243, v243, v241
v_accvgpr_write_b32 a109, v243
v_accvgpr_read_b32 v244, a110
v_mul_f32 v244, v244, v241
v_accvgpr_write_b32 a110, v244
v_accvgpr_read_b32 v245, a111
v_mul_f32 v245, v245, v241
v_accvgpr_write_b32 a111, v245
v_accvgpr_read_b32 v242, a112
v_mul_f32 v242, v242, v241
v_accvgpr_write_b32 a112, v242
v_accvgpr_read_b32 v243, a113
v_mul_f32 v243, v243, v241
v_accvgpr_write_b32 a113, v243
v_accvgpr_read_b32 v244, a114
v_mul_f32 v244, v244, v241
v_accvgpr_write_b32 a114, v244
v_accvgpr_read_b32 v245, a115
v_mul_f32 v245, v245, v241
v_accvgpr_write_b32 a115, v245
v_accvgpr_read_b32 v242, a116
v_mul_f32 v242, v242, v241
v_accvgpr_write_b32 a116, v242
v_accvgpr_read_b32 v243, a117
v_mul_f32 v243, v243, v241
v_accvgpr_write_b32 a117, v243
v_accvgpr_read_b32 v244, a118
v_mul_f32 v244, v244, v241
v_accvgpr_write_b32 a118, v244
v_accvgpr_read_b32 v245, a119
v_mul_f32 v245, v245, v241
v_accvgpr_write_b32 a119, v245
v_accvgpr_read_b32 v242, a120
v_mul_f32 v242, v242, v241
v_accvgpr_write_b32 a120, v242
v_accvgpr_read_b32 v243, a121
v_mul_f32 v243, v243, v241
v_accvgpr_write_b32 a121, v243
v_accvgpr_read_b32 v244, a122
v_mul_f32 v244, v244, v241
v_accvgpr_write_b32 a122, v244
v_accvgpr_read_b32 v245, a123
v_mul_f32 v245, v245, v241
v_accvgpr_write_b32 a123, v245
v_accvgpr_read_b32 v242, a124
v_mul_f32 v242, v242, v241
v_accvgpr_write_b32 a124, v242
v_accvgpr_read_b32 v243, a125
v_mul_f32 v243, v243, v241
v_accvgpr_write_b32 a125, v243
v_accvgpr_read_b32 v244, a126
v_mul_f32 v244, v244, v241
v_accvgpr_write_b32 a126, v244
v_accvgpr_read_b32 v245, a127
v_mul_f32 v245, v245, v241
v_accvgpr_write_b32 a127, v245
s_branch A_ret1z
A_rare2z_b:
s_nop 15
v_sub_f32 v240, 0, v240
v_exp_f32 v240, v240
s_nop 0
v_mul_f32 v232, v232, v240
v_accvgpr_read_b32 v242, a128
v_mul_f32 v242, v242, v240
v_accvgpr_write_b32 a128, v242
v_accvgpr_read_b32 v243, a129
v_mul_f32 v243, v243, v240
v_accvgpr_write_b32 a129, v243
v_accvgpr_read_b32 v244, a130
v_mul_f32 v244, v244, v240
v_accvgpr_write_b32 a130, v244
v_accvgpr_read_b32 v245, a131
v_mul_f32 v245, v245, v240
v_accvgpr_write_b32 a131, v245
v_accvgpr_read_b32 v242, a132
v_mul_f32 v242, v242, v240
v_accvgpr_write_b32 a132, v242
v_accvgpr_read_b32 v243, a133
v_mul_f32 v243, v243, v240
v_accvgpr_write_b32 a133, v243
v_accvgpr_read_b32 v244, a134
v_mul_f32 v244, v244, v240
v_accvgpr_write_b32 a134, v244
v_accvgpr_read_b32 v245, a135
v_mul_f32 v245, v245, v240
v_accvgpr_write_b32 a135, v245
v_accvgpr_read_b32 v242, a136
v_mul_f32 v242, v242, v240
v_accvgpr_write_b32 a136, v242
v_accvgpr_read_b32 v243, a137
v_mul_f32 v243, v243, v240
v_accvgpr_write_b32 a137, v243
v_accvgpr_read_b32 v244, a138
v_mul_f32 v244, v244, v240
v_accvgpr_write_b32 a138, v244
v_accvgpr_read_b32 v245, a139
v_mul_f32 v245, v245, v240
v_accvgpr_write_b32 a139, v245
v_accvgpr_read_b32 v242, a140
v_mul_f32 v242, v242, v240
v_accvgpr_write_b32 a140, v242
v_accvgpr_read_b32 v243, a141
v_mul_f32 v243, v243, v240
v_accvgpr_write_b32 a141, v243
v_accvgpr_read_b32 v244, a142
v_mul_f32 v244, v244, v240
v_accvgpr_write_b32 a142, v244
v_accvgpr_read_b32 v245, a143
v_mul_f32 v245, v245, v240
v_accvgpr_write_b32 a143, v245
v_accvgpr_read_b32 v242, a144
v_mul_f32 v242, v242, v240
v_accvgpr_write_b32 a144, v242
v_accvgpr_read_b32 v243, a145
v_mul_f32 v243, v243, v240
v_accvgpr_write_b32 a145, v243
v_accvgpr_read_b32 v244, a146
v_mul_f32 v244, v244, v240
v_accvgpr_write_b32 a146, v244
v_accvgpr_read_b32 v245, a147
v_mul_f32 v245, v245, v240
v_accvgpr_write_b32 a147, v245
v_accvgpr_read_b32 v242, a148
v_mul_f32 v242, v242, v240
v_accvgpr_write_b32 a148, v242
v_accvgpr_read_b32 v243, a149
v_mul_f32 v243, v243, v240
v_accvgpr_write_b32 a149, v243
v_accvgpr_read_b32 v244, a150
v_mul_f32 v244, v244, v240
v_accvgpr_write_b32 a150, v244
v_accvgpr_read_b32 v245, a151
v_mul_f32 v245, v245, v240
v_accvgpr_write_b32 a151, v245
v_accvgpr_read_b32 v242, a152
v_mul_f32 v242, v242, v240
v_accvgpr_write_b32 a152, v242
v_accvgpr_read_b32 v243, a153
v_mul_f32 v243, v243, v240
v_accvgpr_write_b32 a153, v243
v_accvgpr_read_b32 v244, a154
v_mul_f32 v244, v244, v240
v_accvgpr_write_b32 a154, v244
v_accvgpr_read_b32 v245, a155
v_mul_f32 v245, v245, v240
v_accvgpr_write_b32 a155, v245
v_accvgpr_read_b32 v242, a156
v_mul_f32 v242, v242, v240
v_accvgpr_write_b32 a156, v242
v_accvgpr_read_b32 v243, a157
v_mul_f32 v243, v243, v240
v_accvgpr_write_b32 a157, v243
v_accvgpr_read_b32 v244, a158
v_mul_f32 v244, v244, v240
v_accvgpr_write_b32 a158, v244
v_accvgpr_read_b32 v245, a159
v_mul_f32 v245, v245, v240
v_accvgpr_write_b32 a159, v245
v_sub_f32 v241, 0, v241
v_exp_f32 v241, v241
s_nop 0
v_mul_f32 v236, v236, v241
v_accvgpr_read_b32 v242, a160
v_mul_f32 v242, v242, v241
v_accvgpr_write_b32 a160, v242
v_accvgpr_read_b32 v243, a161
v_mul_f32 v243, v243, v241
v_accvgpr_write_b32 a161, v243
v_accvgpr_read_b32 v244, a162
v_mul_f32 v244, v244, v241
v_accvgpr_write_b32 a162, v244
v_accvgpr_read_b32 v245, a163
v_mul_f32 v245, v245, v241
v_accvgpr_write_b32 a163, v245
v_accvgpr_read_b32 v242, a164
v_mul_f32 v242, v242, v241
v_accvgpr_write_b32 a164, v242
v_accvgpr_read_b32 v243, a165
v_mul_f32 v243, v243, v241
v_accvgpr_write_b32 a165, v243
v_accvgpr_read_b32 v244, a166
v_mul_f32 v244, v244, v241
v_accvgpr_write_b32 a166, v244
v_accvgpr_read_b32 v245, a167
v_mul_f32 v245, v245, v241
v_accvgpr_write_b32 a167, v245
v_accvgpr_read_b32 v242, a168
v_mul_f32 v242, v242, v241
v_accvgpr_write_b32 a168, v242
v_accvgpr_read_b32 v243, a169
v_mul_f32 v243, v243, v241
v_accvgpr_write_b32 a169, v243
v_accvgpr_read_b32 v244, a170
v_mul_f32 v244, v244, v241
v_accvgpr_write_b32 a170, v244
v_accvgpr_read_b32 v245, a171
v_mul_f32 v245, v245, v241
v_accvgpr_write_b32 a171, v245
v_accvgpr_read_b32 v242, a172
v_mul_f32 v242, v242, v241
v_accvgpr_write_b32 a172, v242
v_accvgpr_read_b32 v243, a173
v_mul_f32 v243, v243, v241
v_accvgpr_write_b32 a173, v243
v_accvgpr_read_b32 v244, a174
v_mul_f32 v244, v244, v241
v_accvgpr_write_b32 a174, v244
v_accvgpr_read_b32 v245, a175
v_mul_f32 v245, v245, v241
v_accvgpr_write_b32 a175, v245
v_accvgpr_read_b32 v242, a176
v_mul_f32 v242, v242, v241
v_accvgpr_write_b32 a176, v242
v_accvgpr_read_b32 v243, a177
v_mul_f32 v243, v243, v241
v_accvgpr_write_b32 a177, v243
v_accvgpr_read_b32 v244, a178
v_mul_f32 v244, v244, v241
v_accvgpr_write_b32 a178, v244
v_accvgpr_read_b32 v245, a179
v_mul_f32 v245, v245, v241
v_accvgpr_write_b32 a179, v245
v_accvgpr_read_b32 v242, a180
v_mul_f32 v242, v242, v241
v_accvgpr_write_b32 a180, v242
v_accvgpr_read_b32 v243, a181
v_mul_f32 v243, v243, v241
v_accvgpr_write_b32 a181, v243
v_accvgpr_read_b32 v244, a182
v_mul_f32 v244, v244, v241
v_accvgpr_write_b32 a182, v244
v_accvgpr_read_b32 v245, a183
v_mul_f32 v245, v245, v241
v_accvgpr_write_b32 a183, v245
v_accvgpr_read_b32 v242, a184
v_mul_f32 v242, v242, v241
v_accvgpr_write_b32 a184, v242
v_accvgpr_read_b32 v243, a185
v_mul_f32 v243, v243, v241
v_accvgpr_write_b32 a185, v243
v_accvgpr_read_b32 v244, a186
v_mul_f32 v244, v244, v241
v_accvgpr_write_b32 a186, v244
v_accvgpr_read_b32 v245, a187
v_mul_f32 v245, v245, v241
v_accvgpr_write_b32 a187, v245
v_accvgpr_read_b32 v242, a188
v_mul_f32 v242, v242, v241
v_accvgpr_write_b32 a188, v242
v_accvgpr_read_b32 v243, a189
v_mul_f32 v243, v243, v241
v_accvgpr_write_b32 a189, v243
v_accvgpr_read_b32 v244, a190
v_mul_f32 v244, v244, v241
v_accvgpr_write_b32 a190, v244
v_accvgpr_read_b32 v245, a191
v_mul_f32 v245, v245, v241
v_accvgpr_write_b32 a191, v245
s_branch A_ret2z
A_rare3z_b:
s_nop 15
v_sub_f32 v240, 0, v240
v_exp_f32 v240, v240
s_nop 0
v_mul_f32 v22, v22, v240
v_accvgpr_read_b32 v242, a0
v_mul_f32 v242, v242, v240
v_accvgpr_write_b32 a0, v242
v_accvgpr_read_b32 v243, a1
v_mul_f32 v243, v243, v240
v_accvgpr_write_b32 a1, v243
v_accvgpr_read_b32 v244, a2
v_mul_f32 v244, v244, v240
v_accvgpr_write_b32 a2, v244
v_accvgpr_read_b32 v245, a3
v_mul_f32 v245, v245, v240
v_accvgpr_write_b32 a3, v245
v_accvgpr_read_b32 v242, a4
v_mul_f32 v242, v242, v240
v_accvgpr_write_b32 a4, v242
v_accvgpr_read_b32 v243, a5
v_mul_f32 v243, v243, v240
v_accvgpr_write_b32 a5, v243
v_accvgpr_read_b32 v244, a6
v_mul_f32 v244, v244, v240
v_accvgpr_write_b32 a6, v244
v_accvgpr_read_b32 v245, a7
v_mul_f32 v245, v245, v240
v_accvgpr_write_b32 a7, v245
v_accvgpr_read_b32 v242, a8
v_mul_f32 v242, v242, v240
v_accvgpr_write_b32 a8, v242
v_accvgpr_read_b32 v243, a9
v_mul_f32 v243, v243, v240
v_accvgpr_write_b32 a9, v243
v_accvgpr_read_b32 v244, a10
v_mul_f32 v244, v244, v240
v_accvgpr_write_b32 a10, v244
v_accvgpr_read_b32 v245, a11
v_mul_f32 v245, v245, v240
v_accvgpr_write_b32 a11, v245
v_accvgpr_read_b32 v242, a12
v_mul_f32 v242, v242, v240
v_accvgpr_write_b32 a12, v242
v_accvgpr_read_b32 v243, a13
v_mul_f32 v243, v243, v240
v_accvgpr_write_b32 a13, v243
v_accvgpr_read_b32 v244, a14
v_mul_f32 v244, v244, v240
v_accvgpr_write_b32 a14, v244
v_accvgpr_read_b32 v245, a15
v_mul_f32 v245, v245, v240
v_accvgpr_write_b32 a15, v245
v_accvgpr_read_b32 v242, a16
v_mul_f32 v242, v242, v240
v_accvgpr_write_b32 a16, v242
v_accvgpr_read_b32 v243, a17
v_mul_f32 v243, v243, v240
v_accvgpr_write_b32 a17, v243
v_accvgpr_read_b32 v244, a18
v_mul_f32 v244, v244, v240
v_accvgpr_write_b32 a18, v244
v_accvgpr_read_b32 v245, a19
v_mul_f32 v245, v245, v240
v_accvgpr_write_b32 a19, v245
v_accvgpr_read_b32 v242, a20
v_mul_f32 v242, v242, v240
v_accvgpr_write_b32 a20, v242
v_accvgpr_read_b32 v243, a21
v_mul_f32 v243, v243, v240
v_accvgpr_write_b32 a21, v243
v_accvgpr_read_b32 v244, a22
v_mul_f32 v244, v244, v240
v_accvgpr_write_b32 a22, v244
v_accvgpr_read_b32 v245, a23
v_mul_f32 v245, v245, v240
v_accvgpr_write_b32 a23, v245
v_accvgpr_read_b32 v242, a24
v_mul_f32 v242, v242, v240
v_accvgpr_write_b32 a24, v242
v_accvgpr_read_b32 v243, a25
v_mul_f32 v243, v243, v240
v_accvgpr_write_b32 a25, v243
v_accvgpr_read_b32 v244, a26
v_mul_f32 v244, v244, v240
v_accvgpr_write_b32 a26, v244
v_accvgpr_read_b32 v245, a27
v_mul_f32 v245, v245, v240
v_accvgpr_write_b32 a27, v245
v_accvgpr_read_b32 v242, a28
v_mul_f32 v242, v242, v240
v_accvgpr_write_b32 a28, v242
v_accvgpr_read_b32 v243, a29
v_mul_f32 v243, v243, v240
v_accvgpr_write_b32 a29, v243
v_accvgpr_read_b32 v244, a30
v_mul_f32 v244, v244, v240
v_accvgpr_write_b32 a30, v244
v_accvgpr_read_b32 v245, a31
v_mul_f32 v245, v245, v240
v_accvgpr_write_b32 a31, v245
v_sub_f32 v241, 0, v241
v_exp_f32 v241, v241
s_nop 0
v_mul_f32 v26, v26, v241
v_accvgpr_read_b32 v242, a32
v_mul_f32 v242, v242, v241
v_accvgpr_write_b32 a32, v242
v_accvgpr_read_b32 v243, a33
v_mul_f32 v243, v243, v241
v_accvgpr_write_b32 a33, v243
v_accvgpr_read_b32 v244, a34
v_mul_f32 v244, v244, v241
v_accvgpr_write_b32 a34, v244
v_accvgpr_read_b32 v245, a35
v_mul_f32 v245, v245, v241
v_accvgpr_write_b32 a35, v245
v_accvgpr_read_b32 v242, a36
v_mul_f32 v242, v242, v241
v_accvgpr_write_b32 a36, v242
v_accvgpr_read_b32 v243, a37
v_mul_f32 v243, v243, v241
v_accvgpr_write_b32 a37, v243
v_accvgpr_read_b32 v244, a38
v_mul_f32 v244, v244, v241
v_accvgpr_write_b32 a38, v244
v_accvgpr_read_b32 v245, a39
v_mul_f32 v245, v245, v241
v_accvgpr_write_b32 a39, v245
v_accvgpr_read_b32 v242, a40
v_mul_f32 v242, v242, v241
v_accvgpr_write_b32 a40, v242
v_accvgpr_read_b32 v243, a41
v_mul_f32 v243, v243, v241
v_accvgpr_write_b32 a41, v243
v_accvgpr_read_b32 v244, a42
v_mul_f32 v244, v244, v241
v_accvgpr_write_b32 a42, v244
v_accvgpr_read_b32 v245, a43
v_mul_f32 v245, v245, v241
v_accvgpr_write_b32 a43, v245
v_accvgpr_read_b32 v242, a44
v_mul_f32 v242, v242, v241
v_accvgpr_write_b32 a44, v242
v_accvgpr_read_b32 v243, a45
v_mul_f32 v243, v243, v241
v_accvgpr_write_b32 a45, v243
v_accvgpr_read_b32 v244, a46
v_mul_f32 v244, v244, v241
v_accvgpr_write_b32 a46, v244
v_accvgpr_read_b32 v245, a47
v_mul_f32 v245, v245, v241
v_accvgpr_write_b32 a47, v245
v_accvgpr_read_b32 v242, a48
v_mul_f32 v242, v242, v241
v_accvgpr_write_b32 a48, v242
v_accvgpr_read_b32 v243, a49
v_mul_f32 v243, v243, v241
v_accvgpr_write_b32 a49, v243
v_accvgpr_read_b32 v244, a50
v_mul_f32 v244, v244, v241
v_accvgpr_write_b32 a50, v244
v_accvgpr_read_b32 v245, a51
v_mul_f32 v245, v245, v241
v_accvgpr_write_b32 a51, v245
v_accvgpr_read_b32 v242, a52
v_mul_f32 v242, v242, v241
v_accvgpr_write_b32 a52, v242
v_accvgpr_read_b32 v243, a53
v_mul_f32 v243, v243, v241
v_accvgpr_write_b32 a53, v243
v_accvgpr_read_b32 v244, a54
v_mul_f32 v244, v244, v241
v_accvgpr_write_b32 a54, v244
v_accvgpr_read_b32 v245, a55
v_mul_f32 v245, v245, v241
v_accvgpr_write_b32 a55, v245
v_accvgpr_read_b32 v242, a56
v_mul_f32 v242, v242, v241
v_accvgpr_write_b32 a56, v242
v_accvgpr_read_b32 v243, a57
v_mul_f32 v243, v243, v241
v_accvgpr_write_b32 a57, v243
v_accvgpr_read_b32 v244, a58
v_mul_f32 v244, v244, v241
v_accvgpr_write_b32 a58, v244
v_accvgpr_read_b32 v245, a59
v_mul_f32 v245, v245, v241
v_accvgpr_write_b32 a59, v245
v_accvgpr_read_b32 v242, a60
v_mul_f32 v242, v242, v241
v_accvgpr_write_b32 a60, v242
v_accvgpr_read_b32 v243, a61
v_mul_f32 v243, v243, v241
v_accvgpr_write_b32 a61, v243
v_accvgpr_read_b32 v244, a62
v_mul_f32 v244, v244, v241
v_accvgpr_write_b32 a62, v244
v_accvgpr_read_b32 v245, a63
v_mul_f32 v245, v245, v241
v_accvgpr_write_b32 a63, v245
s_branch A_ret3z
A_rare4z_b:
s_nop 15
v_sub_f32 v240, 0, v240
v_exp_f32 v240, v240
s_nop 0
v_mul_f32 v224, v224, v240
v_accvgpr_read_b32 v242, a64
v_mul_f32 v242, v242, v240
v_accvgpr_write_b32 a64, v242
v_accvgpr_read_b32 v243, a65
v_mul_f32 v243, v243, v240
v_accvgpr_write_b32 a65, v243
v_accvgpr_read_b32 v244, a66
v_mul_f32 v244, v244, v240
v_accvgpr_write_b32 a66, v244
v_accvgpr_read_b32 v245, a67
v_mul_f32 v245, v245, v240
v_accvgpr_write_b32 a67, v245
v_accvgpr_read_b32 v242, a68
v_mul_f32 v242, v242, v240
v_accvgpr_write_b32 a68, v242
v_accvgpr_read_b32 v243, a69
v_mul_f32 v243, v243, v240
v_accvgpr_write_b32 a69, v243
v_accvgpr_read_b32 v244, a70
v_mul_f32 v244, v244, v240
v_accvgpr_write_b32 a70, v244
v_accvgpr_read_b32 v245, a71
v_mul_f32 v245, v245, v240
v_accvgpr_write_b32 a71, v245
v_accvgpr_read_b32 v242, a72
v_mul_f32 v242, v242, v240
v_accvgpr_write_b32 a72, v242
v_accvgpr_read_b32 v243, a73
v_mul_f32 v243, v243, v240
v_accvgpr_write_b32 a73, v243
v_accvgpr_read_b32 v244, a74
v_mul_f32 v244, v244, v240
v_accvgpr_write_b32 a74, v244
v_accvgpr_read_b32 v245, a75
v_mul_f32 v245, v245, v240
v_accvgpr_write_b32 a75, v245
v_accvgpr_read_b32 v242, a76
v_mul_f32 v242, v242, v240
v_accvgpr_write_b32 a76, v242
v_accvgpr_read_b32 v243, a77
v_mul_f32 v243, v243, v240
v_accvgpr_write_b32 a77, v243
v_accvgpr_read_b32 v244, a78
v_mul_f32 v244, v244, v240
v_accvgpr_write_b32 a78, v244
v_accvgpr_read_b32 v245, a79
v_mul_f32 v245, v245, v240
v_accvgpr_write_b32 a79, v245
v_accvgpr_read_b32 v242, a80
v_mul_f32 v242, v242, v240
v_accvgpr_write_b32 a80, v242
v_accvgpr_read_b32 v243, a81
v_mul_f32 v243, v243, v240
v_accvgpr_write_b32 a81, v243
v_accvgpr_read_b32 v244, a82
v_mul_f32 v244, v244, v240
v_accvgpr_write_b32 a82, v244
v_accvgpr_read_b32 v245, a83
v_mul_f32 v245, v245, v240
v_accvgpr_write_b32 a83, v245
v_accvgpr_read_b32 v242, a84
v_mul_f32 v242, v242, v240
v_accvgpr_write_b32 a84, v242
v_accvgpr_read_b32 v243, a85
v_mul_f32 v243, v243, v240
v_accvgpr_write_b32 a85, v243
v_accvgpr_read_b32 v244, a86
v_mul_f32 v244, v244, v240
v_accvgpr_write_b32 a86, v244
v_accvgpr_read_b32 v245, a87
v_mul_f32 v245, v245, v240
v_accvgpr_write_b32 a87, v245
v_accvgpr_read_b32 v242, a88
v_mul_f32 v242, v242, v240
v_accvgpr_write_b32 a88, v242
v_accvgpr_read_b32 v243, a89
v_mul_f32 v243, v243, v240
v_accvgpr_write_b32 a89, v243
v_accvgpr_read_b32 v244, a90
v_mul_f32 v244, v244, v240
v_accvgpr_write_b32 a90, v244
v_accvgpr_read_b32 v245, a91
v_mul_f32 v245, v245, v240
v_accvgpr_write_b32 a91, v245
v_accvgpr_read_b32 v242, a92
v_mul_f32 v242, v242, v240
v_accvgpr_write_b32 a92, v242
v_accvgpr_read_b32 v243, a93
v_mul_f32 v243, v243, v240
v_accvgpr_write_b32 a93, v243
v_accvgpr_read_b32 v244, a94
v_mul_f32 v244, v244, v240
v_accvgpr_write_b32 a94, v244
v_accvgpr_read_b32 v245, a95
v_mul_f32 v245, v245, v240
v_accvgpr_write_b32 a95, v245
v_sub_f32 v241, 0, v241
v_exp_f32 v241, v241
s_nop 0
v_mul_f32 v228, v228, v241
v_accvgpr_read_b32 v242, a96
v_mul_f32 v242, v242, v241
v_accvgpr_write_b32 a96, v242
v_accvgpr_read_b32 v243, a97
v_mul_f32 v243, v243, v241
v_accvgpr_write_b32 a97, v243
v_accvgpr_read_b32 v244, a98
v_mul_f32 v244, v244, v241
v_accvgpr_write_b32 a98, v244
v_accvgpr_read_b32 v245, a99
v_mul_f32 v245, v245, v241
v_accvgpr_write_b32 a99, v245
v_accvgpr_read_b32 v242, a100
v_mul_f32 v242, v242, v241
v_accvgpr_write_b32 a100, v242
v_accvgpr_read_b32 v243, a101
v_mul_f32 v243, v243, v241
v_accvgpr_write_b32 a101, v243
v_accvgpr_read_b32 v244, a102
v_mul_f32 v244, v244, v241
v_accvgpr_write_b32 a102, v244
v_accvgpr_read_b32 v245, a103
v_mul_f32 v245, v245, v241
v_accvgpr_write_b32 a103, v245
v_accvgpr_read_b32 v242, a104
v_mul_f32 v242, v242, v241
v_accvgpr_write_b32 a104, v242
v_accvgpr_read_b32 v243, a105
v_mul_f32 v243, v243, v241
v_accvgpr_write_b32 a105, v243
v_accvgpr_read_b32 v244, a106
v_mul_f32 v244, v244, v241
v_accvgpr_write_b32 a106, v244
v_accvgpr_read_b32 v245, a107
v_mul_f32 v245, v245, v241
v_accvgpr_write_b32 a107, v245
v_accvgpr_read_b32 v242, a108
v_mul_f32 v242, v242, v241
v_accvgpr_write_b32 a108, v242
v_accvgpr_read_b32 v243, a109
v_mul_f32 v243, v243, v241
v_accvgpr_write_b32 a109, v243
v_accvgpr_read_b32 v244, a110
v_mul_f32 v244, v244, v241
v_accvgpr_write_b32 a110, v244
v_accvgpr_read_b32 v245, a111
v_mul_f32 v245, v245, v241
v_accvgpr_write_b32 a111, v245
v_accvgpr_read_b32 v242, a112
v_mul_f32 v242, v242, v241
v_accvgpr_write_b32 a112, v242
v_accvgpr_read_b32 v243, a113
v_mul_f32 v243, v243, v241
v_accvgpr_write_b32 a113, v243
v_accvgpr_read_b32 v244, a114
v_mul_f32 v244, v244, v241
v_accvgpr_write_b32 a114, v244
v_accvgpr_read_b32 v245, a115
v_mul_f32 v245, v245, v241
v_accvgpr_write_b32 a115, v245
v_accvgpr_read_b32 v242, a116
v_mul_f32 v242, v242, v241
v_accvgpr_write_b32 a116, v242
v_accvgpr_read_b32 v243, a117
v_mul_f32 v243, v243, v241
v_accvgpr_write_b32 a117, v243
v_accvgpr_read_b32 v244, a118
v_mul_f32 v244, v244, v241
v_accvgpr_write_b32 a118, v244
v_accvgpr_read_b32 v245, a119
v_mul_f32 v245, v245, v241
v_accvgpr_write_b32 a119, v245
v_accvgpr_read_b32 v242, a120
v_mul_f32 v242, v242, v241
v_accvgpr_write_b32 a120, v242
v_accvgpr_read_b32 v243, a121
v_mul_f32 v243, v243, v241
v_accvgpr_write_b32 a121, v243
v_accvgpr_read_b32 v244, a122
v_mul_f32 v244, v244, v241
v_accvgpr_write_b32 a122, v244
v_accvgpr_read_b32 v245, a123
v_mul_f32 v245, v245, v241
v_accvgpr_write_b32 a123, v245
v_accvgpr_read_b32 v242, a124
v_mul_f32 v242, v242, v241
v_accvgpr_write_b32 a124, v242
v_accvgpr_read_b32 v243, a125
v_mul_f32 v243, v243, v241
v_accvgpr_write_b32 a125, v243
v_accvgpr_read_b32 v244, a126
v_mul_f32 v244, v244, v241
v_accvgpr_write_b32 a126, v244
v_accvgpr_read_b32 v245, a127
v_mul_f32 v245, v245, v241
v_accvgpr_write_b32 a127, v245
s_branch A_ret4z
A_rare5z_b:
s_nop 15
v_sub_f32 v240, 0, v240
v_exp_f32 v240, v240
s_nop 0
v_mul_f32 v232, v232, v240
v_accvgpr_read_b32 v242, a128
v_mul_f32 v242, v242, v240
v_accvgpr_write_b32 a128, v242
v_accvgpr_read_b32 v243, a129
v_mul_f32 v243, v243, v240
v_accvgpr_write_b32 a129, v243
v_accvgpr_read_b32 v244, a130
v_mul_f32 v244, v244, v240
v_accvgpr_write_b32 a130, v244
v_accvgpr_read_b32 v245, a131
v_mul_f32 v245, v245, v240
v_accvgpr_write_b32 a131, v245
v_accvgpr_read_b32 v242, a132
v_mul_f32 v242, v242, v240
v_accvgpr_write_b32 a132, v242
v_accvgpr_read_b32 v243, a133
v_mul_f32 v243, v243, v240
v_accvgpr_write_b32 a133, v243
v_accvgpr_read_b32 v244, a134
v_mul_f32 v244, v244, v240
v_accvgpr_write_b32 a134, v244
v_accvgpr_read_b32 v245, a135
v_mul_f32 v245, v245, v240
v_accvgpr_write_b32 a135, v245
v_accvgpr_read_b32 v242, a136
v_mul_f32 v242, v242, v240
v_accvgpr_write_b32 a136, v242
v_accvgpr_read_b32 v243, a137
v_mul_f32 v243, v243, v240
v_accvgpr_write_b32 a137, v243
v_accvgpr_read_b32 v244, a138
v_mul_f32 v244, v244, v240
v_accvgpr_write_b32 a138, v244
v_accvgpr_read_b32 v245, a139
v_mul_f32 v245, v245, v240
v_accvgpr_write_b32 a139, v245
v_accvgpr_read_b32 v242, a140
v_mul_f32 v242, v242, v240
v_accvgpr_write_b32 a140, v242
v_accvgpr_read_b32 v243, a141
v_mul_f32 v243, v243, v240
v_accvgpr_write_b32 a141, v243
v_accvgpr_read_b32 v244, a142
v_mul_f32 v244, v244, v240
v_accvgpr_write_b32 a142, v244
v_accvgpr_read_b32 v245, a143
v_mul_f32 v245, v245, v240
v_accvgpr_write_b32 a143, v245
v_accvgpr_read_b32 v242, a144
v_mul_f32 v242, v242, v240
v_accvgpr_write_b32 a144, v242
v_accvgpr_read_b32 v243, a145
v_mul_f32 v243, v243, v240
v_accvgpr_write_b32 a145, v243
v_accvgpr_read_b32 v244, a146
v_mul_f32 v244, v244, v240
v_accvgpr_write_b32 a146, v244
v_accvgpr_read_b32 v245, a147
v_mul_f32 v245, v245, v240
v_accvgpr_write_b32 a147, v245
v_accvgpr_read_b32 v242, a148
v_mul_f32 v242, v242, v240
v_accvgpr_write_b32 a148, v242
v_accvgpr_read_b32 v243, a149
v_mul_f32 v243, v243, v240
v_accvgpr_write_b32 a149, v243
v_accvgpr_read_b32 v244, a150
v_mul_f32 v244, v244, v240
v_accvgpr_write_b32 a150, v244
v_accvgpr_read_b32 v245, a151
v_mul_f32 v245, v245, v240
v_accvgpr_write_b32 a151, v245
v_accvgpr_read_b32 v242, a152
v_mul_f32 v242, v242, v240
v_accvgpr_write_b32 a152, v242
v_accvgpr_read_b32 v243, a153
v_mul_f32 v243, v243, v240
v_accvgpr_write_b32 a153, v243
v_accvgpr_read_b32 v244, a154
v_mul_f32 v244, v244, v240
v_accvgpr_write_b32 a154, v244
v_accvgpr_read_b32 v245, a155
v_mul_f32 v245, v245, v240
v_accvgpr_write_b32 a155, v245
v_accvgpr_read_b32 v242, a156
v_mul_f32 v242, v242, v240
v_accvgpr_write_b32 a156, v242
v_accvgpr_read_b32 v243, a157
v_mul_f32 v243, v243, v240
v_accvgpr_write_b32 a157, v243
v_accvgpr_read_b32 v244, a158
v_mul_f32 v244, v244, v240
v_accvgpr_write_b32 a158, v244
v_accvgpr_read_b32 v245, a159
v_mul_f32 v245, v245, v240
v_accvgpr_write_b32 a159, v245
v_sub_f32 v241, 0, v241
v_exp_f32 v241, v241
s_nop 0
v_mul_f32 v236, v236, v241
v_accvgpr_read_b32 v242, a160
v_mul_f32 v242, v242, v241
v_accvgpr_write_b32 a160, v242
v_accvgpr_read_b32 v243, a161
v_mul_f32 v243, v243, v241
v_accvgpr_write_b32 a161, v243
v_accvgpr_read_b32 v244, a162
v_mul_f32 v244, v244, v241
v_accvgpr_write_b32 a162, v244
v_accvgpr_read_b32 v245, a163
v_mul_f32 v245, v245, v241
v_accvgpr_write_b32 a163, v245
v_accvgpr_read_b32 v242, a164
v_mul_f32 v242, v242, v241
v_accvgpr_write_b32 a164, v242
v_accvgpr_read_b32 v243, a165
v_mul_f32 v243, v243, v241
v_accvgpr_write_b32 a165, v243
v_accvgpr_read_b32 v244, a166
v_mul_f32 v244, v244, v241
v_accvgpr_write_b32 a166, v244
v_accvgpr_read_b32 v245, a167
v_mul_f32 v245, v245, v241
v_accvgpr_write_b32 a167, v245
v_accvgpr_read_b32 v242, a168
v_mul_f32 v242, v242, v241
v_accvgpr_write_b32 a168, v242
v_accvgpr_read_b32 v243, a169
v_mul_f32 v243, v243, v241
v_accvgpr_write_b32 a169, v243
v_accvgpr_read_b32 v244, a170
v_mul_f32 v244, v244, v241
v_accvgpr_write_b32 a170, v244
v_accvgpr_read_b32 v245, a171
v_mul_f32 v245, v245, v241
v_accvgpr_write_b32 a171, v245
v_accvgpr_read_b32 v242, a172
v_mul_f32 v242, v242, v241
v_accvgpr_write_b32 a172, v242
v_accvgpr_read_b32 v243, a173
v_mul_f32 v243, v243, v241
v_accvgpr_write_b32 a173, v243
v_accvgpr_read_b32 v244, a174
v_mul_f32 v244, v244, v241
v_accvgpr_write_b32 a174, v244
v_accvgpr_read_b32 v245, a175
v_mul_f32 v245, v245, v241
v_accvgpr_write_b32 a175, v245
v_accvgpr_read_b32 v242, a176
v_mul_f32 v242, v242, v241
v_accvgpr_write_b32 a176, v242
v_accvgpr_read_b32 v243, a177
v_mul_f32 v243, v243, v241
v_accvgpr_write_b32 a177, v243
v_accvgpr_read_b32 v244, a178
v_mul_f32 v244, v244, v241
v_accvgpr_write_b32 a178, v244
v_accvgpr_read_b32 v245, a179
v_mul_f32 v245, v245, v241
v_accvgpr_write_b32 a179, v245
v_accvgpr_read_b32 v242, a180
v_mul_f32 v242, v242, v241
v_accvgpr_write_b32 a180, v242
v_accvgpr_read_b32 v243, a181
v_mul_f32 v243, v243, v241
v_accvgpr_write_b32 a181, v243
v_accvgpr_read_b32 v244, a182
v_mul_f32 v244, v244, v241
v_accvgpr_write_b32 a182, v244
v_accvgpr_read_b32 v245, a183
v_mul_f32 v245, v245, v241
v_accvgpr_write_b32 a183, v245
v_accvgpr_read_b32 v242, a184
v_mul_f32 v242, v242, v241
v_accvgpr_write_b32 a184, v242
v_accvgpr_read_b32 v243, a185
v_mul_f32 v243, v243, v241
v_accvgpr_write_b32 a185, v243
v_accvgpr_read_b32 v244, a186
v_mul_f32 v244, v244, v241
v_accvgpr_write_b32 a186, v244
v_accvgpr_read_b32 v245, a187
v_mul_f32 v245, v245, v241
v_accvgpr_write_b32 a187, v245
v_accvgpr_read_b32 v242, a188
v_mul_f32 v242, v242, v241
v_accvgpr_write_b32 a188, v242
v_accvgpr_read_b32 v243, a189
v_mul_f32 v243, v243, v241
v_accvgpr_write_b32 a189, v243
v_accvgpr_read_b32 v244, a190
v_mul_f32 v244, v244, v241
v_accvgpr_write_b32 a190, v244
v_accvgpr_read_b32 v245, a191
v_mul_f32 v245, v245, v241
v_accvgpr_write_b32 a191, v245
s_branch A_ret5z
L_codeend:
.section .rodata,"a"
.p2align 6
.amdhsa_kernel concat_heads__gqa_block_cached__mha_block_cached__near_ridge_kernel
  .amdhsa_next_free_vgpr 512
  .amdhsa_next_free_sgpr 102
  .amdhsa_accum_offset 256
  .amdhsa_group_segment_fixed_size 0
  .amdhsa_kernarg_size 104
  .amdhsa_user_sgpr_count 2
  .amdhsa_user_sgpr_kernarg_segment_ptr 1
  .amdhsa_system_sgpr_workgroup_id_x 1
  .amdhsa_float_denorm_mode_32 3
.end_amdhsa_kernel
```
